```python
import torch

def _softmax(x, axis=-1):
    return torch.softmax(x, dim=axis)
def _gelu(x):
    return torch.nn.functional.gelu(x, approximate="tanh")
def _silu(x):
    return torch.nn.functional.silu(x)
def _sigmoid(x):
    return torch.sigmoid(x)
def _layernorm(x, axis=-1, eps=1e-5):
    m = x.mean(dim=axis, keepdim=True)
    v = x.var(dim=axis, keepdim=True, unbiased=False)
    return (x - m) / torch.sqrt(v + eps)
def _scatter_add(tgt, idx, src, axis=0):
    return tgt.clone().index_add_(axis, idx, src)
def _segment_sum(src, seg, n):
    out = torch.zeros((n,) + src.shape[1:], dtype=src.dtype)
    return out.index_add_(0, seg, src)
def _pad(x, pw):
    flat = tuple(v for pair in reversed(pw) for v in pair)
    return torch.nn.functional.pad(x, flat)

kernel_name = 'recurrent_scan__mha_block__geglu_ffn__prompt'

def setup_inputs():

    _w = (lambda a: (lambda t: t.to(torch.bfloat16) if t.is_floating_point() else t)(torch.as_tensor(a)))
    def _A_setup():
        B, S, D, H = 1, 2048, 576, 32
        return {
            "x": _w((lambda *s: torch.randn(*s, dtype=torch.bfloat16) * 0.05)(B, S, D)),
            "wqkv": _w((lambda *s: torch.randn(*s, dtype=torch.bfloat16) * 0.05)(D, 3 * D)),
            "wo": _w((lambda *s: torch.randn(*s, dtype=torch.bfloat16) * 0.05)(D, D)),
        }
    _A_in = _A_setup()

    def _B_setup():
        B, S, D, F = 1, 2048, 576, 4608
        return {
            "x": _w((lambda *s: torch.randn(*s, dtype=torch.bfloat16) * 0.05)(B, S, D)),
            "w_gate": _w((lambda *s: torch.randn(*s, dtype=torch.bfloat16) * 0.05)(D, F)),
            "w_up": _w((lambda *s: torch.randn(*s, dtype=torch.bfloat16) * 0.05)(D, F)),
            "w_down": _w((lambda *s: torch.randn(*s, dtype=torch.bfloat16) * 0.05)(F, D)),
        }
    _B_in = _B_setup()

    return {
        "A_x": _A_in["x"],
        "A_wqkv": _A_in["wqkv"],
        "A_wo": _A_in["wo"],
        "B_x": _B_in["x"],
        "B_w_gate": _B_in["w_gate"],
        "B_w_up": _B_in["w_up"],
        "B_w_down": _B_in["w_down"],
    }

def reference(A_x, A_wqkv, A_wo, B_x, B_w_gate, B_w_up, B_w_down):
    def _A_ref(x, wqkv, wo):
        B, S, D = x.shape
        H = 32
        Dh = D // H
        qkv = (lambda x, *d: x.permute(*d))((x @ wqkv).reshape(B, S, 3, H, Dh), 2, 0, 3, 1, 4)
        q, k, v = qkv[0], qkv[1], qkv[2]
        scores = torch.einsum("bhqd,bhkd->bhqk", q, k) * (Dh ** -0.5)
        p = _softmax(scores, axis=-1)
        o = torch.einsum("bhqk,bhkd->bhqd", p, v)
        return (lambda x, *d: x.permute(*d))(o, 0, 2, 1, 3).reshape(B, S, D) @ wo

    def _B_ref(x, w_gate, w_up, w_down):
        return (_gelu(x @ w_gate) * (x @ w_up)) @ w_down

    x = A_x
    xn = _layernorm(x, axis=-1)
    s = _A_ref(xn, A_wqkv, A_wo)
    g = _silu(_B_ref(xn, B_w_gate, B_w_up, B_w_down))
    return x + s * g
```

```asm
; @launch grid=(256,1,1) block=(256,1,1) lds=163840
.amdgcn_target "amdgcn-amd-amdhsa--gfx950"
.text
.globl recurrent_scan__mha_block__geglu_ffn__prompt_kernel
.p2align 8
.type recurrent_scan__mha_block__geglu_ffn__prompt_kernel,@function
recurrent_scan__mha_block__geglu_ffn__prompt_kernel:
  s_getpc_b64 s[32:33]
  s_cmp_ge_u32 s2, 256
  s_cbranch_scc1 .Lk2_end
  s_lshr_b32 s3, s2, 3
  s_lshl_b32 s3, s3, 15
  s_cmp_ge_u32 s3, .Lk2_end-recurrent_scan__mha_block__geglu_ffn__prompt_kernel
  s_cbranch_scc1 .Lk2_nopf
  v_lshlrev_b32 v1, 7, v0
  v_add_u32 v1, s3, v1
  v_min_u32 v1, .Lk2_end-recurrent_scan__mha_block__geglu_ffn__prompt_kernel-8, v1
  v_mov_b32 v3, s33
  v_add_co_u32 v2, vcc, s32, v1
  v_addc_co_u32 v3, vcc, 0, v3, vcc
  global_load_dword a255, v[2:3], off
.Lk2_nopf:
  s_and_b32 s3, s2, 8
  s_cmp_lg_u32 s3, 0
  s_cbranch_scc1 .Lk2_att
  s_lshr_b32 s65, s2, 4
  s_and_b32 s38, s2, 7
  s_and_b32 s39, s65, 1
  s_lshr_b32 s65, s65, 1
  s_and_b32 s36, s38, 1
  s_lshl_b32 s36, s36, 3
  s_add_u32 s65, s65, s36
  s_lshl_b32 s65, s65, 3
  s_andn2_b32 s38, s38, 1
  s_add_u32 s65, s65, s38
  s_add_u32 s65, s65, s39
  s_load_dwordx4 s[4:7], s[0:1], 32
  s_load_dwordx2 s[8:9], s[0:1], 48

  s_load_dwordx2 s[10:11], s[0:1], 0
  s_load_dwordx4 s[12:15], s[0:1], 64
  v_lshrrev_b32 v1, 6, v0
  v_and_b32 v0, 63, v0
  v_readfirstlane_b32 s28, v1
  s_and_b32 s36, s65, 7
  s_lshr_b32 s37, s65, 3
  s_lshl_b32 s38, s37, 2
  s_add_u32 s51, s38, s28
  s_waitcnt lgkmcnt(0)

  s_mov_b32 s56, s10
  s_mov_b32 s57, s11
  s_mov_b32 s58, 2359296
  s_mov_b32 s59, 0x20000
  s_mov_b32 s52, s14
  s_mov_b32 s53, s15
  s_mov_b32 s54, 268435456
  s_mov_b32 s55, 0x20000
  s_mov_b32 s96, s12
  s_mov_b32 s97, s13
  s_mov_b32 s98, 256
  s_mov_b32 s99, 0x20000
  s_load_dwordx2 s[34:35], s[0:1], 16
  s_load_dwordx2 s[64:65], s[0:1], 56
  v_lshrrev_b32 v1, 3, v0
  s_movk_i32 s62, 1152
  v_mul_lo_u32 v7, v1, s62
  v_lshrrev_b32 v1, 4, v0
  v_and_b32 v9, 7, v0
  v_xor_b32 v1, v1, v9
  v_lshlrev_b32 v1, 4, v1
  v_add_u32 v7, v7, v1
  v_xor_b32 v9, 64, v7
  s_mul_i32 s62, s51, 36864
  s_mul_i32 s60, s28, 36864
  s_lshl_b32 s61, s28, 13

  s_add_u32 m0, s60, 32768
  s_add_u32 s63, s62, 1024
  buffer_load_dwordx4 v7, s[56:59], s63 offen offset:0 lds
  s_mov_b32 s16, s4
  s_mov_b32 s17, s5
  s_mov_b32 s18, 5308416
  s_mov_b32 s19, 0x20000
  s_mov_b32 s20, s6
  s_mov_b32 s21, s7
  s_add_u32 s63, s62, 9216
  buffer_load_dwordx4 v9, s[56:59], s63 offen offset:1024 lds
  s_mov_b32 s22, 5308416
  s_mov_b32 s23, 0x20000
  s_mov_b32 s24, s8
  s_mov_b32 s25, s9
  s_mov_b32 s26, 5308416
  s_mov_b32 s27, 0x20000
  s_mul_i32 s38, s36, 1152
  s_add_u32 s63, s62, 17408
  buffer_load_dwordx4 v7, s[56:59], s63 offen offset:2048 lds
  s_add_u32 s16, s16, s38
  s_addc_u32 s17, s17, 0
  s_sub_u32 s18, s18, s38
  s_add_u32 s20, s20, s38
  s_addc_u32 s21, s21, 0
  s_sub_u32 s22, s22, s38
  v_lshrrev_b32 v1, 2, v0
  v_and_b32 v10, 3, v0
  v_lshlrev_b32 v10, 4, v10
  s_add_u32 s63, s62, 25600
  buffer_load_dwordx4 v9, s[56:59], s63 offen offset:3072 lds
  s_movk_i32 s38, 9216
  v_mul_lo_u32 v2, v1, s38
  v_add_u32 v2, v2, v10
  s_movk_i32 s38, 1152
  v_mul_lo_u32 v3, v1, s38
  v_add_u32 v3, v3, v10
  s_add_u32 m0, s61, 0
  s_add_u32 s63, s62, 0
  buffer_load_dwordx4 v7, s[56:59], s63 offen offset:0 lds
  v_bfe_u32 v1, v0, 2, 2
  v_lshlrev_b32 v1, 6, v1
  v_bfe_u32 v10, v0, 4, 1
  v_lshlrev_b32 v10, 5, v10
  v_add_u32 v1, v1, v10
  v_and_b32 v10, 3, v0
  v_lshlrev_b32 v10, 3, v10
  s_add_u32 s63, s62, 8192
  buffer_load_dwordx4 v9, s[56:59], s63 offen offset:1024 lds
  v_add_u32 v1, v1, v10
  v_lshrrev_b32 v10, 5, v0
  v_lshlrev_b32 v11, 9, v10
  v_add_u32 v4, v1, v11
  v_lshlrev_b32 v11, 8, v10
  v_add_u32 v5, v1, v11
  v_mov_b32 v8, 0xbdd2d3e8
  s_add_u32 s63, s62, 16384
  buffer_load_dwordx4 v7, s[56:59], s63 offen offset:2048 lds
  s_mov_b32 s100, 0xbdd2d3e8
  s_mov_b32 s101, 0xc0135761
  s_mul_i32 s30, s28, 9216
  s_mul_i32 s38, s28, 1327104
  v_add_u32 v2, s38, v2
  s_mul_i32 s38, s28, 165888
  s_add_u32 s63, s62, 24576
  buffer_load_dwordx4 v9, s[56:59], s63 offen offset:3072 lds
  v_add_u32 v3, s38, v3
  s_and_b32 s38, s28, 1
  s_lshl_b32 s38, s38, 31
  s_and_b32 s38, s38, 32
  v_xor_b32 v3, s38, v3
  s_mul_i32 s38, s36, 663552
  s_add_u32 s24, s24, s38
  s_addc_u32 s25, s25, 0
  s_add_u32 m0, s61, 4096
  s_add_u32 s63, s62, 128
  buffer_load_dwordx4 v7, s[56:59], s63 offen offset:0 lds
  s_sub_u32 s26, s26, s38
  s_mov_b32 s29, 0
  s_mul_i32 s49, s36, 2359296
  s_mul_i32 s38, s51, 36864
  s_add_u32 s49, s49, s38
  s_add_u32 s49, s49, 12582912
  s_mov_b32 s67, 146432
  s_add_u32 s63, s62, 8320
  buffer_load_dwordx4 v9, s[56:59], s63 offen offset:1024 lds
  s_mov_b32 s41, 17408
  s_mov_b32 s68, 292864
  s_mov_b32 s42, 34816
  s_mov_b32 s69, 439296
  s_mov_b32 s43, 52224
  s_mov_b32 s70, 589824
  s_add_u32 s63, s62, 16512
  buffer_load_dwordx4 v7, s[56:59], s63 offen offset:2048 lds
  s_mov_b32 s44, 73728
  s_mov_b32 s71, 736256
  s_mov_b32 s45, 91136
  s_mov_b32 s72, 882688
  s_mov_b32 s46, 108544
  s_mov_b32 s73, 1029120
  s_mov_b32 s47, 125952
  s_add_u32 s63, s62, 24704
  buffer_load_dwordx4 v9, s[56:59], s63 offen offset:3072 lds
  s_mov_b32 s74, 1179648
  s_mov_b32 s48, 147456
  v_and_b32 v1, 31, v0
  v_lshrrev_b32 v10, 3, v1
  v_lshlrev_b32 v10, 10, v10
  v_and_b32 v11, 7, v1
  v_lshlrev_b32 v11, 7, v11
  s_add_u32 m0, s61, 36864
  s_add_u32 s63, s62, 256
  buffer_load_dwordx4 v7, s[56:59], s63 offen offset:0 lds
  v_add_u32 v10, v10, v11
  v_bfe_u32 v11, v1, 1, 3
  v_lshrrev_b32 v1, 5, v0
  v_xor_b32 v11, v11, v1
  v_lshlrev_b32 v11, 4, v11
  v_add_u32 v10, v10, v11
  s_add_u32 s63, s62, 8448
  buffer_load_dwordx4 v9, s[56:59], s63 offen offset:1024 lds
  v_add_u32 v16, s61, v10
  v_add_u32 v24, s60, v10
  v_add_u32 v20, 73728, v16
  v_xor_b32 v17, 32, v16
  v_xor_b32 v21, 32, v20
  v_xor_b32 v25, 32, v24
  v_xor_b32 v18, 64, v16
  s_add_u32 s63, s62, 16640
  buffer_load_dwordx4 v7, s[56:59], s63 offen offset:2048 lds
  v_xor_b32 v22, 64, v20
  v_xor_b32 v26, 64, v24
  v_xor_b32 v19, 96, v16
  v_xor_b32 v23, 96, v20
  v_xor_b32 v27, 96, v24
  v_mov_b32 v40, 0
  v_mov_b32 v41, 0
  s_add_u32 s63, s62, 24832
  buffer_load_dwordx4 v9, s[56:59], s63 offen offset:3072 lds
  v_mov_b32 v42, 0
  v_mov_b32 v43, 0
  v_mov_b32 v44, 0
  v_mov_b32 v45, 0
  v_mov_b32 v46, 0
  v_mov_b32 v47, 0
  v_mov_b32 v11, 0x3f803f80
  s_waitcnt vmcnt(12)
  ds_read_b128 v[240:243], v24 offset:32768
  ds_read_b128 v[244:247], v25 offset:32768
  ds_read_b128 v[248:251], v26 offset:32768
  ds_read_b128 v[252:255], v27 offset:32768
  s_add_u32 m0, s61, 40960
  s_add_u32 s63, s62, 384
  buffer_load_dwordx4 v7, s[56:59], s63 offen offset:0 lds
  s_add_u32 s63, s62, 8576
  buffer_load_dwordx4 v9, s[56:59], s63 offen offset:1024 lds
  s_add_u32 s63, s62, 16768
  buffer_load_dwordx4 v7, s[56:59], s63 offen offset:2048 lds
  s_add_u32 s63, s62, 24960
  buffer_load_dwordx4 v9, s[56:59], s63 offen offset:3072 lds
  s_waitcnt lgkmcnt(0)
  s_waitcnt vmcnt(12)
  ds_read_b128 v[112:115], v16 offset:0
  ds_read_b128 v[116:119], v17 offset:0
  ds_read_b128 v[120:123], v18 offset:0
  ds_read_b128 v[124:127], v19 offset:0
  s_add_u32 m0, s61, 73728
  s_add_u32 s63, s62, 512
  buffer_load_dwordx4 v7, s[56:59], s63 offen offset:0 lds
  v_dot2c_f32_bf16 v40, v240, v11
  v_dot2c_f32_bf16 v41, v241, v11
  v_dot2c_f32_bf16 v42, v242, v11
  v_dot2c_f32_bf16 v43, v243, v11
  v_dot2c_f32_bf16 v44, v240, v240
  v_dot2c_f32_bf16 v45, v241, v241
  v_dot2c_f32_bf16 v46, v242, v242
  v_dot2c_f32_bf16 v47, v243, v243
  s_add_u32 s63, s62, 8704
  buffer_load_dwordx4 v9, s[56:59], s63 offen offset:1024 lds
  v_dot2c_f32_bf16 v40, v244, v11
  v_dot2c_f32_bf16 v41, v245, v11
  v_dot2c_f32_bf16 v42, v246, v11
  v_dot2c_f32_bf16 v43, v247, v11
  v_dot2c_f32_bf16 v44, v244, v244
  v_dot2c_f32_bf16 v45, v245, v245
  v_dot2c_f32_bf16 v46, v246, v246
  v_dot2c_f32_bf16 v47, v247, v247
  s_add_u32 s63, s62, 16896
  buffer_load_dwordx4 v7, s[56:59], s63 offen offset:2048 lds
  v_dot2c_f32_bf16 v40, v248, v11
  v_dot2c_f32_bf16 v41, v249, v11
  v_dot2c_f32_bf16 v42, v250, v11
  v_dot2c_f32_bf16 v43, v251, v11
  v_dot2c_f32_bf16 v44, v248, v248
  v_dot2c_f32_bf16 v45, v249, v249
  v_dot2c_f32_bf16 v46, v250, v250
  v_dot2c_f32_bf16 v47, v251, v251
  s_add_u32 s63, s62, 25088
  buffer_load_dwordx4 v9, s[56:59], s63 offen offset:3072 lds
  v_dot2c_f32_bf16 v40, v252, v11
  v_dot2c_f32_bf16 v41, v253, v11
  v_dot2c_f32_bf16 v42, v254, v11
  v_dot2c_f32_bf16 v43, v255, v11
  v_dot2c_f32_bf16 v44, v252, v252
  v_dot2c_f32_bf16 v45, v253, v253
  v_dot2c_f32_bf16 v46, v254, v254
  v_dot2c_f32_bf16 v47, v255, v255
  s_waitcnt lgkmcnt(0)
  s_waitcnt vmcnt(12)
  ds_read_b128 v[128:131], v16 offset:4096
  ds_read_b128 v[132:135], v17 offset:4096
  ds_read_b128 v[136:139], v18 offset:4096
  ds_read_b128 v[140:143], v19 offset:4096
  s_add_u32 m0, s61, 77824
  s_add_u32 s63, s62, 640
  buffer_load_dwordx4 v7, s[56:59], s63 offen offset:0 lds
  v_dot2c_f32_bf16 v40, v112, v11
  v_dot2c_f32_bf16 v41, v113, v11
  v_dot2c_f32_bf16 v42, v114, v11
  v_dot2c_f32_bf16 v43, v115, v11
  v_dot2c_f32_bf16 v44, v112, v112
  v_dot2c_f32_bf16 v45, v113, v113
  v_dot2c_f32_bf16 v46, v114, v114
  v_dot2c_f32_bf16 v47, v115, v115
  s_add_u32 s63, s62, 8832
  buffer_load_dwordx4 v9, s[56:59], s63 offen offset:1024 lds
  v_dot2c_f32_bf16 v40, v116, v11
  v_dot2c_f32_bf16 v41, v117, v11
  v_dot2c_f32_bf16 v42, v118, v11
  v_dot2c_f32_bf16 v43, v119, v11
  v_dot2c_f32_bf16 v44, v116, v116
  v_dot2c_f32_bf16 v45, v117, v117
  v_dot2c_f32_bf16 v46, v118, v118
  v_dot2c_f32_bf16 v47, v119, v119
  s_add_u32 s63, s62, 17024
  buffer_load_dwordx4 v7, s[56:59], s63 offen offset:2048 lds
  v_dot2c_f32_bf16 v40, v120, v11
  v_dot2c_f32_bf16 v41, v121, v11
  v_dot2c_f32_bf16 v42, v122, v11
  v_dot2c_f32_bf16 v43, v123, v11
  v_dot2c_f32_bf16 v44, v120, v120
  v_dot2c_f32_bf16 v45, v121, v121
  v_dot2c_f32_bf16 v46, v122, v122
  v_dot2c_f32_bf16 v47, v123, v123
  s_add_u32 s63, s62, 25216
  buffer_load_dwordx4 v9, s[56:59], s63 offen offset:3072 lds
  v_dot2c_f32_bf16 v40, v124, v11
  v_dot2c_f32_bf16 v41, v125, v11
  v_dot2c_f32_bf16 v42, v126, v11
  v_dot2c_f32_bf16 v43, v127, v11
  v_dot2c_f32_bf16 v44, v124, v124
  v_dot2c_f32_bf16 v45, v125, v125
  v_dot2c_f32_bf16 v46, v126, v126
  v_dot2c_f32_bf16 v47, v127, v127
  s_waitcnt lgkmcnt(0)
  s_waitcnt vmcnt(12)
  ds_read_b128 v[144:147], v16 offset:36864
  ds_read_b128 v[148:151], v17 offset:36864
  ds_read_b128 v[152:155], v18 offset:36864
  ds_read_b128 v[156:159], v19 offset:36864
  s_add_u32 m0, s61, 110592
  s_add_u32 s63, s62, 768
  buffer_load_dwordx4 v7, s[56:59], s63 offen offset:0 lds
  v_dot2c_f32_bf16 v40, v128, v11
  v_dot2c_f32_bf16 v41, v129, v11
  v_dot2c_f32_bf16 v42, v130, v11
  v_dot2c_f32_bf16 v43, v131, v11
  v_dot2c_f32_bf16 v44, v128, v128
  v_dot2c_f32_bf16 v45, v129, v129
  v_dot2c_f32_bf16 v46, v130, v130
  v_dot2c_f32_bf16 v47, v131, v131
  s_add_u32 s63, s62, 8960
  buffer_load_dwordx4 v9, s[56:59], s63 offen offset:1024 lds
  v_dot2c_f32_bf16 v40, v132, v11
  v_dot2c_f32_bf16 v41, v133, v11
  v_dot2c_f32_bf16 v42, v134, v11
  v_dot2c_f32_bf16 v43, v135, v11
  v_dot2c_f32_bf16 v44, v132, v132
  v_dot2c_f32_bf16 v45, v133, v133
  v_dot2c_f32_bf16 v46, v134, v134
  v_dot2c_f32_bf16 v47, v135, v135
  s_add_u32 s63, s62, 17152
  buffer_load_dwordx4 v7, s[56:59], s63 offen offset:2048 lds
  v_dot2c_f32_bf16 v40, v136, v11
  v_dot2c_f32_bf16 v41, v137, v11
  v_dot2c_f32_bf16 v42, v138, v11
  v_dot2c_f32_bf16 v43, v139, v11
  v_dot2c_f32_bf16 v44, v136, v136
  v_dot2c_f32_bf16 v45, v137, v137
  v_dot2c_f32_bf16 v46, v138, v138
  v_dot2c_f32_bf16 v47, v139, v139
  s_add_u32 s63, s62, 25344
  buffer_load_dwordx4 v9, s[56:59], s63 offen offset:3072 lds
  v_dot2c_f32_bf16 v40, v140, v11
  v_dot2c_f32_bf16 v41, v141, v11
  v_dot2c_f32_bf16 v42, v142, v11
  v_dot2c_f32_bf16 v43, v143, v11
  v_dot2c_f32_bf16 v44, v140, v140
  v_dot2c_f32_bf16 v45, v141, v141
  v_dot2c_f32_bf16 v46, v142, v142
  v_dot2c_f32_bf16 v47, v143, v143
  s_waitcnt lgkmcnt(0)
  s_waitcnt vmcnt(12)
  ds_read_b128 v[160:163], v16 offset:40960
  ds_read_b128 v[164:167], v17 offset:40960
  ds_read_b128 v[168:171], v18 offset:40960
  ds_read_b128 v[172:175], v19 offset:40960
  s_add_u32 m0, s61, 114688
  s_add_u32 s63, s62, 896
  buffer_load_dwordx4 v7, s[56:59], s63 offen offset:0 lds
  v_dot2c_f32_bf16 v40, v144, v11
  v_dot2c_f32_bf16 v41, v145, v11
  v_dot2c_f32_bf16 v42, v146, v11
  v_dot2c_f32_bf16 v43, v147, v11
  v_dot2c_f32_bf16 v44, v144, v144
  v_dot2c_f32_bf16 v45, v145, v145
  v_dot2c_f32_bf16 v46, v146, v146
  v_dot2c_f32_bf16 v47, v147, v147
  s_add_u32 s63, s62, 9088
  buffer_load_dwordx4 v9, s[56:59], s63 offen offset:1024 lds
  v_dot2c_f32_bf16 v40, v148, v11
  v_dot2c_f32_bf16 v41, v149, v11
  v_dot2c_f32_bf16 v42, v150, v11
  v_dot2c_f32_bf16 v43, v151, v11
  v_dot2c_f32_bf16 v44, v148, v148
  v_dot2c_f32_bf16 v45, v149, v149
  v_dot2c_f32_bf16 v46, v150, v150
  v_dot2c_f32_bf16 v47, v151, v151
  s_add_u32 s63, s62, 17280
  buffer_load_dwordx4 v7, s[56:59], s63 offen offset:2048 lds
  v_dot2c_f32_bf16 v40, v152, v11
  v_dot2c_f32_bf16 v41, v153, v11
  v_dot2c_f32_bf16 v42, v154, v11
  v_dot2c_f32_bf16 v43, v155, v11
  v_dot2c_f32_bf16 v44, v152, v152
  v_dot2c_f32_bf16 v45, v153, v153
  v_dot2c_f32_bf16 v46, v154, v154
  v_dot2c_f32_bf16 v47, v155, v155
  s_add_u32 s63, s62, 25472
  buffer_load_dwordx4 v9, s[56:59], s63 offen offset:3072 lds
  v_dot2c_f32_bf16 v40, v156, v11
  v_dot2c_f32_bf16 v41, v157, v11
  v_dot2c_f32_bf16 v42, v158, v11
  v_dot2c_f32_bf16 v43, v159, v11
  v_dot2c_f32_bf16 v44, v156, v156
  v_dot2c_f32_bf16 v45, v157, v157
  v_dot2c_f32_bf16 v46, v158, v158
  v_dot2c_f32_bf16 v47, v159, v159
  s_mul_i32 s38, s51, 9
  v_add_u32 v9, s38, v0
  s_movk_i32 s38, 9216
  v_mul_lo_u32 v7, v9, s38
  v_mul_u32_u24 v9, 1152, v9
  v_cmp_gt_u32 vcc, 9, v0
  v_mov_b32 v1, 2146435072
  s_nop 0
  v_cndmask_b32 v7, v1, v7, vcc
  v_cndmask_b32 v9, v1, v9, vcc
  v_lshlrev_b32 v1, 4, v0
  v_lshlrev_b32 v96, 7, v0
  v_add_u32 v96, 8192, v96
  v_mov_b32 v97, s33
  v_add_co_u32 v96, vcc, s32, v96
  v_addc_co_u32 v97, vcc, 0, v97, vcc
  buffer_load_dword a253, v7, s[16:19], 0 offen offset:0
  buffer_load_dword a253, v7, s[20:23], 0 offen offset:0
  s_waitcnt lgkmcnt(0)
  s_barrier
  s_waitcnt vmcnt(14)
  ds_read_b128 v[176:179], v20 offset:0
  ds_read_b128 v[180:183], v21 offset:0
  ds_read_b128 v[184:187], v22 offset:0
  ds_read_b128 v[188:191], v23 offset:0
  s_add_u32 m0, s30, 0
  v_dot2c_f32_bf16 v40, v160, v11
  v_dot2c_f32_bf16 v41, v161, v11
  v_dot2c_f32_bf16 v42, v162, v11
  buffer_load_dwordx4 v2, s[16:19], 0 offen offset:0 lds
  v_dot2c_f32_bf16 v43, v163, v11
  v_dot2c_f32_bf16 v44, v160, v160
  v_dot2c_f32_bf16 v45, v161, v161
  v_dot2c_f32_bf16 v46, v162, v162
  buffer_load_dwordx4 v2, s[16:19], s67 offen offset:1024 lds
  v_dot2c_f32_bf16 v47, v163, v163
  v_dot2c_f32_bf16 v40, v164, v11
  v_dot2c_f32_bf16 v41, v165, v11
  buffer_load_dwordx4 v2, s[16:19], s68 offen offset:2048 lds
  v_dot2c_f32_bf16 v42, v166, v11
  v_dot2c_f32_bf16 v43, v167, v11
  v_dot2c_f32_bf16 v44, v164, v164
  v_dot2c_f32_bf16 v45, v165, v165
  buffer_load_dwordx4 v2, s[16:19], s69 offen offset:3072 lds
  s_add_u32 m0, s30, 4096
  v_dot2c_f32_bf16 v46, v166, v166
  v_dot2c_f32_bf16 v47, v167, v167
  v_dot2c_f32_bf16 v40, v168, v11
  buffer_load_dwordx4 v2, s[16:19], s70 offen offset:0 lds
  v_dot2c_f32_bf16 v41, v169, v11
  v_dot2c_f32_bf16 v42, v170, v11
  v_dot2c_f32_bf16 v43, v171, v11
  v_dot2c_f32_bf16 v44, v168, v168
  buffer_load_dwordx4 v2, s[16:19], s71 offen offset:1024 lds
  v_dot2c_f32_bf16 v45, v169, v169
  v_dot2c_f32_bf16 v46, v170, v170
  v_dot2c_f32_bf16 v47, v171, v171
  buffer_load_dwordx4 v2, s[16:19], s72 offen offset:2048 lds
  v_dot2c_f32_bf16 v40, v172, v11
  v_dot2c_f32_bf16 v41, v173, v11
  v_dot2c_f32_bf16 v42, v174, v11
  v_dot2c_f32_bf16 v43, v175, v11
  buffer_load_dwordx4 v2, s[16:19], s73 offen offset:3072 lds
  s_add_u32 m0, s30, 8192
  v_dot2c_f32_bf16 v44, v172, v172
  v_dot2c_f32_bf16 v45, v173, v173
  v_dot2c_f32_bf16 v46, v174, v174
  v_dot2c_f32_bf16 v47, v175, v175
  buffer_load_dwordx4 v2, s[16:19], s74 offen offset:0 lds
  s_waitcnt lgkmcnt(0)
  s_waitcnt vmcnt(19)
  ds_read_b128 v[192:195], v20 offset:4096
  ds_read_b128 v[196:199], v21 offset:4096
  ds_read_b128 v[200:203], v22 offset:4096
  ds_read_b128 v[204:207], v23 offset:4096
  s_add_u32 m0, s30, 36864
  v_dot2c_f32_bf16 v40, v176, v11
  v_dot2c_f32_bf16 v41, v177, v11
  v_dot2c_f32_bf16 v42, v178, v11
  buffer_load_dwordx4 v2, s[20:23], 0 offen offset:0 lds
  v_dot2c_f32_bf16 v43, v179, v11
  v_dot2c_f32_bf16 v44, v176, v176
  v_dot2c_f32_bf16 v45, v177, v177
  v_dot2c_f32_bf16 v46, v178, v178
  buffer_load_dwordx4 v2, s[20:23], s67 offen offset:1024 lds
  v_dot2c_f32_bf16 v47, v179, v179
  v_dot2c_f32_bf16 v40, v180, v11
  v_dot2c_f32_bf16 v41, v181, v11
  buffer_load_dwordx4 v2, s[20:23], s68 offen offset:2048 lds
  v_dot2c_f32_bf16 v42, v182, v11
  v_dot2c_f32_bf16 v43, v183, v11
  v_dot2c_f32_bf16 v44, v180, v180
  v_dot2c_f32_bf16 v45, v181, v181
  buffer_load_dwordx4 v2, s[20:23], s69 offen offset:3072 lds
  s_add_u32 m0, s30, 40960
  v_dot2c_f32_bf16 v46, v182, v182
  v_dot2c_f32_bf16 v47, v183, v183
  v_dot2c_f32_bf16 v40, v184, v11
  buffer_load_dwordx4 v2, s[20:23], s70 offen offset:0 lds
  v_dot2c_f32_bf16 v41, v185, v11
  v_dot2c_f32_bf16 v42, v186, v11
  v_dot2c_f32_bf16 v43, v187, v11
  v_dot2c_f32_bf16 v44, v184, v184
  buffer_load_dwordx4 v2, s[20:23], s71 offen offset:1024 lds
  v_dot2c_f32_bf16 v45, v185, v185
  v_dot2c_f32_bf16 v46, v186, v186
  v_dot2c_f32_bf16 v47, v187, v187
  buffer_load_dwordx4 v2, s[20:23], s72 offen offset:2048 lds
  v_dot2c_f32_bf16 v40, v188, v11
  v_dot2c_f32_bf16 v41, v189, v11
  v_dot2c_f32_bf16 v42, v190, v11
  v_dot2c_f32_bf16 v43, v191, v11
  buffer_load_dwordx4 v2, s[20:23], s73 offen offset:3072 lds
  s_add_u32 m0, s30, 45056
  v_dot2c_f32_bf16 v44, v188, v188
  v_dot2c_f32_bf16 v45, v189, v189
  v_dot2c_f32_bf16 v46, v190, v190
  v_dot2c_f32_bf16 v47, v191, v191
  buffer_load_dwordx4 v2, s[20:23], s74 offen offset:0 lds
  v_add_u32 v2, 64, v2
  s_waitcnt lgkmcnt(0)
  s_waitcnt vmcnt(24)
  ds_read_b128 v[208:211], v20 offset:36864
  ds_read_b128 v[212:215], v21 offset:36864
  ds_read_b128 v[216:219], v22 offset:36864
  ds_read_b128 v[220:223], v23 offset:36864
  v_dot2c_f32_bf16 v40, v192, v11
  v_dot2c_f32_bf16 v41, v193, v11
  v_dot2c_f32_bf16 v42, v194, v11
  v_dot2c_f32_bf16 v43, v195, v11
  v_dot2c_f32_bf16 v44, v192, v192
  v_dot2c_f32_bf16 v45, v193, v193
  v_dot2c_f32_bf16 v46, v194, v194
  v_dot2c_f32_bf16 v47, v195, v195
  v_dot2c_f32_bf16 v40, v196, v11
  v_dot2c_f32_bf16 v41, v197, v11
  v_dot2c_f32_bf16 v42, v198, v11
  v_dot2c_f32_bf16 v43, v199, v11
  v_dot2c_f32_bf16 v44, v196, v196
  v_dot2c_f32_bf16 v45, v197, v197
  v_dot2c_f32_bf16 v46, v198, v198
  v_dot2c_f32_bf16 v47, v199, v199
  v_dot2c_f32_bf16 v40, v200, v11
  v_dot2c_f32_bf16 v41, v201, v11
  v_dot2c_f32_bf16 v42, v202, v11
  v_dot2c_f32_bf16 v43, v203, v11
  v_dot2c_f32_bf16 v44, v200, v200
  v_dot2c_f32_bf16 v45, v201, v201
  v_dot2c_f32_bf16 v46, v202, v202
  v_dot2c_f32_bf16 v47, v203, v203
  v_dot2c_f32_bf16 v40, v204, v11
  v_dot2c_f32_bf16 v41, v205, v11
  v_dot2c_f32_bf16 v42, v206, v11
  v_dot2c_f32_bf16 v43, v207, v11
  v_dot2c_f32_bf16 v44, v204, v204
  v_dot2c_f32_bf16 v45, v205, v205
  v_dot2c_f32_bf16 v46, v206, v206
  v_dot2c_f32_bf16 v47, v207, v207
  s_waitcnt lgkmcnt(0)
  s_waitcnt vmcnt(20)
  ds_read_b128 v[224:227], v20 offset:40960
  ds_read_b128 v[228:231], v21 offset:40960
  ds_read_b128 v[232:235], v22 offset:40960
  ds_read_b128 v[236:239], v23 offset:40960
  v_dot2c_f32_bf16 v40, v208, v11
  v_dot2c_f32_bf16 v41, v209, v11
  v_dot2c_f32_bf16 v42, v210, v11
  v_dot2c_f32_bf16 v43, v211, v11
  v_dot2c_f32_bf16 v44, v208, v208
  v_dot2c_f32_bf16 v45, v209, v209
  v_dot2c_f32_bf16 v46, v210, v210
  v_dot2c_f32_bf16 v47, v211, v211
  v_dot2c_f32_bf16 v40, v212, v11
  v_dot2c_f32_bf16 v41, v213, v11
  v_dot2c_f32_bf16 v42, v214, v11
  v_dot2c_f32_bf16 v43, v215, v11
  v_dot2c_f32_bf16 v44, v212, v212
  v_dot2c_f32_bf16 v45, v213, v213
  v_dot2c_f32_bf16 v46, v214, v214
  v_dot2c_f32_bf16 v47, v215, v215
  v_dot2c_f32_bf16 v40, v216, v11
  v_dot2c_f32_bf16 v41, v217, v11
  v_dot2c_f32_bf16 v42, v218, v11
  v_dot2c_f32_bf16 v43, v219, v11
  v_dot2c_f32_bf16 v44, v216, v216
  v_dot2c_f32_bf16 v45, v217, v217
  v_dot2c_f32_bf16 v46, v218, v218
  v_dot2c_f32_bf16 v47, v219, v219
  v_dot2c_f32_bf16 v40, v220, v11
  v_dot2c_f32_bf16 v41, v221, v11
  v_dot2c_f32_bf16 v42, v222, v11
  v_dot2c_f32_bf16 v43, v223, v11
  v_dot2c_f32_bf16 v44, v220, v220
  v_dot2c_f32_bf16 v45, v221, v221
  v_dot2c_f32_bf16 v46, v222, v222
  v_dot2c_f32_bf16 v47, v223, v223
  s_waitcnt lgkmcnt(0)
  v_dot2c_f32_bf16 v40, v224, v11
  v_dot2c_f32_bf16 v41, v225, v11
  v_dot2c_f32_bf16 v42, v226, v11
  v_dot2c_f32_bf16 v43, v227, v11
  v_dot2c_f32_bf16 v44, v224, v224
  v_dot2c_f32_bf16 v45, v225, v225
  v_dot2c_f32_bf16 v46, v226, v226
  v_dot2c_f32_bf16 v47, v227, v227
  v_dot2c_f32_bf16 v40, v228, v11
  v_dot2c_f32_bf16 v41, v229, v11
  v_dot2c_f32_bf16 v42, v230, v11
  v_dot2c_f32_bf16 v43, v231, v11
  v_dot2c_f32_bf16 v44, v228, v228
  v_dot2c_f32_bf16 v45, v229, v229
  v_dot2c_f32_bf16 v46, v230, v230
  v_dot2c_f32_bf16 v47, v231, v231
  v_dot2c_f32_bf16 v40, v232, v11
  v_dot2c_f32_bf16 v41, v233, v11
  v_dot2c_f32_bf16 v42, v234, v11
  v_dot2c_f32_bf16 v43, v235, v11
  v_dot2c_f32_bf16 v44, v232, v232
  v_dot2c_f32_bf16 v45, v233, v233
  v_dot2c_f32_bf16 v46, v234, v234
  v_dot2c_f32_bf16 v47, v235, v235
  v_dot2c_f32_bf16 v40, v236, v11
  v_dot2c_f32_bf16 v41, v237, v11
  v_dot2c_f32_bf16 v42, v238, v11
  v_dot2c_f32_bf16 v43, v239, v11
  v_dot2c_f32_bf16 v44, v236, v236
  v_dot2c_f32_bf16 v45, v237, v237
  v_dot2c_f32_bf16 v46, v238, v238
  v_dot2c_f32_bf16 v47, v239, v239
  s_nop 2
  v_add_f32 v40, v40, v41
  v_add_f32 v42, v42, v43
  v_add_f32 v44, v44, v45
  v_add_f32 v46, v46, v47
  v_add_f32 v40, v40, v42
  v_add_f32 v44, v44, v46
  v_mov_b32 v41, v40
  v_mov_b32 v45, v44
  s_nop 1
  v_permlane32_swap_b32 v40, v41
  v_permlane32_swap_b32 v44, v45
  s_nop 1
  v_add_f32 v40, v40, v41
  v_add_f32 v44, v44, v45
  v_mul_f32 v40, 0x3ae38e39, v40
  v_mul_f32 v44, 0x3ae38e39, v44
  v_fma_f32 v44, -v40, v40, v44
  v_max_f32 v44, 0, v44
  v_cvt_pk_bf16_f32 v41, v40, v44
  v_lshlrev_b32 v40, 16, v41
  v_and_b32 v44, 0xffff0000, v41
  v_add_f32 v44, 0x3727c5ac, v44
  v_cvt_pk_bf16_f32 v44, v44, v44
  v_and_b32 v44, 0xffff0000, v44
  v_sqrt_f32 v44, v44
  s_nop 0
  v_cvt_pk_bf16_f32 v44, v44, v44
  v_and_b32 v44, 0xffff0000, v44
  v_rcp_f32 v12, v44
  s_nop 0
  v_mul_f32 v14, v40, v12
  v_sub_f32 v14, 0, v14

  v_lshlrev_b32 v40, 16, v112
  v_and_b32 v41, 0xffff0000, v112
  v_lshlrev_b32 v42, 16, v113
  v_and_b32 v43, 0xffff0000, v113
  v_lshlrev_b32 v44, 16, v114
  v_and_b32 v45, 0xffff0000, v114
  v_lshlrev_b32 v46, 16, v115
  v_and_b32 v47, 0xffff0000, v115
  v_pk_fma_f32 v[40:41], v[40:41], v[12:13], v[14:15] op_sel_hi:[1,0,0]
  v_pk_fma_f32 v[42:43], v[42:43], v[12:13], v[14:15] op_sel_hi:[1,0,0]
  v_pk_fma_f32 v[44:45], v[44:45], v[12:13], v[14:15] op_sel_hi:[1,0,0]
  v_pk_fma_f32 v[46:47], v[46:47], v[12:13], v[14:15] op_sel_hi:[1,0,0]
  v_cvt_pk_bf16_f32 v112, v40, v41
  v_cvt_pk_bf16_f32 v113, v42, v43
  v_cvt_pk_bf16_f32 v114, v44, v45
  v_cvt_pk_bf16_f32 v115, v46, v47
  v_lshlrev_b32 v40, 16, v116
  v_and_b32 v41, 0xffff0000, v116
  v_lshlrev_b32 v42, 16, v117
  v_and_b32 v43, 0xffff0000, v117
  v_lshlrev_b32 v44, 16, v118
  v_and_b32 v45, 0xffff0000, v118
  v_lshlrev_b32 v46, 16, v119
  v_and_b32 v47, 0xffff0000, v119
  v_pk_fma_f32 v[40:41], v[40:41], v[12:13], v[14:15] op_sel_hi:[1,0,0]
  v_pk_fma_f32 v[42:43], v[42:43], v[12:13], v[14:15] op_sel_hi:[1,0,0]
  v_pk_fma_f32 v[44:45], v[44:45], v[12:13], v[14:15] op_sel_hi:[1,0,0]
  v_pk_fma_f32 v[46:47], v[46:47], v[12:13], v[14:15] op_sel_hi:[1,0,0]
  v_cvt_pk_bf16_f32 v116, v40, v41
  v_cvt_pk_bf16_f32 v117, v42, v43
  v_cvt_pk_bf16_f32 v118, v44, v45
  v_cvt_pk_bf16_f32 v119, v46, v47
  s_waitcnt vmcnt(9)
  s_barrier
  v_add_u32 v6, 0, v4
  ds_read_b64_tr_b16 v[16:17], v6 offset:0
  ds_read_b64_tr_b16 v[18:19], v6 offset:256
  ds_read_b64_tr_b16 v[20:21], v6 offset:1024
  ds_read_b64_tr_b16 v[22:23], v6 offset:1280
  ds_read_b64_tr_b16 v[24:25], v6 offset:2048
  ds_read_b64_tr_b16 v[26:27], v6 offset:2304
  ds_read_b64_tr_b16 v[28:29], v6 offset:3072
  ds_read_b64_tr_b16 v[30:31], v6 offset:3328
  ds_read_b64_tr_b16 v[32:33], v6 offset:4096
  ds_read_b64_tr_b16 v[34:35], v6 offset:4352
  s_waitcnt lgkmcnt(4)
  v_mfma_f32_32x32x16_bf16 v[48:63], v[16:19], v[112:115], 0
  ds_read_b64_tr_b16 v[36:37], v6 offset:5120
  ds_read_b64_tr_b16 v[38:39], v6 offset:5376
  v_lshlrev_b32 v40, 16, v120
  v_and_b32 v41, 0xffff0000, v120
  v_lshlrev_b32 v42, 16, v121
  v_and_b32 v43, 0xffff0000, v121
  v_lshlrev_b32 v44, 16, v122
  v_and_b32 v45, 0xffff0000, v122
  v_lshlrev_b32 v46, 16, v123
  v_and_b32 v47, 0xffff0000, v123
  v_pk_fma_f32 v[40:41], v[40:41], v[12:13], v[14:15] op_sel_hi:[1,0,0]
  v_pk_fma_f32 v[42:43], v[42:43], v[12:13], v[14:15] op_sel_hi:[1,0,0]
  v_pk_fma_f32 v[44:45], v[44:45], v[12:13], v[14:15] op_sel_hi:[1,0,0]
  v_pk_fma_f32 v[46:47], v[46:47], v[12:13], v[14:15] op_sel_hi:[1,0,0]
  v_cvt_pk_bf16_f32 v120, v40, v41
  v_cvt_pk_bf16_f32 v121, v42, v43
  v_cvt_pk_bf16_f32 v122, v44, v45
  v_cvt_pk_bf16_f32 v123, v46, v47
  v_mfma_f32_32x32x16_bf16 v[48:63], v[20:23], v[116:119], v[48:63]
  ds_read_b64_tr_b16 v[16:17], v6 offset:6144
  ds_read_b64_tr_b16 v[18:19], v6 offset:6400
  v_lshlrev_b32 v40, 16, v124
  v_and_b32 v41, 0xffff0000, v124
  v_lshlrev_b32 v42, 16, v125
  v_and_b32 v43, 0xffff0000, v125
  v_lshlrev_b32 v44, 16, v126
  v_and_b32 v45, 0xffff0000, v126
  v_lshlrev_b32 v46, 16, v127
  v_and_b32 v47, 0xffff0000, v127
  v_pk_fma_f32 v[40:41], v[40:41], v[12:13], v[14:15] op_sel_hi:[1,0,0]
  v_pk_fma_f32 v[42:43], v[42:43], v[12:13], v[14:15] op_sel_hi:[1,0,0]
  v_pk_fma_f32 v[44:45], v[44:45], v[12:13], v[14:15] op_sel_hi:[1,0,0]
  v_pk_fma_f32 v[46:47], v[46:47], v[12:13], v[14:15] op_sel_hi:[1,0,0]
  v_cvt_pk_bf16_f32 v124, v40, v41
  v_cvt_pk_bf16_f32 v125, v42, v43
  v_cvt_pk_bf16_f32 v126, v44, v45
  v_cvt_pk_bf16_f32 v127, v46, v47
  s_add_u32 m0, s30, 73728
  v_mfma_f32_32x32x16_bf16 v[48:63], v[24:27], v[120:123], v[48:63]
  ds_read_b64_tr_b16 v[20:21], v6 offset:7168
  ds_read_b64_tr_b16 v[22:23], v6 offset:7424
  buffer_load_dwordx4 v2, s[16:19], 0 offen offset:0 lds
  v_lshlrev_b32 v40, 16, v128
  v_and_b32 v41, 0xffff0000, v128
  v_lshlrev_b32 v42, 16, v129
  v_and_b32 v43, 0xffff0000, v129
  v_lshlrev_b32 v44, 16, v130
  v_and_b32 v45, 0xffff0000, v130
  v_lshlrev_b32 v46, 16, v131
  v_and_b32 v47, 0xffff0000, v131
  v_pk_fma_f32 v[40:41], v[40:41], v[12:13], v[14:15] op_sel_hi:[1,0,0]
  v_pk_fma_f32 v[42:43], v[42:43], v[12:13], v[14:15] op_sel_hi:[1,0,0]
  v_pk_fma_f32 v[44:45], v[44:45], v[12:13], v[14:15] op_sel_hi:[1,0,0]
  v_pk_fma_f32 v[46:47], v[46:47], v[12:13], v[14:15] op_sel_hi:[1,0,0]
  v_cvt_pk_bf16_f32 v128, v40, v41
  v_cvt_pk_bf16_f32 v129, v42, v43
  v_cvt_pk_bf16_f32 v130, v44, v45
  v_cvt_pk_bf16_f32 v131, v46, v47
  s_waitcnt lgkmcnt(4)
  v_mfma_f32_32x32x16_bf16 v[48:63], v[28:31], v[124:127], v[48:63]
  ds_read_b64_tr_b16 v[24:25], v6 offset:8192
  ds_read_b64_tr_b16 v[26:27], v6 offset:8448
  v_lshlrev_b32 v40, 16, v132
  v_and_b32 v41, 0xffff0000, v132
  v_lshlrev_b32 v42, 16, v133
  v_and_b32 v43, 0xffff0000, v133
  v_lshlrev_b32 v44, 16, v134
  v_and_b32 v45, 0xffff0000, v134
  v_lshlrev_b32 v46, 16, v135
  v_and_b32 v47, 0xffff0000, v135
  v_pk_fma_f32 v[40:41], v[40:41], v[12:13], v[14:15] op_sel_hi:[1,0,0]
  v_pk_fma_f32 v[42:43], v[42:43], v[12:13], v[14:15] op_sel_hi:[1,0,0]
  v_pk_fma_f32 v[44:45], v[44:45], v[12:13], v[14:15] op_sel_hi:[1,0,0]
  v_pk_fma_f32 v[46:47], v[46:47], v[12:13], v[14:15] op_sel_hi:[1,0,0]
  v_cvt_pk_bf16_f32 v132, v40, v41
  v_cvt_pk_bf16_f32 v133, v42, v43
  v_cvt_pk_bf16_f32 v134, v44, v45
  v_cvt_pk_bf16_f32 v135, v46, v47
  v_mfma_f32_32x32x16_bf16 v[48:63], v[32:35], v[128:131], v[48:63]
  ds_read_b64_tr_b16 v[28:29], v6 offset:9216
  ds_read_b64_tr_b16 v[30:31], v6 offset:9472
  v_lshlrev_b32 v40, 16, v136
  v_and_b32 v41, 0xffff0000, v136
  v_lshlrev_b32 v42, 16, v137
  v_and_b32 v43, 0xffff0000, v137
  v_lshlrev_b32 v44, 16, v138
  v_and_b32 v45, 0xffff0000, v138
  v_lshlrev_b32 v46, 16, v139
  v_and_b32 v47, 0xffff0000, v139
  v_pk_fma_f32 v[40:41], v[40:41], v[12:13], v[14:15] op_sel_hi:[1,0,0]
  v_pk_fma_f32 v[42:43], v[42:43], v[12:13], v[14:15] op_sel_hi:[1,0,0]
  v_pk_fma_f32 v[44:45], v[44:45], v[12:13], v[14:15] op_sel_hi:[1,0,0]
  v_pk_fma_f32 v[46:47], v[46:47], v[12:13], v[14:15] op_sel_hi:[1,0,0]
  v_cvt_pk_bf16_f32 v136, v40, v41
  v_cvt_pk_bf16_f32 v137, v42, v43
  v_cvt_pk_bf16_f32 v138, v44, v45
  v_cvt_pk_bf16_f32 v139, v46, v47
  v_mfma_f32_32x32x16_bf16 v[48:63], v[36:39], v[132:135], v[48:63]
  ds_read_b64_tr_b16 v[32:33], v6 offset:10240
  ds_read_b64_tr_b16 v[34:35], v6 offset:10496
  buffer_load_dwordx4 v2, s[16:19], s67 offen offset:1024 lds
  v_lshlrev_b32 v40, 16, v140
  v_and_b32 v41, 0xffff0000, v140
  v_lshlrev_b32 v42, 16, v141
  v_and_b32 v43, 0xffff0000, v141
  v_lshlrev_b32 v44, 16, v142
  v_and_b32 v45, 0xffff0000, v142
  v_lshlrev_b32 v46, 16, v143
  v_and_b32 v47, 0xffff0000, v143
  v_pk_fma_f32 v[40:41], v[40:41], v[12:13], v[14:15] op_sel_hi:[1,0,0]
  v_pk_fma_f32 v[42:43], v[42:43], v[12:13], v[14:15] op_sel_hi:[1,0,0]
  v_pk_fma_f32 v[44:45], v[44:45], v[12:13], v[14:15] op_sel_hi:[1,0,0]
  v_pk_fma_f32 v[46:47], v[46:47], v[12:13], v[14:15] op_sel_hi:[1,0,0]
  v_cvt_pk_bf16_f32 v140, v40, v41
  v_cvt_pk_bf16_f32 v141, v42, v43
  v_cvt_pk_bf16_f32 v142, v44, v45
  v_cvt_pk_bf16_f32 v143, v46, v47
  s_waitcnt lgkmcnt(4)
  v_mfma_f32_32x32x16_bf16 v[48:63], v[16:19], v[136:139], v[48:63]
  ds_read_b64_tr_b16 v[36:37], v6 offset:11264
  ds_read_b64_tr_b16 v[38:39], v6 offset:11520
  v_lshlrev_b32 v40, 16, v144
  v_and_b32 v41, 0xffff0000, v144
  v_lshlrev_b32 v42, 16, v145
  v_and_b32 v43, 0xffff0000, v145
  v_lshlrev_b32 v44, 16, v146
  v_and_b32 v45, 0xffff0000, v146
  v_lshlrev_b32 v46, 16, v147
  v_and_b32 v47, 0xffff0000, v147
  v_pk_fma_f32 v[40:41], v[40:41], v[12:13], v[14:15] op_sel_hi:[1,0,0]
  v_pk_fma_f32 v[42:43], v[42:43], v[12:13], v[14:15] op_sel_hi:[1,0,0]
  v_pk_fma_f32 v[44:45], v[44:45], v[12:13], v[14:15] op_sel_hi:[1,0,0]
  v_pk_fma_f32 v[46:47], v[46:47], v[12:13], v[14:15] op_sel_hi:[1,0,0]
  v_cvt_pk_bf16_f32 v144, v40, v41
  v_cvt_pk_bf16_f32 v145, v42, v43
  v_cvt_pk_bf16_f32 v146, v44, v45
  v_cvt_pk_bf16_f32 v147, v46, v47
  v_mfma_f32_32x32x16_bf16 v[48:63], v[20:23], v[140:143], v[48:63]
  ds_read_b64_tr_b16 v[16:17], v6 offset:12288
  ds_read_b64_tr_b16 v[18:19], v6 offset:12544
  v_lshlrev_b32 v40, 16, v148
  v_and_b32 v41, 0xffff0000, v148
  v_lshlrev_b32 v42, 16, v149
  v_and_b32 v43, 0xffff0000, v149
  v_lshlrev_b32 v44, 16, v150
  v_and_b32 v45, 0xffff0000, v150
  v_lshlrev_b32 v46, 16, v151
  v_and_b32 v47, 0xffff0000, v151
  v_pk_fma_f32 v[40:41], v[40:41], v[12:13], v[14:15] op_sel_hi:[1,0,0]
  v_pk_fma_f32 v[42:43], v[42:43], v[12:13], v[14:15] op_sel_hi:[1,0,0]
  v_pk_fma_f32 v[44:45], v[44:45], v[12:13], v[14:15] op_sel_hi:[1,0,0]
  v_pk_fma_f32 v[46:47], v[46:47], v[12:13], v[14:15] op_sel_hi:[1,0,0]
  v_cvt_pk_bf16_f32 v148, v40, v41
  v_cvt_pk_bf16_f32 v149, v42, v43
  v_cvt_pk_bf16_f32 v150, v44, v45
  v_cvt_pk_bf16_f32 v151, v46, v47
  v_mfma_f32_32x32x16_bf16 v[48:63], v[24:27], v[144:147], v[48:63]
  ds_read_b64_tr_b16 v[20:21], v6 offset:13312
  ds_read_b64_tr_b16 v[22:23], v6 offset:13568
  buffer_load_dwordx4 v2, s[16:19], s68 offen offset:2048 lds
  v_lshlrev_b32 v40, 16, v152
  v_and_b32 v41, 0xffff0000, v152
  v_lshlrev_b32 v42, 16, v153
  v_and_b32 v43, 0xffff0000, v153
  v_lshlrev_b32 v44, 16, v154
  v_and_b32 v45, 0xffff0000, v154
  v_lshlrev_b32 v46, 16, v155
  v_and_b32 v47, 0xffff0000, v155
  v_pk_fma_f32 v[40:41], v[40:41], v[12:13], v[14:15] op_sel_hi:[1,0,0]
  v_pk_fma_f32 v[42:43], v[42:43], v[12:13], v[14:15] op_sel_hi:[1,0,0]
  v_pk_fma_f32 v[44:45], v[44:45], v[12:13], v[14:15] op_sel_hi:[1,0,0]
  v_pk_fma_f32 v[46:47], v[46:47], v[12:13], v[14:15] op_sel_hi:[1,0,0]
  v_cvt_pk_bf16_f32 v152, v40, v41
  v_cvt_pk_bf16_f32 v153, v42, v43
  v_cvt_pk_bf16_f32 v154, v44, v45
  v_cvt_pk_bf16_f32 v155, v46, v47
  s_waitcnt lgkmcnt(4)
  v_mfma_f32_32x32x16_bf16 v[48:63], v[28:31], v[148:151], v[48:63]
  ds_read_b64_tr_b16 v[24:25], v6 offset:14336
  ds_read_b64_tr_b16 v[26:27], v6 offset:14592
  v_lshlrev_b32 v40, 16, v156
  v_and_b32 v41, 0xffff0000, v156
  v_lshlrev_b32 v42, 16, v157
  v_and_b32 v43, 0xffff0000, v157
  v_lshlrev_b32 v44, 16, v158
  v_and_b32 v45, 0xffff0000, v158
  v_lshlrev_b32 v46, 16, v159
  v_and_b32 v47, 0xffff0000, v159
  v_pk_fma_f32 v[40:41], v[40:41], v[12:13], v[14:15] op_sel_hi:[1,0,0]
  v_pk_fma_f32 v[42:43], v[42:43], v[12:13], v[14:15] op_sel_hi:[1,0,0]
  v_pk_fma_f32 v[44:45], v[44:45], v[12:13], v[14:15] op_sel_hi:[1,0,0]
  v_pk_fma_f32 v[46:47], v[46:47], v[12:13], v[14:15] op_sel_hi:[1,0,0]
  v_cvt_pk_bf16_f32 v156, v40, v41
  v_cvt_pk_bf16_f32 v157, v42, v43
  v_cvt_pk_bf16_f32 v158, v44, v45
  v_cvt_pk_bf16_f32 v159, v46, v47
  v_mfma_f32_32x32x16_bf16 v[48:63], v[32:35], v[152:155], v[48:63]
  ds_read_b64_tr_b16 v[28:29], v6 offset:15360
  ds_read_b64_tr_b16 v[30:31], v6 offset:15616
  v_lshlrev_b32 v40, 16, v160
  v_and_b32 v41, 0xffff0000, v160
  v_lshlrev_b32 v42, 16, v161
  v_and_b32 v43, 0xffff0000, v161
  v_lshlrev_b32 v44, 16, v162
  v_and_b32 v45, 0xffff0000, v162
  v_lshlrev_b32 v46, 16, v163
  v_and_b32 v47, 0xffff0000, v163
  v_pk_fma_f32 v[40:41], v[40:41], v[12:13], v[14:15] op_sel_hi:[1,0,0]
  v_pk_fma_f32 v[42:43], v[42:43], v[12:13], v[14:15] op_sel_hi:[1,0,0]
  v_pk_fma_f32 v[44:45], v[44:45], v[12:13], v[14:15] op_sel_hi:[1,0,0]
  v_pk_fma_f32 v[46:47], v[46:47], v[12:13], v[14:15] op_sel_hi:[1,0,0]
  v_cvt_pk_bf16_f32 v160, v40, v41
  v_cvt_pk_bf16_f32 v161, v42, v43
  v_cvt_pk_bf16_f32 v162, v44, v45
  v_cvt_pk_bf16_f32 v163, v46, v47
  v_mfma_f32_32x32x16_bf16 v[48:63], v[36:39], v[156:159], v[48:63]
  ds_read_b64_tr_b16 v[32:33], v6 offset:16384
  ds_read_b64_tr_b16 v[34:35], v6 offset:16640
  buffer_load_dwordx4 v2, s[16:19], s69 offen offset:3072 lds
  v_lshlrev_b32 v40, 16, v164
  v_and_b32 v41, 0xffff0000, v164
  v_lshlrev_b32 v42, 16, v165
  v_and_b32 v43, 0xffff0000, v165
  v_lshlrev_b32 v44, 16, v166
  v_and_b32 v45, 0xffff0000, v166
  v_lshlrev_b32 v46, 16, v167
  v_and_b32 v47, 0xffff0000, v167
  v_pk_fma_f32 v[40:41], v[40:41], v[12:13], v[14:15] op_sel_hi:[1,0,0]
  v_pk_fma_f32 v[42:43], v[42:43], v[12:13], v[14:15] op_sel_hi:[1,0,0]
  v_pk_fma_f32 v[44:45], v[44:45], v[12:13], v[14:15] op_sel_hi:[1,0,0]
  v_pk_fma_f32 v[46:47], v[46:47], v[12:13], v[14:15] op_sel_hi:[1,0,0]
  v_cvt_pk_bf16_f32 v164, v40, v41
  v_cvt_pk_bf16_f32 v165, v42, v43
  v_cvt_pk_bf16_f32 v166, v44, v45
  v_cvt_pk_bf16_f32 v167, v46, v47
  s_waitcnt lgkmcnt(4)
  v_mfma_f32_32x32x16_bf16 v[48:63], v[16:19], v[160:163], v[48:63]
  ds_read_b64_tr_b16 v[36:37], v6 offset:17408
  ds_read_b64_tr_b16 v[38:39], v6 offset:17664
  v_lshlrev_b32 v40, 16, v168
  v_and_b32 v41, 0xffff0000, v168
  v_lshlrev_b32 v42, 16, v169
  v_and_b32 v43, 0xffff0000, v169
  v_lshlrev_b32 v44, 16, v170
  v_and_b32 v45, 0xffff0000, v170
  v_lshlrev_b32 v46, 16, v171
  v_and_b32 v47, 0xffff0000, v171
  v_pk_fma_f32 v[40:41], v[40:41], v[12:13], v[14:15] op_sel_hi:[1,0,0]
  v_pk_fma_f32 v[42:43], v[42:43], v[12:13], v[14:15] op_sel_hi:[1,0,0]
  v_pk_fma_f32 v[44:45], v[44:45], v[12:13], v[14:15] op_sel_hi:[1,0,0]
  v_pk_fma_f32 v[46:47], v[46:47], v[12:13], v[14:15] op_sel_hi:[1,0,0]
  v_cvt_pk_bf16_f32 v168, v40, v41
  v_cvt_pk_bf16_f32 v169, v42, v43
  v_cvt_pk_bf16_f32 v170, v44, v45
  v_cvt_pk_bf16_f32 v171, v46, v47
  v_mfma_f32_32x32x16_bf16 v[48:63], v[20:23], v[164:167], v[48:63]
  ds_read_b64_tr_b16 v[16:17], v6 offset:18432
  ds_read_b64_tr_b16 v[18:19], v6 offset:18688
  v_lshlrev_b32 v40, 16, v172
  v_and_b32 v41, 0xffff0000, v172
  v_lshlrev_b32 v42, 16, v173
  v_and_b32 v43, 0xffff0000, v173
  v_lshlrev_b32 v44, 16, v174
  v_and_b32 v45, 0xffff0000, v174
  v_lshlrev_b32 v46, 16, v175
  v_and_b32 v47, 0xffff0000, v175
  v_pk_fma_f32 v[40:41], v[40:41], v[12:13], v[14:15] op_sel_hi:[1,0,0]
  v_pk_fma_f32 v[42:43], v[42:43], v[12:13], v[14:15] op_sel_hi:[1,0,0]
  v_pk_fma_f32 v[44:45], v[44:45], v[12:13], v[14:15] op_sel_hi:[1,0,0]
  v_pk_fma_f32 v[46:47], v[46:47], v[12:13], v[14:15] op_sel_hi:[1,0,0]
  v_cvt_pk_bf16_f32 v172, v40, v41
  v_cvt_pk_bf16_f32 v173, v42, v43
  v_cvt_pk_bf16_f32 v174, v44, v45
  v_cvt_pk_bf16_f32 v175, v46, v47
  s_add_u32 m0, s30, 77824
  v_mfma_f32_32x32x16_bf16 v[48:63], v[24:27], v[168:171], v[48:63]
  ds_read_b64_tr_b16 v[20:21], v6 offset:19456
  ds_read_b64_tr_b16 v[22:23], v6 offset:19712
  buffer_load_dwordx4 v2, s[16:19], s70 offen offset:0 lds
  v_lshlrev_b32 v40, 16, v176
  v_and_b32 v41, 0xffff0000, v176
  v_lshlrev_b32 v42, 16, v177
  v_and_b32 v43, 0xffff0000, v177
  v_lshlrev_b32 v44, 16, v178
  v_and_b32 v45, 0xffff0000, v178
  v_lshlrev_b32 v46, 16, v179
  v_and_b32 v47, 0xffff0000, v179
  v_pk_fma_f32 v[40:41], v[40:41], v[12:13], v[14:15] op_sel_hi:[1,0,0]
  v_pk_fma_f32 v[42:43], v[42:43], v[12:13], v[14:15] op_sel_hi:[1,0,0]
  v_pk_fma_f32 v[44:45], v[44:45], v[12:13], v[14:15] op_sel_hi:[1,0,0]
  v_pk_fma_f32 v[46:47], v[46:47], v[12:13], v[14:15] op_sel_hi:[1,0,0]
  v_cvt_pk_bf16_f32 v176, v40, v41
  v_cvt_pk_bf16_f32 v177, v42, v43
  v_cvt_pk_bf16_f32 v178, v44, v45
  v_cvt_pk_bf16_f32 v179, v46, v47
  s_waitcnt lgkmcnt(4)
  v_mfma_f32_32x32x16_bf16 v[48:63], v[28:31], v[172:175], v[48:63]
  ds_read_b64_tr_b16 v[24:25], v6 offset:20480
  ds_read_b64_tr_b16 v[26:27], v6 offset:20736
  v_lshlrev_b32 v40, 16, v180
  v_and_b32 v41, 0xffff0000, v180
  v_lshlrev_b32 v42, 16, v181
  v_and_b32 v43, 0xffff0000, v181
  v_lshlrev_b32 v44, 16, v182
  v_and_b32 v45, 0xffff0000, v182
  v_lshlrev_b32 v46, 16, v183
  v_and_b32 v47, 0xffff0000, v183
  v_pk_fma_f32 v[40:41], v[40:41], v[12:13], v[14:15] op_sel_hi:[1,0,0]
  v_pk_fma_f32 v[42:43], v[42:43], v[12:13], v[14:15] op_sel_hi:[1,0,0]
  v_pk_fma_f32 v[44:45], v[44:45], v[12:13], v[14:15] op_sel_hi:[1,0,0]
  v_pk_fma_f32 v[46:47], v[46:47], v[12:13], v[14:15] op_sel_hi:[1,0,0]
  v_cvt_pk_bf16_f32 v180, v40, v41
  v_cvt_pk_bf16_f32 v181, v42, v43
  v_cvt_pk_bf16_f32 v182, v44, v45
  v_cvt_pk_bf16_f32 v183, v46, v47
  v_mfma_f32_32x32x16_bf16 v[48:63], v[32:35], v[176:179], v[48:63]
  ds_read_b64_tr_b16 v[28:29], v6 offset:21504
  ds_read_b64_tr_b16 v[30:31], v6 offset:21760
  v_lshlrev_b32 v40, 16, v184
  v_and_b32 v41, 0xffff0000, v184
  v_lshlrev_b32 v42, 16, v185
  v_and_b32 v43, 0xffff0000, v185
  v_lshlrev_b32 v44, 16, v186
  v_and_b32 v45, 0xffff0000, v186
  v_lshlrev_b32 v46, 16, v187
  v_and_b32 v47, 0xffff0000, v187
  v_pk_fma_f32 v[40:41], v[40:41], v[12:13], v[14:15] op_sel_hi:[1,0,0]
  v_pk_fma_f32 v[42:43], v[42:43], v[12:13], v[14:15] op_sel_hi:[1,0,0]
  v_pk_fma_f32 v[44:45], v[44:45], v[12:13], v[14:15] op_sel_hi:[1,0,0]
  v_pk_fma_f32 v[46:47], v[46:47], v[12:13], v[14:15] op_sel_hi:[1,0,0]
  v_cvt_pk_bf16_f32 v184, v40, v41
  v_cvt_pk_bf16_f32 v185, v42, v43
  v_cvt_pk_bf16_f32 v186, v44, v45
  v_cvt_pk_bf16_f32 v187, v46, v47
  v_mfma_f32_32x32x16_bf16 v[48:63], v[36:39], v[180:183], v[48:63]
  ds_read_b64_tr_b16 v[32:33], v6 offset:22528
  ds_read_b64_tr_b16 v[34:35], v6 offset:22784
  buffer_load_dwordx4 v2, s[16:19], s71 offen offset:1024 lds
  v_lshlrev_b32 v40, 16, v188
  v_and_b32 v41, 0xffff0000, v188
  v_lshlrev_b32 v42, 16, v189
  v_and_b32 v43, 0xffff0000, v189
  v_lshlrev_b32 v44, 16, v190
  v_and_b32 v45, 0xffff0000, v190
  v_lshlrev_b32 v46, 16, v191
  v_and_b32 v47, 0xffff0000, v191
  v_pk_fma_f32 v[40:41], v[40:41], v[12:13], v[14:15] op_sel_hi:[1,0,0]
  v_pk_fma_f32 v[42:43], v[42:43], v[12:13], v[14:15] op_sel_hi:[1,0,0]
  v_pk_fma_f32 v[44:45], v[44:45], v[12:13], v[14:15] op_sel_hi:[1,0,0]
  v_pk_fma_f32 v[46:47], v[46:47], v[12:13], v[14:15] op_sel_hi:[1,0,0]
  v_cvt_pk_bf16_f32 v188, v40, v41
  v_cvt_pk_bf16_f32 v189, v42, v43
  v_cvt_pk_bf16_f32 v190, v44, v45
  v_cvt_pk_bf16_f32 v191, v46, v47
  s_waitcnt lgkmcnt(4)
  v_mfma_f32_32x32x16_bf16 v[48:63], v[16:19], v[184:187], v[48:63]
  ds_read_b64_tr_b16 v[36:37], v6 offset:23552
  ds_read_b64_tr_b16 v[38:39], v6 offset:23808
  v_lshlrev_b32 v40, 16, v192
  v_and_b32 v41, 0xffff0000, v192
  v_lshlrev_b32 v42, 16, v193
  v_and_b32 v43, 0xffff0000, v193
  v_lshlrev_b32 v44, 16, v194
  v_and_b32 v45, 0xffff0000, v194
  v_lshlrev_b32 v46, 16, v195
  v_and_b32 v47, 0xffff0000, v195
  v_pk_fma_f32 v[40:41], v[40:41], v[12:13], v[14:15] op_sel_hi:[1,0,0]
  v_pk_fma_f32 v[42:43], v[42:43], v[12:13], v[14:15] op_sel_hi:[1,0,0]
  v_pk_fma_f32 v[44:45], v[44:45], v[12:13], v[14:15] op_sel_hi:[1,0,0]
  v_pk_fma_f32 v[46:47], v[46:47], v[12:13], v[14:15] op_sel_hi:[1,0,0]
  v_cvt_pk_bf16_f32 v192, v40, v41
  v_cvt_pk_bf16_f32 v193, v42, v43
  v_cvt_pk_bf16_f32 v194, v44, v45
  v_cvt_pk_bf16_f32 v195, v46, v47
  v_mfma_f32_32x32x16_bf16 v[48:63], v[20:23], v[188:191], v[48:63]
  ds_read_b64_tr_b16 v[16:17], v6 offset:24576
  ds_read_b64_tr_b16 v[18:19], v6 offset:24832
  v_lshlrev_b32 v40, 16, v196
  v_and_b32 v41, 0xffff0000, v196
  v_lshlrev_b32 v42, 16, v197
  v_and_b32 v43, 0xffff0000, v197
  v_lshlrev_b32 v44, 16, v198
  v_and_b32 v45, 0xffff0000, v198
  v_lshlrev_b32 v46, 16, v199
  v_and_b32 v47, 0xffff0000, v199
  v_pk_fma_f32 v[40:41], v[40:41], v[12:13], v[14:15] op_sel_hi:[1,0,0]
  v_pk_fma_f32 v[42:43], v[42:43], v[12:13], v[14:15] op_sel_hi:[1,0,0]
  v_pk_fma_f32 v[44:45], v[44:45], v[12:13], v[14:15] op_sel_hi:[1,0,0]
  v_pk_fma_f32 v[46:47], v[46:47], v[12:13], v[14:15] op_sel_hi:[1,0,0]
  v_cvt_pk_bf16_f32 v196, v40, v41
  v_cvt_pk_bf16_f32 v197, v42, v43
  v_cvt_pk_bf16_f32 v198, v44, v45
  v_cvt_pk_bf16_f32 v199, v46, v47
  v_mfma_f32_32x32x16_bf16 v[48:63], v[24:27], v[192:195], v[48:63]
  ds_read_b64_tr_b16 v[20:21], v6 offset:25600
  ds_read_b64_tr_b16 v[22:23], v6 offset:25856
  buffer_load_dwordx4 v2, s[16:19], s72 offen offset:2048 lds
  v_lshlrev_b32 v40, 16, v200
  v_and_b32 v41, 0xffff0000, v200
  v_lshlrev_b32 v42, 16, v201
  v_and_b32 v43, 0xffff0000, v201
  v_lshlrev_b32 v44, 16, v202
  v_and_b32 v45, 0xffff0000, v202
  v_lshlrev_b32 v46, 16, v203
  v_and_b32 v47, 0xffff0000, v203
  v_pk_fma_f32 v[40:41], v[40:41], v[12:13], v[14:15] op_sel_hi:[1,0,0]
  v_pk_fma_f32 v[42:43], v[42:43], v[12:13], v[14:15] op_sel_hi:[1,0,0]
  v_pk_fma_f32 v[44:45], v[44:45], v[12:13], v[14:15] op_sel_hi:[1,0,0]
  v_pk_fma_f32 v[46:47], v[46:47], v[12:13], v[14:15] op_sel_hi:[1,0,0]
  v_cvt_pk_bf16_f32 v200, v40, v41
  v_cvt_pk_bf16_f32 v201, v42, v43
  v_cvt_pk_bf16_f32 v202, v44, v45
  v_cvt_pk_bf16_f32 v203, v46, v47
  s_waitcnt lgkmcnt(4)
  v_mfma_f32_32x32x16_bf16 v[48:63], v[28:31], v[196:199], v[48:63]
  ds_read_b64_tr_b16 v[24:25], v6 offset:26624
  ds_read_b64_tr_b16 v[26:27], v6 offset:26880
  v_lshlrev_b32 v40, 16, v204
  v_and_b32 v41, 0xffff0000, v204
  v_lshlrev_b32 v42, 16, v205
  v_and_b32 v43, 0xffff0000, v205
  v_lshlrev_b32 v44, 16, v206
  v_and_b32 v45, 0xffff0000, v206
  v_lshlrev_b32 v46, 16, v207
  v_and_b32 v47, 0xffff0000, v207
  v_pk_fma_f32 v[40:41], v[40:41], v[12:13], v[14:15] op_sel_hi:[1,0,0]
  v_pk_fma_f32 v[42:43], v[42:43], v[12:13], v[14:15] op_sel_hi:[1,0,0]
  v_pk_fma_f32 v[44:45], v[44:45], v[12:13], v[14:15] op_sel_hi:[1,0,0]
  v_pk_fma_f32 v[46:47], v[46:47], v[12:13], v[14:15] op_sel_hi:[1,0,0]
  v_cvt_pk_bf16_f32 v204, v40, v41
  v_cvt_pk_bf16_f32 v205, v42, v43
  v_cvt_pk_bf16_f32 v206, v44, v45
  v_cvt_pk_bf16_f32 v207, v46, v47
  v_mfma_f32_32x32x16_bf16 v[48:63], v[32:35], v[200:203], v[48:63]
  ds_read_b64_tr_b16 v[28:29], v6 offset:27648
  ds_read_b64_tr_b16 v[30:31], v6 offset:27904
  v_lshlrev_b32 v40, 16, v208
  v_and_b32 v41, 0xffff0000, v208
  v_lshlrev_b32 v42, 16, v209
  v_and_b32 v43, 0xffff0000, v209
  v_lshlrev_b32 v44, 16, v210
  v_and_b32 v45, 0xffff0000, v210
  v_lshlrev_b32 v46, 16, v211
  v_and_b32 v47, 0xffff0000, v211
  v_pk_fma_f32 v[40:41], v[40:41], v[12:13], v[14:15] op_sel_hi:[1,0,0]
  v_pk_fma_f32 v[42:43], v[42:43], v[12:13], v[14:15] op_sel_hi:[1,0,0]
  v_pk_fma_f32 v[44:45], v[44:45], v[12:13], v[14:15] op_sel_hi:[1,0,0]
  v_pk_fma_f32 v[46:47], v[46:47], v[12:13], v[14:15] op_sel_hi:[1,0,0]
  v_cvt_pk_bf16_f32 v208, v40, v41
  v_cvt_pk_bf16_f32 v209, v42, v43
  v_cvt_pk_bf16_f32 v210, v44, v45
  v_cvt_pk_bf16_f32 v211, v46, v47
  v_mfma_f32_32x32x16_bf16 v[48:63], v[36:39], v[204:207], v[48:63]
  ds_read_b64_tr_b16 v[32:33], v6 offset:28672
  ds_read_b64_tr_b16 v[34:35], v6 offset:28928
  buffer_load_dwordx4 v2, s[16:19], s73 offen offset:3072 lds
  v_lshlrev_b32 v40, 16, v212
  v_and_b32 v41, 0xffff0000, v212
  v_lshlrev_b32 v42, 16, v213
  v_and_b32 v43, 0xffff0000, v213
  v_lshlrev_b32 v44, 16, v214
  v_and_b32 v45, 0xffff0000, v214
  v_lshlrev_b32 v46, 16, v215
  v_and_b32 v47, 0xffff0000, v215
  v_pk_fma_f32 v[40:41], v[40:41], v[12:13], v[14:15] op_sel_hi:[1,0,0]
  v_pk_fma_f32 v[42:43], v[42:43], v[12:13], v[14:15] op_sel_hi:[1,0,0]
  v_pk_fma_f32 v[44:45], v[44:45], v[12:13], v[14:15] op_sel_hi:[1,0,0]
  v_pk_fma_f32 v[46:47], v[46:47], v[12:13], v[14:15] op_sel_hi:[1,0,0]
  v_cvt_pk_bf16_f32 v212, v40, v41
  v_cvt_pk_bf16_f32 v213, v42, v43
  v_cvt_pk_bf16_f32 v214, v44, v45
  v_cvt_pk_bf16_f32 v215, v46, v47
  s_waitcnt lgkmcnt(4)
  v_mfma_f32_32x32x16_bf16 v[48:63], v[16:19], v[208:211], v[48:63]
  ds_read_b64_tr_b16 v[36:37], v6 offset:29696
  ds_read_b64_tr_b16 v[38:39], v6 offset:29952
  v_lshlrev_b32 v40, 16, v216
  v_and_b32 v41, 0xffff0000, v216
  v_lshlrev_b32 v42, 16, v217
  v_and_b32 v43, 0xffff0000, v217
  v_lshlrev_b32 v44, 16, v218
  v_and_b32 v45, 0xffff0000, v218
  v_lshlrev_b32 v46, 16, v219
  v_and_b32 v47, 0xffff0000, v219
  v_pk_fma_f32 v[40:41], v[40:41], v[12:13], v[14:15] op_sel_hi:[1,0,0]
  v_pk_fma_f32 v[42:43], v[42:43], v[12:13], v[14:15] op_sel_hi:[1,0,0]
  v_pk_fma_f32 v[44:45], v[44:45], v[12:13], v[14:15] op_sel_hi:[1,0,0]
  v_pk_fma_f32 v[46:47], v[46:47], v[12:13], v[14:15] op_sel_hi:[1,0,0]
  v_cvt_pk_bf16_f32 v216, v40, v41
  v_cvt_pk_bf16_f32 v217, v42, v43
  v_cvt_pk_bf16_f32 v218, v44, v45
  v_cvt_pk_bf16_f32 v219, v46, v47
  v_mfma_f32_32x32x16_bf16 v[48:63], v[20:23], v[212:215], v[48:63]
  ds_read_b64_tr_b16 v[16:17], v6 offset:30720
  ds_read_b64_tr_b16 v[18:19], v6 offset:30976
  v_lshlrev_b32 v40, 16, v220
  v_and_b32 v41, 0xffff0000, v220
  v_lshlrev_b32 v42, 16, v221
  v_and_b32 v43, 0xffff0000, v221
  v_lshlrev_b32 v44, 16, v222
  v_and_b32 v45, 0xffff0000, v222
  v_lshlrev_b32 v46, 16, v223
  v_and_b32 v47, 0xffff0000, v223
  v_pk_fma_f32 v[40:41], v[40:41], v[12:13], v[14:15] op_sel_hi:[1,0,0]
  v_pk_fma_f32 v[42:43], v[42:43], v[12:13], v[14:15] op_sel_hi:[1,0,0]
  v_pk_fma_f32 v[44:45], v[44:45], v[12:13], v[14:15] op_sel_hi:[1,0,0]
  v_pk_fma_f32 v[46:47], v[46:47], v[12:13], v[14:15] op_sel_hi:[1,0,0]
  v_cvt_pk_bf16_f32 v220, v40, v41
  v_cvt_pk_bf16_f32 v221, v42, v43
  v_cvt_pk_bf16_f32 v222, v44, v45
  v_cvt_pk_bf16_f32 v223, v46, v47
  s_add_u32 m0, s30, 81920
  v_mfma_f32_32x32x16_bf16 v[48:63], v[24:27], v[216:219], v[48:63]
  ds_read_b64_tr_b16 v[20:21], v6 offset:31744
  ds_read_b64_tr_b16 v[22:23], v6 offset:32000
  buffer_load_dwordx4 v2, s[16:19], s74 offen offset:0 lds
  v_lshlrev_b32 v40, 16, v224
  v_and_b32 v41, 0xffff0000, v224
  v_lshlrev_b32 v42, 16, v225
  v_and_b32 v43, 0xffff0000, v225
  v_lshlrev_b32 v44, 16, v226
  v_and_b32 v45, 0xffff0000, v226
  v_lshlrev_b32 v46, 16, v227
  v_and_b32 v47, 0xffff0000, v227
  v_pk_fma_f32 v[40:41], v[40:41], v[12:13], v[14:15] op_sel_hi:[1,0,0]
  v_pk_fma_f32 v[42:43], v[42:43], v[12:13], v[14:15] op_sel_hi:[1,0,0]
  v_pk_fma_f32 v[44:45], v[44:45], v[12:13], v[14:15] op_sel_hi:[1,0,0]
  v_pk_fma_f32 v[46:47], v[46:47], v[12:13], v[14:15] op_sel_hi:[1,0,0]
  v_cvt_pk_bf16_f32 v224, v40, v41
  v_cvt_pk_bf16_f32 v225, v42, v43
  v_cvt_pk_bf16_f32 v226, v44, v45
  v_cvt_pk_bf16_f32 v227, v46, v47
  s_waitcnt lgkmcnt(4)
  v_mfma_f32_32x32x16_bf16 v[48:63], v[28:31], v[220:223], v[48:63]
  ds_read_b64_tr_b16 v[24:25], v6 offset:32768
  ds_read_b64_tr_b16 v[26:27], v6 offset:33024
  v_lshlrev_b32 v40, 16, v228
  v_and_b32 v41, 0xffff0000, v228
  v_lshlrev_b32 v42, 16, v229
  v_and_b32 v43, 0xffff0000, v229
  v_lshlrev_b32 v44, 16, v230
  v_and_b32 v45, 0xffff0000, v230
  v_lshlrev_b32 v46, 16, v231
  v_and_b32 v47, 0xffff0000, v231
  v_pk_fma_f32 v[40:41], v[40:41], v[12:13], v[14:15] op_sel_hi:[1,0,0]
  v_pk_fma_f32 v[42:43], v[42:43], v[12:13], v[14:15] op_sel_hi:[1,0,0]
  v_pk_fma_f32 v[44:45], v[44:45], v[12:13], v[14:15] op_sel_hi:[1,0,0]
  v_pk_fma_f32 v[46:47], v[46:47], v[12:13], v[14:15] op_sel_hi:[1,0,0]
  v_cvt_pk_bf16_f32 v228, v40, v41
  v_cvt_pk_bf16_f32 v229, v42, v43
  v_cvt_pk_bf16_f32 v230, v44, v45
  v_cvt_pk_bf16_f32 v231, v46, v47
  v_mfma_f32_32x32x16_bf16 v[48:63], v[32:35], v[224:227], v[48:63]
  ds_read_b64_tr_b16 v[28:29], v6 offset:33792
  ds_read_b64_tr_b16 v[30:31], v6 offset:34048
  v_lshlrev_b32 v40, 16, v232
  v_and_b32 v41, 0xffff0000, v232
  v_lshlrev_b32 v42, 16, v233
  v_and_b32 v43, 0xffff0000, v233
  v_lshlrev_b32 v44, 16, v234
  v_and_b32 v45, 0xffff0000, v234
  v_lshlrev_b32 v46, 16, v235
  v_and_b32 v47, 0xffff0000, v235
  v_pk_fma_f32 v[40:41], v[40:41], v[12:13], v[14:15] op_sel_hi:[1,0,0]
  v_pk_fma_f32 v[42:43], v[42:43], v[12:13], v[14:15] op_sel_hi:[1,0,0]
  v_pk_fma_f32 v[44:45], v[44:45], v[12:13], v[14:15] op_sel_hi:[1,0,0]
  v_pk_fma_f32 v[46:47], v[46:47], v[12:13], v[14:15] op_sel_hi:[1,0,0]
  v_cvt_pk_bf16_f32 v232, v40, v41
  v_cvt_pk_bf16_f32 v233, v42, v43
  v_cvt_pk_bf16_f32 v234, v44, v45
  v_cvt_pk_bf16_f32 v235, v46, v47
  v_mfma_f32_32x32x16_bf16 v[48:63], v[36:39], v[228:231], v[48:63]
  ds_read_b64_tr_b16 v[32:33], v6 offset:34816
  ds_read_b64_tr_b16 v[34:35], v6 offset:35072
  v_lshlrev_b32 v40, 16, v236
  v_and_b32 v41, 0xffff0000, v236
  v_lshlrev_b32 v42, 16, v237
  v_and_b32 v43, 0xffff0000, v237
  v_lshlrev_b32 v44, 16, v238
  v_and_b32 v45, 0xffff0000, v238
  v_lshlrev_b32 v46, 16, v239
  v_and_b32 v47, 0xffff0000, v239
  v_pk_fma_f32 v[40:41], v[40:41], v[12:13], v[14:15] op_sel_hi:[1,0,0]
  v_pk_fma_f32 v[42:43], v[42:43], v[12:13], v[14:15] op_sel_hi:[1,0,0]
  v_pk_fma_f32 v[44:45], v[44:45], v[12:13], v[14:15] op_sel_hi:[1,0,0]
  v_pk_fma_f32 v[46:47], v[46:47], v[12:13], v[14:15] op_sel_hi:[1,0,0]
  v_cvt_pk_bf16_f32 v236, v40, v41
  v_cvt_pk_bf16_f32 v237, v42, v43
  v_cvt_pk_bf16_f32 v238, v44, v45
  v_cvt_pk_bf16_f32 v239, v46, v47
  s_waitcnt lgkmcnt(4)
  v_mfma_f32_32x32x16_bf16 v[48:63], v[16:19], v[232:235], v[48:63]
  ds_read_b64_tr_b16 v[36:37], v6 offset:35840
  ds_read_b64_tr_b16 v[38:39], v6 offset:36096
  v_lshlrev_b32 v40, 16, v240
  v_and_b32 v41, 0xffff0000, v240
  v_lshlrev_b32 v42, 16, v241
  v_and_b32 v43, 0xffff0000, v241
  v_lshlrev_b32 v44, 16, v242
  v_and_b32 v45, 0xffff0000, v242
  v_lshlrev_b32 v46, 16, v243
  v_and_b32 v47, 0xffff0000, v243
  v_pk_fma_f32 v[40:41], v[40:41], v[12:13], v[14:15] op_sel_hi:[1,0,0]
  v_pk_fma_f32 v[42:43], v[42:43], v[12:13], v[14:15] op_sel_hi:[1,0,0]
  v_pk_fma_f32 v[44:45], v[44:45], v[12:13], v[14:15] op_sel_hi:[1,0,0]
  v_pk_fma_f32 v[46:47], v[46:47], v[12:13], v[14:15] op_sel_hi:[1,0,0]
  v_cvt_pk_bf16_f32 v240, v40, v41
  v_cvt_pk_bf16_f32 v241, v42, v43
  v_cvt_pk_bf16_f32 v242, v44, v45
  v_cvt_pk_bf16_f32 v243, v46, v47
  buffer_load_dword a253, v7, s[16:19], 0 offen offset:128
  v_mfma_f32_32x32x16_bf16 v[48:63], v[20:23], v[236:239], v[48:63]
  s_waitcnt vmcnt(10)
  s_barrier
  v_add_u32 v6, 36864, v4
  ds_read_b64_tr_b16 v[16:17], v6 offset:0
  ds_read_b64_tr_b16 v[18:19], v6 offset:256
  v_lshlrev_b32 v40, 16, v244
  v_and_b32 v41, 0xffff0000, v244
  v_lshlrev_b32 v42, 16, v245
  v_and_b32 v43, 0xffff0000, v245
  v_lshlrev_b32 v44, 16, v246
  v_and_b32 v45, 0xffff0000, v246
  v_lshlrev_b32 v46, 16, v247
  v_and_b32 v47, 0xffff0000, v247
  v_pk_fma_f32 v[40:41], v[40:41], v[12:13], v[14:15] op_sel_hi:[1,0,0]
  v_pk_fma_f32 v[42:43], v[42:43], v[12:13], v[14:15] op_sel_hi:[1,0,0]
  v_pk_fma_f32 v[44:45], v[44:45], v[12:13], v[14:15] op_sel_hi:[1,0,0]
  v_pk_fma_f32 v[46:47], v[46:47], v[12:13], v[14:15] op_sel_hi:[1,0,0]
  v_cvt_pk_bf16_f32 v244, v40, v41
  v_cvt_pk_bf16_f32 v245, v42, v43
  v_cvt_pk_bf16_f32 v246, v44, v45
  v_cvt_pk_bf16_f32 v247, v46, v47
  buffer_load_dword a253, v7, s[16:19], 0 offen offset:256
  v_mfma_f32_32x32x16_bf16 v[48:63], v[24:27], v[240:243], v[48:63]
  ds_read_b64_tr_b16 v[20:21], v6 offset:1024
  ds_read_b64_tr_b16 v[22:23], v6 offset:1280
  v_lshlrev_b32 v40, 16, v248
  v_and_b32 v41, 0xffff0000, v248
  v_lshlrev_b32 v42, 16, v249
  v_and_b32 v43, 0xffff0000, v249
  v_lshlrev_b32 v44, 16, v250
  v_and_b32 v45, 0xffff0000, v250
  v_lshlrev_b32 v46, 16, v251
  v_and_b32 v47, 0xffff0000, v251
  v_pk_fma_f32 v[40:41], v[40:41], v[12:13], v[14:15] op_sel_hi:[1,0,0]
  v_pk_fma_f32 v[42:43], v[42:43], v[12:13], v[14:15] op_sel_hi:[1,0,0]
  v_pk_fma_f32 v[44:45], v[44:45], v[12:13], v[14:15] op_sel_hi:[1,0,0]
  v_pk_fma_f32 v[46:47], v[46:47], v[12:13], v[14:15] op_sel_hi:[1,0,0]
  v_cvt_pk_bf16_f32 v248, v40, v41
  v_cvt_pk_bf16_f32 v249, v42, v43
  v_cvt_pk_bf16_f32 v250, v44, v45
  v_cvt_pk_bf16_f32 v251, v46, v47
  s_waitcnt lgkmcnt(4)
  v_mfma_f32_32x32x16_bf16 v[48:63], v[28:31], v[244:247], v[48:63]
  ds_read_b64_tr_b16 v[24:25], v6 offset:2048
  ds_read_b64_tr_b16 v[26:27], v6 offset:2304
  v_lshlrev_b32 v40, 16, v252
  v_and_b32 v41, 0xffff0000, v252
  v_lshlrev_b32 v42, 16, v253
  v_and_b32 v43, 0xffff0000, v253
  v_lshlrev_b32 v44, 16, v254
  v_and_b32 v45, 0xffff0000, v254
  v_lshlrev_b32 v46, 16, v255
  v_and_b32 v47, 0xffff0000, v255
  v_pk_fma_f32 v[40:41], v[40:41], v[12:13], v[14:15] op_sel_hi:[1,0,0]
  v_pk_fma_f32 v[42:43], v[42:43], v[12:13], v[14:15] op_sel_hi:[1,0,0]
  v_pk_fma_f32 v[44:45], v[44:45], v[12:13], v[14:15] op_sel_hi:[1,0,0]
  v_pk_fma_f32 v[46:47], v[46:47], v[12:13], v[14:15] op_sel_hi:[1,0,0]
  v_cvt_pk_bf16_f32 v252, v40, v41
  v_cvt_pk_bf16_f32 v253, v42, v43
  v_cvt_pk_bf16_f32 v254, v44, v45
  v_cvt_pk_bf16_f32 v255, v46, v47
  v_mfma_f32_32x32x16_bf16 v[48:63], v[32:35], v[248:251], v[48:63]
  ds_read_b64_tr_b16 v[28:29], v6 offset:3072
  ds_read_b64_tr_b16 v[30:31], v6 offset:3328
  v_mfma_f32_32x32x16_bf16 v[48:63], v[36:39], v[252:255], v[48:63]
  ds_read_b64_tr_b16 v[32:33], v6 offset:4096
  ds_read_b64_tr_b16 v[34:35], v6 offset:4352
  s_waitcnt lgkmcnt(4)
  v_mfma_f32_32x32x16_bf16 v[64:79], v[16:19], v[112:115], 0
  ds_read_b64_tr_b16 v[36:37], v6 offset:5120
  ds_read_b64_tr_b16 v[38:39], v6 offset:5376
  v_mfma_f32_32x32x16_bf16 v[64:79], v[20:23], v[116:119], v[64:79]
  ds_read_b64_tr_b16 v[16:17], v6 offset:6144
  ds_read_b64_tr_b16 v[18:19], v6 offset:6400
  s_add_u32 m0, s30, 110592
  v_mfma_f32_32x32x16_bf16 v[64:79], v[24:27], v[120:123], v[64:79]
  ds_read_b64_tr_b16 v[20:21], v6 offset:7168
  ds_read_b64_tr_b16 v[22:23], v6 offset:7424
  buffer_load_dwordx4 v2, s[20:23], 0 offen offset:0 lds
  s_waitcnt lgkmcnt(4)
  v_mfma_f32_32x32x16_bf16 v[64:79], v[28:31], v[124:127], v[64:79]
  ds_read_b64_tr_b16 v[24:25], v6 offset:8192
  ds_read_b64_tr_b16 v[26:27], v6 offset:8448
  v_mul_f32 v10, v48, v48
  v_mul_f32 v11, v49, v49
  v_mul_f32 v12, v50, v50
  v_mfma_f32_32x32x16_bf16 v[64:79], v[32:35], v[128:131], v[64:79]
  ds_read_b64_tr_b16 v[28:29], v6 offset:9216
  ds_read_b64_tr_b16 v[30:31], v6 offset:9472
  v_mul_f32 v13, v51, v51
  v_fmaak_f32 v10, v10, v8, 0xc0135761
  v_fmaak_f32 v11, v11, v8, 0xc0135761
  v_fmaak_f32 v12, v12, v8, 0xc0135761
  v_mfma_f32_32x32x16_bf16 v[64:79], v[36:39], v[132:135], v[64:79]
  ds_read_b64_tr_b16 v[32:33], v6 offset:10240
  ds_read_b64_tr_b16 v[34:35], v6 offset:10496
  buffer_load_dwordx4 v2, s[20:23], s67 offen offset:1024 lds
  v_fmaak_f32 v13, v13, v8, 0xc0135761
  s_waitcnt lgkmcnt(4)
  v_mfma_f32_32x32x16_bf16 v[64:79], v[16:19], v[136:139], v[64:79]
  ds_read_b64_tr_b16 v[36:37], v6 offset:11264
  ds_read_b64_tr_b16 v[38:39], v6 offset:11520
  v_mul_f32 v10, v10, v48
  v_mul_f32 v11, v11, v49
  v_mul_f32 v12, v12, v50
  v_mfma_f32_32x32x16_bf16 v[64:79], v[20:23], v[140:143], v[64:79]
  ds_read_b64_tr_b16 v[16:17], v6 offset:12288
  ds_read_b64_tr_b16 v[18:19], v6 offset:12544
  v_mul_f32 v13, v13, v51
  v_exp_f32 v10, v10
  v_exp_f32 v11, v11
  v_mfma_f32_32x32x16_bf16 v[64:79], v[24:27], v[144:147], v[64:79]
  ds_read_b64_tr_b16 v[20:21], v6 offset:13312
  ds_read_b64_tr_b16 v[22:23], v6 offset:13568
  buffer_load_dwordx4 v2, s[20:23], s68 offen offset:2048 lds
  s_waitcnt lgkmcnt(4)
  v_mfma_f32_32x32x16_bf16 v[64:79], v[28:31], v[148:151], v[64:79]
  ds_read_b64_tr_b16 v[24:25], v6 offset:14336
  ds_read_b64_tr_b16 v[26:27], v6 offset:14592
  v_exp_f32 v12, v12
  v_mfma_f32_32x32x16_bf16 v[64:79], v[32:35], v[152:155], v[64:79]
  ds_read_b64_tr_b16 v[28:29], v6 offset:15360
  ds_read_b64_tr_b16 v[30:31], v6 offset:15616
  v_exp_f32 v13, v13
  v_add_f32 v10, 1.0, v10
  v_add_f32 v11, 1.0, v11
  v_add_f32 v12, 1.0, v12
  v_mfma_f32_32x32x16_bf16 v[64:79], v[36:39], v[156:159], v[64:79]
  ds_read_b64_tr_b16 v[32:33], v6 offset:16384
  ds_read_b64_tr_b16 v[34:35], v6 offset:16640
  buffer_load_dwordx4 v2, s[20:23], s69 offen offset:3072 lds
  s_waitcnt lgkmcnt(4)
  v_mfma_f32_32x32x16_bf16 v[64:79], v[16:19], v[160:163], v[64:79]
  ds_read_b64_tr_b16 v[36:37], v6 offset:17408
  ds_read_b64_tr_b16 v[38:39], v6 offset:17664
  v_add_f32 v13, 1.0, v13
  v_rcp_f32 v10, v10
  v_mfma_f32_32x32x16_bf16 v[64:79], v[20:23], v[164:167], v[64:79]
  ds_read_b64_tr_b16 v[16:17], v6 offset:18432
  ds_read_b64_tr_b16 v[18:19], v6 offset:18688
  v_rcp_f32 v11, v11
  v_rcp_f32 v12, v12
  s_add_u32 m0, s30, 114688
  v_mfma_f32_32x32x16_bf16 v[64:79], v[24:27], v[168:171], v[64:79]
  ds_read_b64_tr_b16 v[20:21], v6 offset:19456
  ds_read_b64_tr_b16 v[22:23], v6 offset:19712
  buffer_load_dwordx4 v2, s[20:23], s70 offen offset:0 lds
  s_waitcnt lgkmcnt(4)
  v_mfma_f32_32x32x16_bf16 v[64:79], v[28:31], v[172:175], v[64:79]
  ds_read_b64_tr_b16 v[24:25], v6 offset:20480
  ds_read_b64_tr_b16 v[26:27], v6 offset:20736
  v_rcp_f32 v13, v13
  v_mul_f32 v48, v48, v10
  v_mfma_f32_32x32x16_bf16 v[64:79], v[32:35], v[176:179], v[64:79]
  ds_read_b64_tr_b16 v[28:29], v6 offset:21504
  ds_read_b64_tr_b16 v[30:31], v6 offset:21760
  v_mul_f32 v49, v49, v11
  v_mul_f32 v50, v50, v12
  v_mul_f32 v51, v51, v13
  v_mul_f32 v10, v52, v52
  v_mfma_f32_32x32x16_bf16 v[64:79], v[36:39], v[180:183], v[64:79]
  ds_read_b64_tr_b16 v[32:33], v6 offset:22528
  ds_read_b64_tr_b16 v[34:35], v6 offset:22784
  buffer_load_dwordx4 v2, s[20:23], s71 offen offset:1024 lds
  s_waitcnt lgkmcnt(4)
  v_mfma_f32_32x32x16_bf16 v[64:79], v[16:19], v[184:187], v[64:79]
  ds_read_b64_tr_b16 v[36:37], v6 offset:23552
  ds_read_b64_tr_b16 v[38:39], v6 offset:23808
  v_mul_f32 v11, v53, v53
  v_mul_f32 v12, v54, v54
  v_mul_f32 v13, v55, v55
  v_fmaak_f32 v10, v10, v8, 0xc0135761
  v_mfma_f32_32x32x16_bf16 v[64:79], v[20:23], v[188:191], v[64:79]
  ds_read_b64_tr_b16 v[16:17], v6 offset:24576
  ds_read_b64_tr_b16 v[18:19], v6 offset:24832
  v_fmaak_f32 v11, v11, v8, 0xc0135761
  v_fmaak_f32 v12, v12, v8, 0xc0135761
  v_fmaak_f32 v13, v13, v8, 0xc0135761
  v_mul_f32 v10, v10, v52
  v_mfma_f32_32x32x16_bf16 v[64:79], v[24:27], v[192:195], v[64:79]
  ds_read_b64_tr_b16 v[20:21], v6 offset:25600
  ds_read_b64_tr_b16 v[22:23], v6 offset:25856
  buffer_load_dwordx4 v2, s[20:23], s72 offen offset:2048 lds
  s_waitcnt lgkmcnt(4)
  v_mfma_f32_32x32x16_bf16 v[64:79], v[28:31], v[196:199], v[64:79]
  ds_read_b64_tr_b16 v[24:25], v6 offset:26624
  ds_read_b64_tr_b16 v[26:27], v6 offset:26880
  v_mul_f32 v11, v11, v53
  v_mul_f32 v12, v12, v54
  v_mul_f32 v13, v13, v55
  v_mfma_f32_32x32x16_bf16 v[64:79], v[32:35], v[200:203], v[64:79]
  ds_read_b64_tr_b16 v[28:29], v6 offset:27648
  ds_read_b64_tr_b16 v[30:31], v6 offset:27904
  v_exp_f32 v10, v10
  v_exp_f32 v11, v11
  v_mfma_f32_32x32x16_bf16 v[64:79], v[36:39], v[204:207], v[64:79]
  ds_read_b64_tr_b16 v[32:33], v6 offset:28672
  ds_read_b64_tr_b16 v[34:35], v6 offset:28928
  buffer_load_dwordx4 v2, s[20:23], s73 offen offset:3072 lds
  s_waitcnt lgkmcnt(4)
  v_mfma_f32_32x32x16_bf16 v[64:79], v[16:19], v[208:211], v[64:79]
  ds_read_b64_tr_b16 v[36:37], v6 offset:29696
  ds_read_b64_tr_b16 v[38:39], v6 offset:29952
  v_exp_f32 v12, v12
  v_exp_f32 v13, v13
  v_mfma_f32_32x32x16_bf16 v[64:79], v[20:23], v[212:215], v[64:79]
  ds_read_b64_tr_b16 v[16:17], v6 offset:30720
  ds_read_b64_tr_b16 v[18:19], v6 offset:30976
  v_add_f32 v10, 1.0, v10
  v_add_f32 v11, 1.0, v11
  v_add_f32 v12, 1.0, v12
  s_add_u32 m0, s30, 118784
  v_mfma_f32_32x32x16_bf16 v[64:79], v[24:27], v[216:219], v[64:79]
  ds_read_b64_tr_b16 v[20:21], v6 offset:31744
  ds_read_b64_tr_b16 v[22:23], v6 offset:32000
  buffer_load_dwordx4 v2, s[20:23], s74 offen offset:0 lds
  s_waitcnt lgkmcnt(4)
  v_mfma_f32_32x32x16_bf16 v[64:79], v[28:31], v[220:223], v[64:79]
  ds_read_b64_tr_b16 v[24:25], v6 offset:32768
  ds_read_b64_tr_b16 v[26:27], v6 offset:33024
  v_add_f32 v13, 1.0, v13
  v_rcp_f32 v10, v10
  v_add_u32 v2, 64, v2
  v_mfma_f32_32x32x16_bf16 v[64:79], v[32:35], v[224:227], v[64:79]
  ds_read_b64_tr_b16 v[28:29], v6 offset:33792
  ds_read_b64_tr_b16 v[30:31], v6 offset:34048
  v_rcp_f32 v11, v11
  v_rcp_f32 v12, v12
  v_mfma_f32_32x32x16_bf16 v[64:79], v[36:39], v[228:231], v[64:79]
  ds_read_b64_tr_b16 v[32:33], v6 offset:34816
  ds_read_b64_tr_b16 v[34:35], v6 offset:35072
  v_rcp_f32 v13, v13
  v_mul_f32 v52, v52, v10
  v_mul_f32 v53, v53, v11
  s_waitcnt lgkmcnt(4)
  v_mfma_f32_32x32x16_bf16 v[64:79], v[16:19], v[232:235], v[64:79]
  ds_read_b64_tr_b16 v[36:37], v6 offset:35840
  ds_read_b64_tr_b16 v[38:39], v6 offset:36096
  buffer_load_dword a253, v7, s[20:23], 0 offen offset:128
  v_mul_f32 v54, v54, v12
  v_mul_f32 v55, v55, v13
  v_mfma_f32_32x32x16_bf16 v[64:79], v[20:23], v[236:239], v[64:79]
  s_waitcnt vmcnt(12)
  s_barrier
  v_add_u32 v6, 73728, v4
  ds_read_b64_tr_b16 v[16:17], v6 offset:0
  ds_read_b64_tr_b16 v[18:19], v6 offset:256
  global_load_dword a255, v[96:97], off
  v_add_co_u32 v96, vcc, 0x2000, v96
  v_addc_co_u32 v97, vcc, 0, v97, vcc
  v_mfma_f32_32x32x16_bf16 v[64:79], v[24:27], v[240:243], v[64:79]
  ds_read_b64_tr_b16 v[20:21], v6 offset:1024
  ds_read_b64_tr_b16 v[22:23], v6 offset:1280
  v_mul_f32 v10, v56, v56
  v_mul_f32 v11, v57, v57
  v_mul_f32 v12, v58, v58
  v_mul_f32 v13, v59, v59
  s_waitcnt lgkmcnt(4)
  v_mfma_f32_32x32x16_bf16 v[64:79], v[28:31], v[244:247], v[64:79]
  ds_read_b64_tr_b16 v[24:25], v6 offset:2048
  ds_read_b64_tr_b16 v[26:27], v6 offset:2304
  v_fmaak_f32 v10, v10, v8, 0xc0135761
  v_fmaak_f32 v11, v11, v8, 0xc0135761
  v_fmaak_f32 v12, v12, v8, 0xc0135761
  v_fmaak_f32 v13, v13, v8, 0xc0135761
  v_mfma_f32_32x32x16_bf16 v[64:79], v[32:35], v[248:251], v[64:79]
  ds_read_b64_tr_b16 v[28:29], v6 offset:3072
  ds_read_b64_tr_b16 v[30:31], v6 offset:3328
  v_mul_f32 v10, v10, v56
  v_mul_f32 v11, v11, v57
  v_mul_f32 v12, v12, v58
  v_mul_f32 v13, v13, v59
  v_mfma_f32_32x32x16_bf16 v[64:79], v[36:39], v[252:255], v[64:79]
  ds_read_b64_tr_b16 v[32:33], v6 offset:4096
  ds_read_b64_tr_b16 v[34:35], v6 offset:4352
  v_exp_f32 v10, v10
  v_exp_f32 v11, v11
  s_waitcnt lgkmcnt(4)
  v_mfma_f32_32x32x16_bf16 v[80:95], v[16:19], v[112:115], 0
  ds_read_b64_tr_b16 v[36:37], v6 offset:5120
  ds_read_b64_tr_b16 v[38:39], v6 offset:5376
  v_mfma_f32_32x32x16_bf16 v[80:95], v[20:23], v[116:119], v[80:95]
  ds_read_b64_tr_b16 v[16:17], v6 offset:6144
  ds_read_b64_tr_b16 v[18:19], v6 offset:6400
  v_exp_f32 v12, v12
  v_exp_f32 v13, v13
  s_add_u32 m0, s30, 0
  v_mfma_f32_32x32x16_bf16 v[80:95], v[24:27], v[120:123], v[80:95]
  ds_read_b64_tr_b16 v[20:21], v6 offset:7168
  ds_read_b64_tr_b16 v[22:23], v6 offset:7424
  buffer_load_dwordx4 v2, s[16:19], 0 offen offset:0 lds
  s_waitcnt lgkmcnt(4)
  v_mfma_f32_32x32x16_bf16 v[80:95], v[28:31], v[124:127], v[80:95]
  ds_read_b64_tr_b16 v[24:25], v6 offset:8192
  ds_read_b64_tr_b16 v[26:27], v6 offset:8448
  v_add_f32 v10, 1.0, v10
  v_add_f32 v11, 1.0, v11
  v_mfma_f32_32x32x16_bf16 v[80:95], v[32:35], v[128:131], v[80:95]
  ds_read_b64_tr_b16 v[28:29], v6 offset:9216
  ds_read_b64_tr_b16 v[30:31], v6 offset:9472
  v_add_f32 v12, 1.0, v12
  v_add_f32 v13, 1.0, v13
  v_rcp_f32 v10, v10
  v_mfma_f32_32x32x16_bf16 v[80:95], v[36:39], v[132:135], v[80:95]
  ds_read_b64_tr_b16 v[32:33], v6 offset:10240
  ds_read_b64_tr_b16 v[34:35], v6 offset:10496
  buffer_load_dwordx4 v2, s[16:19], s67 offen offset:1024 lds
  s_waitcnt lgkmcnt(4)
  v_mfma_f32_32x32x16_bf16 v[80:95], v[16:19], v[136:139], v[80:95]
  ds_read_b64_tr_b16 v[36:37], v6 offset:11264
  ds_read_b64_tr_b16 v[38:39], v6 offset:11520
  v_rcp_f32 v11, v11
  v_rcp_f32 v12, v12
  v_mfma_f32_32x32x16_bf16 v[80:95], v[20:23], v[140:143], v[80:95]
  ds_read_b64_tr_b16 v[16:17], v6 offset:12288
  ds_read_b64_tr_b16 v[18:19], v6 offset:12544
  v_rcp_f32 v13, v13
  v_mul_f32 v56, v56, v10
  v_mfma_f32_32x32x16_bf16 v[80:95], v[24:27], v[144:147], v[80:95]
  ds_read_b64_tr_b16 v[20:21], v6 offset:13312
  ds_read_b64_tr_b16 v[22:23], v6 offset:13568
  buffer_load_dwordx4 v2, s[16:19], s68 offen offset:2048 lds
  s_waitcnt lgkmcnt(4)
  v_mfma_f32_32x32x16_bf16 v[80:95], v[28:31], v[148:151], v[80:95]
  ds_read_b64_tr_b16 v[24:25], v6 offset:14336
  ds_read_b64_tr_b16 v[26:27], v6 offset:14592
  v_mul_f32 v57, v57, v11
  v_mul_f32 v58, v58, v12
  v_mul_f32 v59, v59, v13
  v_mul_f32 v10, v60, v60
  v_mfma_f32_32x32x16_bf16 v[80:95], v[32:35], v[152:155], v[80:95]
  ds_read_b64_tr_b16 v[28:29], v6 offset:15360
  ds_read_b64_tr_b16 v[30:31], v6 offset:15616
  v_mul_f32 v11, v61, v61
  v_mul_f32 v12, v62, v62
  v_mul_f32 v13, v63, v63
  v_fmaak_f32 v10, v10, v8, 0xc0135761
  v_mfma_f32_32x32x16_bf16 v[80:95], v[36:39], v[156:159], v[80:95]
  ds_read_b64_tr_b16 v[32:33], v6 offset:16384
  ds_read_b64_tr_b16 v[34:35], v6 offset:16640
  buffer_load_dwordx4 v2, s[16:19], s69 offen offset:3072 lds
  s_waitcnt lgkmcnt(4)
  v_mfma_f32_32x32x16_bf16 v[80:95], v[16:19], v[160:163], v[80:95]
  ds_read_b64_tr_b16 v[36:37], v6 offset:17408
  ds_read_b64_tr_b16 v[38:39], v6 offset:17664
  v_fmaak_f32 v11, v11, v8, 0xc0135761
  v_fmaak_f32 v12, v12, v8, 0xc0135761
  v_fmaak_f32 v13, v13, v8, 0xc0135761
  v_mfma_f32_32x32x16_bf16 v[80:95], v[20:23], v[164:167], v[80:95]
  ds_read_b64_tr_b16 v[16:17], v6 offset:18432
  ds_read_b64_tr_b16 v[18:19], v6 offset:18688
  v_mul_f32 v10, v10, v60
  v_mul_f32 v11, v11, v61
  v_mul_f32 v12, v12, v62
  s_add_u32 m0, s30, 4096
  v_mfma_f32_32x32x16_bf16 v[80:95], v[24:27], v[168:171], v[80:95]
  ds_read_b64_tr_b16 v[20:21], v6 offset:19456
  ds_read_b64_tr_b16 v[22:23], v6 offset:19712
  buffer_load_dwordx4 v2, s[16:19], s70 offen offset:0 lds
  s_waitcnt lgkmcnt(4)
  v_mfma_f32_32x32x16_bf16 v[80:95], v[28:31], v[172:175], v[80:95]
  ds_read_b64_tr_b16 v[24:25], v6 offset:20480
  ds_read_b64_tr_b16 v[26:27], v6 offset:20736
  v_mul_f32 v13, v13, v63
  v_exp_f32 v10, v10
  v_mfma_f32_32x32x16_bf16 v[80:95], v[32:35], v[176:179], v[80:95]
  ds_read_b64_tr_b16 v[28:29], v6 offset:21504
  ds_read_b64_tr_b16 v[30:31], v6 offset:21760
  v_exp_f32 v11, v11
  v_exp_f32 v12, v12
  v_mfma_f32_32x32x16_bf16 v[80:95], v[36:39], v[180:183], v[80:95]
  ds_read_b64_tr_b16 v[32:33], v6 offset:22528
  ds_read_b64_tr_b16 v[34:35], v6 offset:22784
  buffer_load_dwordx4 v2, s[16:19], s71 offen offset:1024 lds
  s_waitcnt lgkmcnt(4)
  v_mfma_f32_32x32x16_bf16 v[80:95], v[16:19], v[184:187], v[80:95]
  ds_read_b64_tr_b16 v[36:37], v6 offset:23552
  ds_read_b64_tr_b16 v[38:39], v6 offset:23808
  v_exp_f32 v13, v13
  v_add_f32 v10, 1.0, v10
  v_mfma_f32_32x32x16_bf16 v[80:95], v[20:23], v[188:191], v[80:95]
  ds_read_b64_tr_b16 v[16:17], v6 offset:24576
  ds_read_b64_tr_b16 v[18:19], v6 offset:24832
  v_add_f32 v11, 1.0, v11
  v_add_f32 v12, 1.0, v12
  v_add_f32 v13, 1.0, v13
  v_rcp_f32 v10, v10
  v_mfma_f32_32x32x16_bf16 v[80:95], v[24:27], v[192:195], v[80:95]
  ds_read_b64_tr_b16 v[20:21], v6 offset:25600
  ds_read_b64_tr_b16 v[22:23], v6 offset:25856
  buffer_load_dwordx4 v2, s[16:19], s72 offen offset:2048 lds
  s_waitcnt lgkmcnt(4)
  v_mfma_f32_32x32x16_bf16 v[80:95], v[28:31], v[196:199], v[80:95]
  ds_read_b64_tr_b16 v[24:25], v6 offset:26624
  ds_read_b64_tr_b16 v[26:27], v6 offset:26880
  v_rcp_f32 v11, v11
  v_mfma_f32_32x32x16_bf16 v[80:95], v[32:35], v[200:203], v[80:95]
  ds_read_b64_tr_b16 v[28:29], v6 offset:27648
  ds_read_b64_tr_b16 v[30:31], v6 offset:27904
  v_rcp_f32 v12, v12
  v_rcp_f32 v13, v13
  v_mfma_f32_32x32x16_bf16 v[80:95], v[36:39], v[204:207], v[80:95]
  ds_read_b64_tr_b16 v[32:33], v6 offset:28672
  ds_read_b64_tr_b16 v[34:35], v6 offset:28928
  buffer_load_dwordx4 v2, s[16:19], s73 offen offset:3072 lds
  s_waitcnt lgkmcnt(4)
  v_mfma_f32_32x32x16_bf16 v[80:95], v[16:19], v[208:211], v[80:95]
  ds_read_b64_tr_b16 v[36:37], v6 offset:29696
  ds_read_b64_tr_b16 v[38:39], v6 offset:29952
  v_mul_f32 v60, v60, v10
  v_mul_f32 v61, v61, v11
  v_mul_f32 v62, v62, v12
  v_mfma_f32_32x32x16_bf16 v[80:95], v[20:23], v[212:215], v[80:95]
  ds_read_b64_tr_b16 v[16:17], v6 offset:30720
  ds_read_b64_tr_b16 v[18:19], v6 offset:30976
  v_mul_f32 v63, v63, v13
  v_mul_f32 v64, v64, v48
  v_mul_f32 v65, v65, v49
  s_add_u32 m0, s30, 8192
  v_mfma_f32_32x32x16_bf16 v[80:95], v[24:27], v[216:219], v[80:95]
  ds_read_b64_tr_b16 v[20:21], v6 offset:31744
  ds_read_b64_tr_b16 v[22:23], v6 offset:32000
  buffer_load_dwordx4 v2, s[16:19], s74 offen offset:0 lds
  s_waitcnt lgkmcnt(4)
  v_mfma_f32_32x32x16_bf16 v[80:95], v[28:31], v[220:223], v[80:95]
  ds_read_b64_tr_b16 v[24:25], v6 offset:32768
  ds_read_b64_tr_b16 v[26:27], v6 offset:33024
  v_mul_f32 v66, v66, v50
  v_mul_f32 v67, v67, v51
  v_mul_f32 v68, v68, v52
  v_mul_f32 v69, v69, v53
  v_mfma_f32_32x32x16_bf16 v[80:95], v[32:35], v[224:227], v[80:95]
  ds_read_b64_tr_b16 v[28:29], v6 offset:33792
  ds_read_b64_tr_b16 v[30:31], v6 offset:34048
  v_mul_f32 v70, v70, v54
  v_mul_f32 v71, v71, v55
  v_mul_f32 v72, v72, v56
  v_mul_f32 v73, v73, v57
  v_mfma_f32_32x32x16_bf16 v[80:95], v[36:39], v[228:231], v[80:95]
  ds_read_b64_tr_b16 v[32:33], v6 offset:34816
  ds_read_b64_tr_b16 v[34:35], v6 offset:35072
  buffer_load_dword a253, v7, s[16:19], 0 offen offset:384
  v_mul_f32 v74, v74, v58
  v_mul_f32 v75, v75, v59
  v_mul_f32 v76, v76, v60
  s_waitcnt lgkmcnt(4)
  v_mfma_f32_32x32x16_bf16 v[80:95], v[16:19], v[232:235], v[80:95]
  ds_read_b64_tr_b16 v[36:37], v6 offset:35840
  ds_read_b64_tr_b16 v[38:39], v6 offset:36096
  v_mul_f32 v77, v77, v61
  v_mul_f32 v78, v78, v62
  v_mul_f32 v79, v79, v63
  v_mfma_f32_32x32x16_bf16 v[80:95], v[20:23], v[236:239], v[80:95]
  s_waitcnt vmcnt(12)
  s_barrier
  v_add_u32 v6, 110592, v4
  ds_read_b64_tr_b16 v[16:17], v6 offset:0
  ds_read_b64_tr_b16 v[18:19], v6 offset:256
  v_cvt_pk_bf16_f32 v40, v64, v65
  v_mfma_f32_32x32x16_bf16 v[80:95], v[24:27], v[240:243], v[80:95]
  ds_read_b64_tr_b16 v[20:21], v6 offset:1024
  ds_read_b64_tr_b16 v[22:23], v6 offset:1280
  v_cvt_pk_bf16_f32 v41, v66, v67
  v_cvt_pk_bf16_f32 v42, v68, v69
  v_cvt_pk_bf16_f32 v43, v70, v71
  v_cvt_pk_bf16_f32 v44, v72, v73
  s_waitcnt lgkmcnt(4)
  v_mfma_f32_32x32x16_bf16 v[80:95], v[28:31], v[244:247], v[80:95]
  ds_read_b64_tr_b16 v[24:25], v6 offset:2048
  ds_read_b64_tr_b16 v[26:27], v6 offset:2304
  v_cvt_pk_bf16_f32 v45, v74, v75
  v_cvt_pk_bf16_f32 v46, v76, v77
  v_cvt_pk_bf16_f32 v47, v78, v79
  v_mfma_f32_32x32x16_bf16 v[80:95], v[32:35], v[248:251], v[80:95]
  ds_read_b64_tr_b16 v[28:29], v6 offset:3072
  ds_read_b64_tr_b16 v[30:31], v6 offset:3328
  v_accvgpr_write_b32 a0, v40
  v_accvgpr_write_b32 a1, v41
  v_accvgpr_write_b32 a2, v42
  v_accvgpr_write_b32 a3, v43
  v_mfma_f32_32x32x16_bf16 v[80:95], v[36:39], v[252:255], v[80:95]
  ds_read_b64_tr_b16 v[32:33], v6 offset:4096
  ds_read_b64_tr_b16 v[34:35], v6 offset:4352
  v_accvgpr_write_b32 a4, v44
  v_accvgpr_write_b32 a5, v45
  v_accvgpr_write_b32 a6, v46
  v_accvgpr_write_b32 a7, v47
  s_waitcnt lgkmcnt(4)
  v_mfma_f32_32x32x16_bf16 v[64:79], v[16:19], v[112:115], 0
  ds_read_b64_tr_b16 v[36:37], v6 offset:5120
  ds_read_b64_tr_b16 v[38:39], v6 offset:5376
  v_mfma_f32_32x32x16_bf16 v[64:79], v[20:23], v[116:119], v[64:79]
  ds_read_b64_tr_b16 v[16:17], v6 offset:6144
  ds_read_b64_tr_b16 v[18:19], v6 offset:6400
  s_add_u32 m0, s30, 36864
  v_mfma_f32_32x32x16_bf16 v[64:79], v[24:27], v[120:123], v[64:79]
  ds_read_b64_tr_b16 v[20:21], v6 offset:7168
  ds_read_b64_tr_b16 v[22:23], v6 offset:7424
  buffer_load_dwordx4 v2, s[20:23], 0 offen offset:0 lds
  s_waitcnt lgkmcnt(4)
  v_mfma_f32_32x32x16_bf16 v[64:79], v[28:31], v[124:127], v[64:79]
  ds_read_b64_tr_b16 v[24:25], v6 offset:8192
  ds_read_b64_tr_b16 v[26:27], v6 offset:8448
  v_mul_f32 v10, v80, v80
  v_mul_f32 v11, v81, v81
  v_mul_f32 v12, v82, v82
  v_mfma_f32_32x32x16_bf16 v[64:79], v[32:35], v[128:131], v[64:79]
  ds_read_b64_tr_b16 v[28:29], v6 offset:9216
  ds_read_b64_tr_b16 v[30:31], v6 offset:9472
  v_mul_f32 v13, v83, v83
  v_fmaak_f32 v10, v10, v8, 0xc0135761
  v_fmaak_f32 v11, v11, v8, 0xc0135761
  v_fmaak_f32 v12, v12, v8, 0xc0135761
  v_mfma_f32_32x32x16_bf16 v[64:79], v[36:39], v[132:135], v[64:79]
  ds_read_b64_tr_b16 v[32:33], v6 offset:10240
  ds_read_b64_tr_b16 v[34:35], v6 offset:10496
  buffer_load_dwordx4 v2, s[20:23], s67 offen offset:1024 lds
  v_fmaak_f32 v13, v13, v8, 0xc0135761
  s_waitcnt lgkmcnt(4)
  v_mfma_f32_32x32x16_bf16 v[64:79], v[16:19], v[136:139], v[64:79]
  ds_read_b64_tr_b16 v[36:37], v6 offset:11264
  ds_read_b64_tr_b16 v[38:39], v6 offset:11520
  v_mul_f32 v10, v10, v80
  v_mul_f32 v11, v11, v81
  v_mul_f32 v12, v12, v82
  v_mfma_f32_32x32x16_bf16 v[64:79], v[20:23], v[140:143], v[64:79]
  ds_read_b64_tr_b16 v[16:17], v6 offset:12288
  ds_read_b64_tr_b16 v[18:19], v6 offset:12544
  v_mul_f32 v13, v13, v83
  v_exp_f32 v10, v10
  v_mfma_f32_32x32x16_bf16 v[64:79], v[24:27], v[144:147], v[64:79]
  ds_read_b64_tr_b16 v[20:21], v6 offset:13312
  ds_read_b64_tr_b16 v[22:23], v6 offset:13568
  buffer_load_dwordx4 v2, s[20:23], s68 offen offset:2048 lds
  v_exp_f32 v11, v11
  s_waitcnt lgkmcnt(4)
  v_mfma_f32_32x32x16_bf16 v[64:79], v[28:31], v[148:151], v[64:79]
  ds_read_b64_tr_b16 v[24:25], v6 offset:14336
  ds_read_b64_tr_b16 v[26:27], v6 offset:14592
  v_exp_f32 v12, v12
  v_mfma_f32_32x32x16_bf16 v[64:79], v[32:35], v[152:155], v[64:79]
  ds_read_b64_tr_b16 v[28:29], v6 offset:15360
  ds_read_b64_tr_b16 v[30:31], v6 offset:15616
  v_exp_f32 v13, v13
  v_add_f32 v10, 1.0, v10
  v_add_f32 v11, 1.0, v11
  v_mfma_f32_32x32x16_bf16 v[64:79], v[36:39], v[156:159], v[64:79]
  ds_read_b64_tr_b16 v[32:33], v6 offset:16384
  ds_read_b64_tr_b16 v[34:35], v6 offset:16640
  buffer_load_dwordx4 v2, s[20:23], s69 offen offset:3072 lds
  v_add_f32 v12, 1.0, v12
  s_waitcnt lgkmcnt(4)
  v_mfma_f32_32x32x16_bf16 v[64:79], v[16:19], v[160:163], v[64:79]
  ds_read_b64_tr_b16 v[36:37], v6 offset:17408
  ds_read_b64_tr_b16 v[38:39], v6 offset:17664
  v_add_f32 v13, 1.0, v13
  v_rcp_f32 v10, v10
  v_mfma_f32_32x32x16_bf16 v[64:79], v[20:23], v[164:167], v[64:79]
  ds_read_b64_tr_b16 v[16:17], v6 offset:18432
  ds_read_b64_tr_b16 v[18:19], v6 offset:18688
  v_rcp_f32 v11, v11
  v_rcp_f32 v12, v12
  s_add_u32 m0, s30, 40960
  v_mfma_f32_32x32x16_bf16 v[64:79], v[24:27], v[168:171], v[64:79]
  ds_read_b64_tr_b16 v[20:21], v6 offset:19456
  ds_read_b64_tr_b16 v[22:23], v6 offset:19712
  buffer_load_dwordx4 v2, s[20:23], s70 offen offset:0 lds
  s_waitcnt lgkmcnt(4)
  v_mfma_f32_32x32x16_bf16 v[64:79], v[28:31], v[172:175], v[64:79]
  ds_read_b64_tr_b16 v[24:25], v6 offset:20480
  ds_read_b64_tr_b16 v[26:27], v6 offset:20736
  v_rcp_f32 v13, v13
  v_mfma_f32_32x32x16_bf16 v[64:79], v[32:35], v[176:179], v[64:79]
  ds_read_b64_tr_b16 v[28:29], v6 offset:21504
  ds_read_b64_tr_b16 v[30:31], v6 offset:21760
  v_mul_f32 v80, v80, v10
  v_mul_f32 v81, v81, v11
  v_mul_f32 v82, v82, v12
  v_mul_f32 v83, v83, v13
  v_mul_f32 v10, v84, v84
  v_mfma_f32_32x32x16_bf16 v[64:79], v[36:39], v[180:183], v[64:79]
  ds_read_b64_tr_b16 v[32:33], v6 offset:22528
  ds_read_b64_tr_b16 v[34:35], v6 offset:22784
  buffer_load_dwordx4 v2, s[20:23], s71 offen offset:1024 lds
  s_waitcnt lgkmcnt(4)
  v_mfma_f32_32x32x16_bf16 v[64:79], v[16:19], v[184:187], v[64:79]
  ds_read_b64_tr_b16 v[36:37], v6 offset:23552
  ds_read_b64_tr_b16 v[38:39], v6 offset:23808
  v_mul_f32 v11, v85, v85
  v_mul_f32 v12, v86, v86
  v_mul_f32 v13, v87, v87
  v_mfma_f32_32x32x16_bf16 v[64:79], v[20:23], v[188:191], v[64:79]
  ds_read_b64_tr_b16 v[16:17], v6 offset:24576
  ds_read_b64_tr_b16 v[18:19], v6 offset:24832
  v_fmaak_f32 v10, v10, v8, 0xc0135761
  v_fmaak_f32 v11, v11, v8, 0xc0135761
  v_fmaak_f32 v12, v12, v8, 0xc0135761
  v_fmaak_f32 v13, v13, v8, 0xc0135761
  v_mfma_f32_32x32x16_bf16 v[64:79], v[24:27], v[192:195], v[64:79]
  ds_read_b64_tr_b16 v[20:21], v6 offset:25600
  ds_read_b64_tr_b16 v[22:23], v6 offset:25856
  buffer_load_dwordx4 v2, s[20:23], s72 offen offset:2048 lds
  s_waitcnt lgkmcnt(4)
  v_mfma_f32_32x32x16_bf16 v[64:79], v[28:31], v[196:199], v[64:79]
  ds_read_b64_tr_b16 v[24:25], v6 offset:26624
  ds_read_b64_tr_b16 v[26:27], v6 offset:26880
  v_mul_f32 v10, v10, v84
  v_mul_f32 v11, v11, v85
  v_mul_f32 v12, v12, v86
  v_mfma_f32_32x32x16_bf16 v[64:79], v[32:35], v[200:203], v[64:79]
  ds_read_b64_tr_b16 v[28:29], v6 offset:27648
  ds_read_b64_tr_b16 v[30:31], v6 offset:27904
  v_mul_f32 v13, v13, v87
  v_exp_f32 v10, v10
  v_exp_f32 v11, v11
  v_mfma_f32_32x32x16_bf16 v[64:79], v[36:39], v[204:207], v[64:79]
  ds_read_b64_tr_b16 v[32:33], v6 offset:28672
  ds_read_b64_tr_b16 v[34:35], v6 offset:28928
  buffer_load_dwordx4 v2, s[20:23], s73 offen offset:3072 lds
  s_waitcnt lgkmcnt(4)
  v_mfma_f32_32x32x16_bf16 v[64:79], v[16:19], v[208:211], v[64:79]
  ds_read_b64_tr_b16 v[36:37], v6 offset:29696
  ds_read_b64_tr_b16 v[38:39], v6 offset:29952
  v_exp_f32 v12, v12
  v_exp_f32 v13, v13
  v_mfma_f32_32x32x16_bf16 v[64:79], v[20:23], v[212:215], v[64:79]
  ds_read_b64_tr_b16 v[16:17], v6 offset:30720
  ds_read_b64_tr_b16 v[18:19], v6 offset:30976
  v_add_f32 v10, 1.0, v10
  v_add_f32 v11, 1.0, v11
  s_add_u32 m0, s30, 45056
  v_mfma_f32_32x32x16_bf16 v[64:79], v[24:27], v[216:219], v[64:79]
  ds_read_b64_tr_b16 v[20:21], v6 offset:31744
  ds_read_b64_tr_b16 v[22:23], v6 offset:32000
  buffer_load_dwordx4 v2, s[20:23], s74 offen offset:0 lds
  s_waitcnt lgkmcnt(4)
  v_mfma_f32_32x32x16_bf16 v[64:79], v[28:31], v[220:223], v[64:79]
  ds_read_b64_tr_b16 v[24:25], v6 offset:32768
  ds_read_b64_tr_b16 v[26:27], v6 offset:33024
  v_add_f32 v12, 1.0, v12
  v_add_f32 v13, 1.0, v13
  v_add_u32 v2, 64, v2
  v_mfma_f32_32x32x16_bf16 v[64:79], v[32:35], v[224:227], v[64:79]
  ds_read_b64_tr_b16 v[28:29], v6 offset:33792
  ds_read_b64_tr_b16 v[30:31], v6 offset:34048
  v_rcp_f32 v10, v10
  v_rcp_f32 v11, v11
  v_mfma_f32_32x32x16_bf16 v[64:79], v[36:39], v[228:231], v[64:79]
  ds_read_b64_tr_b16 v[32:33], v6 offset:34816
  ds_read_b64_tr_b16 v[34:35], v6 offset:35072
  buffer_load_dword a253, v7, s[20:23], 0 offen offset:384
  v_rcp_f32 v12, v12
  v_rcp_f32 v13, v13
  s_waitcnt lgkmcnt(4)
  v_mfma_f32_32x32x16_bf16 v[64:79], v[16:19], v[232:235], v[64:79]
  ds_read_b64_tr_b16 v[36:37], v6 offset:35840
  ds_read_b64_tr_b16 v[38:39], v6 offset:36096
  v_mul_f32 v84, v84, v10
  v_mul_f32 v85, v85, v11
  v_mul_f32 v86, v86, v12
  v_mfma_f32_32x32x16_bf16 v[64:79], v[20:23], v[236:239], v[64:79]
  s_waitcnt vmcnt(11)
  s_barrier
  v_add_u32 v6, 0, v4
  ds_read_b64_tr_b16 v[16:17], v6 offset:0
  ds_read_b64_tr_b16 v[18:19], v6 offset:256
  v_mul_f32 v87, v87, v13
  v_mfma_f32_32x32x16_bf16 v[64:79], v[24:27], v[240:243], v[64:79]
  ds_read_b64_tr_b16 v[20:21], v6 offset:1024
  ds_read_b64_tr_b16 v[22:23], v6 offset:1280
  v_mul_f32 v10, v88, v88
  v_mul_f32 v11, v89, v89
  v_mul_f32 v12, v90, v90
  v_mul_f32 v13, v91, v91
  s_waitcnt lgkmcnt(4)
  v_mfma_f32_32x32x16_bf16 v[64:79], v[28:31], v[244:247], v[64:79]
  ds_read_b64_tr_b16 v[24:25], v6 offset:2048
  ds_read_b64_tr_b16 v[26:27], v6 offset:2304
  v_fmaak_f32 v10, v10, v8, 0xc0135761
  v_fmaak_f32 v11, v11, v8, 0xc0135761
  v_fmaak_f32 v12, v12, v8, 0xc0135761
  v_fmaak_f32 v13, v13, v8, 0xc0135761
  v_mfma_f32_32x32x16_bf16 v[64:79], v[32:35], v[248:251], v[64:79]
  ds_read_b64_tr_b16 v[28:29], v6 offset:3072
  ds_read_b64_tr_b16 v[30:31], v6 offset:3328
  v_mul_f32 v10, v10, v88
  v_mul_f32 v11, v11, v89
  v_mul_f32 v12, v12, v90
  v_mul_f32 v13, v13, v91
  v_mfma_f32_32x32x16_bf16 v[64:79], v[36:39], v[252:255], v[64:79]
  ds_read_b64_tr_b16 v[32:33], v6 offset:4096
  ds_read_b64_tr_b16 v[34:35], v6 offset:4352
  v_exp_f32 v10, v10
  v_exp_f32 v11, v11
  s_waitcnt lgkmcnt(4)
  v_mfma_f32_32x32x16_bf16 v[48:63], v[16:19], v[112:115], 0
  ds_read_b64_tr_b16 v[36:37], v6 offset:5120
  ds_read_b64_tr_b16 v[38:39], v6 offset:5376
  v_mfma_f32_32x32x16_bf16 v[48:63], v[20:23], v[116:119], v[48:63]
  ds_read_b64_tr_b16 v[16:17], v6 offset:6144
  ds_read_b64_tr_b16 v[18:19], v6 offset:6400
  v_exp_f32 v12, v12
  v_exp_f32 v13, v13
  s_add_u32 m0, s30, 73728
  v_mfma_f32_32x32x16_bf16 v[48:63], v[24:27], v[120:123], v[48:63]
  ds_read_b64_tr_b16 v[20:21], v6 offset:7168
  ds_read_b64_tr_b16 v[22:23], v6 offset:7424
  buffer_load_dwordx4 v2, s[16:19], 0 offen offset:0 lds
  s_waitcnt lgkmcnt(4)
  v_mfma_f32_32x32x16_bf16 v[48:63], v[28:31], v[124:127], v[48:63]
  ds_read_b64_tr_b16 v[24:25], v6 offset:8192
  ds_read_b64_tr_b16 v[26:27], v6 offset:8448
  v_add_f32 v10, 1.0, v10
  v_add_f32 v11, 1.0, v11
  v_mfma_f32_32x32x16_bf16 v[48:63], v[32:35], v[128:131], v[48:63]
  ds_read_b64_tr_b16 v[28:29], v6 offset:9216
  ds_read_b64_tr_b16 v[30:31], v6 offset:9472
  v_add_f32 v12, 1.0, v12
  v_add_f32 v13, 1.0, v13
  v_rcp_f32 v10, v10
  v_mfma_f32_32x32x16_bf16 v[48:63], v[36:39], v[132:135], v[48:63]
  ds_read_b64_tr_b16 v[32:33], v6 offset:10240
  ds_read_b64_tr_b16 v[34:35], v6 offset:10496
  buffer_load_dwordx4 v2, s[16:19], s67 offen offset:1024 lds
  s_waitcnt lgkmcnt(4)
  v_mfma_f32_32x32x16_bf16 v[48:63], v[16:19], v[136:139], v[48:63]
  ds_read_b64_tr_b16 v[36:37], v6 offset:11264
  ds_read_b64_tr_b16 v[38:39], v6 offset:11520
  v_rcp_f32 v11, v11
  v_rcp_f32 v12, v12
  v_mfma_f32_32x32x16_bf16 v[48:63], v[20:23], v[140:143], v[48:63]
  ds_read_b64_tr_b16 v[16:17], v6 offset:12288
  ds_read_b64_tr_b16 v[18:19], v6 offset:12544
  v_rcp_f32 v13, v13
  v_mul_f32 v88, v88, v10
  v_mfma_f32_32x32x16_bf16 v[48:63], v[24:27], v[144:147], v[48:63]
  ds_read_b64_tr_b16 v[20:21], v6 offset:13312
  ds_read_b64_tr_b16 v[22:23], v6 offset:13568
  buffer_load_dwordx4 v2, s[16:19], s68 offen offset:2048 lds
  s_waitcnt lgkmcnt(4)
  v_mfma_f32_32x32x16_bf16 v[48:63], v[28:31], v[148:151], v[48:63]
  ds_read_b64_tr_b16 v[24:25], v6 offset:14336
  ds_read_b64_tr_b16 v[26:27], v6 offset:14592
  v_mul_f32 v89, v89, v11
  v_mul_f32 v90, v90, v12
  v_mul_f32 v91, v91, v13
  v_mfma_f32_32x32x16_bf16 v[48:63], v[32:35], v[152:155], v[48:63]
  ds_read_b64_tr_b16 v[28:29], v6 offset:15360
  ds_read_b64_tr_b16 v[30:31], v6 offset:15616
  v_mul_f32 v10, v92, v92
  v_mul_f32 v11, v93, v93
  v_mul_f32 v12, v94, v94
  v_mul_f32 v13, v95, v95
  v_mfma_f32_32x32x16_bf16 v[48:63], v[36:39], v[156:159], v[48:63]
  ds_read_b64_tr_b16 v[32:33], v6 offset:16384
  ds_read_b64_tr_b16 v[34:35], v6 offset:16640
  buffer_load_dwordx4 v2, s[16:19], s69 offen offset:3072 lds
  s_waitcnt lgkmcnt(4)
  v_mfma_f32_32x32x16_bf16 v[48:63], v[16:19], v[160:163], v[48:63]
  ds_read_b64_tr_b16 v[36:37], v6 offset:17408
  ds_read_b64_tr_b16 v[38:39], v6 offset:17664
  v_fmaak_f32 v10, v10, v8, 0xc0135761
  v_fmaak_f32 v11, v11, v8, 0xc0135761
  v_fmaak_f32 v12, v12, v8, 0xc0135761
  v_mfma_f32_32x32x16_bf16 v[48:63], v[20:23], v[164:167], v[48:63]
  ds_read_b64_tr_b16 v[16:17], v6 offset:18432
  ds_read_b64_tr_b16 v[18:19], v6 offset:18688
  v_fmaak_f32 v13, v13, v8, 0xc0135761
  v_mul_f32 v10, v10, v92
  v_mul_f32 v11, v11, v93
  s_add_u32 m0, s30, 77824
  v_mfma_f32_32x32x16_bf16 v[48:63], v[24:27], v[168:171], v[48:63]
  ds_read_b64_tr_b16 v[20:21], v6 offset:19456
  ds_read_b64_tr_b16 v[22:23], v6 offset:19712
  buffer_load_dwordx4 v2, s[16:19], s70 offen offset:0 lds
  s_waitcnt lgkmcnt(4)
  v_mfma_f32_32x32x16_bf16 v[48:63], v[28:31], v[172:175], v[48:63]
  ds_read_b64_tr_b16 v[24:25], v6 offset:20480
  ds_read_b64_tr_b16 v[26:27], v6 offset:20736
  v_mul_f32 v12, v12, v94
  v_mul_f32 v13, v13, v95
  v_exp_f32 v10, v10
  v_mfma_f32_32x32x16_bf16 v[48:63], v[32:35], v[176:179], v[48:63]
  ds_read_b64_tr_b16 v[28:29], v6 offset:21504
  ds_read_b64_tr_b16 v[30:31], v6 offset:21760
  v_exp_f32 v11, v11
  v_exp_f32 v12, v12
  v_mfma_f32_32x32x16_bf16 v[48:63], v[36:39], v[180:183], v[48:63]
  ds_read_b64_tr_b16 v[32:33], v6 offset:22528
  ds_read_b64_tr_b16 v[34:35], v6 offset:22784
  buffer_load_dwordx4 v2, s[16:19], s71 offen offset:1024 lds
  s_waitcnt lgkmcnt(4)
  v_mfma_f32_32x32x16_bf16 v[48:63], v[16:19], v[184:187], v[48:63]
  ds_read_b64_tr_b16 v[36:37], v6 offset:23552
  ds_read_b64_tr_b16 v[38:39], v6 offset:23808
  v_exp_f32 v13, v13
  v_add_f32 v10, 1.0, v10
  v_mfma_f32_32x32x16_bf16 v[48:63], v[20:23], v[188:191], v[48:63]
  ds_read_b64_tr_b16 v[16:17], v6 offset:24576
  ds_read_b64_tr_b16 v[18:19], v6 offset:24832
  v_add_f32 v11, 1.0, v11
  v_add_f32 v12, 1.0, v12
  v_add_f32 v13, 1.0, v13
  v_mfma_f32_32x32x16_bf16 v[48:63], v[24:27], v[192:195], v[48:63]
  ds_read_b64_tr_b16 v[20:21], v6 offset:25600
  ds_read_b64_tr_b16 v[22:23], v6 offset:25856
  buffer_load_dwordx4 v2, s[16:19], s72 offen offset:2048 lds
  s_waitcnt lgkmcnt(4)
  v_mfma_f32_32x32x16_bf16 v[48:63], v[28:31], v[196:199], v[48:63]
  ds_read_b64_tr_b16 v[24:25], v6 offset:26624
  ds_read_b64_tr_b16 v[26:27], v6 offset:26880
  v_rcp_f32 v10, v10
  v_rcp_f32 v11, v11
  v_mfma_f32_32x32x16_bf16 v[48:63], v[32:35], v[200:203], v[48:63]
  ds_read_b64_tr_b16 v[28:29], v6 offset:27648
  ds_read_b64_tr_b16 v[30:31], v6 offset:27904
  v_rcp_f32 v12, v12
  v_rcp_f32 v13, v13
  v_mfma_f32_32x32x16_bf16 v[48:63], v[36:39], v[204:207], v[48:63]
  ds_read_b64_tr_b16 v[32:33], v6 offset:28672
  ds_read_b64_tr_b16 v[34:35], v6 offset:28928
  buffer_load_dwordx4 v2, s[16:19], s73 offen offset:3072 lds
  s_waitcnt lgkmcnt(4)
  v_mfma_f32_32x32x16_bf16 v[48:63], v[16:19], v[208:211], v[48:63]
  ds_read_b64_tr_b16 v[36:37], v6 offset:29696
  ds_read_b64_tr_b16 v[38:39], v6 offset:29952
  v_mul_f32 v92, v92, v10
  v_mul_f32 v93, v93, v11
  v_mul_f32 v94, v94, v12
  v_mfma_f32_32x32x16_bf16 v[48:63], v[20:23], v[212:215], v[48:63]
  ds_read_b64_tr_b16 v[16:17], v6 offset:30720
  ds_read_b64_tr_b16 v[18:19], v6 offset:30976
  v_mul_f32 v95, v95, v13
  v_mul_f32 v64, v64, v80
  v_mul_f32 v65, v65, v81
  s_add_u32 m0, s30, 81920
  v_mfma_f32_32x32x16_bf16 v[48:63], v[24:27], v[216:219], v[48:63]
  ds_read_b64_tr_b16 v[20:21], v6 offset:31744
  ds_read_b64_tr_b16 v[22:23], v6 offset:32000
  buffer_load_dwordx4 v2, s[16:19], s74 offen offset:0 lds
  s_waitcnt lgkmcnt(4)
  v_mfma_f32_32x32x16_bf16 v[48:63], v[28:31], v[220:223], v[48:63]
  ds_read_b64_tr_b16 v[24:25], v6 offset:32768
  ds_read_b64_tr_b16 v[26:27], v6 offset:33024
  v_mul_f32 v66, v66, v82
  v_mul_f32 v67, v67, v83
  v_mul_f32 v68, v68, v84
  v_mfma_f32_32x32x16_bf16 v[48:63], v[32:35], v[224:227], v[48:63]
  ds_read_b64_tr_b16 v[28:29], v6 offset:33792
  ds_read_b64_tr_b16 v[30:31], v6 offset:34048
  v_mul_f32 v69, v69, v85
  v_mul_f32 v70, v70, v86
  v_mul_f32 v71, v71, v87
  v_mul_f32 v72, v72, v88
  v_mfma_f32_32x32x16_bf16 v[48:63], v[36:39], v[228:231], v[48:63]
  ds_read_b64_tr_b16 v[32:33], v6 offset:34816
  ds_read_b64_tr_b16 v[34:35], v6 offset:35072
  v_mul_f32 v73, v73, v89
  v_mul_f32 v74, v74, v90
  v_mul_f32 v75, v75, v91
  v_mul_f32 v76, v76, v92
  s_waitcnt lgkmcnt(4)
  v_mfma_f32_32x32x16_bf16 v[48:63], v[16:19], v[232:235], v[48:63]
  ds_read_b64_tr_b16 v[36:37], v6 offset:35840
  ds_read_b64_tr_b16 v[38:39], v6 offset:36096
  v_mul_f32 v77, v77, v93
  v_mul_f32 v78, v78, v94
  v_mul_f32 v79, v79, v95
  v_mfma_f32_32x32x16_bf16 v[48:63], v[20:23], v[236:239], v[48:63]
  s_waitcnt vmcnt(10)
  s_barrier
  v_add_u32 v6, 36864, v4
  ds_read_b64_tr_b16 v[16:17], v6 offset:0
  ds_read_b64_tr_b16 v[18:19], v6 offset:256
  v_cvt_pk_bf16_f32 v40, v64, v65
  v_mfma_f32_32x32x16_bf16 v[48:63], v[24:27], v[240:243], v[48:63]
  ds_read_b64_tr_b16 v[20:21], v6 offset:1024
  ds_read_b64_tr_b16 v[22:23], v6 offset:1280
  v_cvt_pk_bf16_f32 v41, v66, v67
  v_cvt_pk_bf16_f32 v42, v68, v69
  v_cvt_pk_bf16_f32 v43, v70, v71
  v_cvt_pk_bf16_f32 v44, v72, v73
  s_waitcnt lgkmcnt(4)
  v_mfma_f32_32x32x16_bf16 v[48:63], v[28:31], v[244:247], v[48:63]
  ds_read_b64_tr_b16 v[24:25], v6 offset:2048
  ds_read_b64_tr_b16 v[26:27], v6 offset:2304
  v_cvt_pk_bf16_f32 v45, v74, v75
  v_cvt_pk_bf16_f32 v46, v76, v77
  v_cvt_pk_bf16_f32 v47, v78, v79
  v_mfma_f32_32x32x16_bf16 v[48:63], v[32:35], v[248:251], v[48:63]
  ds_read_b64_tr_b16 v[28:29], v6 offset:3072
  ds_read_b64_tr_b16 v[30:31], v6 offset:3328
  v_accvgpr_write_b32 a8, v40
  v_accvgpr_write_b32 a9, v41
  v_accvgpr_write_b32 a10, v42
  v_accvgpr_write_b32 a11, v43
  v_mfma_f32_32x32x16_bf16 v[48:63], v[36:39], v[252:255], v[48:63]
  ds_read_b64_tr_b16 v[32:33], v6 offset:4096
  ds_read_b64_tr_b16 v[34:35], v6 offset:4352
  v_accvgpr_write_b32 a12, v44
  v_accvgpr_write_b32 a13, v45
  v_accvgpr_write_b32 a14, v46
  v_accvgpr_write_b32 a15, v47
  s_waitcnt lgkmcnt(4)
  v_mfma_f32_32x32x16_bf16 v[64:79], v[16:19], v[112:115], 0
  ds_read_b64_tr_b16 v[36:37], v6 offset:5120
  ds_read_b64_tr_b16 v[38:39], v6 offset:5376
  v_mfma_f32_32x32x16_bf16 v[64:79], v[20:23], v[116:119], v[64:79]
  ds_read_b64_tr_b16 v[16:17], v6 offset:6144
  ds_read_b64_tr_b16 v[18:19], v6 offset:6400
  s_add_u32 m0, s30, 110592
  v_mfma_f32_32x32x16_bf16 v[64:79], v[24:27], v[120:123], v[64:79]
  ds_read_b64_tr_b16 v[20:21], v6 offset:7168
  ds_read_b64_tr_b16 v[22:23], v6 offset:7424
  buffer_load_dwordx4 v2, s[20:23], 0 offen offset:0 lds
  s_waitcnt lgkmcnt(4)
  v_mfma_f32_32x32x16_bf16 v[64:79], v[28:31], v[124:127], v[64:79]
  ds_read_b64_tr_b16 v[24:25], v6 offset:8192
  ds_read_b64_tr_b16 v[26:27], v6 offset:8448
  v_mul_f32 v10, v48, v48
  v_mul_f32 v11, v49, v49
  v_mul_f32 v12, v50, v50
  v_mfma_f32_32x32x16_bf16 v[64:79], v[32:35], v[128:131], v[64:79]
  ds_read_b64_tr_b16 v[28:29], v6 offset:9216
  ds_read_b64_tr_b16 v[30:31], v6 offset:9472
  v_mul_f32 v13, v51, v51
  v_fmaak_f32 v10, v10, v8, 0xc0135761
  v_fmaak_f32 v11, v11, v8, 0xc0135761
  v_fmaak_f32 v12, v12, v8, 0xc0135761
  v_mfma_f32_32x32x16_bf16 v[64:79], v[36:39], v[132:135], v[64:79]
  ds_read_b64_tr_b16 v[32:33], v6 offset:10240
  ds_read_b64_tr_b16 v[34:35], v6 offset:10496
  buffer_load_dwordx4 v2, s[20:23], s67 offen offset:1024 lds
  v_fmaak_f32 v13, v13, v8, 0xc0135761
  s_waitcnt lgkmcnt(4)
  v_mfma_f32_32x32x16_bf16 v[64:79], v[16:19], v[136:139], v[64:79]
  ds_read_b64_tr_b16 v[36:37], v6 offset:11264
  ds_read_b64_tr_b16 v[38:39], v6 offset:11520
  v_mul_f32 v10, v10, v48
  v_mul_f32 v11, v11, v49
  v_mul_f32 v12, v12, v50
  v_mfma_f32_32x32x16_bf16 v[64:79], v[20:23], v[140:143], v[64:79]
  ds_read_b64_tr_b16 v[16:17], v6 offset:12288
  ds_read_b64_tr_b16 v[18:19], v6 offset:12544
  v_mul_f32 v13, v13, v51
  v_exp_f32 v10, v10
  v_mfma_f32_32x32x16_bf16 v[64:79], v[24:27], v[144:147], v[64:79]
  ds_read_b64_tr_b16 v[20:21], v6 offset:13312
  ds_read_b64_tr_b16 v[22:23], v6 offset:13568
  buffer_load_dwordx4 v2, s[20:23], s68 offen offset:2048 lds
  v_exp_f32 v11, v11
  s_waitcnt lgkmcnt(4)
  v_mfma_f32_32x32x16_bf16 v[64:79], v[28:31], v[148:151], v[64:79]
  ds_read_b64_tr_b16 v[24:25], v6 offset:14336
  ds_read_b64_tr_b16 v[26:27], v6 offset:14592
  v_exp_f32 v12, v12
  v_mfma_f32_32x32x16_bf16 v[64:79], v[32:35], v[152:155], v[64:79]
  ds_read_b64_tr_b16 v[28:29], v6 offset:15360
  ds_read_b64_tr_b16 v[30:31], v6 offset:15616
  v_exp_f32 v13, v13
  v_add_f32 v10, 1.0, v10
  v_add_f32 v11, 1.0, v11
  v_add_f32 v12, 1.0, v12
  v_mfma_f32_32x32x16_bf16 v[64:79], v[36:39], v[156:159], v[64:79]
  ds_read_b64_tr_b16 v[32:33], v6 offset:16384
  ds_read_b64_tr_b16 v[34:35], v6 offset:16640
  buffer_load_dwordx4 v2, s[20:23], s69 offen offset:3072 lds
  s_waitcnt lgkmcnt(4)
  v_mfma_f32_32x32x16_bf16 v[64:79], v[16:19], v[160:163], v[64:79]
  ds_read_b64_tr_b16 v[36:37], v6 offset:17408
  ds_read_b64_tr_b16 v[38:39], v6 offset:17664
  v_add_f32 v13, 1.0, v13
  v_rcp_f32 v10, v10
  v_mfma_f32_32x32x16_bf16 v[64:79], v[20:23], v[164:167], v[64:79]
  ds_read_b64_tr_b16 v[16:17], v6 offset:18432
  ds_read_b64_tr_b16 v[18:19], v6 offset:18688
  v_rcp_f32 v11, v11
  v_rcp_f32 v12, v12
  s_add_u32 m0, s30, 114688
  v_mfma_f32_32x32x16_bf16 v[64:79], v[24:27], v[168:171], v[64:79]
  ds_read_b64_tr_b16 v[20:21], v6 offset:19456
  ds_read_b64_tr_b16 v[22:23], v6 offset:19712
  buffer_load_dwordx4 v2, s[20:23], s70 offen offset:0 lds
  s_waitcnt lgkmcnt(4)
  v_mfma_f32_32x32x16_bf16 v[64:79], v[28:31], v[172:175], v[64:79]
  ds_read_b64_tr_b16 v[24:25], v6 offset:20480
  ds_read_b64_tr_b16 v[26:27], v6 offset:20736
  v_rcp_f32 v13, v13
  v_mfma_f32_32x32x16_bf16 v[64:79], v[32:35], v[176:179], v[64:79]
  ds_read_b64_tr_b16 v[28:29], v6 offset:21504
  ds_read_b64_tr_b16 v[30:31], v6 offset:21760
  v_mul_f32 v48, v48, v10
  v_mul_f32 v49, v49, v11
  v_mul_f32 v50, v50, v12
  v_mul_f32 v51, v51, v13
  v_mul_f32 v10, v52, v52
  v_mfma_f32_32x32x16_bf16 v[64:79], v[36:39], v[180:183], v[64:79]
  ds_read_b64_tr_b16 v[32:33], v6 offset:22528
  ds_read_b64_tr_b16 v[34:35], v6 offset:22784
  buffer_load_dwordx4 v2, s[20:23], s71 offen offset:1024 lds
  s_waitcnt lgkmcnt(4)
  v_mfma_f32_32x32x16_bf16 v[64:79], v[16:19], v[184:187], v[64:79]
  ds_read_b64_tr_b16 v[36:37], v6 offset:23552
  ds_read_b64_tr_b16 v[38:39], v6 offset:23808
  v_mul_f32 v11, v53, v53
  v_mul_f32 v12, v54, v54
  v_mul_f32 v13, v55, v55
  v_mfma_f32_32x32x16_bf16 v[64:79], v[20:23], v[188:191], v[64:79]
  ds_read_b64_tr_b16 v[16:17], v6 offset:24576
  ds_read_b64_tr_b16 v[18:19], v6 offset:24832
  v_fmaak_f32 v10, v10, v8, 0xc0135761
  v_fmaak_f32 v11, v11, v8, 0xc0135761
  v_fmaak_f32 v12, v12, v8, 0xc0135761
  v_fmaak_f32 v13, v13, v8, 0xc0135761
  v_mfma_f32_32x32x16_bf16 v[64:79], v[24:27], v[192:195], v[64:79]
  ds_read_b64_tr_b16 v[20:21], v6 offset:25600
  ds_read_b64_tr_b16 v[22:23], v6 offset:25856
  buffer_load_dwordx4 v2, s[20:23], s72 offen offset:2048 lds
  s_waitcnt lgkmcnt(4)
  v_mfma_f32_32x32x16_bf16 v[64:79], v[28:31], v[196:199], v[64:79]
  ds_read_b64_tr_b16 v[24:25], v6 offset:26624
  ds_read_b64_tr_b16 v[26:27], v6 offset:26880
  v_mul_f32 v10, v10, v52
  v_mul_f32 v11, v11, v53
  v_mul_f32 v12, v12, v54
  v_mul_f32 v13, v13, v55
  v_mfma_f32_32x32x16_bf16 v[64:79], v[32:35], v[200:203], v[64:79]
  ds_read_b64_tr_b16 v[28:29], v6 offset:27648
  ds_read_b64_tr_b16 v[30:31], v6 offset:27904
  v_exp_f32 v10, v10
  v_exp_f32 v11, v11
  v_mfma_f32_32x32x16_bf16 v[64:79], v[36:39], v[204:207], v[64:79]
  ds_read_b64_tr_b16 v[32:33], v6 offset:28672
  ds_read_b64_tr_b16 v[34:35], v6 offset:28928
  buffer_load_dwordx4 v2, s[20:23], s73 offen offset:3072 lds
  s_waitcnt lgkmcnt(4)
  v_mfma_f32_32x32x16_bf16 v[64:79], v[16:19], v[208:211], v[64:79]
  ds_read_b64_tr_b16 v[36:37], v6 offset:29696
  ds_read_b64_tr_b16 v[38:39], v6 offset:29952
  v_exp_f32 v12, v12
  v_exp_f32 v13, v13
  v_mfma_f32_32x32x16_bf16 v[64:79], v[20:23], v[212:215], v[64:79]
  ds_read_b64_tr_b16 v[16:17], v6 offset:30720
  ds_read_b64_tr_b16 v[18:19], v6 offset:30976
  v_add_f32 v10, 1.0, v10
  v_add_f32 v11, 1.0, v11
  s_add_u32 m0, s30, 118784
  v_mfma_f32_32x32x16_bf16 v[64:79], v[24:27], v[216:219], v[64:79]
  ds_read_b64_tr_b16 v[20:21], v6 offset:31744
  ds_read_b64_tr_b16 v[22:23], v6 offset:32000
  buffer_load_dwordx4 v2, s[20:23], s74 offen offset:0 lds
  v_add_f32 v12, 1.0, v12
  s_waitcnt lgkmcnt(4)
  v_mfma_f32_32x32x16_bf16 v[64:79], v[28:31], v[220:223], v[64:79]
  ds_read_b64_tr_b16 v[24:25], v6 offset:32768
  ds_read_b64_tr_b16 v[26:27], v6 offset:33024
  v_add_f32 v13, 1.0, v13
  v_add_u32 v2, 64, v2
  v_mfma_f32_32x32x16_bf16 v[64:79], v[32:35], v[224:227], v[64:79]
  ds_read_b64_tr_b16 v[28:29], v6 offset:33792
  ds_read_b64_tr_b16 v[30:31], v6 offset:34048
  v_rcp_f32 v10, v10
  v_rcp_f32 v11, v11
  v_mfma_f32_32x32x16_bf16 v[64:79], v[36:39], v[228:231], v[64:79]
  ds_read_b64_tr_b16 v[32:33], v6 offset:34816
  ds_read_b64_tr_b16 v[34:35], v6 offset:35072
  v_rcp_f32 v12, v12
  v_rcp_f32 v13, v13
  v_mul_f32 v52, v52, v10
  s_waitcnt lgkmcnt(4)
  v_mfma_f32_32x32x16_bf16 v[64:79], v[16:19], v[232:235], v[64:79]
  ds_read_b64_tr_b16 v[36:37], v6 offset:35840
  ds_read_b64_tr_b16 v[38:39], v6 offset:36096
  v_mul_f32 v53, v53, v11
  v_mul_f32 v54, v54, v12
  v_mul_f32 v55, v55, v13
  v_mfma_f32_32x32x16_bf16 v[64:79], v[20:23], v[236:239], v[64:79]
  s_waitcnt vmcnt(9)
  s_barrier
  v_add_u32 v6, 73728, v4
  ds_read_b64_tr_b16 v[16:17], v6 offset:0
  ds_read_b64_tr_b16 v[18:19], v6 offset:256
  global_load_dword a255, v[96:97], off
  v_add_co_u32 v96, vcc, 0x2000, v96
  v_addc_co_u32 v97, vcc, 0, v97, vcc
  v_mfma_f32_32x32x16_bf16 v[64:79], v[24:27], v[240:243], v[64:79]
  ds_read_b64_tr_b16 v[20:21], v6 offset:1024
  ds_read_b64_tr_b16 v[22:23], v6 offset:1280
  v_mul_f32 v10, v56, v56
  v_mul_f32 v11, v57, v57
  v_mul_f32 v12, v58, v58
  v_mul_f32 v13, v59, v59
  s_waitcnt lgkmcnt(4)
  v_mfma_f32_32x32x16_bf16 v[64:79], v[28:31], v[244:247], v[64:79]
  ds_read_b64_tr_b16 v[24:25], v6 offset:2048
  ds_read_b64_tr_b16 v[26:27], v6 offset:2304
  v_fmaak_f32 v10, v10, v8, 0xc0135761
  v_fmaak_f32 v11, v11, v8, 0xc0135761
  v_fmaak_f32 v12, v12, v8, 0xc0135761
  v_fmaak_f32 v13, v13, v8, 0xc0135761
  v_mfma_f32_32x32x16_bf16 v[64:79], v[32:35], v[248:251], v[64:79]
  ds_read_b64_tr_b16 v[28:29], v6 offset:3072
  ds_read_b64_tr_b16 v[30:31], v6 offset:3328
  v_mul_f32 v10, v10, v56
  v_mul_f32 v11, v11, v57
  v_mul_f32 v12, v12, v58
  v_mul_f32 v13, v13, v59
  v_mfma_f32_32x32x16_bf16 v[64:79], v[36:39], v[252:255], v[64:79]
  ds_read_b64_tr_b16 v[32:33], v6 offset:4096
  ds_read_b64_tr_b16 v[34:35], v6 offset:4352
  v_exp_f32 v10, v10
  v_exp_f32 v11, v11
  s_waitcnt lgkmcnt(4)
  v_mfma_f32_32x32x16_bf16 v[80:95], v[16:19], v[112:115], 0
  ds_read_b64_tr_b16 v[36:37], v6 offset:5120
  ds_read_b64_tr_b16 v[38:39], v6 offset:5376
  v_mfma_f32_32x32x16_bf16 v[80:95], v[20:23], v[116:119], v[80:95]
  ds_read_b64_tr_b16 v[16:17], v6 offset:6144
  ds_read_b64_tr_b16 v[18:19], v6 offset:6400
  v_exp_f32 v12, v12
  v_exp_f32 v13, v13
  s_add_u32 m0, s30, 0
  v_mfma_f32_32x32x16_bf16 v[80:95], v[24:27], v[120:123], v[80:95]
  ds_read_b64_tr_b16 v[20:21], v6 offset:7168
  ds_read_b64_tr_b16 v[22:23], v6 offset:7424
  buffer_load_dwordx4 v2, s[16:19], 0 offen offset:0 lds
  s_waitcnt lgkmcnt(4)
  v_mfma_f32_32x32x16_bf16 v[80:95], v[28:31], v[124:127], v[80:95]
  ds_read_b64_tr_b16 v[24:25], v6 offset:8192
  ds_read_b64_tr_b16 v[26:27], v6 offset:8448
  v_add_f32 v10, 1.0, v10
  v_add_f32 v11, 1.0, v11
  v_mfma_f32_32x32x16_bf16 v[80:95], v[32:35], v[128:131], v[80:95]
  ds_read_b64_tr_b16 v[28:29], v6 offset:9216
  ds_read_b64_tr_b16 v[30:31], v6 offset:9472
  v_add_f32 v12, 1.0, v12
  v_add_f32 v13, 1.0, v13
  v_rcp_f32 v10, v10
  v_mfma_f32_32x32x16_bf16 v[80:95], v[36:39], v[132:135], v[80:95]
  ds_read_b64_tr_b16 v[32:33], v6 offset:10240
  ds_read_b64_tr_b16 v[34:35], v6 offset:10496
  buffer_load_dwordx4 v2, s[16:19], s67 offen offset:1024 lds
  s_waitcnt lgkmcnt(4)
  v_mfma_f32_32x32x16_bf16 v[80:95], v[16:19], v[136:139], v[80:95]
  ds_read_b64_tr_b16 v[36:37], v6 offset:11264
  ds_read_b64_tr_b16 v[38:39], v6 offset:11520
  v_rcp_f32 v11, v11
  v_rcp_f32 v12, v12
  v_mfma_f32_32x32x16_bf16 v[80:95], v[20:23], v[140:143], v[80:95]
  ds_read_b64_tr_b16 v[16:17], v6 offset:12288
  ds_read_b64_tr_b16 v[18:19], v6 offset:12544
  v_rcp_f32 v13, v13
  v_mul_f32 v56, v56, v10
  v_mfma_f32_32x32x16_bf16 v[80:95], v[24:27], v[144:147], v[80:95]
  ds_read_b64_tr_b16 v[20:21], v6 offset:13312
  ds_read_b64_tr_b16 v[22:23], v6 offset:13568
  buffer_load_dwordx4 v2, s[16:19], s68 offen offset:2048 lds
  s_waitcnt lgkmcnt(4)
  v_mfma_f32_32x32x16_bf16 v[80:95], v[28:31], v[148:151], v[80:95]
  ds_read_b64_tr_b16 v[24:25], v6 offset:14336
  ds_read_b64_tr_b16 v[26:27], v6 offset:14592
  v_mul_f32 v57, v57, v11
  v_mul_f32 v58, v58, v12
  v_mul_f32 v59, v59, v13
  v_mul_f32 v10, v60, v60
  v_mfma_f32_32x32x16_bf16 v[80:95], v[32:35], v[152:155], v[80:95]
  ds_read_b64_tr_b16 v[28:29], v6 offset:15360
  ds_read_b64_tr_b16 v[30:31], v6 offset:15616
  v_mul_f32 v11, v61, v61
  v_mul_f32 v12, v62, v62
  v_mul_f32 v13, v63, v63
  v_fmaak_f32 v10, v10, v8, 0xc0135761
  v_mfma_f32_32x32x16_bf16 v[80:95], v[36:39], v[156:159], v[80:95]
  ds_read_b64_tr_b16 v[32:33], v6 offset:16384
  ds_read_b64_tr_b16 v[34:35], v6 offset:16640
  buffer_load_dwordx4 v2, s[16:19], s69 offen offset:3072 lds
  s_waitcnt lgkmcnt(4)
  v_mfma_f32_32x32x16_bf16 v[80:95], v[16:19], v[160:163], v[80:95]
  ds_read_b64_tr_b16 v[36:37], v6 offset:17408
  ds_read_b64_tr_b16 v[38:39], v6 offset:17664
  v_fmaak_f32 v11, v11, v8, 0xc0135761
  v_fmaak_f32 v12, v12, v8, 0xc0135761
  v_fmaak_f32 v13, v13, v8, 0xc0135761
  v_mfma_f32_32x32x16_bf16 v[80:95], v[20:23], v[164:167], v[80:95]
  ds_read_b64_tr_b16 v[16:17], v6 offset:18432
  ds_read_b64_tr_b16 v[18:19], v6 offset:18688
  v_mul_f32 v10, v10, v60
  v_mul_f32 v11, v11, v61
  v_mul_f32 v12, v12, v62
  s_add_u32 m0, s30, 4096
  v_mfma_f32_32x32x16_bf16 v[80:95], v[24:27], v[168:171], v[80:95]
  ds_read_b64_tr_b16 v[20:21], v6 offset:19456
  ds_read_b64_tr_b16 v[22:23], v6 offset:19712
  buffer_load_dwordx4 v2, s[16:19], s70 offen offset:0 lds
  s_waitcnt lgkmcnt(4)
  v_mfma_f32_32x32x16_bf16 v[80:95], v[28:31], v[172:175], v[80:95]
  ds_read_b64_tr_b16 v[24:25], v6 offset:20480
  ds_read_b64_tr_b16 v[26:27], v6 offset:20736
  v_mul_f32 v13, v13, v63
  v_exp_f32 v10, v10
  v_mfma_f32_32x32x16_bf16 v[80:95], v[32:35], v[176:179], v[80:95]
  ds_read_b64_tr_b16 v[28:29], v6 offset:21504
  ds_read_b64_tr_b16 v[30:31], v6 offset:21760
  v_exp_f32 v11, v11
  v_exp_f32 v12, v12
  v_mfma_f32_32x32x16_bf16 v[80:95], v[36:39], v[180:183], v[80:95]
  ds_read_b64_tr_b16 v[32:33], v6 offset:22528
  ds_read_b64_tr_b16 v[34:35], v6 offset:22784
  buffer_load_dwordx4 v2, s[16:19], s71 offen offset:1024 lds
  s_waitcnt lgkmcnt(4)
  v_mfma_f32_32x32x16_bf16 v[80:95], v[16:19], v[184:187], v[80:95]
  ds_read_b64_tr_b16 v[36:37], v6 offset:23552
  ds_read_b64_tr_b16 v[38:39], v6 offset:23808
  v_exp_f32 v13, v13
  v_add_f32 v10, 1.0, v10
  v_mfma_f32_32x32x16_bf16 v[80:95], v[20:23], v[188:191], v[80:95]
  ds_read_b64_tr_b16 v[16:17], v6 offset:24576
  ds_read_b64_tr_b16 v[18:19], v6 offset:24832
  v_add_f32 v11, 1.0, v11
  v_add_f32 v12, 1.0, v12
  v_add_f32 v13, 1.0, v13
  v_rcp_f32 v10, v10
  v_mfma_f32_32x32x16_bf16 v[80:95], v[24:27], v[192:195], v[80:95]
  ds_read_b64_tr_b16 v[20:21], v6 offset:25600
  ds_read_b64_tr_b16 v[22:23], v6 offset:25856
  buffer_load_dwordx4 v2, s[16:19], s72 offen offset:2048 lds
  s_waitcnt lgkmcnt(4)
  v_mfma_f32_32x32x16_bf16 v[80:95], v[28:31], v[196:199], v[80:95]
  ds_read_b64_tr_b16 v[24:25], v6 offset:26624
  ds_read_b64_tr_b16 v[26:27], v6 offset:26880
  v_rcp_f32 v11, v11
  v_mfma_f32_32x32x16_bf16 v[80:95], v[32:35], v[200:203], v[80:95]
  ds_read_b64_tr_b16 v[28:29], v6 offset:27648
  ds_read_b64_tr_b16 v[30:31], v6 offset:27904
  v_rcp_f32 v12, v12
  v_rcp_f32 v13, v13
  v_mfma_f32_32x32x16_bf16 v[80:95], v[36:39], v[204:207], v[80:95]
  ds_read_b64_tr_b16 v[32:33], v6 offset:28672
  ds_read_b64_tr_b16 v[34:35], v6 offset:28928
  buffer_load_dwordx4 v2, s[16:19], s73 offen offset:3072 lds
  s_waitcnt lgkmcnt(4)
  v_mfma_f32_32x32x16_bf16 v[80:95], v[16:19], v[208:211], v[80:95]
  ds_read_b64_tr_b16 v[36:37], v6 offset:29696
  ds_read_b64_tr_b16 v[38:39], v6 offset:29952
  v_mul_f32 v60, v60, v10
  v_mul_f32 v61, v61, v11
  v_mul_f32 v62, v62, v12
  v_mfma_f32_32x32x16_bf16 v[80:95], v[20:23], v[212:215], v[80:95]
  ds_read_b64_tr_b16 v[16:17], v6 offset:30720
  ds_read_b64_tr_b16 v[18:19], v6 offset:30976
  v_mul_f32 v63, v63, v13
  v_mul_f32 v64, v64, v48
  v_mul_f32 v65, v65, v49
  s_add_u32 m0, s30, 8192
  v_mfma_f32_32x32x16_bf16 v[80:95], v[24:27], v[216:219], v[80:95]
  ds_read_b64_tr_b16 v[20:21], v6 offset:31744
  ds_read_b64_tr_b16 v[22:23], v6 offset:32000
  buffer_load_dwordx4 v2, s[16:19], s74 offen offset:0 lds
  s_waitcnt lgkmcnt(4)
  v_mfma_f32_32x32x16_bf16 v[80:95], v[28:31], v[220:223], v[80:95]
  ds_read_b64_tr_b16 v[24:25], v6 offset:32768
  ds_read_b64_tr_b16 v[26:27], v6 offset:33024
  v_mul_f32 v66, v66, v50
  v_mul_f32 v67, v67, v51
  v_mul_f32 v68, v68, v52
  v_mul_f32 v69, v69, v53
  v_mfma_f32_32x32x16_bf16 v[80:95], v[32:35], v[224:227], v[80:95]
  ds_read_b64_tr_b16 v[28:29], v6 offset:33792
  ds_read_b64_tr_b16 v[30:31], v6 offset:34048
  v_mul_f32 v70, v70, v54
  v_mul_f32 v71, v71, v55
  v_mul_f32 v72, v72, v56
  v_mul_f32 v73, v73, v57
  v_mfma_f32_32x32x16_bf16 v[80:95], v[36:39], v[228:231], v[80:95]
  ds_read_b64_tr_b16 v[32:33], v6 offset:34816
  ds_read_b64_tr_b16 v[34:35], v6 offset:35072
  buffer_load_dword a253, v7, s[16:19], 0 offen offset:512
  v_mul_f32 v74, v74, v58
  v_mul_f32 v75, v75, v59
  v_mul_f32 v76, v76, v60
  s_waitcnt lgkmcnt(4)
  v_mfma_f32_32x32x16_bf16 v[80:95], v[16:19], v[232:235], v[80:95]
  ds_read_b64_tr_b16 v[36:37], v6 offset:35840
  ds_read_b64_tr_b16 v[38:39], v6 offset:36096
  v_mul_f32 v77, v77, v61
  v_mul_f32 v78, v78, v62
  v_mul_f32 v79, v79, v63
  v_mfma_f32_32x32x16_bf16 v[80:95], v[20:23], v[236:239], v[80:95]
  s_waitcnt vmcnt(11)
  s_barrier
  v_add_u32 v6, 110592, v4
  ds_read_b64_tr_b16 v[16:17], v6 offset:0
  ds_read_b64_tr_b16 v[18:19], v6 offset:256
  v_cvt_pk_bf16_f32 v40, v64, v65
  v_mfma_f32_32x32x16_bf16 v[80:95], v[24:27], v[240:243], v[80:95]
  ds_read_b64_tr_b16 v[20:21], v6 offset:1024
  ds_read_b64_tr_b16 v[22:23], v6 offset:1280
  v_cvt_pk_bf16_f32 v41, v66, v67
  v_cvt_pk_bf16_f32 v42, v68, v69
  v_cvt_pk_bf16_f32 v43, v70, v71
  v_cvt_pk_bf16_f32 v44, v72, v73
  s_waitcnt lgkmcnt(4)
  v_mfma_f32_32x32x16_bf16 v[80:95], v[28:31], v[244:247], v[80:95]
  ds_read_b64_tr_b16 v[24:25], v6 offset:2048
  ds_read_b64_tr_b16 v[26:27], v6 offset:2304
  v_cvt_pk_bf16_f32 v45, v74, v75
  v_cvt_pk_bf16_f32 v46, v76, v77
  v_cvt_pk_bf16_f32 v47, v78, v79
  v_mfma_f32_32x32x16_bf16 v[80:95], v[32:35], v[248:251], v[80:95]
  ds_read_b64_tr_b16 v[28:29], v6 offset:3072
  ds_read_b64_tr_b16 v[30:31], v6 offset:3328
  v_accvgpr_write_b32 a16, v40
  v_accvgpr_write_b32 a17, v41
  v_accvgpr_write_b32 a18, v42
  v_accvgpr_write_b32 a19, v43
  v_mfma_f32_32x32x16_bf16 v[80:95], v[36:39], v[252:255], v[80:95]
  ds_read_b64_tr_b16 v[32:33], v6 offset:4096
  ds_read_b64_tr_b16 v[34:35], v6 offset:4352
  v_accvgpr_write_b32 a20, v44
  v_accvgpr_write_b32 a21, v45
  v_accvgpr_write_b32 a22, v46
  v_accvgpr_write_b32 a23, v47
  s_waitcnt lgkmcnt(4)
  v_mfma_f32_32x32x16_bf16 v[64:79], v[16:19], v[112:115], 0
  ds_read_b64_tr_b16 v[36:37], v6 offset:5120
  ds_read_b64_tr_b16 v[38:39], v6 offset:5376
  v_mfma_f32_32x32x16_bf16 v[64:79], v[20:23], v[116:119], v[64:79]
  ds_read_b64_tr_b16 v[16:17], v6 offset:6144
  ds_read_b64_tr_b16 v[18:19], v6 offset:6400
  s_add_u32 m0, s30, 36864
  v_mfma_f32_32x32x16_bf16 v[64:79], v[24:27], v[120:123], v[64:79]
  ds_read_b64_tr_b16 v[20:21], v6 offset:7168
  ds_read_b64_tr_b16 v[22:23], v6 offset:7424
  buffer_load_dwordx4 v2, s[20:23], 0 offen offset:0 lds
  s_waitcnt lgkmcnt(4)
  v_mfma_f32_32x32x16_bf16 v[64:79], v[28:31], v[124:127], v[64:79]
  ds_read_b64_tr_b16 v[24:25], v6 offset:8192
  ds_read_b64_tr_b16 v[26:27], v6 offset:8448
  v_mul_f32 v10, v80, v80
  v_mul_f32 v11, v81, v81
  v_mul_f32 v12, v82, v82
  v_mfma_f32_32x32x16_bf16 v[64:79], v[32:35], v[128:131], v[64:79]
  ds_read_b64_tr_b16 v[28:29], v6 offset:9216
  ds_read_b64_tr_b16 v[30:31], v6 offset:9472
  v_mul_f32 v13, v83, v83
  v_fmaak_f32 v10, v10, v8, 0xc0135761
  v_fmaak_f32 v11, v11, v8, 0xc0135761
  v_fmaak_f32 v12, v12, v8, 0xc0135761
  v_mfma_f32_32x32x16_bf16 v[64:79], v[36:39], v[132:135], v[64:79]
  ds_read_b64_tr_b16 v[32:33], v6 offset:10240
  ds_read_b64_tr_b16 v[34:35], v6 offset:10496
  buffer_load_dwordx4 v2, s[20:23], s67 offen offset:1024 lds
  v_fmaak_f32 v13, v13, v8, 0xc0135761
  s_waitcnt lgkmcnt(4)
  v_mfma_f32_32x32x16_bf16 v[64:79], v[16:19], v[136:139], v[64:79]
  ds_read_b64_tr_b16 v[36:37], v6 offset:11264
  ds_read_b64_tr_b16 v[38:39], v6 offset:11520
  v_mul_f32 v10, v10, v80
  v_mul_f32 v11, v11, v81
  v_mul_f32 v12, v12, v82
  v_mfma_f32_32x32x16_bf16 v[64:79], v[20:23], v[140:143], v[64:79]
  ds_read_b64_tr_b16 v[16:17], v6 offset:12288
  ds_read_b64_tr_b16 v[18:19], v6 offset:12544
  v_mul_f32 v13, v13, v83
  v_exp_f32 v10, v10
  v_mfma_f32_32x32x16_bf16 v[64:79], v[24:27], v[144:147], v[64:79]
  ds_read_b64_tr_b16 v[20:21], v6 offset:13312
  ds_read_b64_tr_b16 v[22:23], v6 offset:13568
  buffer_load_dwordx4 v2, s[20:23], s68 offen offset:2048 lds
  v_exp_f32 v11, v11
  s_waitcnt lgkmcnt(4)
  v_mfma_f32_32x32x16_bf16 v[64:79], v[28:31], v[148:151], v[64:79]
  ds_read_b64_tr_b16 v[24:25], v6 offset:14336
  ds_read_b64_tr_b16 v[26:27], v6 offset:14592
  v_exp_f32 v12, v12
  v_mfma_f32_32x32x16_bf16 v[64:79], v[32:35], v[152:155], v[64:79]
  ds_read_b64_tr_b16 v[28:29], v6 offset:15360
  ds_read_b64_tr_b16 v[30:31], v6 offset:15616
  v_exp_f32 v13, v13
  v_add_f32 v10, 1.0, v10
  v_add_f32 v11, 1.0, v11
  v_mfma_f32_32x32x16_bf16 v[64:79], v[36:39], v[156:159], v[64:79]
  ds_read_b64_tr_b16 v[32:33], v6 offset:16384
  ds_read_b64_tr_b16 v[34:35], v6 offset:16640
  buffer_load_dwordx4 v2, s[20:23], s69 offen offset:3072 lds
  v_add_f32 v12, 1.0, v12
  s_waitcnt lgkmcnt(4)
  v_mfma_f32_32x32x16_bf16 v[64:79], v[16:19], v[160:163], v[64:79]
  ds_read_b64_tr_b16 v[36:37], v6 offset:17408
  ds_read_b64_tr_b16 v[38:39], v6 offset:17664
  v_add_f32 v13, 1.0, v13
  v_rcp_f32 v10, v10
  v_mfma_f32_32x32x16_bf16 v[64:79], v[20:23], v[164:167], v[64:79]
  ds_read_b64_tr_b16 v[16:17], v6 offset:18432
  ds_read_b64_tr_b16 v[18:19], v6 offset:18688
  v_rcp_f32 v11, v11
  v_rcp_f32 v12, v12
  s_add_u32 m0, s30, 40960
  v_mfma_f32_32x32x16_bf16 v[64:79], v[24:27], v[168:171], v[64:79]
  ds_read_b64_tr_b16 v[20:21], v6 offset:19456
  ds_read_b64_tr_b16 v[22:23], v6 offset:19712
  buffer_load_dwordx4 v2, s[20:23], s70 offen offset:0 lds
  s_waitcnt lgkmcnt(4)
  v_mfma_f32_32x32x16_bf16 v[64:79], v[28:31], v[172:175], v[64:79]
  ds_read_b64_tr_b16 v[24:25], v6 offset:20480
  ds_read_b64_tr_b16 v[26:27], v6 offset:20736
  v_rcp_f32 v13, v13
  v_mfma_f32_32x32x16_bf16 v[64:79], v[32:35], v[176:179], v[64:79]
  ds_read_b64_tr_b16 v[28:29], v6 offset:21504
  ds_read_b64_tr_b16 v[30:31], v6 offset:21760
  v_mul_f32 v80, v80, v10
  v_mul_f32 v81, v81, v11
  v_mul_f32 v82, v82, v12
  v_mul_f32 v83, v83, v13
  v_mul_f32 v10, v84, v84
  v_mfma_f32_32x32x16_bf16 v[64:79], v[36:39], v[180:183], v[64:79]
  ds_read_b64_tr_b16 v[32:33], v6 offset:22528
  ds_read_b64_tr_b16 v[34:35], v6 offset:22784
  buffer_load_dwordx4 v2, s[20:23], s71 offen offset:1024 lds
  s_waitcnt lgkmcnt(4)
  v_mfma_f32_32x32x16_bf16 v[64:79], v[16:19], v[184:187], v[64:79]
  ds_read_b64_tr_b16 v[36:37], v6 offset:23552
  ds_read_b64_tr_b16 v[38:39], v6 offset:23808
  v_mul_f32 v11, v85, v85
  v_mul_f32 v12, v86, v86
  v_mul_f32 v13, v87, v87
  v_mfma_f32_32x32x16_bf16 v[64:79], v[20:23], v[188:191], v[64:79]
  ds_read_b64_tr_b16 v[16:17], v6 offset:24576
  ds_read_b64_tr_b16 v[18:19], v6 offset:24832
  v_fmaak_f32 v10, v10, v8, 0xc0135761
  v_fmaak_f32 v11, v11, v8, 0xc0135761
  v_fmaak_f32 v12, v12, v8, 0xc0135761
  v_fmaak_f32 v13, v13, v8, 0xc0135761
  v_mfma_f32_32x32x16_bf16 v[64:79], v[24:27], v[192:195], v[64:79]
  ds_read_b64_tr_b16 v[20:21], v6 offset:25600
  ds_read_b64_tr_b16 v[22:23], v6 offset:25856
  buffer_load_dwordx4 v2, s[20:23], s72 offen offset:2048 lds
  s_waitcnt lgkmcnt(4)
  v_mfma_f32_32x32x16_bf16 v[64:79], v[28:31], v[196:199], v[64:79]
  ds_read_b64_tr_b16 v[24:25], v6 offset:26624
  ds_read_b64_tr_b16 v[26:27], v6 offset:26880
  v_mul_f32 v10, v10, v84
  v_mul_f32 v11, v11, v85
  v_mul_f32 v12, v12, v86
  v_mfma_f32_32x32x16_bf16 v[64:79], v[32:35], v[200:203], v[64:79]
  ds_read_b64_tr_b16 v[28:29], v6 offset:27648
  ds_read_b64_tr_b16 v[30:31], v6 offset:27904
  v_mul_f32 v13, v13, v87
  v_exp_f32 v10, v10
  v_exp_f32 v11, v11
  v_mfma_f32_32x32x16_bf16 v[64:79], v[36:39], v[204:207], v[64:79]
  ds_read_b64_tr_b16 v[32:33], v6 offset:28672
  ds_read_b64_tr_b16 v[34:35], v6 offset:28928
  buffer_load_dwordx4 v2, s[20:23], s73 offen offset:3072 lds
  s_waitcnt lgkmcnt(4)
  v_mfma_f32_32x32x16_bf16 v[64:79], v[16:19], v[208:211], v[64:79]
  ds_read_b64_tr_b16 v[36:37], v6 offset:29696
  ds_read_b64_tr_b16 v[38:39], v6 offset:29952
  v_exp_f32 v12, v12
  v_exp_f32 v13, v13
  v_mfma_f32_32x32x16_bf16 v[64:79], v[20:23], v[212:215], v[64:79]
  ds_read_b64_tr_b16 v[16:17], v6 offset:30720
  ds_read_b64_tr_b16 v[18:19], v6 offset:30976
  v_add_f32 v10, 1.0, v10
  v_add_f32 v11, 1.0, v11
  s_add_u32 m0, s30, 45056
  v_mfma_f32_32x32x16_bf16 v[64:79], v[24:27], v[216:219], v[64:79]
  ds_read_b64_tr_b16 v[20:21], v6 offset:31744
  ds_read_b64_tr_b16 v[22:23], v6 offset:32000
  buffer_load_dwordx4 v2, s[20:23], s74 offen offset:0 lds
  s_waitcnt lgkmcnt(4)
  v_mfma_f32_32x32x16_bf16 v[64:79], v[28:31], v[220:223], v[64:79]
  ds_read_b64_tr_b16 v[24:25], v6 offset:32768
  ds_read_b64_tr_b16 v[26:27], v6 offset:33024
  v_add_f32 v12, 1.0, v12
  v_add_f32 v13, 1.0, v13
  v_add_u32 v2, 64, v2
  v_mfma_f32_32x32x16_bf16 v[64:79], v[32:35], v[224:227], v[64:79]
  ds_read_b64_tr_b16 v[28:29], v6 offset:33792
  ds_read_b64_tr_b16 v[30:31], v6 offset:34048
  v_rcp_f32 v10, v10
  v_rcp_f32 v11, v11
  v_mfma_f32_32x32x16_bf16 v[64:79], v[36:39], v[228:231], v[64:79]
  ds_read_b64_tr_b16 v[32:33], v6 offset:34816
  ds_read_b64_tr_b16 v[34:35], v6 offset:35072
  buffer_load_dword a253, v7, s[20:23], 0 offen offset:512
  v_rcp_f32 v12, v12
  v_rcp_f32 v13, v13
  s_waitcnt lgkmcnt(4)
  v_mfma_f32_32x32x16_bf16 v[64:79], v[16:19], v[232:235], v[64:79]
  ds_read_b64_tr_b16 v[36:37], v6 offset:35840
  ds_read_b64_tr_b16 v[38:39], v6 offset:36096
  v_mul_f32 v84, v84, v10
  v_mul_f32 v85, v85, v11
  v_mul_f32 v86, v86, v12
  v_mfma_f32_32x32x16_bf16 v[64:79], v[20:23], v[236:239], v[64:79]
  s_waitcnt vmcnt(11)
  s_barrier
  v_add_u32 v6, 0, v4
  ds_read_b64_tr_b16 v[16:17], v6 offset:0
  ds_read_b64_tr_b16 v[18:19], v6 offset:256
  v_mul_f32 v87, v87, v13
  v_mfma_f32_32x32x16_bf16 v[64:79], v[24:27], v[240:243], v[64:79]
  ds_read_b64_tr_b16 v[20:21], v6 offset:1024
  ds_read_b64_tr_b16 v[22:23], v6 offset:1280
  v_mul_f32 v10, v88, v88
  v_mul_f32 v11, v89, v89
  v_mul_f32 v12, v90, v90
  v_mul_f32 v13, v91, v91
  s_waitcnt lgkmcnt(4)
  v_mfma_f32_32x32x16_bf16 v[64:79], v[28:31], v[244:247], v[64:79]
  ds_read_b64_tr_b16 v[24:25], v6 offset:2048
  ds_read_b64_tr_b16 v[26:27], v6 offset:2304
  v_fmaak_f32 v10, v10, v8, 0xc0135761
  v_fmaak_f32 v11, v11, v8, 0xc0135761
  v_fmaak_f32 v12, v12, v8, 0xc0135761
  v_fmaak_f32 v13, v13, v8, 0xc0135761
  v_mfma_f32_32x32x16_bf16 v[64:79], v[32:35], v[248:251], v[64:79]
  ds_read_b64_tr_b16 v[28:29], v6 offset:3072
  ds_read_b64_tr_b16 v[30:31], v6 offset:3328
  v_mul_f32 v10, v10, v88
  v_mul_f32 v11, v11, v89
  v_mul_f32 v12, v12, v90
  v_mul_f32 v13, v13, v91
  v_mfma_f32_32x32x16_bf16 v[64:79], v[36:39], v[252:255], v[64:79]
  ds_read_b64_tr_b16 v[32:33], v6 offset:4096
  ds_read_b64_tr_b16 v[34:35], v6 offset:4352
  v_exp_f32 v10, v10
  v_exp_f32 v11, v11
  s_waitcnt lgkmcnt(4)
  v_mfma_f32_32x32x16_bf16 v[48:63], v[16:19], v[112:115], 0
  ds_read_b64_tr_b16 v[36:37], v6 offset:5120
  ds_read_b64_tr_b16 v[38:39], v6 offset:5376
  v_mfma_f32_32x32x16_bf16 v[48:63], v[20:23], v[116:119], v[48:63]
  ds_read_b64_tr_b16 v[16:17], v6 offset:6144
  ds_read_b64_tr_b16 v[18:19], v6 offset:6400
  v_exp_f32 v12, v12
  v_exp_f32 v13, v13
  s_add_u32 m0, s30, 73728
  v_mfma_f32_32x32x16_bf16 v[48:63], v[24:27], v[120:123], v[48:63]
  ds_read_b64_tr_b16 v[20:21], v6 offset:7168
  ds_read_b64_tr_b16 v[22:23], v6 offset:7424
  buffer_load_dwordx4 v2, s[16:19], 0 offen offset:0 lds
  s_waitcnt lgkmcnt(4)
  v_mfma_f32_32x32x16_bf16 v[48:63], v[28:31], v[124:127], v[48:63]
  ds_read_b64_tr_b16 v[24:25], v6 offset:8192
  ds_read_b64_tr_b16 v[26:27], v6 offset:8448
  v_add_f32 v10, 1.0, v10
  v_add_f32 v11, 1.0, v11
  v_mfma_f32_32x32x16_bf16 v[48:63], v[32:35], v[128:131], v[48:63]
  ds_read_b64_tr_b16 v[28:29], v6 offset:9216
  ds_read_b64_tr_b16 v[30:31], v6 offset:9472
  v_add_f32 v12, 1.0, v12
  v_add_f32 v13, 1.0, v13
  v_rcp_f32 v10, v10
  v_mfma_f32_32x32x16_bf16 v[48:63], v[36:39], v[132:135], v[48:63]
  ds_read_b64_tr_b16 v[32:33], v6 offset:10240
  ds_read_b64_tr_b16 v[34:35], v6 offset:10496
  buffer_load_dwordx4 v2, s[16:19], s67 offen offset:1024 lds
  s_waitcnt lgkmcnt(4)
  v_mfma_f32_32x32x16_bf16 v[48:63], v[16:19], v[136:139], v[48:63]
  ds_read_b64_tr_b16 v[36:37], v6 offset:11264
  ds_read_b64_tr_b16 v[38:39], v6 offset:11520
  v_rcp_f32 v11, v11
  v_rcp_f32 v12, v12
  v_mfma_f32_32x32x16_bf16 v[48:63], v[20:23], v[140:143], v[48:63]
  ds_read_b64_tr_b16 v[16:17], v6 offset:12288
  ds_read_b64_tr_b16 v[18:19], v6 offset:12544
  v_rcp_f32 v13, v13
  v_mul_f32 v88, v88, v10
  v_mfma_f32_32x32x16_bf16 v[48:63], v[24:27], v[144:147], v[48:63]
  ds_read_b64_tr_b16 v[20:21], v6 offset:13312
  ds_read_b64_tr_b16 v[22:23], v6 offset:13568
  buffer_load_dwordx4 v2, s[16:19], s68 offen offset:2048 lds
  s_waitcnt lgkmcnt(4)
  v_mfma_f32_32x32x16_bf16 v[48:63], v[28:31], v[148:151], v[48:63]
  ds_read_b64_tr_b16 v[24:25], v6 offset:14336
  ds_read_b64_tr_b16 v[26:27], v6 offset:14592
  v_mul_f32 v89, v89, v11
  v_mul_f32 v90, v90, v12
  v_mul_f32 v91, v91, v13
  v_mfma_f32_32x32x16_bf16 v[48:63], v[32:35], v[152:155], v[48:63]
  ds_read_b64_tr_b16 v[28:29], v6 offset:15360
  ds_read_b64_tr_b16 v[30:31], v6 offset:15616
  v_mul_f32 v10, v92, v92
  v_mul_f32 v11, v93, v93
  v_mul_f32 v12, v94, v94
  v_mul_f32 v13, v95, v95
  v_mfma_f32_32x32x16_bf16 v[48:63], v[36:39], v[156:159], v[48:63]
  ds_read_b64_tr_b16 v[32:33], v6 offset:16384
  ds_read_b64_tr_b16 v[34:35], v6 offset:16640
  buffer_load_dwordx4 v2, s[16:19], s69 offen offset:3072 lds
  s_waitcnt lgkmcnt(4)
  v_mfma_f32_32x32x16_bf16 v[48:63], v[16:19], v[160:163], v[48:63]
  ds_read_b64_tr_b16 v[36:37], v6 offset:17408
  ds_read_b64_tr_b16 v[38:39], v6 offset:17664
  v_fmaak_f32 v10, v10, v8, 0xc0135761
  v_fmaak_f32 v11, v11, v8, 0xc0135761
  v_fmaak_f32 v12, v12, v8, 0xc0135761
  v_mfma_f32_32x32x16_bf16 v[48:63], v[20:23], v[164:167], v[48:63]
  ds_read_b64_tr_b16 v[16:17], v6 offset:18432
  ds_read_b64_tr_b16 v[18:19], v6 offset:18688
  v_fmaak_f32 v13, v13, v8, 0xc0135761
  v_mul_f32 v10, v10, v92
  v_mul_f32 v11, v11, v93
  s_add_u32 m0, s30, 77824
  v_mfma_f32_32x32x16_bf16 v[48:63], v[24:27], v[168:171], v[48:63]
  ds_read_b64_tr_b16 v[20:21], v6 offset:19456
  ds_read_b64_tr_b16 v[22:23], v6 offset:19712
  buffer_load_dwordx4 v2, s[16:19], s70 offen offset:0 lds
  s_waitcnt lgkmcnt(4)
  v_mfma_f32_32x32x16_bf16 v[48:63], v[28:31], v[172:175], v[48:63]
  ds_read_b64_tr_b16 v[24:25], v6 offset:20480
  ds_read_b64_tr_b16 v[26:27], v6 offset:20736
  v_mul_f32 v12, v12, v94
  v_mul_f32 v13, v13, v95
  v_exp_f32 v10, v10
  v_mfma_f32_32x32x16_bf16 v[48:63], v[32:35], v[176:179], v[48:63]
  ds_read_b64_tr_b16 v[28:29], v6 offset:21504
  ds_read_b64_tr_b16 v[30:31], v6 offset:21760
  v_exp_f32 v11, v11
  v_exp_f32 v12, v12
  v_mfma_f32_32x32x16_bf16 v[48:63], v[36:39], v[180:183], v[48:63]
  ds_read_b64_tr_b16 v[32:33], v6 offset:22528
  ds_read_b64_tr_b16 v[34:35], v6 offset:22784
  buffer_load_dwordx4 v2, s[16:19], s71 offen offset:1024 lds
  s_waitcnt lgkmcnt(4)
  v_mfma_f32_32x32x16_bf16 v[48:63], v[16:19], v[184:187], v[48:63]
  ds_read_b64_tr_b16 v[36:37], v6 offset:23552
  ds_read_b64_tr_b16 v[38:39], v6 offset:23808
  v_exp_f32 v13, v13
  v_add_f32 v10, 1.0, v10
  v_mfma_f32_32x32x16_bf16 v[48:63], v[20:23], v[188:191], v[48:63]
  ds_read_b64_tr_b16 v[16:17], v6 offset:24576
  ds_read_b64_tr_b16 v[18:19], v6 offset:24832
  v_add_f32 v11, 1.0, v11
  v_add_f32 v12, 1.0, v12
  v_add_f32 v13, 1.0, v13
  v_mfma_f32_32x32x16_bf16 v[48:63], v[24:27], v[192:195], v[48:63]
  ds_read_b64_tr_b16 v[20:21], v6 offset:25600
  ds_read_b64_tr_b16 v[22:23], v6 offset:25856
  buffer_load_dwordx4 v2, s[16:19], s72 offen offset:2048 lds
  s_waitcnt lgkmcnt(4)
  v_mfma_f32_32x32x16_bf16 v[48:63], v[28:31], v[196:199], v[48:63]
  ds_read_b64_tr_b16 v[24:25], v6 offset:26624
  ds_read_b64_tr_b16 v[26:27], v6 offset:26880
  v_rcp_f32 v10, v10
  v_rcp_f32 v11, v11
  v_mfma_f32_32x32x16_bf16 v[48:63], v[32:35], v[200:203], v[48:63]
  ds_read_b64_tr_b16 v[28:29], v6 offset:27648
  ds_read_b64_tr_b16 v[30:31], v6 offset:27904
  v_rcp_f32 v12, v12
  v_rcp_f32 v13, v13
  v_mfma_f32_32x32x16_bf16 v[48:63], v[36:39], v[204:207], v[48:63]
  ds_read_b64_tr_b16 v[32:33], v6 offset:28672
  ds_read_b64_tr_b16 v[34:35], v6 offset:28928
  buffer_load_dwordx4 v2, s[16:19], s73 offen offset:3072 lds
  s_waitcnt lgkmcnt(4)
  v_mfma_f32_32x32x16_bf16 v[48:63], v[16:19], v[208:211], v[48:63]
  ds_read_b64_tr_b16 v[36:37], v6 offset:29696
  ds_read_b64_tr_b16 v[38:39], v6 offset:29952
  v_mul_f32 v92, v92, v10
  v_mul_f32 v93, v93, v11
  v_mul_f32 v94, v94, v12
  v_mfma_f32_32x32x16_bf16 v[48:63], v[20:23], v[212:215], v[48:63]
  ds_read_b64_tr_b16 v[16:17], v6 offset:30720
  ds_read_b64_tr_b16 v[18:19], v6 offset:30976
  v_mul_f32 v95, v95, v13
  v_mul_f32 v64, v64, v80
  v_mul_f32 v65, v65, v81
  s_add_u32 m0, s30, 81920
  v_mfma_f32_32x32x16_bf16 v[48:63], v[24:27], v[216:219], v[48:63]
  ds_read_b64_tr_b16 v[20:21], v6 offset:31744
  ds_read_b64_tr_b16 v[22:23], v6 offset:32000
  buffer_load_dwordx4 v2, s[16:19], s74 offen offset:0 lds
  s_waitcnt lgkmcnt(4)
  v_mfma_f32_32x32x16_bf16 v[48:63], v[28:31], v[220:223], v[48:63]
  ds_read_b64_tr_b16 v[24:25], v6 offset:32768
  ds_read_b64_tr_b16 v[26:27], v6 offset:33024
  v_mul_f32 v66, v66, v82
  v_mul_f32 v67, v67, v83
  v_mul_f32 v68, v68, v84
  v_mfma_f32_32x32x16_bf16 v[48:63], v[32:35], v[224:227], v[48:63]
  ds_read_b64_tr_b16 v[28:29], v6 offset:33792
  ds_read_b64_tr_b16 v[30:31], v6 offset:34048
  v_mul_f32 v69, v69, v85
  v_mul_f32 v70, v70, v86
  v_mul_f32 v71, v71, v87
  v_mul_f32 v72, v72, v88
  v_mfma_f32_32x32x16_bf16 v[48:63], v[36:39], v[228:231], v[48:63]
  ds_read_b64_tr_b16 v[32:33], v6 offset:34816
  ds_read_b64_tr_b16 v[34:35], v6 offset:35072
  v_mul_f32 v73, v73, v89
  v_mul_f32 v74, v74, v90
  v_mul_f32 v75, v75, v91
  v_mul_f32 v76, v76, v92
  s_waitcnt lgkmcnt(4)
  v_mfma_f32_32x32x16_bf16 v[48:63], v[16:19], v[232:235], v[48:63]
  ds_read_b64_tr_b16 v[36:37], v6 offset:35840
  ds_read_b64_tr_b16 v[38:39], v6 offset:36096
  v_mul_f32 v77, v77, v93
  v_mul_f32 v78, v78, v94
  v_mul_f32 v79, v79, v95
  v_mfma_f32_32x32x16_bf16 v[48:63], v[20:23], v[236:239], v[48:63]
  s_waitcnt vmcnt(10)
  s_barrier
  v_add_u32 v6, 36864, v4
  ds_read_b64_tr_b16 v[16:17], v6 offset:0
  ds_read_b64_tr_b16 v[18:19], v6 offset:256
  v_cvt_pk_bf16_f32 v40, v64, v65
  v_mfma_f32_32x32x16_bf16 v[48:63], v[24:27], v[240:243], v[48:63]
  ds_read_b64_tr_b16 v[20:21], v6 offset:1024
  ds_read_b64_tr_b16 v[22:23], v6 offset:1280
  v_cvt_pk_bf16_f32 v41, v66, v67
  v_cvt_pk_bf16_f32 v42, v68, v69
  v_cvt_pk_bf16_f32 v43, v70, v71
  v_cvt_pk_bf16_f32 v44, v72, v73
  s_waitcnt lgkmcnt(4)
  v_mfma_f32_32x32x16_bf16 v[48:63], v[28:31], v[244:247], v[48:63]
  ds_read_b64_tr_b16 v[24:25], v6 offset:2048
  ds_read_b64_tr_b16 v[26:27], v6 offset:2304
  v_cvt_pk_bf16_f32 v45, v74, v75
  v_cvt_pk_bf16_f32 v46, v76, v77
  v_cvt_pk_bf16_f32 v47, v78, v79
  v_mfma_f32_32x32x16_bf16 v[48:63], v[32:35], v[248:251], v[48:63]
  ds_read_b64_tr_b16 v[28:29], v6 offset:3072
  ds_read_b64_tr_b16 v[30:31], v6 offset:3328
  v_accvgpr_write_b32 a24, v40
  v_accvgpr_write_b32 a25, v41
  v_accvgpr_write_b32 a26, v42
  v_accvgpr_write_b32 a27, v43
  v_mfma_f32_32x32x16_bf16 v[48:63], v[36:39], v[252:255], v[48:63]
  ds_read_b64_tr_b16 v[32:33], v6 offset:4096
  ds_read_b64_tr_b16 v[34:35], v6 offset:4352
  v_accvgpr_write_b32 a28, v44
  v_accvgpr_write_b32 a29, v45
  v_accvgpr_write_b32 a30, v46
  v_accvgpr_write_b32 a31, v47
  s_waitcnt lgkmcnt(4)
  v_mfma_f32_32x32x16_bf16 v[64:79], v[16:19], v[112:115], 0
  ds_read_b64_tr_b16 v[36:37], v6 offset:5120
  ds_read_b64_tr_b16 v[38:39], v6 offset:5376
  v_mfma_f32_32x32x16_bf16 v[64:79], v[20:23], v[116:119], v[64:79]
  ds_read_b64_tr_b16 v[16:17], v6 offset:6144
  ds_read_b64_tr_b16 v[18:19], v6 offset:6400
  s_add_u32 m0, s30, 110592
  v_mfma_f32_32x32x16_bf16 v[64:79], v[24:27], v[120:123], v[64:79]
  ds_read_b64_tr_b16 v[20:21], v6 offset:7168
  ds_read_b64_tr_b16 v[22:23], v6 offset:7424
  buffer_load_dwordx4 v2, s[20:23], 0 offen offset:0 lds
  s_waitcnt lgkmcnt(4)
  v_mfma_f32_32x32x16_bf16 v[64:79], v[28:31], v[124:127], v[64:79]
  ds_read_b64_tr_b16 v[24:25], v6 offset:8192
  ds_read_b64_tr_b16 v[26:27], v6 offset:8448
  v_mul_f32 v10, v48, v48
  v_mul_f32 v11, v49, v49
  v_mul_f32 v12, v50, v50
  v_mfma_f32_32x32x16_bf16 v[64:79], v[32:35], v[128:131], v[64:79]
  ds_read_b64_tr_b16 v[28:29], v6 offset:9216
  ds_read_b64_tr_b16 v[30:31], v6 offset:9472
  v_mul_f32 v13, v51, v51
  v_fmaak_f32 v10, v10, v8, 0xc0135761
  v_fmaak_f32 v11, v11, v8, 0xc0135761
  v_fmaak_f32 v12, v12, v8, 0xc0135761
  v_mfma_f32_32x32x16_bf16 v[64:79], v[36:39], v[132:135], v[64:79]
  ds_read_b64_tr_b16 v[32:33], v6 offset:10240
  ds_read_b64_tr_b16 v[34:35], v6 offset:10496
  buffer_load_dwordx4 v2, s[20:23], s67 offen offset:1024 lds
  v_fmaak_f32 v13, v13, v8, 0xc0135761
  s_waitcnt lgkmcnt(4)
  v_mfma_f32_32x32x16_bf16 v[64:79], v[16:19], v[136:139], v[64:79]
  ds_read_b64_tr_b16 v[36:37], v6 offset:11264
  ds_read_b64_tr_b16 v[38:39], v6 offset:11520
  v_mul_f32 v10, v10, v48
  v_mul_f32 v11, v11, v49
  v_mul_f32 v12, v12, v50
  v_mfma_f32_32x32x16_bf16 v[64:79], v[20:23], v[140:143], v[64:79]
  ds_read_b64_tr_b16 v[16:17], v6 offset:12288
  ds_read_b64_tr_b16 v[18:19], v6 offset:12544
  v_mul_f32 v13, v13, v51
  v_exp_f32 v10, v10
  v_mfma_f32_32x32x16_bf16 v[64:79], v[24:27], v[144:147], v[64:79]
  ds_read_b64_tr_b16 v[20:21], v6 offset:13312
  ds_read_b64_tr_b16 v[22:23], v6 offset:13568
  buffer_load_dwordx4 v2, s[20:23], s68 offen offset:2048 lds
  v_exp_f32 v11, v11
  s_waitcnt lgkmcnt(4)
  v_mfma_f32_32x32x16_bf16 v[64:79], v[28:31], v[148:151], v[64:79]
  ds_read_b64_tr_b16 v[24:25], v6 offset:14336
  ds_read_b64_tr_b16 v[26:27], v6 offset:14592
  v_exp_f32 v12, v12
  v_mfma_f32_32x32x16_bf16 v[64:79], v[32:35], v[152:155], v[64:79]
  ds_read_b64_tr_b16 v[28:29], v6 offset:15360
  ds_read_b64_tr_b16 v[30:31], v6 offset:15616
  v_exp_f32 v13, v13
  v_add_f32 v10, 1.0, v10
  v_add_f32 v11, 1.0, v11
  v_add_f32 v12, 1.0, v12
  v_mfma_f32_32x32x16_bf16 v[64:79], v[36:39], v[156:159], v[64:79]
  ds_read_b64_tr_b16 v[32:33], v6 offset:16384
  ds_read_b64_tr_b16 v[34:35], v6 offset:16640
  buffer_load_dwordx4 v2, s[20:23], s69 offen offset:3072 lds
  s_waitcnt lgkmcnt(4)
  v_mfma_f32_32x32x16_bf16 v[64:79], v[16:19], v[160:163], v[64:79]
  ds_read_b64_tr_b16 v[36:37], v6 offset:17408
  ds_read_b64_tr_b16 v[38:39], v6 offset:17664
  v_add_f32 v13, 1.0, v13
  v_rcp_f32 v10, v10
  v_mfma_f32_32x32x16_bf16 v[64:79], v[20:23], v[164:167], v[64:79]
  ds_read_b64_tr_b16 v[16:17], v6 offset:18432
  ds_read_b64_tr_b16 v[18:19], v6 offset:18688
  v_rcp_f32 v11, v11
  v_rcp_f32 v12, v12
  s_add_u32 m0, s30, 114688
  v_mfma_f32_32x32x16_bf16 v[64:79], v[24:27], v[168:171], v[64:79]
  ds_read_b64_tr_b16 v[20:21], v6 offset:19456
  ds_read_b64_tr_b16 v[22:23], v6 offset:19712
  buffer_load_dwordx4 v2, s[20:23], s70 offen offset:0 lds
  s_waitcnt lgkmcnt(4)
  v_mfma_f32_32x32x16_bf16 v[64:79], v[28:31], v[172:175], v[64:79]
  ds_read_b64_tr_b16 v[24:25], v6 offset:20480
  ds_read_b64_tr_b16 v[26:27], v6 offset:20736
  v_rcp_f32 v13, v13
  v_mfma_f32_32x32x16_bf16 v[64:79], v[32:35], v[176:179], v[64:79]
  ds_read_b64_tr_b16 v[28:29], v6 offset:21504
  ds_read_b64_tr_b16 v[30:31], v6 offset:21760
  v_mul_f32 v48, v48, v10
  v_mul_f32 v49, v49, v11
  v_mul_f32 v50, v50, v12
  v_mul_f32 v51, v51, v13
  v_mul_f32 v10, v52, v52
  v_mfma_f32_32x32x16_bf16 v[64:79], v[36:39], v[180:183], v[64:79]
  ds_read_b64_tr_b16 v[32:33], v6 offset:22528
  ds_read_b64_tr_b16 v[34:35], v6 offset:22784
  buffer_load_dwordx4 v2, s[20:23], s71 offen offset:1024 lds
  s_waitcnt lgkmcnt(4)
  v_mfma_f32_32x32x16_bf16 v[64:79], v[16:19], v[184:187], v[64:79]
  ds_read_b64_tr_b16 v[36:37], v6 offset:23552
  ds_read_b64_tr_b16 v[38:39], v6 offset:23808
  v_mul_f32 v11, v53, v53
  v_mul_f32 v12, v54, v54
  v_mul_f32 v13, v55, v55
  v_mfma_f32_32x32x16_bf16 v[64:79], v[20:23], v[188:191], v[64:79]
  ds_read_b64_tr_b16 v[16:17], v6 offset:24576
  ds_read_b64_tr_b16 v[18:19], v6 offset:24832
  v_fmaak_f32 v10, v10, v8, 0xc0135761
  v_fmaak_f32 v11, v11, v8, 0xc0135761
  v_fmaak_f32 v12, v12, v8, 0xc0135761
  v_fmaak_f32 v13, v13, v8, 0xc0135761
  v_mfma_f32_32x32x16_bf16 v[64:79], v[24:27], v[192:195], v[64:79]
  ds_read_b64_tr_b16 v[20:21], v6 offset:25600
  ds_read_b64_tr_b16 v[22:23], v6 offset:25856
  buffer_load_dwordx4 v2, s[20:23], s72 offen offset:2048 lds
  s_waitcnt lgkmcnt(4)
  v_mfma_f32_32x32x16_bf16 v[64:79], v[28:31], v[196:199], v[64:79]
  ds_read_b64_tr_b16 v[24:25], v6 offset:26624
  ds_read_b64_tr_b16 v[26:27], v6 offset:26880
  v_mul_f32 v10, v10, v52
  v_mul_f32 v11, v11, v53
  v_mul_f32 v12, v12, v54
  v_mul_f32 v13, v13, v55
  v_mfma_f32_32x32x16_bf16 v[64:79], v[32:35], v[200:203], v[64:79]
  ds_read_b64_tr_b16 v[28:29], v6 offset:27648
  ds_read_b64_tr_b16 v[30:31], v6 offset:27904
  v_exp_f32 v10, v10
  v_exp_f32 v11, v11
  v_mfma_f32_32x32x16_bf16 v[64:79], v[36:39], v[204:207], v[64:79]
  ds_read_b64_tr_b16 v[32:33], v6 offset:28672
  ds_read_b64_tr_b16 v[34:35], v6 offset:28928
  buffer_load_dwordx4 v2, s[20:23], s73 offen offset:3072 lds
  s_waitcnt lgkmcnt(4)
  v_mfma_f32_32x32x16_bf16 v[64:79], v[16:19], v[208:211], v[64:79]
  ds_read_b64_tr_b16 v[36:37], v6 offset:29696
  ds_read_b64_tr_b16 v[38:39], v6 offset:29952
  v_exp_f32 v12, v12
  v_exp_f32 v13, v13
  v_mfma_f32_32x32x16_bf16 v[64:79], v[20:23], v[212:215], v[64:79]
  ds_read_b64_tr_b16 v[16:17], v6 offset:30720
  ds_read_b64_tr_b16 v[18:19], v6 offset:30976
  v_add_f32 v10, 1.0, v10
  v_add_f32 v11, 1.0, v11
  s_add_u32 m0, s30, 118784
  v_mfma_f32_32x32x16_bf16 v[64:79], v[24:27], v[216:219], v[64:79]
  ds_read_b64_tr_b16 v[20:21], v6 offset:31744
  ds_read_b64_tr_b16 v[22:23], v6 offset:32000
  buffer_load_dwordx4 v2, s[20:23], s74 offen offset:0 lds
  v_add_f32 v12, 1.0, v12
  s_waitcnt lgkmcnt(4)
  v_mfma_f32_32x32x16_bf16 v[64:79], v[28:31], v[220:223], v[64:79]
  ds_read_b64_tr_b16 v[24:25], v6 offset:32768
  ds_read_b64_tr_b16 v[26:27], v6 offset:33024
  v_add_f32 v13, 1.0, v13
  v_add_u32 v2, 64, v2
  v_mfma_f32_32x32x16_bf16 v[64:79], v[32:35], v[224:227], v[64:79]
  ds_read_b64_tr_b16 v[28:29], v6 offset:33792
  ds_read_b64_tr_b16 v[30:31], v6 offset:34048
  v_rcp_f32 v10, v10
  v_rcp_f32 v11, v11
  v_mfma_f32_32x32x16_bf16 v[64:79], v[36:39], v[228:231], v[64:79]
  ds_read_b64_tr_b16 v[32:33], v6 offset:34816
  ds_read_b64_tr_b16 v[34:35], v6 offset:35072
  v_rcp_f32 v12, v12
  v_rcp_f32 v13, v13
  v_mul_f32 v52, v52, v10
  s_waitcnt lgkmcnt(4)
  v_mfma_f32_32x32x16_bf16 v[64:79], v[16:19], v[232:235], v[64:79]
  ds_read_b64_tr_b16 v[36:37], v6 offset:35840
  ds_read_b64_tr_b16 v[38:39], v6 offset:36096
  v_mul_f32 v53, v53, v11
  v_mul_f32 v54, v54, v12
  v_mul_f32 v55, v55, v13
  v_mfma_f32_32x32x16_bf16 v[64:79], v[20:23], v[236:239], v[64:79]
  s_waitcnt vmcnt(9)
  s_barrier
  v_add_u32 v6, 73728, v4
  ds_read_b64_tr_b16 v[16:17], v6 offset:0
  ds_read_b64_tr_b16 v[18:19], v6 offset:256
  global_load_dword a255, v[96:97], off
  v_add_co_u32 v96, vcc, 0x2000, v96
  v_addc_co_u32 v97, vcc, 0, v97, vcc
  v_mfma_f32_32x32x16_bf16 v[64:79], v[24:27], v[240:243], v[64:79]
  ds_read_b64_tr_b16 v[20:21], v6 offset:1024
  ds_read_b64_tr_b16 v[22:23], v6 offset:1280
  v_mul_f32 v10, v56, v56
  v_mul_f32 v11, v57, v57
  v_mul_f32 v12, v58, v58
  v_mul_f32 v13, v59, v59
  s_waitcnt lgkmcnt(4)
  v_mfma_f32_32x32x16_bf16 v[64:79], v[28:31], v[244:247], v[64:79]
  ds_read_b64_tr_b16 v[24:25], v6 offset:2048
  ds_read_b64_tr_b16 v[26:27], v6 offset:2304
  v_fmaak_f32 v10, v10, v8, 0xc0135761
  v_fmaak_f32 v11, v11, v8, 0xc0135761
  v_fmaak_f32 v12, v12, v8, 0xc0135761
  v_fmaak_f32 v13, v13, v8, 0xc0135761
  v_mfma_f32_32x32x16_bf16 v[64:79], v[32:35], v[248:251], v[64:79]
  ds_read_b64_tr_b16 v[28:29], v6 offset:3072
  ds_read_b64_tr_b16 v[30:31], v6 offset:3328
  v_mul_f32 v10, v10, v56
  v_mul_f32 v11, v11, v57
  v_mul_f32 v12, v12, v58
  v_mul_f32 v13, v13, v59
  v_mfma_f32_32x32x16_bf16 v[64:79], v[36:39], v[252:255], v[64:79]
  ds_read_b64_tr_b16 v[32:33], v6 offset:4096
  ds_read_b64_tr_b16 v[34:35], v6 offset:4352
  v_exp_f32 v10, v10
  v_exp_f32 v11, v11
  s_waitcnt lgkmcnt(4)
  v_mfma_f32_32x32x16_bf16 v[80:95], v[16:19], v[112:115], 0
  ds_read_b64_tr_b16 v[36:37], v6 offset:5120
  ds_read_b64_tr_b16 v[38:39], v6 offset:5376
  v_mfma_f32_32x32x16_bf16 v[80:95], v[20:23], v[116:119], v[80:95]
  ds_read_b64_tr_b16 v[16:17], v6 offset:6144
  ds_read_b64_tr_b16 v[18:19], v6 offset:6400
  v_exp_f32 v12, v12
  v_exp_f32 v13, v13
  s_add_u32 m0, s30, 0
  v_mfma_f32_32x32x16_bf16 v[80:95], v[24:27], v[120:123], v[80:95]
  ds_read_b64_tr_b16 v[20:21], v6 offset:7168
  ds_read_b64_tr_b16 v[22:23], v6 offset:7424
  buffer_load_dwordx4 v2, s[16:19], 0 offen offset:0 lds
  s_waitcnt lgkmcnt(4)
  v_mfma_f32_32x32x16_bf16 v[80:95], v[28:31], v[124:127], v[80:95]
  ds_read_b64_tr_b16 v[24:25], v6 offset:8192
  ds_read_b64_tr_b16 v[26:27], v6 offset:8448
  v_add_f32 v10, 1.0, v10
  v_add_f32 v11, 1.0, v11
  v_mfma_f32_32x32x16_bf16 v[80:95], v[32:35], v[128:131], v[80:95]
  ds_read_b64_tr_b16 v[28:29], v6 offset:9216
  ds_read_b64_tr_b16 v[30:31], v6 offset:9472
  v_add_f32 v12, 1.0, v12
  v_add_f32 v13, 1.0, v13
  v_rcp_f32 v10, v10
  v_mfma_f32_32x32x16_bf16 v[80:95], v[36:39], v[132:135], v[80:95]
  ds_read_b64_tr_b16 v[32:33], v6 offset:10240
  ds_read_b64_tr_b16 v[34:35], v6 offset:10496
  buffer_load_dwordx4 v2, s[16:19], s67 offen offset:1024 lds
  s_waitcnt lgkmcnt(4)
  v_mfma_f32_32x32x16_bf16 v[80:95], v[16:19], v[136:139], v[80:95]
  ds_read_b64_tr_b16 v[36:37], v6 offset:11264
  ds_read_b64_tr_b16 v[38:39], v6 offset:11520
  v_rcp_f32 v11, v11
  v_rcp_f32 v12, v12
  v_mfma_f32_32x32x16_bf16 v[80:95], v[20:23], v[140:143], v[80:95]
  ds_read_b64_tr_b16 v[16:17], v6 offset:12288
  ds_read_b64_tr_b16 v[18:19], v6 offset:12544
  v_rcp_f32 v13, v13
  v_mul_f32 v56, v56, v10
  v_mfma_f32_32x32x16_bf16 v[80:95], v[24:27], v[144:147], v[80:95]
  ds_read_b64_tr_b16 v[20:21], v6 offset:13312
  ds_read_b64_tr_b16 v[22:23], v6 offset:13568
  buffer_load_dwordx4 v2, s[16:19], s68 offen offset:2048 lds
  s_waitcnt lgkmcnt(4)
  v_mfma_f32_32x32x16_bf16 v[80:95], v[28:31], v[148:151], v[80:95]
  ds_read_b64_tr_b16 v[24:25], v6 offset:14336
  ds_read_b64_tr_b16 v[26:27], v6 offset:14592
  v_mul_f32 v57, v57, v11
  v_mul_f32 v58, v58, v12
  v_mul_f32 v59, v59, v13
  v_mul_f32 v10, v60, v60
  v_mfma_f32_32x32x16_bf16 v[80:95], v[32:35], v[152:155], v[80:95]
  ds_read_b64_tr_b16 v[28:29], v6 offset:15360
  ds_read_b64_tr_b16 v[30:31], v6 offset:15616
  v_mul_f32 v11, v61, v61
  v_mul_f32 v12, v62, v62
  v_mul_f32 v13, v63, v63
  v_fmaak_f32 v10, v10, v8, 0xc0135761
  v_mfma_f32_32x32x16_bf16 v[80:95], v[36:39], v[156:159], v[80:95]
  ds_read_b64_tr_b16 v[32:33], v6 offset:16384
  ds_read_b64_tr_b16 v[34:35], v6 offset:16640
  buffer_load_dwordx4 v2, s[16:19], s69 offen offset:3072 lds
  s_waitcnt lgkmcnt(4)
  v_mfma_f32_32x32x16_bf16 v[80:95], v[16:19], v[160:163], v[80:95]
  ds_read_b64_tr_b16 v[36:37], v6 offset:17408
  ds_read_b64_tr_b16 v[38:39], v6 offset:17664
  v_fmaak_f32 v11, v11, v8, 0xc0135761
  v_fmaak_f32 v12, v12, v8, 0xc0135761
  v_fmaak_f32 v13, v13, v8, 0xc0135761
  v_mfma_f32_32x32x16_bf16 v[80:95], v[20:23], v[164:167], v[80:95]
  ds_read_b64_tr_b16 v[16:17], v6 offset:18432
  ds_read_b64_tr_b16 v[18:19], v6 offset:18688
  v_mul_f32 v10, v10, v60
  v_mul_f32 v11, v11, v61
  v_mul_f32 v12, v12, v62
  s_add_u32 m0, s30, 4096
  v_mfma_f32_32x32x16_bf16 v[80:95], v[24:27], v[168:171], v[80:95]
  ds_read_b64_tr_b16 v[20:21], v6 offset:19456
  ds_read_b64_tr_b16 v[22:23], v6 offset:19712
  buffer_load_dwordx4 v2, s[16:19], s70 offen offset:0 lds
  s_waitcnt lgkmcnt(4)
  v_mfma_f32_32x32x16_bf16 v[80:95], v[28:31], v[172:175], v[80:95]
  ds_read_b64_tr_b16 v[24:25], v6 offset:20480
  ds_read_b64_tr_b16 v[26:27], v6 offset:20736
  v_mul_f32 v13, v13, v63
  v_exp_f32 v10, v10
  v_mfma_f32_32x32x16_bf16 v[80:95], v[32:35], v[176:179], v[80:95]
  ds_read_b64_tr_b16 v[28:29], v6 offset:21504
  ds_read_b64_tr_b16 v[30:31], v6 offset:21760
  v_exp_f32 v11, v11
  v_exp_f32 v12, v12
  v_mfma_f32_32x32x16_bf16 v[80:95], v[36:39], v[180:183], v[80:95]
  ds_read_b64_tr_b16 v[32:33], v6 offset:22528
  ds_read_b64_tr_b16 v[34:35], v6 offset:22784
  buffer_load_dwordx4 v2, s[16:19], s71 offen offset:1024 lds
  s_waitcnt lgkmcnt(4)
  v_mfma_f32_32x32x16_bf16 v[80:95], v[16:19], v[184:187], v[80:95]
  ds_read_b64_tr_b16 v[36:37], v6 offset:23552
  ds_read_b64_tr_b16 v[38:39], v6 offset:23808
  v_exp_f32 v13, v13
  v_add_f32 v10, 1.0, v10
  v_mfma_f32_32x32x16_bf16 v[80:95], v[20:23], v[188:191], v[80:95]
  ds_read_b64_tr_b16 v[16:17], v6 offset:24576
  ds_read_b64_tr_b16 v[18:19], v6 offset:24832
  v_add_f32 v11, 1.0, v11
  v_add_f32 v12, 1.0, v12
  v_add_f32 v13, 1.0, v13
  v_rcp_f32 v10, v10
  v_mfma_f32_32x32x16_bf16 v[80:95], v[24:27], v[192:195], v[80:95]
  ds_read_b64_tr_b16 v[20:21], v6 offset:25600
  ds_read_b64_tr_b16 v[22:23], v6 offset:25856
  buffer_load_dwordx4 v2, s[16:19], s72 offen offset:2048 lds
  s_waitcnt lgkmcnt(4)
  v_mfma_f32_32x32x16_bf16 v[80:95], v[28:31], v[196:199], v[80:95]
  ds_read_b64_tr_b16 v[24:25], v6 offset:26624
  ds_read_b64_tr_b16 v[26:27], v6 offset:26880
  v_rcp_f32 v11, v11
  v_mfma_f32_32x32x16_bf16 v[80:95], v[32:35], v[200:203], v[80:95]
  ds_read_b64_tr_b16 v[28:29], v6 offset:27648
  ds_read_b64_tr_b16 v[30:31], v6 offset:27904
  v_rcp_f32 v12, v12
  v_rcp_f32 v13, v13
  v_mfma_f32_32x32x16_bf16 v[80:95], v[36:39], v[204:207], v[80:95]
  ds_read_b64_tr_b16 v[32:33], v6 offset:28672
  ds_read_b64_tr_b16 v[34:35], v6 offset:28928
  buffer_load_dwordx4 v2, s[16:19], s73 offen offset:3072 lds
  s_waitcnt lgkmcnt(4)
  v_mfma_f32_32x32x16_bf16 v[80:95], v[16:19], v[208:211], v[80:95]
  ds_read_b64_tr_b16 v[36:37], v6 offset:29696
  ds_read_b64_tr_b16 v[38:39], v6 offset:29952
  v_mul_f32 v60, v60, v10
  v_mul_f32 v61, v61, v11
  v_mul_f32 v62, v62, v12
  v_mfma_f32_32x32x16_bf16 v[80:95], v[20:23], v[212:215], v[80:95]
  ds_read_b64_tr_b16 v[16:17], v6 offset:30720
  ds_read_b64_tr_b16 v[18:19], v6 offset:30976
  v_mul_f32 v63, v63, v13
  v_mul_f32 v64, v64, v48
  v_mul_f32 v65, v65, v49
  s_add_u32 m0, s30, 8192
  v_mfma_f32_32x32x16_bf16 v[80:95], v[24:27], v[216:219], v[80:95]
  ds_read_b64_tr_b16 v[20:21], v6 offset:31744
  ds_read_b64_tr_b16 v[22:23], v6 offset:32000
  buffer_load_dwordx4 v2, s[16:19], s74 offen offset:0 lds
  s_waitcnt lgkmcnt(4)
  v_mfma_f32_32x32x16_bf16 v[80:95], v[28:31], v[220:223], v[80:95]
  ds_read_b64_tr_b16 v[24:25], v6 offset:32768
  ds_read_b64_tr_b16 v[26:27], v6 offset:33024
  v_mul_f32 v66, v66, v50
  v_mul_f32 v67, v67, v51
  v_mul_f32 v68, v68, v52
  v_mul_f32 v69, v69, v53
  v_mfma_f32_32x32x16_bf16 v[80:95], v[32:35], v[224:227], v[80:95]
  ds_read_b64_tr_b16 v[28:29], v6 offset:33792
  ds_read_b64_tr_b16 v[30:31], v6 offset:34048
  v_mul_f32 v70, v70, v54
  v_mul_f32 v71, v71, v55
  v_mul_f32 v72, v72, v56
  v_mul_f32 v73, v73, v57
  v_mfma_f32_32x32x16_bf16 v[80:95], v[36:39], v[228:231], v[80:95]
  ds_read_b64_tr_b16 v[32:33], v6 offset:34816
  ds_read_b64_tr_b16 v[34:35], v6 offset:35072
  buffer_load_dword a253, v7, s[16:19], 0 offen offset:640
  v_mul_f32 v74, v74, v58
  v_mul_f32 v75, v75, v59
  v_mul_f32 v76, v76, v60
  s_waitcnt lgkmcnt(4)
  v_mfma_f32_32x32x16_bf16 v[80:95], v[16:19], v[232:235], v[80:95]
  ds_read_b64_tr_b16 v[36:37], v6 offset:35840
  ds_read_b64_tr_b16 v[38:39], v6 offset:36096
  v_mul_f32 v77, v77, v61
  v_mul_f32 v78, v78, v62
  v_mul_f32 v79, v79, v63
  v_mfma_f32_32x32x16_bf16 v[80:95], v[20:23], v[236:239], v[80:95]
  s_waitcnt vmcnt(11)
  s_barrier
  v_add_u32 v6, 110592, v4
  ds_read_b64_tr_b16 v[16:17], v6 offset:0
  ds_read_b64_tr_b16 v[18:19], v6 offset:256
  v_cvt_pk_bf16_f32 v40, v64, v65
  v_mfma_f32_32x32x16_bf16 v[80:95], v[24:27], v[240:243], v[80:95]
  ds_read_b64_tr_b16 v[20:21], v6 offset:1024
  ds_read_b64_tr_b16 v[22:23], v6 offset:1280
  v_cvt_pk_bf16_f32 v41, v66, v67
  v_cvt_pk_bf16_f32 v42, v68, v69
  v_cvt_pk_bf16_f32 v43, v70, v71
  v_cvt_pk_bf16_f32 v44, v72, v73
  s_waitcnt lgkmcnt(4)
  v_mfma_f32_32x32x16_bf16 v[80:95], v[28:31], v[244:247], v[80:95]
  ds_read_b64_tr_b16 v[24:25], v6 offset:2048
  ds_read_b64_tr_b16 v[26:27], v6 offset:2304
  v_cvt_pk_bf16_f32 v45, v74, v75
  v_cvt_pk_bf16_f32 v46, v76, v77
  v_cvt_pk_bf16_f32 v47, v78, v79
  v_mfma_f32_32x32x16_bf16 v[80:95], v[32:35], v[248:251], v[80:95]
  ds_read_b64_tr_b16 v[28:29], v6 offset:3072
  ds_read_b64_tr_b16 v[30:31], v6 offset:3328
  v_accvgpr_write_b32 a32, v40
  v_accvgpr_write_b32 a33, v41
  v_accvgpr_write_b32 a34, v42
  v_accvgpr_write_b32 a35, v43
  v_mfma_f32_32x32x16_bf16 v[80:95], v[36:39], v[252:255], v[80:95]
  ds_read_b64_tr_b16 v[32:33], v6 offset:4096
  ds_read_b64_tr_b16 v[34:35], v6 offset:4352
  v_accvgpr_write_b32 a36, v44
  v_accvgpr_write_b32 a37, v45
  v_accvgpr_write_b32 a38, v46
  v_accvgpr_write_b32 a39, v47
  s_waitcnt lgkmcnt(4)
  v_mfma_f32_32x32x16_bf16 v[64:79], v[16:19], v[112:115], 0
  ds_read_b64_tr_b16 v[36:37], v6 offset:5120
  ds_read_b64_tr_b16 v[38:39], v6 offset:5376
  v_mfma_f32_32x32x16_bf16 v[64:79], v[20:23], v[116:119], v[64:79]
  ds_read_b64_tr_b16 v[16:17], v6 offset:6144
  ds_read_b64_tr_b16 v[18:19], v6 offset:6400
  s_add_u32 m0, s30, 36864
  v_mfma_f32_32x32x16_bf16 v[64:79], v[24:27], v[120:123], v[64:79]
  ds_read_b64_tr_b16 v[20:21], v6 offset:7168
  ds_read_b64_tr_b16 v[22:23], v6 offset:7424
  buffer_load_dwordx4 v2, s[20:23], 0 offen offset:0 lds
  s_waitcnt lgkmcnt(4)
  v_mfma_f32_32x32x16_bf16 v[64:79], v[28:31], v[124:127], v[64:79]
  ds_read_b64_tr_b16 v[24:25], v6 offset:8192
  ds_read_b64_tr_b16 v[26:27], v6 offset:8448
  v_mul_f32 v10, v80, v80
  v_mul_f32 v11, v81, v81
  v_mul_f32 v12, v82, v82
  v_mfma_f32_32x32x16_bf16 v[64:79], v[32:35], v[128:131], v[64:79]
  ds_read_b64_tr_b16 v[28:29], v6 offset:9216
  ds_read_b64_tr_b16 v[30:31], v6 offset:9472
  v_mul_f32 v13, v83, v83
  v_fmaak_f32 v10, v10, v8, 0xc0135761
  v_fmaak_f32 v11, v11, v8, 0xc0135761
  v_fmaak_f32 v12, v12, v8, 0xc0135761
  v_mfma_f32_32x32x16_bf16 v[64:79], v[36:39], v[132:135], v[64:79]
  ds_read_b64_tr_b16 v[32:33], v6 offset:10240
  ds_read_b64_tr_b16 v[34:35], v6 offset:10496
  buffer_load_dwordx4 v2, s[20:23], s67 offen offset:1024 lds
  v_fmaak_f32 v13, v13, v8, 0xc0135761
  s_waitcnt lgkmcnt(4)
  v_mfma_f32_32x32x16_bf16 v[64:79], v[16:19], v[136:139], v[64:79]
  ds_read_b64_tr_b16 v[36:37], v6 offset:11264
  ds_read_b64_tr_b16 v[38:39], v6 offset:11520
  v_mul_f32 v10, v10, v80
  v_mul_f32 v11, v11, v81
  v_mul_f32 v12, v12, v82
  v_mfma_f32_32x32x16_bf16 v[64:79], v[20:23], v[140:143], v[64:79]
  ds_read_b64_tr_b16 v[16:17], v6 offset:12288
  ds_read_b64_tr_b16 v[18:19], v6 offset:12544
  v_mul_f32 v13, v13, v83
  v_exp_f32 v10, v10
  v_mfma_f32_32x32x16_bf16 v[64:79], v[24:27], v[144:147], v[64:79]
  ds_read_b64_tr_b16 v[20:21], v6 offset:13312
  ds_read_b64_tr_b16 v[22:23], v6 offset:13568
  buffer_load_dwordx4 v2, s[20:23], s68 offen offset:2048 lds
  v_exp_f32 v11, v11
  s_waitcnt lgkmcnt(4)
  v_mfma_f32_32x32x16_bf16 v[64:79], v[28:31], v[148:151], v[64:79]
  ds_read_b64_tr_b16 v[24:25], v6 offset:14336
  ds_read_b64_tr_b16 v[26:27], v6 offset:14592
  v_exp_f32 v12, v12
  v_mfma_f32_32x32x16_bf16 v[64:79], v[32:35], v[152:155], v[64:79]
  ds_read_b64_tr_b16 v[28:29], v6 offset:15360
  ds_read_b64_tr_b16 v[30:31], v6 offset:15616
  v_exp_f32 v13, v13
  v_add_f32 v10, 1.0, v10
  v_add_f32 v11, 1.0, v11
  v_mfma_f32_32x32x16_bf16 v[64:79], v[36:39], v[156:159], v[64:79]
  ds_read_b64_tr_b16 v[32:33], v6 offset:16384
  ds_read_b64_tr_b16 v[34:35], v6 offset:16640
  buffer_load_dwordx4 v2, s[20:23], s69 offen offset:3072 lds
  v_add_f32 v12, 1.0, v12
  s_waitcnt lgkmcnt(4)
  v_mfma_f32_32x32x16_bf16 v[64:79], v[16:19], v[160:163], v[64:79]
  ds_read_b64_tr_b16 v[36:37], v6 offset:17408
  ds_read_b64_tr_b16 v[38:39], v6 offset:17664
  v_add_f32 v13, 1.0, v13
  v_rcp_f32 v10, v10
  v_mfma_f32_32x32x16_bf16 v[64:79], v[20:23], v[164:167], v[64:79]
  ds_read_b64_tr_b16 v[16:17], v6 offset:18432
  ds_read_b64_tr_b16 v[18:19], v6 offset:18688
  v_rcp_f32 v11, v11
  v_rcp_f32 v12, v12
  s_add_u32 m0, s30, 40960
  v_mfma_f32_32x32x16_bf16 v[64:79], v[24:27], v[168:171], v[64:79]
  ds_read_b64_tr_b16 v[20:21], v6 offset:19456
  ds_read_b64_tr_b16 v[22:23], v6 offset:19712
  buffer_load_dwordx4 v2, s[20:23], s70 offen offset:0 lds
  s_waitcnt lgkmcnt(4)
  v_mfma_f32_32x32x16_bf16 v[64:79], v[28:31], v[172:175], v[64:79]
  ds_read_b64_tr_b16 v[24:25], v6 offset:20480
  ds_read_b64_tr_b16 v[26:27], v6 offset:20736
  v_rcp_f32 v13, v13
  v_mfma_f32_32x32x16_bf16 v[64:79], v[32:35], v[176:179], v[64:79]
  ds_read_b64_tr_b16 v[28:29], v6 offset:21504
  ds_read_b64_tr_b16 v[30:31], v6 offset:21760
  v_mul_f32 v80, v80, v10
  v_mul_f32 v81, v81, v11
  v_mul_f32 v82, v82, v12
  v_mul_f32 v83, v83, v13
  v_mul_f32 v10, v84, v84
  v_mfma_f32_32x32x16_bf16 v[64:79], v[36:39], v[180:183], v[64:79]
  ds_read_b64_tr_b16 v[32:33], v6 offset:22528
  ds_read_b64_tr_b16 v[34:35], v6 offset:22784
  buffer_load_dwordx4 v2, s[20:23], s71 offen offset:1024 lds
  s_waitcnt lgkmcnt(4)
  v_mfma_f32_32x32x16_bf16 v[64:79], v[16:19], v[184:187], v[64:79]
  ds_read_b64_tr_b16 v[36:37], v6 offset:23552
  ds_read_b64_tr_b16 v[38:39], v6 offset:23808
  v_mul_f32 v11, v85, v85
  v_mul_f32 v12, v86, v86
  v_mul_f32 v13, v87, v87
  v_mfma_f32_32x32x16_bf16 v[64:79], v[20:23], v[188:191], v[64:79]
  ds_read_b64_tr_b16 v[16:17], v6 offset:24576
  ds_read_b64_tr_b16 v[18:19], v6 offset:24832
  v_fmaak_f32 v10, v10, v8, 0xc0135761
  v_fmaak_f32 v11, v11, v8, 0xc0135761
  v_fmaak_f32 v12, v12, v8, 0xc0135761
  v_fmaak_f32 v13, v13, v8, 0xc0135761
  v_mfma_f32_32x32x16_bf16 v[64:79], v[24:27], v[192:195], v[64:79]
  ds_read_b64_tr_b16 v[20:21], v6 offset:25600
  ds_read_b64_tr_b16 v[22:23], v6 offset:25856
  buffer_load_dwordx4 v2, s[20:23], s72 offen offset:2048 lds
  s_waitcnt lgkmcnt(4)
  v_mfma_f32_32x32x16_bf16 v[64:79], v[28:31], v[196:199], v[64:79]
  ds_read_b64_tr_b16 v[24:25], v6 offset:26624
  ds_read_b64_tr_b16 v[26:27], v6 offset:26880
  v_mul_f32 v10, v10, v84
  v_mul_f32 v11, v11, v85
  v_mul_f32 v12, v12, v86
  v_mfma_f32_32x32x16_bf16 v[64:79], v[32:35], v[200:203], v[64:79]
  ds_read_b64_tr_b16 v[28:29], v6 offset:27648
  ds_read_b64_tr_b16 v[30:31], v6 offset:27904
  v_mul_f32 v13, v13, v87
  v_exp_f32 v10, v10
  v_exp_f32 v11, v11
  v_mfma_f32_32x32x16_bf16 v[64:79], v[36:39], v[204:207], v[64:79]
  ds_read_b64_tr_b16 v[32:33], v6 offset:28672
  ds_read_b64_tr_b16 v[34:35], v6 offset:28928
  buffer_load_dwordx4 v2, s[20:23], s73 offen offset:3072 lds
  s_waitcnt lgkmcnt(4)
  v_mfma_f32_32x32x16_bf16 v[64:79], v[16:19], v[208:211], v[64:79]
  ds_read_b64_tr_b16 v[36:37], v6 offset:29696
  ds_read_b64_tr_b16 v[38:39], v6 offset:29952
  v_exp_f32 v12, v12
  v_exp_f32 v13, v13
  v_mfma_f32_32x32x16_bf16 v[64:79], v[20:23], v[212:215], v[64:79]
  ds_read_b64_tr_b16 v[16:17], v6 offset:30720
  ds_read_b64_tr_b16 v[18:19], v6 offset:30976
  v_add_f32 v10, 1.0, v10
  v_add_f32 v11, 1.0, v11
  s_add_u32 m0, s30, 45056
  v_mfma_f32_32x32x16_bf16 v[64:79], v[24:27], v[216:219], v[64:79]
  ds_read_b64_tr_b16 v[20:21], v6 offset:31744
  ds_read_b64_tr_b16 v[22:23], v6 offset:32000
  buffer_load_dwordx4 v2, s[20:23], s74 offen offset:0 lds
  s_waitcnt lgkmcnt(4)
  v_mfma_f32_32x32x16_bf16 v[64:79], v[28:31], v[220:223], v[64:79]
  ds_read_b64_tr_b16 v[24:25], v6 offset:32768
  ds_read_b64_tr_b16 v[26:27], v6 offset:33024
  v_add_f32 v12, 1.0, v12
  v_add_f32 v13, 1.0, v13
  v_add_u32 v2, 64, v2
  v_mfma_f32_32x32x16_bf16 v[64:79], v[32:35], v[224:227], v[64:79]
  ds_read_b64_tr_b16 v[28:29], v6 offset:33792
  ds_read_b64_tr_b16 v[30:31], v6 offset:34048
  v_rcp_f32 v10, v10
  v_rcp_f32 v11, v11
  v_mfma_f32_32x32x16_bf16 v[64:79], v[36:39], v[228:231], v[64:79]
  ds_read_b64_tr_b16 v[32:33], v6 offset:34816
  ds_read_b64_tr_b16 v[34:35], v6 offset:35072
  buffer_load_dword a253, v7, s[20:23], 0 offen offset:640
  v_rcp_f32 v12, v12
  v_rcp_f32 v13, v13
  s_waitcnt lgkmcnt(4)
  v_mfma_f32_32x32x16_bf16 v[64:79], v[16:19], v[232:235], v[64:79]
  ds_read_b64_tr_b16 v[36:37], v6 offset:35840
  ds_read_b64_tr_b16 v[38:39], v6 offset:36096
  v_mul_f32 v84, v84, v10
  v_mul_f32 v85, v85, v11
  v_mul_f32 v86, v86, v12
  v_mfma_f32_32x32x16_bf16 v[64:79], v[20:23], v[236:239], v[64:79]
  s_waitcnt vmcnt(11)
  s_barrier
  v_add_u32 v6, 0, v4
  ds_read_b64_tr_b16 v[16:17], v6 offset:0
  ds_read_b64_tr_b16 v[18:19], v6 offset:256
  v_mul_f32 v87, v87, v13
  v_mfma_f32_32x32x16_bf16 v[64:79], v[24:27], v[240:243], v[64:79]
  ds_read_b64_tr_b16 v[20:21], v6 offset:1024
  ds_read_b64_tr_b16 v[22:23], v6 offset:1280
  v_mul_f32 v10, v88, v88
  v_mul_f32 v11, v89, v89
  v_mul_f32 v12, v90, v90
  v_mul_f32 v13, v91, v91
  s_waitcnt lgkmcnt(4)
  v_mfma_f32_32x32x16_bf16 v[64:79], v[28:31], v[244:247], v[64:79]
  ds_read_b64_tr_b16 v[24:25], v6 offset:2048
  ds_read_b64_tr_b16 v[26:27], v6 offset:2304
  v_fmaak_f32 v10, v10, v8, 0xc0135761
  v_fmaak_f32 v11, v11, v8, 0xc0135761
  v_fmaak_f32 v12, v12, v8, 0xc0135761
  v_fmaak_f32 v13, v13, v8, 0xc0135761
  v_mfma_f32_32x32x16_bf16 v[64:79], v[32:35], v[248:251], v[64:79]
  ds_read_b64_tr_b16 v[28:29], v6 offset:3072
  ds_read_b64_tr_b16 v[30:31], v6 offset:3328
  v_mul_f32 v10, v10, v88
  v_mul_f32 v11, v11, v89
  v_mul_f32 v12, v12, v90
  v_mul_f32 v13, v13, v91
  v_mfma_f32_32x32x16_bf16 v[64:79], v[36:39], v[252:255], v[64:79]
  ds_read_b64_tr_b16 v[32:33], v6 offset:4096
  ds_read_b64_tr_b16 v[34:35], v6 offset:4352
  v_exp_f32 v10, v10
  v_exp_f32 v11, v11
  s_waitcnt lgkmcnt(4)
  v_mfma_f32_32x32x16_bf16 v[48:63], v[16:19], v[112:115], 0
  ds_read_b64_tr_b16 v[36:37], v6 offset:5120
  ds_read_b64_tr_b16 v[38:39], v6 offset:5376
  v_mfma_f32_32x32x16_bf16 v[48:63], v[20:23], v[116:119], v[48:63]
  ds_read_b64_tr_b16 v[16:17], v6 offset:6144
  ds_read_b64_tr_b16 v[18:19], v6 offset:6400
  v_exp_f32 v12, v12
  v_exp_f32 v13, v13
  s_add_u32 m0, s30, 73728
  v_mfma_f32_32x32x16_bf16 v[48:63], v[24:27], v[120:123], v[48:63]
  ds_read_b64_tr_b16 v[20:21], v6 offset:7168
  ds_read_b64_tr_b16 v[22:23], v6 offset:7424
  buffer_load_dwordx4 v2, s[16:19], 0 offen offset:0 lds
  s_waitcnt lgkmcnt(4)
  v_mfma_f32_32x32x16_bf16 v[48:63], v[28:31], v[124:127], v[48:63]
  ds_read_b64_tr_b16 v[24:25], v6 offset:8192
  ds_read_b64_tr_b16 v[26:27], v6 offset:8448
  v_add_f32 v10, 1.0, v10
  v_add_f32 v11, 1.0, v11
  v_mfma_f32_32x32x16_bf16 v[48:63], v[32:35], v[128:131], v[48:63]
  ds_read_b64_tr_b16 v[28:29], v6 offset:9216
  ds_read_b64_tr_b16 v[30:31], v6 offset:9472
  v_add_f32 v12, 1.0, v12
  v_add_f32 v13, 1.0, v13
  v_rcp_f32 v10, v10
  v_mfma_f32_32x32x16_bf16 v[48:63], v[36:39], v[132:135], v[48:63]
  ds_read_b64_tr_b16 v[32:33], v6 offset:10240
  ds_read_b64_tr_b16 v[34:35], v6 offset:10496
  buffer_load_dwordx4 v2, s[16:19], s67 offen offset:1024 lds
  s_waitcnt lgkmcnt(4)
  v_mfma_f32_32x32x16_bf16 v[48:63], v[16:19], v[136:139], v[48:63]
  ds_read_b64_tr_b16 v[36:37], v6 offset:11264
  ds_read_b64_tr_b16 v[38:39], v6 offset:11520
  v_rcp_f32 v11, v11
  v_rcp_f32 v12, v12
  v_mfma_f32_32x32x16_bf16 v[48:63], v[20:23], v[140:143], v[48:63]
  ds_read_b64_tr_b16 v[16:17], v6 offset:12288
  ds_read_b64_tr_b16 v[18:19], v6 offset:12544
  v_rcp_f32 v13, v13
  v_mul_f32 v88, v88, v10
  v_mfma_f32_32x32x16_bf16 v[48:63], v[24:27], v[144:147], v[48:63]
  ds_read_b64_tr_b16 v[20:21], v6 offset:13312
  ds_read_b64_tr_b16 v[22:23], v6 offset:13568
  buffer_load_dwordx4 v2, s[16:19], s68 offen offset:2048 lds
  s_waitcnt lgkmcnt(4)
  v_mfma_f32_32x32x16_bf16 v[48:63], v[28:31], v[148:151], v[48:63]
  ds_read_b64_tr_b16 v[24:25], v6 offset:14336
  ds_read_b64_tr_b16 v[26:27], v6 offset:14592
  v_mul_f32 v89, v89, v11
  v_mul_f32 v90, v90, v12
  v_mul_f32 v91, v91, v13
  v_mfma_f32_32x32x16_bf16 v[48:63], v[32:35], v[152:155], v[48:63]
  ds_read_b64_tr_b16 v[28:29], v6 offset:15360
  ds_read_b64_tr_b16 v[30:31], v6 offset:15616
  v_mul_f32 v10, v92, v92
  v_mul_f32 v11, v93, v93
  v_mul_f32 v12, v94, v94
  v_mul_f32 v13, v95, v95
  v_mfma_f32_32x32x16_bf16 v[48:63], v[36:39], v[156:159], v[48:63]
  ds_read_b64_tr_b16 v[32:33], v6 offset:16384
  ds_read_b64_tr_b16 v[34:35], v6 offset:16640
  buffer_load_dwordx4 v2, s[16:19], s69 offen offset:3072 lds
  s_waitcnt lgkmcnt(4)
  v_mfma_f32_32x32x16_bf16 v[48:63], v[16:19], v[160:163], v[48:63]
  ds_read_b64_tr_b16 v[36:37], v6 offset:17408
  ds_read_b64_tr_b16 v[38:39], v6 offset:17664
  v_fmaak_f32 v10, v10, v8, 0xc0135761
  v_fmaak_f32 v11, v11, v8, 0xc0135761
  v_fmaak_f32 v12, v12, v8, 0xc0135761
  v_mfma_f32_32x32x16_bf16 v[48:63], v[20:23], v[164:167], v[48:63]
  ds_read_b64_tr_b16 v[16:17], v6 offset:18432
  ds_read_b64_tr_b16 v[18:19], v6 offset:18688
  v_fmaak_f32 v13, v13, v8, 0xc0135761
  v_mul_f32 v10, v10, v92
  v_mul_f32 v11, v11, v93
  s_add_u32 m0, s30, 77824
  v_mfma_f32_32x32x16_bf16 v[48:63], v[24:27], v[168:171], v[48:63]
  ds_read_b64_tr_b16 v[20:21], v6 offset:19456
  ds_read_b64_tr_b16 v[22:23], v6 offset:19712
  buffer_load_dwordx4 v2, s[16:19], s70 offen offset:0 lds
  s_waitcnt lgkmcnt(4)
  v_mfma_f32_32x32x16_bf16 v[48:63], v[28:31], v[172:175], v[48:63]
  ds_read_b64_tr_b16 v[24:25], v6 offset:20480
  ds_read_b64_tr_b16 v[26:27], v6 offset:20736
  v_mul_f32 v12, v12, v94
  v_mul_f32 v13, v13, v95
  v_exp_f32 v10, v10
  v_mfma_f32_32x32x16_bf16 v[48:63], v[32:35], v[176:179], v[48:63]
  ds_read_b64_tr_b16 v[28:29], v6 offset:21504
  ds_read_b64_tr_b16 v[30:31], v6 offset:21760
  v_exp_f32 v11, v11
  v_exp_f32 v12, v12
  v_mfma_f32_32x32x16_bf16 v[48:63], v[36:39], v[180:183], v[48:63]
  ds_read_b64_tr_b16 v[32:33], v6 offset:22528
  ds_read_b64_tr_b16 v[34:35], v6 offset:22784
  buffer_load_dwordx4 v2, s[16:19], s71 offen offset:1024 lds
  s_waitcnt lgkmcnt(4)
  v_mfma_f32_32x32x16_bf16 v[48:63], v[16:19], v[184:187], v[48:63]
  ds_read_b64_tr_b16 v[36:37], v6 offset:23552
  ds_read_b64_tr_b16 v[38:39], v6 offset:23808
  v_exp_f32 v13, v13
  v_add_f32 v10, 1.0, v10
  v_mfma_f32_32x32x16_bf16 v[48:63], v[20:23], v[188:191], v[48:63]
  ds_read_b64_tr_b16 v[16:17], v6 offset:24576
  ds_read_b64_tr_b16 v[18:19], v6 offset:24832
  v_add_f32 v11, 1.0, v11
  v_add_f32 v12, 1.0, v12
  v_add_f32 v13, 1.0, v13
  v_mfma_f32_32x32x16_bf16 v[48:63], v[24:27], v[192:195], v[48:63]
  ds_read_b64_tr_b16 v[20:21], v6 offset:25600
  ds_read_b64_tr_b16 v[22:23], v6 offset:25856
  buffer_load_dwordx4 v2, s[16:19], s72 offen offset:2048 lds
  s_waitcnt lgkmcnt(4)
  v_mfma_f32_32x32x16_bf16 v[48:63], v[28:31], v[196:199], v[48:63]
  ds_read_b64_tr_b16 v[24:25], v6 offset:26624
  ds_read_b64_tr_b16 v[26:27], v6 offset:26880
  v_rcp_f32 v10, v10
  v_rcp_f32 v11, v11
  v_mfma_f32_32x32x16_bf16 v[48:63], v[32:35], v[200:203], v[48:63]
  ds_read_b64_tr_b16 v[28:29], v6 offset:27648
  ds_read_b64_tr_b16 v[30:31], v6 offset:27904
  v_rcp_f32 v12, v12
  v_rcp_f32 v13, v13
  v_mfma_f32_32x32x16_bf16 v[48:63], v[36:39], v[204:207], v[48:63]
  ds_read_b64_tr_b16 v[32:33], v6 offset:28672
  ds_read_b64_tr_b16 v[34:35], v6 offset:28928
  buffer_load_dwordx4 v2, s[16:19], s73 offen offset:3072 lds
  s_waitcnt lgkmcnt(4)
  v_mfma_f32_32x32x16_bf16 v[48:63], v[16:19], v[208:211], v[48:63]
  ds_read_b64_tr_b16 v[36:37], v6 offset:29696
  ds_read_b64_tr_b16 v[38:39], v6 offset:29952
  v_mul_f32 v92, v92, v10
  v_mul_f32 v93, v93, v11
  v_mul_f32 v94, v94, v12
  v_mfma_f32_32x32x16_bf16 v[48:63], v[20:23], v[212:215], v[48:63]
  ds_read_b64_tr_b16 v[16:17], v6 offset:30720
  ds_read_b64_tr_b16 v[18:19], v6 offset:30976
  v_mul_f32 v95, v95, v13
  v_mul_f32 v64, v64, v80
  v_mul_f32 v65, v65, v81
  s_add_u32 m0, s30, 81920
  v_mfma_f32_32x32x16_bf16 v[48:63], v[24:27], v[216:219], v[48:63]
  ds_read_b64_tr_b16 v[20:21], v6 offset:31744
  ds_read_b64_tr_b16 v[22:23], v6 offset:32000
  buffer_load_dwordx4 v2, s[16:19], s74 offen offset:0 lds
  s_waitcnt lgkmcnt(4)
  v_mfma_f32_32x32x16_bf16 v[48:63], v[28:31], v[220:223], v[48:63]
  ds_read_b64_tr_b16 v[24:25], v6 offset:32768
  ds_read_b64_tr_b16 v[26:27], v6 offset:33024
  v_mul_f32 v66, v66, v82
  v_mul_f32 v67, v67, v83
  v_mul_f32 v68, v68, v84
  v_mfma_f32_32x32x16_bf16 v[48:63], v[32:35], v[224:227], v[48:63]
  ds_read_b64_tr_b16 v[28:29], v6 offset:33792
  ds_read_b64_tr_b16 v[30:31], v6 offset:34048
  v_mul_f32 v69, v69, v85
  v_mul_f32 v70, v70, v86
  v_mul_f32 v71, v71, v87
  v_mul_f32 v72, v72, v88
  v_mfma_f32_32x32x16_bf16 v[48:63], v[36:39], v[228:231], v[48:63]
  ds_read_b64_tr_b16 v[32:33], v6 offset:34816
  ds_read_b64_tr_b16 v[34:35], v6 offset:35072
  v_mul_f32 v73, v73, v89
  v_mul_f32 v74, v74, v90
  v_mul_f32 v75, v75, v91
  v_mul_f32 v76, v76, v92
  s_waitcnt lgkmcnt(4)
  v_mfma_f32_32x32x16_bf16 v[48:63], v[16:19], v[232:235], v[48:63]
  ds_read_b64_tr_b16 v[36:37], v6 offset:35840
  ds_read_b64_tr_b16 v[38:39], v6 offset:36096
  v_mul_f32 v77, v77, v93
  v_mul_f32 v78, v78, v94
  v_mul_f32 v79, v79, v95
  v_mfma_f32_32x32x16_bf16 v[48:63], v[20:23], v[236:239], v[48:63]
  s_waitcnt vmcnt(10)
  s_barrier
  v_add_u32 v6, 36864, v4
  ds_read_b64_tr_b16 v[16:17], v6 offset:0
  ds_read_b64_tr_b16 v[18:19], v6 offset:256
  v_cvt_pk_bf16_f32 v40, v64, v65
  v_mfma_f32_32x32x16_bf16 v[48:63], v[24:27], v[240:243], v[48:63]
  ds_read_b64_tr_b16 v[20:21], v6 offset:1024
  ds_read_b64_tr_b16 v[22:23], v6 offset:1280
  v_cvt_pk_bf16_f32 v41, v66, v67
  v_cvt_pk_bf16_f32 v42, v68, v69
  v_cvt_pk_bf16_f32 v43, v70, v71
  v_cvt_pk_bf16_f32 v44, v72, v73
  s_waitcnt lgkmcnt(4)
  v_mfma_f32_32x32x16_bf16 v[48:63], v[28:31], v[244:247], v[48:63]
  ds_read_b64_tr_b16 v[24:25], v6 offset:2048
  ds_read_b64_tr_b16 v[26:27], v6 offset:2304
  v_cvt_pk_bf16_f32 v45, v74, v75
  v_cvt_pk_bf16_f32 v46, v76, v77
  v_cvt_pk_bf16_f32 v47, v78, v79
  v_mfma_f32_32x32x16_bf16 v[48:63], v[32:35], v[248:251], v[48:63]
  ds_read_b64_tr_b16 v[28:29], v6 offset:3072
  ds_read_b64_tr_b16 v[30:31], v6 offset:3328
  v_accvgpr_write_b32 a40, v40
  v_accvgpr_write_b32 a41, v41
  v_accvgpr_write_b32 a42, v42
  v_accvgpr_write_b32 a43, v43
  v_mfma_f32_32x32x16_bf16 v[48:63], v[36:39], v[252:255], v[48:63]
  ds_read_b64_tr_b16 v[32:33], v6 offset:4096
  ds_read_b64_tr_b16 v[34:35], v6 offset:4352
  v_accvgpr_write_b32 a44, v44
  v_accvgpr_write_b32 a45, v45
  v_accvgpr_write_b32 a46, v46
  v_accvgpr_write_b32 a47, v47
  s_waitcnt lgkmcnt(4)
  v_mfma_f32_32x32x16_bf16 v[64:79], v[16:19], v[112:115], 0
  ds_read_b64_tr_b16 v[36:37], v6 offset:5120
  ds_read_b64_tr_b16 v[38:39], v6 offset:5376
  v_mfma_f32_32x32x16_bf16 v[64:79], v[20:23], v[116:119], v[64:79]
  ds_read_b64_tr_b16 v[16:17], v6 offset:6144
  ds_read_b64_tr_b16 v[18:19], v6 offset:6400
  s_add_u32 m0, s30, 110592
  v_mfma_f32_32x32x16_bf16 v[64:79], v[24:27], v[120:123], v[64:79]
  ds_read_b64_tr_b16 v[20:21], v6 offset:7168
  ds_read_b64_tr_b16 v[22:23], v6 offset:7424
  buffer_load_dwordx4 v2, s[20:23], 0 offen offset:0 lds
  s_waitcnt lgkmcnt(4)
  v_mfma_f32_32x32x16_bf16 v[64:79], v[28:31], v[124:127], v[64:79]
  ds_read_b64_tr_b16 v[24:25], v6 offset:8192
  ds_read_b64_tr_b16 v[26:27], v6 offset:8448
  v_mul_f32 v10, v48, v48
  v_mul_f32 v11, v49, v49
  v_mul_f32 v12, v50, v50
  v_mfma_f32_32x32x16_bf16 v[64:79], v[32:35], v[128:131], v[64:79]
  ds_read_b64_tr_b16 v[28:29], v6 offset:9216
  ds_read_b64_tr_b16 v[30:31], v6 offset:9472
  v_mul_f32 v13, v51, v51
  v_fmaak_f32 v10, v10, v8, 0xc0135761
  v_fmaak_f32 v11, v11, v8, 0xc0135761
  v_fmaak_f32 v12, v12, v8, 0xc0135761
  v_mfma_f32_32x32x16_bf16 v[64:79], v[36:39], v[132:135], v[64:79]
  ds_read_b64_tr_b16 v[32:33], v6 offset:10240
  ds_read_b64_tr_b16 v[34:35], v6 offset:10496
  buffer_load_dwordx4 v2, s[20:23], s67 offen offset:1024 lds
  v_fmaak_f32 v13, v13, v8, 0xc0135761
  s_waitcnt lgkmcnt(4)
  v_mfma_f32_32x32x16_bf16 v[64:79], v[16:19], v[136:139], v[64:79]
  ds_read_b64_tr_b16 v[36:37], v6 offset:11264
  ds_read_b64_tr_b16 v[38:39], v6 offset:11520
  v_mul_f32 v10, v10, v48
  v_mul_f32 v11, v11, v49
  v_mul_f32 v12, v12, v50
  v_mfma_f32_32x32x16_bf16 v[64:79], v[20:23], v[140:143], v[64:79]
  ds_read_b64_tr_b16 v[16:17], v6 offset:12288
  ds_read_b64_tr_b16 v[18:19], v6 offset:12544
  v_mul_f32 v13, v13, v51
  v_exp_f32 v10, v10
  v_mfma_f32_32x32x16_bf16 v[64:79], v[24:27], v[144:147], v[64:79]
  ds_read_b64_tr_b16 v[20:21], v6 offset:13312
  ds_read_b64_tr_b16 v[22:23], v6 offset:13568
  buffer_load_dwordx4 v2, s[20:23], s68 offen offset:2048 lds
  v_exp_f32 v11, v11
  s_waitcnt lgkmcnt(4)
  v_mfma_f32_32x32x16_bf16 v[64:79], v[28:31], v[148:151], v[64:79]
  ds_read_b64_tr_b16 v[24:25], v6 offset:14336
  ds_read_b64_tr_b16 v[26:27], v6 offset:14592
  v_exp_f32 v12, v12
  v_mfma_f32_32x32x16_bf16 v[64:79], v[32:35], v[152:155], v[64:79]
  ds_read_b64_tr_b16 v[28:29], v6 offset:15360
  ds_read_b64_tr_b16 v[30:31], v6 offset:15616
  v_exp_f32 v13, v13
  v_add_f32 v10, 1.0, v10
  v_add_f32 v11, 1.0, v11
  v_add_f32 v12, 1.0, v12
  v_mfma_f32_32x32x16_bf16 v[64:79], v[36:39], v[156:159], v[64:79]
  ds_read_b64_tr_b16 v[32:33], v6 offset:16384
  ds_read_b64_tr_b16 v[34:35], v6 offset:16640
  buffer_load_dwordx4 v2, s[20:23], s69 offen offset:3072 lds
  s_waitcnt lgkmcnt(4)
  v_mfma_f32_32x32x16_bf16 v[64:79], v[16:19], v[160:163], v[64:79]
  ds_read_b64_tr_b16 v[36:37], v6 offset:17408
  ds_read_b64_tr_b16 v[38:39], v6 offset:17664
  v_add_f32 v13, 1.0, v13
  v_rcp_f32 v10, v10
  v_mfma_f32_32x32x16_bf16 v[64:79], v[20:23], v[164:167], v[64:79]
  ds_read_b64_tr_b16 v[16:17], v6 offset:18432
  ds_read_b64_tr_b16 v[18:19], v6 offset:18688
  v_rcp_f32 v11, v11
  v_rcp_f32 v12, v12
  s_add_u32 m0, s30, 114688
  v_mfma_f32_32x32x16_bf16 v[64:79], v[24:27], v[168:171], v[64:79]
  ds_read_b64_tr_b16 v[20:21], v6 offset:19456
  ds_read_b64_tr_b16 v[22:23], v6 offset:19712
  buffer_load_dwordx4 v2, s[20:23], s70 offen offset:0 lds
  s_waitcnt lgkmcnt(4)
  v_mfma_f32_32x32x16_bf16 v[64:79], v[28:31], v[172:175], v[64:79]
  ds_read_b64_tr_b16 v[24:25], v6 offset:20480
  ds_read_b64_tr_b16 v[26:27], v6 offset:20736
  v_rcp_f32 v13, v13
  v_mfma_f32_32x32x16_bf16 v[64:79], v[32:35], v[176:179], v[64:79]
  ds_read_b64_tr_b16 v[28:29], v6 offset:21504
  ds_read_b64_tr_b16 v[30:31], v6 offset:21760
  v_mul_f32 v48, v48, v10
  v_mul_f32 v49, v49, v11
  v_mul_f32 v50, v50, v12
  v_mul_f32 v51, v51, v13
  v_mul_f32 v10, v52, v52
  v_mfma_f32_32x32x16_bf16 v[64:79], v[36:39], v[180:183], v[64:79]
  ds_read_b64_tr_b16 v[32:33], v6 offset:22528
  ds_read_b64_tr_b16 v[34:35], v6 offset:22784
  buffer_load_dwordx4 v2, s[20:23], s71 offen offset:1024 lds
  s_waitcnt lgkmcnt(4)
  v_mfma_f32_32x32x16_bf16 v[64:79], v[16:19], v[184:187], v[64:79]
  ds_read_b64_tr_b16 v[36:37], v6 offset:23552
  ds_read_b64_tr_b16 v[38:39], v6 offset:23808
  v_mul_f32 v11, v53, v53
  v_mul_f32 v12, v54, v54
  v_mul_f32 v13, v55, v55
  v_mfma_f32_32x32x16_bf16 v[64:79], v[20:23], v[188:191], v[64:79]
  ds_read_b64_tr_b16 v[16:17], v6 offset:24576
  ds_read_b64_tr_b16 v[18:19], v6 offset:24832
  v_fmaak_f32 v10, v10, v8, 0xc0135761
  v_fmaak_f32 v11, v11, v8, 0xc0135761
  v_fmaak_f32 v12, v12, v8, 0xc0135761
  v_fmaak_f32 v13, v13, v8, 0xc0135761
  v_mfma_f32_32x32x16_bf16 v[64:79], v[24:27], v[192:195], v[64:79]
  ds_read_b64_tr_b16 v[20:21], v6 offset:25600
  ds_read_b64_tr_b16 v[22:23], v6 offset:25856
  buffer_load_dwordx4 v2, s[20:23], s72 offen offset:2048 lds
  s_waitcnt lgkmcnt(4)
  v_mfma_f32_32x32x16_bf16 v[64:79], v[28:31], v[196:199], v[64:79]
  ds_read_b64_tr_b16 v[24:25], v6 offset:26624
  ds_read_b64_tr_b16 v[26:27], v6 offset:26880
  v_mul_f32 v10, v10, v52
  v_mul_f32 v11, v11, v53
  v_mul_f32 v12, v12, v54
  v_mul_f32 v13, v13, v55
  v_mfma_f32_32x32x16_bf16 v[64:79], v[32:35], v[200:203], v[64:79]
  ds_read_b64_tr_b16 v[28:29], v6 offset:27648
  ds_read_b64_tr_b16 v[30:31], v6 offset:27904
  v_exp_f32 v10, v10
  v_exp_f32 v11, v11
  v_mfma_f32_32x32x16_bf16 v[64:79], v[36:39], v[204:207], v[64:79]
  ds_read_b64_tr_b16 v[32:33], v6 offset:28672
  ds_read_b64_tr_b16 v[34:35], v6 offset:28928
  buffer_load_dwordx4 v2, s[20:23], s73 offen offset:3072 lds
  s_waitcnt lgkmcnt(4)
  v_mfma_f32_32x32x16_bf16 v[64:79], v[16:19], v[208:211], v[64:79]
  ds_read_b64_tr_b16 v[36:37], v6 offset:29696
  ds_read_b64_tr_b16 v[38:39], v6 offset:29952
  v_exp_f32 v12, v12
  v_exp_f32 v13, v13
  v_mfma_f32_32x32x16_bf16 v[64:79], v[20:23], v[212:215], v[64:79]
  ds_read_b64_tr_b16 v[16:17], v6 offset:30720
  ds_read_b64_tr_b16 v[18:19], v6 offset:30976
  v_add_f32 v10, 1.0, v10
  v_add_f32 v11, 1.0, v11
  s_add_u32 m0, s30, 118784
  v_mfma_f32_32x32x16_bf16 v[64:79], v[24:27], v[216:219], v[64:79]
  ds_read_b64_tr_b16 v[20:21], v6 offset:31744
  ds_read_b64_tr_b16 v[22:23], v6 offset:32000
  buffer_load_dwordx4 v2, s[20:23], s74 offen offset:0 lds
  v_add_f32 v12, 1.0, v12
  s_waitcnt lgkmcnt(4)
  v_mfma_f32_32x32x16_bf16 v[64:79], v[28:31], v[220:223], v[64:79]
  ds_read_b64_tr_b16 v[24:25], v6 offset:32768
  ds_read_b64_tr_b16 v[26:27], v6 offset:33024
  v_add_f32 v13, 1.0, v13
  v_add_u32 v2, 64, v2
  v_mfma_f32_32x32x16_bf16 v[64:79], v[32:35], v[224:227], v[64:79]
  ds_read_b64_tr_b16 v[28:29], v6 offset:33792
  ds_read_b64_tr_b16 v[30:31], v6 offset:34048
  v_rcp_f32 v10, v10
  v_rcp_f32 v11, v11
  v_mfma_f32_32x32x16_bf16 v[64:79], v[36:39], v[228:231], v[64:79]
  ds_read_b64_tr_b16 v[32:33], v6 offset:34816
  ds_read_b64_tr_b16 v[34:35], v6 offset:35072
  v_rcp_f32 v12, v12
  v_rcp_f32 v13, v13
  v_mul_f32 v52, v52, v10
  s_waitcnt lgkmcnt(4)
  v_mfma_f32_32x32x16_bf16 v[64:79], v[16:19], v[232:235], v[64:79]
  ds_read_b64_tr_b16 v[36:37], v6 offset:35840
  ds_read_b64_tr_b16 v[38:39], v6 offset:36096
  v_mul_f32 v53, v53, v11
  v_mul_f32 v54, v54, v12
  v_mul_f32 v55, v55, v13
  v_mfma_f32_32x32x16_bf16 v[64:79], v[20:23], v[236:239], v[64:79]
  s_waitcnt vmcnt(9)
  s_barrier
  v_add_u32 v6, 73728, v4
  ds_read_b64_tr_b16 v[16:17], v6 offset:0
  ds_read_b64_tr_b16 v[18:19], v6 offset:256
  global_load_dword a255, v[96:97], off
  v_add_co_u32 v96, vcc, 0x2000, v96
  v_addc_co_u32 v97, vcc, 0, v97, vcc
  v_mfma_f32_32x32x16_bf16 v[64:79], v[24:27], v[240:243], v[64:79]
  ds_read_b64_tr_b16 v[20:21], v6 offset:1024
  ds_read_b64_tr_b16 v[22:23], v6 offset:1280
  v_mul_f32 v10, v56, v56
  v_mul_f32 v11, v57, v57
  v_mul_f32 v12, v58, v58
  v_mul_f32 v13, v59, v59
  s_waitcnt lgkmcnt(4)
  v_mfma_f32_32x32x16_bf16 v[64:79], v[28:31], v[244:247], v[64:79]
  ds_read_b64_tr_b16 v[24:25], v6 offset:2048
  ds_read_b64_tr_b16 v[26:27], v6 offset:2304
  v_fmaak_f32 v10, v10, v8, 0xc0135761
  v_fmaak_f32 v11, v11, v8, 0xc0135761
  v_fmaak_f32 v12, v12, v8, 0xc0135761
  v_fmaak_f32 v13, v13, v8, 0xc0135761
  v_mfma_f32_32x32x16_bf16 v[64:79], v[32:35], v[248:251], v[64:79]
  ds_read_b64_tr_b16 v[28:29], v6 offset:3072
  ds_read_b64_tr_b16 v[30:31], v6 offset:3328
  v_mul_f32 v10, v10, v56
  v_mul_f32 v11, v11, v57
  v_mul_f32 v12, v12, v58
  v_mul_f32 v13, v13, v59
  v_mfma_f32_32x32x16_bf16 v[64:79], v[36:39], v[252:255], v[64:79]
  ds_read_b64_tr_b16 v[32:33], v6 offset:4096
  ds_read_b64_tr_b16 v[34:35], v6 offset:4352
  v_exp_f32 v10, v10
  v_exp_f32 v11, v11
  s_waitcnt lgkmcnt(4)
  v_mfma_f32_32x32x16_bf16 v[80:95], v[16:19], v[112:115], 0
  ds_read_b64_tr_b16 v[36:37], v6 offset:5120
  ds_read_b64_tr_b16 v[38:39], v6 offset:5376
  v_mfma_f32_32x32x16_bf16 v[80:95], v[20:23], v[116:119], v[80:95]
  ds_read_b64_tr_b16 v[16:17], v6 offset:6144
  ds_read_b64_tr_b16 v[18:19], v6 offset:6400
  v_exp_f32 v12, v12
  v_exp_f32 v13, v13
  s_add_u32 m0, s30, 0
  v_mfma_f32_32x32x16_bf16 v[80:95], v[24:27], v[120:123], v[80:95]
  ds_read_b64_tr_b16 v[20:21], v6 offset:7168
  ds_read_b64_tr_b16 v[22:23], v6 offset:7424
  buffer_load_dwordx4 v2, s[16:19], 0 offen offset:0 lds
  s_waitcnt lgkmcnt(4)
  v_mfma_f32_32x32x16_bf16 v[80:95], v[28:31], v[124:127], v[80:95]
  ds_read_b64_tr_b16 v[24:25], v6 offset:8192
  ds_read_b64_tr_b16 v[26:27], v6 offset:8448
  v_add_f32 v10, 1.0, v10
  v_add_f32 v11, 1.0, v11
  v_mfma_f32_32x32x16_bf16 v[80:95], v[32:35], v[128:131], v[80:95]
  ds_read_b64_tr_b16 v[28:29], v6 offset:9216
  ds_read_b64_tr_b16 v[30:31], v6 offset:9472
  v_add_f32 v12, 1.0, v12
  v_add_f32 v13, 1.0, v13
  v_rcp_f32 v10, v10
  v_mfma_f32_32x32x16_bf16 v[80:95], v[36:39], v[132:135], v[80:95]
  ds_read_b64_tr_b16 v[32:33], v6 offset:10240
  ds_read_b64_tr_b16 v[34:35], v6 offset:10496
  buffer_load_dwordx4 v2, s[16:19], s67 offen offset:1024 lds
  s_waitcnt lgkmcnt(4)
  v_mfma_f32_32x32x16_bf16 v[80:95], v[16:19], v[136:139], v[80:95]
  ds_read_b64_tr_b16 v[36:37], v6 offset:11264
  ds_read_b64_tr_b16 v[38:39], v6 offset:11520
  v_rcp_f32 v11, v11
  v_rcp_f32 v12, v12
  v_mfma_f32_32x32x16_bf16 v[80:95], v[20:23], v[140:143], v[80:95]
  ds_read_b64_tr_b16 v[16:17], v6 offset:12288
  ds_read_b64_tr_b16 v[18:19], v6 offset:12544
  v_rcp_f32 v13, v13
  v_mul_f32 v56, v56, v10
  v_mfma_f32_32x32x16_bf16 v[80:95], v[24:27], v[144:147], v[80:95]
  ds_read_b64_tr_b16 v[20:21], v6 offset:13312
  ds_read_b64_tr_b16 v[22:23], v6 offset:13568
  buffer_load_dwordx4 v2, s[16:19], s68 offen offset:2048 lds
  s_waitcnt lgkmcnt(4)
  v_mfma_f32_32x32x16_bf16 v[80:95], v[28:31], v[148:151], v[80:95]
  ds_read_b64_tr_b16 v[24:25], v6 offset:14336
  ds_read_b64_tr_b16 v[26:27], v6 offset:14592
  v_mul_f32 v57, v57, v11
  v_mul_f32 v58, v58, v12
  v_mul_f32 v59, v59, v13
  v_mul_f32 v10, v60, v60
  v_mfma_f32_32x32x16_bf16 v[80:95], v[32:35], v[152:155], v[80:95]
  ds_read_b64_tr_b16 v[28:29], v6 offset:15360
  ds_read_b64_tr_b16 v[30:31], v6 offset:15616
  v_mul_f32 v11, v61, v61
  v_mul_f32 v12, v62, v62
  v_mul_f32 v13, v63, v63
  v_fmaak_f32 v10, v10, v8, 0xc0135761
  v_mfma_f32_32x32x16_bf16 v[80:95], v[36:39], v[156:159], v[80:95]
  ds_read_b64_tr_b16 v[32:33], v6 offset:16384
  ds_read_b64_tr_b16 v[34:35], v6 offset:16640
  buffer_load_dwordx4 v2, s[16:19], s69 offen offset:3072 lds
  s_waitcnt lgkmcnt(4)
  v_mfma_f32_32x32x16_bf16 v[80:95], v[16:19], v[160:163], v[80:95]
  ds_read_b64_tr_b16 v[36:37], v6 offset:17408
  ds_read_b64_tr_b16 v[38:39], v6 offset:17664
  v_fmaak_f32 v11, v11, v8, 0xc0135761
  v_fmaak_f32 v12, v12, v8, 0xc0135761
  v_fmaak_f32 v13, v13, v8, 0xc0135761
  v_mfma_f32_32x32x16_bf16 v[80:95], v[20:23], v[164:167], v[80:95]
  ds_read_b64_tr_b16 v[16:17], v6 offset:18432
  ds_read_b64_tr_b16 v[18:19], v6 offset:18688
  v_mul_f32 v10, v10, v60
  v_mul_f32 v11, v11, v61
  v_mul_f32 v12, v12, v62
  s_add_u32 m0, s30, 4096
  v_mfma_f32_32x32x16_bf16 v[80:95], v[24:27], v[168:171], v[80:95]
  ds_read_b64_tr_b16 v[20:21], v6 offset:19456
  ds_read_b64_tr_b16 v[22:23], v6 offset:19712
  buffer_load_dwordx4 v2, s[16:19], s70 offen offset:0 lds
  s_waitcnt lgkmcnt(4)
  v_mfma_f32_32x32x16_bf16 v[80:95], v[28:31], v[172:175], v[80:95]
  ds_read_b64_tr_b16 v[24:25], v6 offset:20480
  ds_read_b64_tr_b16 v[26:27], v6 offset:20736
  v_mul_f32 v13, v13, v63
  v_exp_f32 v10, v10
  v_mfma_f32_32x32x16_bf16 v[80:95], v[32:35], v[176:179], v[80:95]
  ds_read_b64_tr_b16 v[28:29], v6 offset:21504
  ds_read_b64_tr_b16 v[30:31], v6 offset:21760
  v_exp_f32 v11, v11
  v_exp_f32 v12, v12
  v_mfma_f32_32x32x16_bf16 v[80:95], v[36:39], v[180:183], v[80:95]
  ds_read_b64_tr_b16 v[32:33], v6 offset:22528
  ds_read_b64_tr_b16 v[34:35], v6 offset:22784
  buffer_load_dwordx4 v2, s[16:19], s71 offen offset:1024 lds
  s_waitcnt lgkmcnt(4)
  v_mfma_f32_32x32x16_bf16 v[80:95], v[16:19], v[184:187], v[80:95]
  ds_read_b64_tr_b16 v[36:37], v6 offset:23552
  ds_read_b64_tr_b16 v[38:39], v6 offset:23808
  v_exp_f32 v13, v13
  v_add_f32 v10, 1.0, v10
  v_mfma_f32_32x32x16_bf16 v[80:95], v[20:23], v[188:191], v[80:95]
  ds_read_b64_tr_b16 v[16:17], v6 offset:24576
  ds_read_b64_tr_b16 v[18:19], v6 offset:24832
  v_add_f32 v11, 1.0, v11
  v_add_f32 v12, 1.0, v12
  v_add_f32 v13, 1.0, v13
  v_rcp_f32 v10, v10
  v_mfma_f32_32x32x16_bf16 v[80:95], v[24:27], v[192:195], v[80:95]
  ds_read_b64_tr_b16 v[20:21], v6 offset:25600
  ds_read_b64_tr_b16 v[22:23], v6 offset:25856
  buffer_load_dwordx4 v2, s[16:19], s72 offen offset:2048 lds
  s_waitcnt lgkmcnt(4)
  v_mfma_f32_32x32x16_bf16 v[80:95], v[28:31], v[196:199], v[80:95]
  ds_read_b64_tr_b16 v[24:25], v6 offset:26624
  ds_read_b64_tr_b16 v[26:27], v6 offset:26880
  v_rcp_f32 v11, v11
  v_mfma_f32_32x32x16_bf16 v[80:95], v[32:35], v[200:203], v[80:95]
  ds_read_b64_tr_b16 v[28:29], v6 offset:27648
  ds_read_b64_tr_b16 v[30:31], v6 offset:27904
  v_rcp_f32 v12, v12
  v_rcp_f32 v13, v13
  v_mfma_f32_32x32x16_bf16 v[80:95], v[36:39], v[204:207], v[80:95]
  ds_read_b64_tr_b16 v[32:33], v6 offset:28672
  ds_read_b64_tr_b16 v[34:35], v6 offset:28928
  buffer_load_dwordx4 v2, s[16:19], s73 offen offset:3072 lds
  s_waitcnt lgkmcnt(4)
  v_mfma_f32_32x32x16_bf16 v[80:95], v[16:19], v[208:211], v[80:95]
  ds_read_b64_tr_b16 v[36:37], v6 offset:29696
  ds_read_b64_tr_b16 v[38:39], v6 offset:29952
  v_mul_f32 v60, v60, v10
  v_mul_f32 v61, v61, v11
  v_mul_f32 v62, v62, v12
  v_mfma_f32_32x32x16_bf16 v[80:95], v[20:23], v[212:215], v[80:95]
  ds_read_b64_tr_b16 v[16:17], v6 offset:30720
  ds_read_b64_tr_b16 v[18:19], v6 offset:30976
  v_mul_f32 v63, v63, v13
  v_mul_f32 v64, v64, v48
  v_mul_f32 v65, v65, v49
  s_add_u32 m0, s30, 8192
  v_mfma_f32_32x32x16_bf16 v[80:95], v[24:27], v[216:219], v[80:95]
  ds_read_b64_tr_b16 v[20:21], v6 offset:31744
  ds_read_b64_tr_b16 v[22:23], v6 offset:32000
  buffer_load_dwordx4 v2, s[16:19], s74 offen offset:0 lds
  s_waitcnt lgkmcnt(4)
  v_mfma_f32_32x32x16_bf16 v[80:95], v[28:31], v[220:223], v[80:95]
  ds_read_b64_tr_b16 v[24:25], v6 offset:32768
  ds_read_b64_tr_b16 v[26:27], v6 offset:33024
  v_mul_f32 v66, v66, v50
  v_mul_f32 v67, v67, v51
  v_mul_f32 v68, v68, v52
  v_mul_f32 v69, v69, v53
  v_mfma_f32_32x32x16_bf16 v[80:95], v[32:35], v[224:227], v[80:95]
  ds_read_b64_tr_b16 v[28:29], v6 offset:33792
  ds_read_b64_tr_b16 v[30:31], v6 offset:34048
  v_mul_f32 v70, v70, v54
  v_mul_f32 v71, v71, v55
  v_mul_f32 v72, v72, v56
  v_mul_f32 v73, v73, v57
  v_mfma_f32_32x32x16_bf16 v[80:95], v[36:39], v[228:231], v[80:95]
  ds_read_b64_tr_b16 v[32:33], v6 offset:34816
  ds_read_b64_tr_b16 v[34:35], v6 offset:35072
  buffer_load_dword a253, v7, s[16:19], 0 offen offset:768
  v_mul_f32 v74, v74, v58
  v_mul_f32 v75, v75, v59
  v_mul_f32 v76, v76, v60
  s_waitcnt lgkmcnt(4)
  v_mfma_f32_32x32x16_bf16 v[80:95], v[16:19], v[232:235], v[80:95]
  ds_read_b64_tr_b16 v[36:37], v6 offset:35840
  ds_read_b64_tr_b16 v[38:39], v6 offset:36096
  v_mul_f32 v77, v77, v61
  v_mul_f32 v78, v78, v62
  v_mul_f32 v79, v79, v63
  v_mfma_f32_32x32x16_bf16 v[80:95], v[20:23], v[236:239], v[80:95]
  s_waitcnt vmcnt(11)
  s_barrier
  v_add_u32 v6, 110592, v4
  ds_read_b64_tr_b16 v[16:17], v6 offset:0
  ds_read_b64_tr_b16 v[18:19], v6 offset:256
  v_cvt_pk_bf16_f32 v40, v64, v65
  v_mfma_f32_32x32x16_bf16 v[80:95], v[24:27], v[240:243], v[80:95]
  ds_read_b64_tr_b16 v[20:21], v6 offset:1024
  ds_read_b64_tr_b16 v[22:23], v6 offset:1280
  v_cvt_pk_bf16_f32 v41, v66, v67
  v_cvt_pk_bf16_f32 v42, v68, v69
  v_cvt_pk_bf16_f32 v43, v70, v71
  v_cvt_pk_bf16_f32 v44, v72, v73
  s_waitcnt lgkmcnt(4)
  v_mfma_f32_32x32x16_bf16 v[80:95], v[28:31], v[244:247], v[80:95]
  ds_read_b64_tr_b16 v[24:25], v6 offset:2048
  ds_read_b64_tr_b16 v[26:27], v6 offset:2304
  v_cvt_pk_bf16_f32 v45, v74, v75
  v_cvt_pk_bf16_f32 v46, v76, v77
  v_cvt_pk_bf16_f32 v47, v78, v79
  v_mfma_f32_32x32x16_bf16 v[80:95], v[32:35], v[248:251], v[80:95]
  ds_read_b64_tr_b16 v[28:29], v6 offset:3072
  ds_read_b64_tr_b16 v[30:31], v6 offset:3328
  v_accvgpr_write_b32 a48, v40
  v_accvgpr_write_b32 a49, v41
  v_accvgpr_write_b32 a50, v42
  v_accvgpr_write_b32 a51, v43
  v_mfma_f32_32x32x16_bf16 v[80:95], v[36:39], v[252:255], v[80:95]
  ds_read_b64_tr_b16 v[32:33], v6 offset:4096
  ds_read_b64_tr_b16 v[34:35], v6 offset:4352
  v_accvgpr_write_b32 a52, v44
  v_accvgpr_write_b32 a53, v45
  v_accvgpr_write_b32 a54, v46
  v_accvgpr_write_b32 a55, v47
  s_waitcnt lgkmcnt(4)
  v_mfma_f32_32x32x16_bf16 v[64:79], v[16:19], v[112:115], 0
  ds_read_b64_tr_b16 v[36:37], v6 offset:5120
  ds_read_b64_tr_b16 v[38:39], v6 offset:5376
  v_mfma_f32_32x32x16_bf16 v[64:79], v[20:23], v[116:119], v[64:79]
  ds_read_b64_tr_b16 v[16:17], v6 offset:6144
  ds_read_b64_tr_b16 v[18:19], v6 offset:6400
  s_add_u32 m0, s30, 36864
  v_mfma_f32_32x32x16_bf16 v[64:79], v[24:27], v[120:123], v[64:79]
  ds_read_b64_tr_b16 v[20:21], v6 offset:7168
  ds_read_b64_tr_b16 v[22:23], v6 offset:7424
  buffer_load_dwordx4 v2, s[20:23], 0 offen offset:0 lds
  s_waitcnt lgkmcnt(4)
  v_mfma_f32_32x32x16_bf16 v[64:79], v[28:31], v[124:127], v[64:79]
  ds_read_b64_tr_b16 v[24:25], v6 offset:8192
  ds_read_b64_tr_b16 v[26:27], v6 offset:8448
  v_mul_f32 v10, v80, v80
  v_mul_f32 v11, v81, v81
  v_mul_f32 v12, v82, v82
  v_mfma_f32_32x32x16_bf16 v[64:79], v[32:35], v[128:131], v[64:79]
  ds_read_b64_tr_b16 v[28:29], v6 offset:9216
  ds_read_b64_tr_b16 v[30:31], v6 offset:9472
  v_mul_f32 v13, v83, v83
  v_fmaak_f32 v10, v10, v8, 0xc0135761
  v_fmaak_f32 v11, v11, v8, 0xc0135761
  v_fmaak_f32 v12, v12, v8, 0xc0135761
  v_mfma_f32_32x32x16_bf16 v[64:79], v[36:39], v[132:135], v[64:79]
  ds_read_b64_tr_b16 v[32:33], v6 offset:10240
  ds_read_b64_tr_b16 v[34:35], v6 offset:10496
  buffer_load_dwordx4 v2, s[20:23], s67 offen offset:1024 lds
  v_fmaak_f32 v13, v13, v8, 0xc0135761
  s_waitcnt lgkmcnt(4)
  v_mfma_f32_32x32x16_bf16 v[64:79], v[16:19], v[136:139], v[64:79]
  ds_read_b64_tr_b16 v[36:37], v6 offset:11264
  ds_read_b64_tr_b16 v[38:39], v6 offset:11520
  v_mul_f32 v10, v10, v80
  v_mul_f32 v11, v11, v81
  v_mul_f32 v12, v12, v82
  v_mfma_f32_32x32x16_bf16 v[64:79], v[20:23], v[140:143], v[64:79]
  ds_read_b64_tr_b16 v[16:17], v6 offset:12288
  ds_read_b64_tr_b16 v[18:19], v6 offset:12544
  v_mul_f32 v13, v13, v83
  v_exp_f32 v10, v10
  v_mfma_f32_32x32x16_bf16 v[64:79], v[24:27], v[144:147], v[64:79]
  ds_read_b64_tr_b16 v[20:21], v6 offset:13312
  ds_read_b64_tr_b16 v[22:23], v6 offset:13568
  buffer_load_dwordx4 v2, s[20:23], s68 offen offset:2048 lds
  v_exp_f32 v11, v11
  s_waitcnt lgkmcnt(4)
  v_mfma_f32_32x32x16_bf16 v[64:79], v[28:31], v[148:151], v[64:79]
  ds_read_b64_tr_b16 v[24:25], v6 offset:14336
  ds_read_b64_tr_b16 v[26:27], v6 offset:14592
  v_exp_f32 v12, v12
  v_mfma_f32_32x32x16_bf16 v[64:79], v[32:35], v[152:155], v[64:79]
  ds_read_b64_tr_b16 v[28:29], v6 offset:15360
  ds_read_b64_tr_b16 v[30:31], v6 offset:15616
  v_exp_f32 v13, v13
  v_add_f32 v10, 1.0, v10
  v_add_f32 v11, 1.0, v11
  v_mfma_f32_32x32x16_bf16 v[64:79], v[36:39], v[156:159], v[64:79]
  ds_read_b64_tr_b16 v[32:33], v6 offset:16384
  ds_read_b64_tr_b16 v[34:35], v6 offset:16640
  buffer_load_dwordx4 v2, s[20:23], s69 offen offset:3072 lds
  v_add_f32 v12, 1.0, v12
  s_waitcnt lgkmcnt(4)
  v_mfma_f32_32x32x16_bf16 v[64:79], v[16:19], v[160:163], v[64:79]
  ds_read_b64_tr_b16 v[36:37], v6 offset:17408
  ds_read_b64_tr_b16 v[38:39], v6 offset:17664
  v_add_f32 v13, 1.0, v13
  v_rcp_f32 v10, v10
  v_mfma_f32_32x32x16_bf16 v[64:79], v[20:23], v[164:167], v[64:79]
  ds_read_b64_tr_b16 v[16:17], v6 offset:18432
  ds_read_b64_tr_b16 v[18:19], v6 offset:18688
  v_rcp_f32 v11, v11
  v_rcp_f32 v12, v12
  s_add_u32 m0, s30, 40960
  v_mfma_f32_32x32x16_bf16 v[64:79], v[24:27], v[168:171], v[64:79]
  ds_read_b64_tr_b16 v[20:21], v6 offset:19456
  ds_read_b64_tr_b16 v[22:23], v6 offset:19712
  buffer_load_dwordx4 v2, s[20:23], s70 offen offset:0 lds
  s_waitcnt lgkmcnt(4)
  v_mfma_f32_32x32x16_bf16 v[64:79], v[28:31], v[172:175], v[64:79]
  ds_read_b64_tr_b16 v[24:25], v6 offset:20480
  ds_read_b64_tr_b16 v[26:27], v6 offset:20736
  v_rcp_f32 v13, v13
  v_mfma_f32_32x32x16_bf16 v[64:79], v[32:35], v[176:179], v[64:79]
  ds_read_b64_tr_b16 v[28:29], v6 offset:21504
  ds_read_b64_tr_b16 v[30:31], v6 offset:21760
  v_mul_f32 v80, v80, v10
  v_mul_f32 v81, v81, v11
  v_mul_f32 v82, v82, v12
  v_mul_f32 v83, v83, v13
  v_mul_f32 v10, v84, v84
  v_mfma_f32_32x32x16_bf16 v[64:79], v[36:39], v[180:183], v[64:79]
  ds_read_b64_tr_b16 v[32:33], v6 offset:22528
  ds_read_b64_tr_b16 v[34:35], v6 offset:22784
  buffer_load_dwordx4 v2, s[20:23], s71 offen offset:1024 lds
  s_waitcnt lgkmcnt(4)
  v_mfma_f32_32x32x16_bf16 v[64:79], v[16:19], v[184:187], v[64:79]
  ds_read_b64_tr_b16 v[36:37], v6 offset:23552
  ds_read_b64_tr_b16 v[38:39], v6 offset:23808
  v_mul_f32 v11, v85, v85
  v_mul_f32 v12, v86, v86
  v_mul_f32 v13, v87, v87
  v_mfma_f32_32x32x16_bf16 v[64:79], v[20:23], v[188:191], v[64:79]
  ds_read_b64_tr_b16 v[16:17], v6 offset:24576
  ds_read_b64_tr_b16 v[18:19], v6 offset:24832
  v_fmaak_f32 v10, v10, v8, 0xc0135761
  v_fmaak_f32 v11, v11, v8, 0xc0135761
  v_fmaak_f32 v12, v12, v8, 0xc0135761
  v_fmaak_f32 v13, v13, v8, 0xc0135761
  v_mfma_f32_32x32x16_bf16 v[64:79], v[24:27], v[192:195], v[64:79]
  ds_read_b64_tr_b16 v[20:21], v6 offset:25600
  ds_read_b64_tr_b16 v[22:23], v6 offset:25856
  buffer_load_dwordx4 v2, s[20:23], s72 offen offset:2048 lds
  s_waitcnt lgkmcnt(4)
  v_mfma_f32_32x32x16_bf16 v[64:79], v[28:31], v[196:199], v[64:79]
  ds_read_b64_tr_b16 v[24:25], v6 offset:26624
  ds_read_b64_tr_b16 v[26:27], v6 offset:26880
  v_mul_f32 v10, v10, v84
  v_mul_f32 v11, v11, v85
  v_mul_f32 v12, v12, v86
  v_mfma_f32_32x32x16_bf16 v[64:79], v[32:35], v[200:203], v[64:79]
  ds_read_b64_tr_b16 v[28:29], v6 offset:27648
  ds_read_b64_tr_b16 v[30:31], v6 offset:27904
  v_mul_f32 v13, v13, v87
  v_exp_f32 v10, v10
  v_exp_f32 v11, v11
  v_mfma_f32_32x32x16_bf16 v[64:79], v[36:39], v[204:207], v[64:79]
  ds_read_b64_tr_b16 v[32:33], v6 offset:28672
  ds_read_b64_tr_b16 v[34:35], v6 offset:28928
  buffer_load_dwordx4 v2, s[20:23], s73 offen offset:3072 lds
  s_waitcnt lgkmcnt(4)
  v_mfma_f32_32x32x16_bf16 v[64:79], v[16:19], v[208:211], v[64:79]
  ds_read_b64_tr_b16 v[36:37], v6 offset:29696
  ds_read_b64_tr_b16 v[38:39], v6 offset:29952
  v_exp_f32 v12, v12
  v_exp_f32 v13, v13
  v_mfma_f32_32x32x16_bf16 v[64:79], v[20:23], v[212:215], v[64:79]
  ds_read_b64_tr_b16 v[16:17], v6 offset:30720
  ds_read_b64_tr_b16 v[18:19], v6 offset:30976
  v_add_f32 v10, 1.0, v10
  v_add_f32 v11, 1.0, v11
  s_add_u32 m0, s30, 45056
  v_mfma_f32_32x32x16_bf16 v[64:79], v[24:27], v[216:219], v[64:79]
  ds_read_b64_tr_b16 v[20:21], v6 offset:31744
  ds_read_b64_tr_b16 v[22:23], v6 offset:32000
  buffer_load_dwordx4 v2, s[20:23], s74 offen offset:0 lds
  s_waitcnt lgkmcnt(4)
  v_mfma_f32_32x32x16_bf16 v[64:79], v[28:31], v[220:223], v[64:79]
  ds_read_b64_tr_b16 v[24:25], v6 offset:32768
  ds_read_b64_tr_b16 v[26:27], v6 offset:33024
  v_add_f32 v12, 1.0, v12
  v_add_f32 v13, 1.0, v13
  v_add_u32 v2, 64, v2
  v_mfma_f32_32x32x16_bf16 v[64:79], v[32:35], v[224:227], v[64:79]
  ds_read_b64_tr_b16 v[28:29], v6 offset:33792
  ds_read_b64_tr_b16 v[30:31], v6 offset:34048
  v_rcp_f32 v10, v10
  v_rcp_f32 v11, v11
  v_mfma_f32_32x32x16_bf16 v[64:79], v[36:39], v[228:231], v[64:79]
  ds_read_b64_tr_b16 v[32:33], v6 offset:34816
  ds_read_b64_tr_b16 v[34:35], v6 offset:35072
  buffer_load_dword a253, v7, s[20:23], 0 offen offset:768
  v_rcp_f32 v12, v12
  v_rcp_f32 v13, v13
  s_waitcnt lgkmcnt(4)
  v_mfma_f32_32x32x16_bf16 v[64:79], v[16:19], v[232:235], v[64:79]
  ds_read_b64_tr_b16 v[36:37], v6 offset:35840
  ds_read_b64_tr_b16 v[38:39], v6 offset:36096
  v_mul_f32 v84, v84, v10
  v_mul_f32 v85, v85, v11
  v_mul_f32 v86, v86, v12
  v_mfma_f32_32x32x16_bf16 v[64:79], v[20:23], v[236:239], v[64:79]
  s_waitcnt vmcnt(11)
  s_barrier
  v_add_u32 v6, 0, v4
  ds_read_b64_tr_b16 v[16:17], v6 offset:0
  ds_read_b64_tr_b16 v[18:19], v6 offset:256
  v_mul_f32 v87, v87, v13
  v_mfma_f32_32x32x16_bf16 v[64:79], v[24:27], v[240:243], v[64:79]
  ds_read_b64_tr_b16 v[20:21], v6 offset:1024
  ds_read_b64_tr_b16 v[22:23], v6 offset:1280
  v_mul_f32 v10, v88, v88
  v_mul_f32 v11, v89, v89
  v_mul_f32 v12, v90, v90
  v_mul_f32 v13, v91, v91
  s_waitcnt lgkmcnt(4)
  v_mfma_f32_32x32x16_bf16 v[64:79], v[28:31], v[244:247], v[64:79]
  ds_read_b64_tr_b16 v[24:25], v6 offset:2048
  ds_read_b64_tr_b16 v[26:27], v6 offset:2304
  v_fmaak_f32 v10, v10, v8, 0xc0135761
  v_fmaak_f32 v11, v11, v8, 0xc0135761
  v_fmaak_f32 v12, v12, v8, 0xc0135761
  v_fmaak_f32 v13, v13, v8, 0xc0135761
  v_mfma_f32_32x32x16_bf16 v[64:79], v[32:35], v[248:251], v[64:79]
  ds_read_b64_tr_b16 v[28:29], v6 offset:3072
  ds_read_b64_tr_b16 v[30:31], v6 offset:3328
  v_mul_f32 v10, v10, v88
  v_mul_f32 v11, v11, v89
  v_mul_f32 v12, v12, v90
  v_mul_f32 v13, v13, v91
  v_mfma_f32_32x32x16_bf16 v[64:79], v[36:39], v[252:255], v[64:79]
  ds_read_b64_tr_b16 v[32:33], v6 offset:4096
  ds_read_b64_tr_b16 v[34:35], v6 offset:4352
  v_exp_f32 v10, v10
  v_exp_f32 v11, v11
  s_waitcnt lgkmcnt(4)
  v_mfma_f32_32x32x16_bf16 v[48:63], v[16:19], v[112:115], 0
  ds_read_b64_tr_b16 v[36:37], v6 offset:5120
  ds_read_b64_tr_b16 v[38:39], v6 offset:5376
  v_mfma_f32_32x32x16_bf16 v[48:63], v[20:23], v[116:119], v[48:63]
  ds_read_b64_tr_b16 v[16:17], v6 offset:6144
  ds_read_b64_tr_b16 v[18:19], v6 offset:6400
  v_exp_f32 v12, v12
  v_exp_f32 v13, v13
  s_add_u32 m0, s30, 73728
  v_mfma_f32_32x32x16_bf16 v[48:63], v[24:27], v[120:123], v[48:63]
  ds_read_b64_tr_b16 v[20:21], v6 offset:7168
  ds_read_b64_tr_b16 v[22:23], v6 offset:7424
  buffer_load_dwordx4 v2, s[16:19], 0 offen offset:0 lds
  s_waitcnt lgkmcnt(4)
  v_mfma_f32_32x32x16_bf16 v[48:63], v[28:31], v[124:127], v[48:63]
  ds_read_b64_tr_b16 v[24:25], v6 offset:8192
  ds_read_b64_tr_b16 v[26:27], v6 offset:8448
  v_add_f32 v10, 1.0, v10
  v_add_f32 v11, 1.0, v11
  v_mfma_f32_32x32x16_bf16 v[48:63], v[32:35], v[128:131], v[48:63]
  ds_read_b64_tr_b16 v[28:29], v6 offset:9216
  ds_read_b64_tr_b16 v[30:31], v6 offset:9472
  v_add_f32 v12, 1.0, v12
  v_add_f32 v13, 1.0, v13
  v_rcp_f32 v10, v10
  v_mfma_f32_32x32x16_bf16 v[48:63], v[36:39], v[132:135], v[48:63]
  ds_read_b64_tr_b16 v[32:33], v6 offset:10240
  ds_read_b64_tr_b16 v[34:35], v6 offset:10496
  buffer_load_dwordx4 v2, s[16:19], s67 offen offset:1024 lds
  s_waitcnt lgkmcnt(4)
  v_mfma_f32_32x32x16_bf16 v[48:63], v[16:19], v[136:139], v[48:63]
  ds_read_b64_tr_b16 v[36:37], v6 offset:11264
  ds_read_b64_tr_b16 v[38:39], v6 offset:11520
  v_rcp_f32 v11, v11
  v_rcp_f32 v12, v12
  v_mfma_f32_32x32x16_bf16 v[48:63], v[20:23], v[140:143], v[48:63]
  ds_read_b64_tr_b16 v[16:17], v6 offset:12288
  ds_read_b64_tr_b16 v[18:19], v6 offset:12544
  v_rcp_f32 v13, v13
  v_mul_f32 v88, v88, v10
  v_mfma_f32_32x32x16_bf16 v[48:63], v[24:27], v[144:147], v[48:63]
  ds_read_b64_tr_b16 v[20:21], v6 offset:13312
  ds_read_b64_tr_b16 v[22:23], v6 offset:13568
  buffer_load_dwordx4 v2, s[16:19], s68 offen offset:2048 lds
  s_waitcnt lgkmcnt(4)
  v_mfma_f32_32x32x16_bf16 v[48:63], v[28:31], v[148:151], v[48:63]
  ds_read_b64_tr_b16 v[24:25], v6 offset:14336
  ds_read_b64_tr_b16 v[26:27], v6 offset:14592
  v_mul_f32 v89, v89, v11
  v_mul_f32 v90, v90, v12
  v_mul_f32 v91, v91, v13
  v_mfma_f32_32x32x16_bf16 v[48:63], v[32:35], v[152:155], v[48:63]
  ds_read_b64_tr_b16 v[28:29], v6 offset:15360
  ds_read_b64_tr_b16 v[30:31], v6 offset:15616
  v_mul_f32 v10, v92, v92
  v_mul_f32 v11, v93, v93
  v_mul_f32 v12, v94, v94
  v_mul_f32 v13, v95, v95
  v_mfma_f32_32x32x16_bf16 v[48:63], v[36:39], v[156:159], v[48:63]
  ds_read_b64_tr_b16 v[32:33], v6 offset:16384
  ds_read_b64_tr_b16 v[34:35], v6 offset:16640
  buffer_load_dwordx4 v2, s[16:19], s69 offen offset:3072 lds
  s_waitcnt lgkmcnt(4)
  v_mfma_f32_32x32x16_bf16 v[48:63], v[16:19], v[160:163], v[48:63]
  ds_read_b64_tr_b16 v[36:37], v6 offset:17408
  ds_read_b64_tr_b16 v[38:39], v6 offset:17664
  v_fmaak_f32 v10, v10, v8, 0xc0135761
  v_fmaak_f32 v11, v11, v8, 0xc0135761
  v_fmaak_f32 v12, v12, v8, 0xc0135761
  v_mfma_f32_32x32x16_bf16 v[48:63], v[20:23], v[164:167], v[48:63]
  ds_read_b64_tr_b16 v[16:17], v6 offset:18432
  ds_read_b64_tr_b16 v[18:19], v6 offset:18688
  v_fmaak_f32 v13, v13, v8, 0xc0135761
  v_mul_f32 v10, v10, v92
  v_mul_f32 v11, v11, v93
  s_add_u32 m0, s30, 77824
  v_mfma_f32_32x32x16_bf16 v[48:63], v[24:27], v[168:171], v[48:63]
  ds_read_b64_tr_b16 v[20:21], v6 offset:19456
  ds_read_b64_tr_b16 v[22:23], v6 offset:19712
  buffer_load_dwordx4 v2, s[16:19], s70 offen offset:0 lds
  s_waitcnt lgkmcnt(4)
  v_mfma_f32_32x32x16_bf16 v[48:63], v[28:31], v[172:175], v[48:63]
  ds_read_b64_tr_b16 v[24:25], v6 offset:20480
  ds_read_b64_tr_b16 v[26:27], v6 offset:20736
  v_mul_f32 v12, v12, v94
  v_mul_f32 v13, v13, v95
  v_exp_f32 v10, v10
  v_mfma_f32_32x32x16_bf16 v[48:63], v[32:35], v[176:179], v[48:63]
  ds_read_b64_tr_b16 v[28:29], v6 offset:21504
  ds_read_b64_tr_b16 v[30:31], v6 offset:21760
  v_exp_f32 v11, v11
  v_exp_f32 v12, v12
  v_mfma_f32_32x32x16_bf16 v[48:63], v[36:39], v[180:183], v[48:63]
  ds_read_b64_tr_b16 v[32:33], v6 offset:22528
  ds_read_b64_tr_b16 v[34:35], v6 offset:22784
  buffer_load_dwordx4 v2, s[16:19], s71 offen offset:1024 lds
  s_waitcnt lgkmcnt(4)
  v_mfma_f32_32x32x16_bf16 v[48:63], v[16:19], v[184:187], v[48:63]
  ds_read_b64_tr_b16 v[36:37], v6 offset:23552
  ds_read_b64_tr_b16 v[38:39], v6 offset:23808
  v_exp_f32 v13, v13
  v_add_f32 v10, 1.0, v10
  v_mfma_f32_32x32x16_bf16 v[48:63], v[20:23], v[188:191], v[48:63]
  ds_read_b64_tr_b16 v[16:17], v6 offset:24576
  ds_read_b64_tr_b16 v[18:19], v6 offset:24832
  v_add_f32 v11, 1.0, v11
  v_add_f32 v12, 1.0, v12
  v_add_f32 v13, 1.0, v13
  v_mfma_f32_32x32x16_bf16 v[48:63], v[24:27], v[192:195], v[48:63]
  ds_read_b64_tr_b16 v[20:21], v6 offset:25600
  ds_read_b64_tr_b16 v[22:23], v6 offset:25856
  buffer_load_dwordx4 v2, s[16:19], s72 offen offset:2048 lds
  s_waitcnt lgkmcnt(4)
  v_mfma_f32_32x32x16_bf16 v[48:63], v[28:31], v[196:199], v[48:63]
  ds_read_b64_tr_b16 v[24:25], v6 offset:26624
  ds_read_b64_tr_b16 v[26:27], v6 offset:26880
  v_rcp_f32 v10, v10
  v_rcp_f32 v11, v11
  v_mfma_f32_32x32x16_bf16 v[48:63], v[32:35], v[200:203], v[48:63]
  ds_read_b64_tr_b16 v[28:29], v6 offset:27648
  ds_read_b64_tr_b16 v[30:31], v6 offset:27904
  v_rcp_f32 v12, v12
  v_rcp_f32 v13, v13
  v_mfma_f32_32x32x16_bf16 v[48:63], v[36:39], v[204:207], v[48:63]
  ds_read_b64_tr_b16 v[32:33], v6 offset:28672
  ds_read_b64_tr_b16 v[34:35], v6 offset:28928
  buffer_load_dwordx4 v2, s[16:19], s73 offen offset:3072 lds
  s_waitcnt lgkmcnt(4)
  v_mfma_f32_32x32x16_bf16 v[48:63], v[16:19], v[208:211], v[48:63]
  ds_read_b64_tr_b16 v[36:37], v6 offset:29696
  ds_read_b64_tr_b16 v[38:39], v6 offset:29952
  v_mul_f32 v92, v92, v10
  v_mul_f32 v93, v93, v11
  v_mul_f32 v94, v94, v12
  v_mfma_f32_32x32x16_bf16 v[48:63], v[20:23], v[212:215], v[48:63]
  ds_read_b64_tr_b16 v[16:17], v6 offset:30720
  ds_read_b64_tr_b16 v[18:19], v6 offset:30976
  v_mul_f32 v95, v95, v13
  v_mul_f32 v64, v64, v80
  v_mul_f32 v65, v65, v81
  s_add_u32 m0, s30, 81920
  v_mfma_f32_32x32x16_bf16 v[48:63], v[24:27], v[216:219], v[48:63]
  ds_read_b64_tr_b16 v[20:21], v6 offset:31744
  ds_read_b64_tr_b16 v[22:23], v6 offset:32000
  buffer_load_dwordx4 v2, s[16:19], s74 offen offset:0 lds
  s_waitcnt lgkmcnt(4)
  v_mfma_f32_32x32x16_bf16 v[48:63], v[28:31], v[220:223], v[48:63]
  ds_read_b64_tr_b16 v[24:25], v6 offset:32768
  ds_read_b64_tr_b16 v[26:27], v6 offset:33024
  v_mul_f32 v66, v66, v82
  v_mul_f32 v67, v67, v83
  v_mul_f32 v68, v68, v84
  v_mfma_f32_32x32x16_bf16 v[48:63], v[32:35], v[224:227], v[48:63]
  ds_read_b64_tr_b16 v[28:29], v6 offset:33792
  ds_read_b64_tr_b16 v[30:31], v6 offset:34048
  v_mul_f32 v69, v69, v85
  v_mul_f32 v70, v70, v86
  v_mul_f32 v71, v71, v87
  v_mul_f32 v72, v72, v88
  v_mfma_f32_32x32x16_bf16 v[48:63], v[36:39], v[228:231], v[48:63]
  ds_read_b64_tr_b16 v[32:33], v6 offset:34816
  ds_read_b64_tr_b16 v[34:35], v6 offset:35072
  v_mul_f32 v73, v73, v89
  v_mul_f32 v74, v74, v90
  v_mul_f32 v75, v75, v91
  v_mul_f32 v76, v76, v92
  s_waitcnt lgkmcnt(4)
  v_mfma_f32_32x32x16_bf16 v[48:63], v[16:19], v[232:235], v[48:63]
  ds_read_b64_tr_b16 v[36:37], v6 offset:35840
  ds_read_b64_tr_b16 v[38:39], v6 offset:36096
  v_mul_f32 v77, v77, v93
  v_mul_f32 v78, v78, v94
  v_mul_f32 v79, v79, v95
  v_mfma_f32_32x32x16_bf16 v[48:63], v[20:23], v[236:239], v[48:63]
  s_waitcnt vmcnt(10)
  s_barrier
  v_add_u32 v6, 36864, v4
  ds_read_b64_tr_b16 v[16:17], v6 offset:0
  ds_read_b64_tr_b16 v[18:19], v6 offset:256
  v_cvt_pk_bf16_f32 v40, v64, v65
  v_mfma_f32_32x32x16_bf16 v[48:63], v[24:27], v[240:243], v[48:63]
  ds_read_b64_tr_b16 v[20:21], v6 offset:1024
  ds_read_b64_tr_b16 v[22:23], v6 offset:1280
  v_cvt_pk_bf16_f32 v41, v66, v67
  v_cvt_pk_bf16_f32 v42, v68, v69
  v_cvt_pk_bf16_f32 v43, v70, v71
  v_cvt_pk_bf16_f32 v44, v72, v73
  s_waitcnt lgkmcnt(4)
  v_mfma_f32_32x32x16_bf16 v[48:63], v[28:31], v[244:247], v[48:63]
  ds_read_b64_tr_b16 v[24:25], v6 offset:2048
  ds_read_b64_tr_b16 v[26:27], v6 offset:2304
  v_cvt_pk_bf16_f32 v45, v74, v75
  v_cvt_pk_bf16_f32 v46, v76, v77
  v_cvt_pk_bf16_f32 v47, v78, v79
  v_mfma_f32_32x32x16_bf16 v[48:63], v[32:35], v[248:251], v[48:63]
  ds_read_b64_tr_b16 v[28:29], v6 offset:3072
  ds_read_b64_tr_b16 v[30:31], v6 offset:3328
  v_accvgpr_write_b32 a56, v40
  v_accvgpr_write_b32 a57, v41
  v_accvgpr_write_b32 a58, v42
  v_accvgpr_write_b32 a59, v43
  v_mfma_f32_32x32x16_bf16 v[48:63], v[36:39], v[252:255], v[48:63]
  ds_read_b64_tr_b16 v[32:33], v6 offset:4096
  ds_read_b64_tr_b16 v[34:35], v6 offset:4352
  v_accvgpr_write_b32 a60, v44
  v_accvgpr_write_b32 a61, v45
  v_accvgpr_write_b32 a62, v46
  v_accvgpr_write_b32 a63, v47
  s_waitcnt lgkmcnt(4)
  v_mfma_f32_32x32x16_bf16 v[64:79], v[16:19], v[112:115], 0
  ds_read_b64_tr_b16 v[36:37], v6 offset:5120
  ds_read_b64_tr_b16 v[38:39], v6 offset:5376
  v_mfma_f32_32x32x16_bf16 v[64:79], v[20:23], v[116:119], v[64:79]
  ds_read_b64_tr_b16 v[16:17], v6 offset:6144
  ds_read_b64_tr_b16 v[18:19], v6 offset:6400
  s_add_u32 m0, s30, 110592
  v_mfma_f32_32x32x16_bf16 v[64:79], v[24:27], v[120:123], v[64:79]
  ds_read_b64_tr_b16 v[20:21], v6 offset:7168
  ds_read_b64_tr_b16 v[22:23], v6 offset:7424
  buffer_load_dwordx4 v2, s[20:23], 0 offen offset:0 lds
  s_waitcnt lgkmcnt(4)
  v_mfma_f32_32x32x16_bf16 v[64:79], v[28:31], v[124:127], v[64:79]
  ds_read_b64_tr_b16 v[24:25], v6 offset:8192
  ds_read_b64_tr_b16 v[26:27], v6 offset:8448
  v_mul_f32 v10, v48, v48
  v_mul_f32 v11, v49, v49
  v_mul_f32 v12, v50, v50
  v_mfma_f32_32x32x16_bf16 v[64:79], v[32:35], v[128:131], v[64:79]
  ds_read_b64_tr_b16 v[28:29], v6 offset:9216
  ds_read_b64_tr_b16 v[30:31], v6 offset:9472
  v_mul_f32 v13, v51, v51
  v_fmaak_f32 v10, v10, v8, 0xc0135761
  v_fmaak_f32 v11, v11, v8, 0xc0135761
  v_fmaak_f32 v12, v12, v8, 0xc0135761
  v_mfma_f32_32x32x16_bf16 v[64:79], v[36:39], v[132:135], v[64:79]
  ds_read_b64_tr_b16 v[32:33], v6 offset:10240
  ds_read_b64_tr_b16 v[34:35], v6 offset:10496
  buffer_load_dwordx4 v2, s[20:23], s67 offen offset:1024 lds
  v_fmaak_f32 v13, v13, v8, 0xc0135761
  s_waitcnt lgkmcnt(4)
  v_mfma_f32_32x32x16_bf16 v[64:79], v[16:19], v[136:139], v[64:79]
  ds_read_b64_tr_b16 v[36:37], v6 offset:11264
  ds_read_b64_tr_b16 v[38:39], v6 offset:11520
  v_mul_f32 v10, v10, v48
  v_mul_f32 v11, v11, v49
  v_mul_f32 v12, v12, v50
  v_mfma_f32_32x32x16_bf16 v[64:79], v[20:23], v[140:143], v[64:79]
  ds_read_b64_tr_b16 v[16:17], v6 offset:12288
  ds_read_b64_tr_b16 v[18:19], v6 offset:12544
  v_mul_f32 v13, v13, v51
  v_exp_f32 v10, v10
  v_mfma_f32_32x32x16_bf16 v[64:79], v[24:27], v[144:147], v[64:79]
  ds_read_b64_tr_b16 v[20:21], v6 offset:13312
  ds_read_b64_tr_b16 v[22:23], v6 offset:13568
  buffer_load_dwordx4 v2, s[20:23], s68 offen offset:2048 lds
  v_exp_f32 v11, v11
  s_waitcnt lgkmcnt(4)
  v_mfma_f32_32x32x16_bf16 v[64:79], v[28:31], v[148:151], v[64:79]
  ds_read_b64_tr_b16 v[24:25], v6 offset:14336
  ds_read_b64_tr_b16 v[26:27], v6 offset:14592
  v_exp_f32 v12, v12
  v_mfma_f32_32x32x16_bf16 v[64:79], v[32:35], v[152:155], v[64:79]
  ds_read_b64_tr_b16 v[28:29], v6 offset:15360
  ds_read_b64_tr_b16 v[30:31], v6 offset:15616
  v_exp_f32 v13, v13
  v_add_f32 v10, 1.0, v10
  v_add_f32 v11, 1.0, v11
  v_add_f32 v12, 1.0, v12
  v_mfma_f32_32x32x16_bf16 v[64:79], v[36:39], v[156:159], v[64:79]
  ds_read_b64_tr_b16 v[32:33], v6 offset:16384
  ds_read_b64_tr_b16 v[34:35], v6 offset:16640
  buffer_load_dwordx4 v2, s[20:23], s69 offen offset:3072 lds
  s_waitcnt lgkmcnt(4)
  v_mfma_f32_32x32x16_bf16 v[64:79], v[16:19], v[160:163], v[64:79]
  ds_read_b64_tr_b16 v[36:37], v6 offset:17408
  ds_read_b64_tr_b16 v[38:39], v6 offset:17664
  v_add_f32 v13, 1.0, v13
  v_rcp_f32 v10, v10
  v_mfma_f32_32x32x16_bf16 v[64:79], v[20:23], v[164:167], v[64:79]
  ds_read_b64_tr_b16 v[16:17], v6 offset:18432
  ds_read_b64_tr_b16 v[18:19], v6 offset:18688
  v_rcp_f32 v11, v11
  v_rcp_f32 v12, v12
  s_add_u32 m0, s30, 114688
  v_mfma_f32_32x32x16_bf16 v[64:79], v[24:27], v[168:171], v[64:79]
  ds_read_b64_tr_b16 v[20:21], v6 offset:19456
  ds_read_b64_tr_b16 v[22:23], v6 offset:19712
  buffer_load_dwordx4 v2, s[20:23], s70 offen offset:0 lds
  s_waitcnt lgkmcnt(4)
  v_mfma_f32_32x32x16_bf16 v[64:79], v[28:31], v[172:175], v[64:79]
  ds_read_b64_tr_b16 v[24:25], v6 offset:20480
  ds_read_b64_tr_b16 v[26:27], v6 offset:20736
  v_rcp_f32 v13, v13
  v_mfma_f32_32x32x16_bf16 v[64:79], v[32:35], v[176:179], v[64:79]
  ds_read_b64_tr_b16 v[28:29], v6 offset:21504
  ds_read_b64_tr_b16 v[30:31], v6 offset:21760
  v_mul_f32 v48, v48, v10
  v_mul_f32 v49, v49, v11
  v_mul_f32 v50, v50, v12
  v_mul_f32 v51, v51, v13
  v_mul_f32 v10, v52, v52
  v_mfma_f32_32x32x16_bf16 v[64:79], v[36:39], v[180:183], v[64:79]
  ds_read_b64_tr_b16 v[32:33], v6 offset:22528
  ds_read_b64_tr_b16 v[34:35], v6 offset:22784
  buffer_load_dwordx4 v2, s[20:23], s71 offen offset:1024 lds
  s_waitcnt lgkmcnt(4)
  v_mfma_f32_32x32x16_bf16 v[64:79], v[16:19], v[184:187], v[64:79]
  ds_read_b64_tr_b16 v[36:37], v6 offset:23552
  ds_read_b64_tr_b16 v[38:39], v6 offset:23808
  v_mul_f32 v11, v53, v53
  v_mul_f32 v12, v54, v54
  v_mul_f32 v13, v55, v55
  v_mfma_f32_32x32x16_bf16 v[64:79], v[20:23], v[188:191], v[64:79]
  ds_read_b64_tr_b16 v[16:17], v6 offset:24576
  ds_read_b64_tr_b16 v[18:19], v6 offset:24832
  v_fmaak_f32 v10, v10, v8, 0xc0135761
  v_fmaak_f32 v11, v11, v8, 0xc0135761
  v_fmaak_f32 v12, v12, v8, 0xc0135761
  v_fmaak_f32 v13, v13, v8, 0xc0135761
  v_mfma_f32_32x32x16_bf16 v[64:79], v[24:27], v[192:195], v[64:79]
  ds_read_b64_tr_b16 v[20:21], v6 offset:25600
  ds_read_b64_tr_b16 v[22:23], v6 offset:25856
  buffer_load_dwordx4 v2, s[20:23], s72 offen offset:2048 lds
  s_waitcnt lgkmcnt(4)
  v_mfma_f32_32x32x16_bf16 v[64:79], v[28:31], v[196:199], v[64:79]
  ds_read_b64_tr_b16 v[24:25], v6 offset:26624
  ds_read_b64_tr_b16 v[26:27], v6 offset:26880
  v_mul_f32 v10, v10, v52
  v_mul_f32 v11, v11, v53
  v_mul_f32 v12, v12, v54
  v_mul_f32 v13, v13, v55
  v_mfma_f32_32x32x16_bf16 v[64:79], v[32:35], v[200:203], v[64:79]
  ds_read_b64_tr_b16 v[28:29], v6 offset:27648
  ds_read_b64_tr_b16 v[30:31], v6 offset:27904
  v_exp_f32 v10, v10
  v_exp_f32 v11, v11
  v_mfma_f32_32x32x16_bf16 v[64:79], v[36:39], v[204:207], v[64:79]
  ds_read_b64_tr_b16 v[32:33], v6 offset:28672
  ds_read_b64_tr_b16 v[34:35], v6 offset:28928
  buffer_load_dwordx4 v2, s[20:23], s73 offen offset:3072 lds
  s_waitcnt lgkmcnt(4)
  v_mfma_f32_32x32x16_bf16 v[64:79], v[16:19], v[208:211], v[64:79]
  ds_read_b64_tr_b16 v[36:37], v6 offset:29696
  ds_read_b64_tr_b16 v[38:39], v6 offset:29952
  v_exp_f32 v12, v12
  v_exp_f32 v13, v13
  v_mfma_f32_32x32x16_bf16 v[64:79], v[20:23], v[212:215], v[64:79]
  ds_read_b64_tr_b16 v[16:17], v6 offset:30720
  ds_read_b64_tr_b16 v[18:19], v6 offset:30976
  v_add_f32 v10, 1.0, v10
  v_add_f32 v11, 1.0, v11
  s_add_u32 m0, s30, 118784
  v_mfma_f32_32x32x16_bf16 v[64:79], v[24:27], v[216:219], v[64:79]
  ds_read_b64_tr_b16 v[20:21], v6 offset:31744
  ds_read_b64_tr_b16 v[22:23], v6 offset:32000
  buffer_load_dwordx4 v2, s[20:23], s74 offen offset:0 lds
  v_add_f32 v12, 1.0, v12
  s_waitcnt lgkmcnt(4)
  v_mfma_f32_32x32x16_bf16 v[64:79], v[28:31], v[220:223], v[64:79]
  ds_read_b64_tr_b16 v[24:25], v6 offset:32768
  ds_read_b64_tr_b16 v[26:27], v6 offset:33024
  v_add_f32 v13, 1.0, v13
  v_add_u32 v2, 64, v2
  v_mfma_f32_32x32x16_bf16 v[64:79], v[32:35], v[224:227], v[64:79]
  ds_read_b64_tr_b16 v[28:29], v6 offset:33792
  ds_read_b64_tr_b16 v[30:31], v6 offset:34048
  v_rcp_f32 v10, v10
  v_rcp_f32 v11, v11
  v_mfma_f32_32x32x16_bf16 v[64:79], v[36:39], v[228:231], v[64:79]
  ds_read_b64_tr_b16 v[32:33], v6 offset:34816
  ds_read_b64_tr_b16 v[34:35], v6 offset:35072
  v_rcp_f32 v12, v12
  v_rcp_f32 v13, v13
  v_mul_f32 v52, v52, v10
  s_waitcnt lgkmcnt(4)
  v_mfma_f32_32x32x16_bf16 v[64:79], v[16:19], v[232:235], v[64:79]
  ds_read_b64_tr_b16 v[36:37], v6 offset:35840
  ds_read_b64_tr_b16 v[38:39], v6 offset:36096
  v_mul_f32 v53, v53, v11
  v_mul_f32 v54, v54, v12
  v_mul_f32 v55, v55, v13
  v_mfma_f32_32x32x16_bf16 v[64:79], v[20:23], v[236:239], v[64:79]
  s_waitcnt vmcnt(9)
  s_barrier
  v_add_u32 v6, 73728, v4
  ds_read_b64_tr_b16 v[16:17], v6 offset:0
  ds_read_b64_tr_b16 v[18:19], v6 offset:256
  global_load_dword a255, v[96:97], off
  v_add_co_u32 v96, vcc, 0x2000, v96
  v_addc_co_u32 v97, vcc, 0, v97, vcc
  v_mfma_f32_32x32x16_bf16 v[64:79], v[24:27], v[240:243], v[64:79]
  ds_read_b64_tr_b16 v[20:21], v6 offset:1024
  ds_read_b64_tr_b16 v[22:23], v6 offset:1280
  v_mul_f32 v10, v56, v56
  v_mul_f32 v11, v57, v57
  v_mul_f32 v12, v58, v58
  v_mul_f32 v13, v59, v59
  s_waitcnt lgkmcnt(4)
  v_mfma_f32_32x32x16_bf16 v[64:79], v[28:31], v[244:247], v[64:79]
  ds_read_b64_tr_b16 v[24:25], v6 offset:2048
  ds_read_b64_tr_b16 v[26:27], v6 offset:2304
  v_fmaak_f32 v10, v10, v8, 0xc0135761
  v_fmaak_f32 v11, v11, v8, 0xc0135761
  v_fmaak_f32 v12, v12, v8, 0xc0135761
  v_fmaak_f32 v13, v13, v8, 0xc0135761
  v_mfma_f32_32x32x16_bf16 v[64:79], v[32:35], v[248:251], v[64:79]
  ds_read_b64_tr_b16 v[28:29], v6 offset:3072
  ds_read_b64_tr_b16 v[30:31], v6 offset:3328
  v_mul_f32 v10, v10, v56
  v_mul_f32 v11, v11, v57
  v_mul_f32 v12, v12, v58
  v_mul_f32 v13, v13, v59
  v_mfma_f32_32x32x16_bf16 v[64:79], v[36:39], v[252:255], v[64:79]
  ds_read_b64_tr_b16 v[32:33], v6 offset:4096
  ds_read_b64_tr_b16 v[34:35], v6 offset:4352
  v_exp_f32 v10, v10
  v_exp_f32 v11, v11
  s_waitcnt lgkmcnt(4)
  v_mfma_f32_32x32x16_bf16 v[80:95], v[16:19], v[112:115], 0
  ds_read_b64_tr_b16 v[36:37], v6 offset:5120
  ds_read_b64_tr_b16 v[38:39], v6 offset:5376
  v_mfma_f32_32x32x16_bf16 v[80:95], v[20:23], v[116:119], v[80:95]
  ds_read_b64_tr_b16 v[16:17], v6 offset:6144
  ds_read_b64_tr_b16 v[18:19], v6 offset:6400
  v_exp_f32 v12, v12
  v_exp_f32 v13, v13
  s_add_u32 m0, s30, 0
  v_mfma_f32_32x32x16_bf16 v[80:95], v[24:27], v[120:123], v[80:95]
  ds_read_b64_tr_b16 v[20:21], v6 offset:7168
  ds_read_b64_tr_b16 v[22:23], v6 offset:7424
  buffer_load_dwordx4 v2, s[16:19], 0 offen offset:0 lds
  s_waitcnt lgkmcnt(4)
  v_mfma_f32_32x32x16_bf16 v[80:95], v[28:31], v[124:127], v[80:95]
  ds_read_b64_tr_b16 v[24:25], v6 offset:8192
  ds_read_b64_tr_b16 v[26:27], v6 offset:8448
  v_add_f32 v10, 1.0, v10
  v_add_f32 v11, 1.0, v11
  v_mfma_f32_32x32x16_bf16 v[80:95], v[32:35], v[128:131], v[80:95]
  ds_read_b64_tr_b16 v[28:29], v6 offset:9216
  ds_read_b64_tr_b16 v[30:31], v6 offset:9472
  v_add_f32 v12, 1.0, v12
  v_add_f32 v13, 1.0, v13
  v_rcp_f32 v10, v10
  v_mfma_f32_32x32x16_bf16 v[80:95], v[36:39], v[132:135], v[80:95]
  ds_read_b64_tr_b16 v[32:33], v6 offset:10240
  ds_read_b64_tr_b16 v[34:35], v6 offset:10496
  buffer_load_dwordx4 v2, s[16:19], s67 offen offset:1024 lds
  s_waitcnt lgkmcnt(4)
  v_mfma_f32_32x32x16_bf16 v[80:95], v[16:19], v[136:139], v[80:95]
  ds_read_b64_tr_b16 v[36:37], v6 offset:11264
  ds_read_b64_tr_b16 v[38:39], v6 offset:11520
  v_rcp_f32 v11, v11
  v_rcp_f32 v12, v12
  v_mfma_f32_32x32x16_bf16 v[80:95], v[20:23], v[140:143], v[80:95]
  ds_read_b64_tr_b16 v[16:17], v6 offset:12288
  ds_read_b64_tr_b16 v[18:19], v6 offset:12544
  v_rcp_f32 v13, v13
  v_mul_f32 v56, v56, v10
  v_mfma_f32_32x32x16_bf16 v[80:95], v[24:27], v[144:147], v[80:95]
  ds_read_b64_tr_b16 v[20:21], v6 offset:13312
  ds_read_b64_tr_b16 v[22:23], v6 offset:13568
  buffer_load_dwordx4 v2, s[16:19], s68 offen offset:2048 lds
  s_waitcnt lgkmcnt(4)
  v_mfma_f32_32x32x16_bf16 v[80:95], v[28:31], v[148:151], v[80:95]
  ds_read_b64_tr_b16 v[24:25], v6 offset:14336
  ds_read_b64_tr_b16 v[26:27], v6 offset:14592
  v_mul_f32 v57, v57, v11
  v_mul_f32 v58, v58, v12
  v_mul_f32 v59, v59, v13
  v_mul_f32 v10, v60, v60
  v_mfma_f32_32x32x16_bf16 v[80:95], v[32:35], v[152:155], v[80:95]
  ds_read_b64_tr_b16 v[28:29], v6 offset:15360
  ds_read_b64_tr_b16 v[30:31], v6 offset:15616
  v_mul_f32 v11, v61, v61
  v_mul_f32 v12, v62, v62
  v_mul_f32 v13, v63, v63
  v_fmaak_f32 v10, v10, v8, 0xc0135761
  v_mfma_f32_32x32x16_bf16 v[80:95], v[36:39], v[156:159], v[80:95]
  ds_read_b64_tr_b16 v[32:33], v6 offset:16384
  ds_read_b64_tr_b16 v[34:35], v6 offset:16640
  buffer_load_dwordx4 v2, s[16:19], s69 offen offset:3072 lds
  s_waitcnt lgkmcnt(4)
  v_mfma_f32_32x32x16_bf16 v[80:95], v[16:19], v[160:163], v[80:95]
  ds_read_b64_tr_b16 v[36:37], v6 offset:17408
  ds_read_b64_tr_b16 v[38:39], v6 offset:17664
  v_fmaak_f32 v11, v11, v8, 0xc0135761
  v_fmaak_f32 v12, v12, v8, 0xc0135761
  v_fmaak_f32 v13, v13, v8, 0xc0135761
  v_mfma_f32_32x32x16_bf16 v[80:95], v[20:23], v[164:167], v[80:95]
  ds_read_b64_tr_b16 v[16:17], v6 offset:18432
  ds_read_b64_tr_b16 v[18:19], v6 offset:18688
  v_mul_f32 v10, v10, v60
  v_mul_f32 v11, v11, v61
  v_mul_f32 v12, v12, v62
  s_add_u32 m0, s30, 4096
  v_mfma_f32_32x32x16_bf16 v[80:95], v[24:27], v[168:171], v[80:95]
  ds_read_b64_tr_b16 v[20:21], v6 offset:19456
  ds_read_b64_tr_b16 v[22:23], v6 offset:19712
  buffer_load_dwordx4 v2, s[16:19], s70 offen offset:0 lds
  s_waitcnt lgkmcnt(4)
  v_mfma_f32_32x32x16_bf16 v[80:95], v[28:31], v[172:175], v[80:95]
  ds_read_b64_tr_b16 v[24:25], v6 offset:20480
  ds_read_b64_tr_b16 v[26:27], v6 offset:20736
  v_mul_f32 v13, v13, v63
  v_exp_f32 v10, v10
  v_mfma_f32_32x32x16_bf16 v[80:95], v[32:35], v[176:179], v[80:95]
  ds_read_b64_tr_b16 v[28:29], v6 offset:21504
  ds_read_b64_tr_b16 v[30:31], v6 offset:21760
  v_exp_f32 v11, v11
  v_exp_f32 v12, v12
  v_mfma_f32_32x32x16_bf16 v[80:95], v[36:39], v[180:183], v[80:95]
  ds_read_b64_tr_b16 v[32:33], v6 offset:22528
  ds_read_b64_tr_b16 v[34:35], v6 offset:22784
  buffer_load_dwordx4 v2, s[16:19], s71 offen offset:1024 lds
  s_waitcnt lgkmcnt(4)
  v_mfma_f32_32x32x16_bf16 v[80:95], v[16:19], v[184:187], v[80:95]
  ds_read_b64_tr_b16 v[36:37], v6 offset:23552
  ds_read_b64_tr_b16 v[38:39], v6 offset:23808
  v_exp_f32 v13, v13
  v_add_f32 v10, 1.0, v10
  v_mfma_f32_32x32x16_bf16 v[80:95], v[20:23], v[188:191], v[80:95]
  ds_read_b64_tr_b16 v[16:17], v6 offset:24576
  ds_read_b64_tr_b16 v[18:19], v6 offset:24832
  v_add_f32 v11, 1.0, v11
  v_add_f32 v12, 1.0, v12
  v_add_f32 v13, 1.0, v13
  v_rcp_f32 v10, v10
  v_mfma_f32_32x32x16_bf16 v[80:95], v[24:27], v[192:195], v[80:95]
  ds_read_b64_tr_b16 v[20:21], v6 offset:25600
  ds_read_b64_tr_b16 v[22:23], v6 offset:25856
  buffer_load_dwordx4 v2, s[16:19], s72 offen offset:2048 lds
  s_waitcnt lgkmcnt(4)
  v_mfma_f32_32x32x16_bf16 v[80:95], v[28:31], v[196:199], v[80:95]
  ds_read_b64_tr_b16 v[24:25], v6 offset:26624
  ds_read_b64_tr_b16 v[26:27], v6 offset:26880
  v_rcp_f32 v11, v11
  v_mfma_f32_32x32x16_bf16 v[80:95], v[32:35], v[200:203], v[80:95]
  ds_read_b64_tr_b16 v[28:29], v6 offset:27648
  ds_read_b64_tr_b16 v[30:31], v6 offset:27904
  v_rcp_f32 v12, v12
  v_rcp_f32 v13, v13
  v_mfma_f32_32x32x16_bf16 v[80:95], v[36:39], v[204:207], v[80:95]
  ds_read_b64_tr_b16 v[32:33], v6 offset:28672
  ds_read_b64_tr_b16 v[34:35], v6 offset:28928
  buffer_load_dwordx4 v2, s[16:19], s73 offen offset:3072 lds
  s_waitcnt lgkmcnt(4)
  v_mfma_f32_32x32x16_bf16 v[80:95], v[16:19], v[208:211], v[80:95]
  ds_read_b64_tr_b16 v[36:37], v6 offset:29696
  ds_read_b64_tr_b16 v[38:39], v6 offset:29952
  v_mul_f32 v60, v60, v10
  v_mul_f32 v61, v61, v11
  v_mul_f32 v62, v62, v12
  v_mfma_f32_32x32x16_bf16 v[80:95], v[20:23], v[212:215], v[80:95]
  ds_read_b64_tr_b16 v[16:17], v6 offset:30720
  ds_read_b64_tr_b16 v[18:19], v6 offset:30976
  v_mul_f32 v63, v63, v13
  v_mul_f32 v64, v64, v48
  v_mul_f32 v65, v65, v49
  s_add_u32 m0, s30, 8192
  v_mfma_f32_32x32x16_bf16 v[80:95], v[24:27], v[216:219], v[80:95]
  ds_read_b64_tr_b16 v[20:21], v6 offset:31744
  ds_read_b64_tr_b16 v[22:23], v6 offset:32000
  buffer_load_dwordx4 v2, s[16:19], s74 offen offset:0 lds
  s_waitcnt lgkmcnt(4)
  v_mfma_f32_32x32x16_bf16 v[80:95], v[28:31], v[220:223], v[80:95]
  ds_read_b64_tr_b16 v[24:25], v6 offset:32768
  ds_read_b64_tr_b16 v[26:27], v6 offset:33024
  v_mul_f32 v66, v66, v50
  v_mul_f32 v67, v67, v51
  v_mul_f32 v68, v68, v52
  v_mul_f32 v69, v69, v53
  v_mfma_f32_32x32x16_bf16 v[80:95], v[32:35], v[224:227], v[80:95]
  ds_read_b64_tr_b16 v[28:29], v6 offset:33792
  ds_read_b64_tr_b16 v[30:31], v6 offset:34048
  v_mul_f32 v70, v70, v54
  v_mul_f32 v71, v71, v55
  v_mul_f32 v72, v72, v56
  v_mul_f32 v73, v73, v57
  v_mfma_f32_32x32x16_bf16 v[80:95], v[36:39], v[228:231], v[80:95]
  ds_read_b64_tr_b16 v[32:33], v6 offset:34816
  ds_read_b64_tr_b16 v[34:35], v6 offset:35072
  buffer_load_dword a253, v7, s[16:19], 0 offen offset:896
  v_mul_f32 v74, v74, v58
  v_mul_f32 v75, v75, v59
  v_mul_f32 v76, v76, v60
  s_waitcnt lgkmcnt(4)
  v_mfma_f32_32x32x16_bf16 v[80:95], v[16:19], v[232:235], v[80:95]
  ds_read_b64_tr_b16 v[36:37], v6 offset:35840
  ds_read_b64_tr_b16 v[38:39], v6 offset:36096
  v_mul_f32 v77, v77, v61
  v_mul_f32 v78, v78, v62
  v_mul_f32 v79, v79, v63
  v_mfma_f32_32x32x16_bf16 v[80:95], v[20:23], v[236:239], v[80:95]
  s_waitcnt vmcnt(11)
  s_barrier
  v_add_u32 v6, 110592, v4
  ds_read_b64_tr_b16 v[16:17], v6 offset:0
  ds_read_b64_tr_b16 v[18:19], v6 offset:256
  v_cvt_pk_bf16_f32 v40, v64, v65
  v_mfma_f32_32x32x16_bf16 v[80:95], v[24:27], v[240:243], v[80:95]
  ds_read_b64_tr_b16 v[20:21], v6 offset:1024
  ds_read_b64_tr_b16 v[22:23], v6 offset:1280
  v_cvt_pk_bf16_f32 v41, v66, v67
  v_cvt_pk_bf16_f32 v42, v68, v69
  v_cvt_pk_bf16_f32 v43, v70, v71
  v_cvt_pk_bf16_f32 v44, v72, v73
  s_waitcnt lgkmcnt(4)
  v_mfma_f32_32x32x16_bf16 v[80:95], v[28:31], v[244:247], v[80:95]
  ds_read_b64_tr_b16 v[24:25], v6 offset:2048
  ds_read_b64_tr_b16 v[26:27], v6 offset:2304
  v_cvt_pk_bf16_f32 v45, v74, v75
  v_cvt_pk_bf16_f32 v46, v76, v77
  v_cvt_pk_bf16_f32 v47, v78, v79
  v_mfma_f32_32x32x16_bf16 v[80:95], v[32:35], v[248:251], v[80:95]
  ds_read_b64_tr_b16 v[28:29], v6 offset:3072
  ds_read_b64_tr_b16 v[30:31], v6 offset:3328
  v_accvgpr_write_b32 a64, v40
  v_accvgpr_write_b32 a65, v41
  v_accvgpr_write_b32 a66, v42
  v_accvgpr_write_b32 a67, v43
  v_mfma_f32_32x32x16_bf16 v[80:95], v[36:39], v[252:255], v[80:95]
  ds_read_b64_tr_b16 v[32:33], v6 offset:4096
  ds_read_b64_tr_b16 v[34:35], v6 offset:4352
  v_accvgpr_write_b32 a68, v44
  v_accvgpr_write_b32 a69, v45
  v_accvgpr_write_b32 a70, v46
  v_accvgpr_write_b32 a71, v47
  s_waitcnt lgkmcnt(4)
  v_mfma_f32_32x32x16_bf16 v[64:79], v[16:19], v[112:115], 0
  ds_read_b64_tr_b16 v[36:37], v6 offset:5120
  ds_read_b64_tr_b16 v[38:39], v6 offset:5376
  v_mfma_f32_32x32x16_bf16 v[64:79], v[20:23], v[116:119], v[64:79]
  ds_read_b64_tr_b16 v[16:17], v6 offset:6144
  ds_read_b64_tr_b16 v[18:19], v6 offset:6400
  s_add_u32 m0, s30, 36864
  v_mfma_f32_32x32x16_bf16 v[64:79], v[24:27], v[120:123], v[64:79]
  ds_read_b64_tr_b16 v[20:21], v6 offset:7168
  ds_read_b64_tr_b16 v[22:23], v6 offset:7424
  buffer_load_dwordx4 v2, s[20:23], 0 offen offset:0 lds
  s_waitcnt lgkmcnt(4)
  v_mfma_f32_32x32x16_bf16 v[64:79], v[28:31], v[124:127], v[64:79]
  ds_read_b64_tr_b16 v[24:25], v6 offset:8192
  ds_read_b64_tr_b16 v[26:27], v6 offset:8448
  v_mul_f32 v10, v80, v80
  v_mul_f32 v11, v81, v81
  v_mul_f32 v12, v82, v82
  v_mfma_f32_32x32x16_bf16 v[64:79], v[32:35], v[128:131], v[64:79]
  ds_read_b64_tr_b16 v[28:29], v6 offset:9216
  ds_read_b64_tr_b16 v[30:31], v6 offset:9472
  v_mul_f32 v13, v83, v83
  v_fmaak_f32 v10, v10, v8, 0xc0135761
  v_fmaak_f32 v11, v11, v8, 0xc0135761
  v_fmaak_f32 v12, v12, v8, 0xc0135761
  v_mfma_f32_32x32x16_bf16 v[64:79], v[36:39], v[132:135], v[64:79]
  ds_read_b64_tr_b16 v[32:33], v6 offset:10240
  ds_read_b64_tr_b16 v[34:35], v6 offset:10496
  buffer_load_dwordx4 v2, s[20:23], s67 offen offset:1024 lds
  v_fmaak_f32 v13, v13, v8, 0xc0135761
  s_waitcnt lgkmcnt(4)
  v_mfma_f32_32x32x16_bf16 v[64:79], v[16:19], v[136:139], v[64:79]
  ds_read_b64_tr_b16 v[36:37], v6 offset:11264
  ds_read_b64_tr_b16 v[38:39], v6 offset:11520
  v_mul_f32 v10, v10, v80
  v_mul_f32 v11, v11, v81
  v_mul_f32 v12, v12, v82
  v_mfma_f32_32x32x16_bf16 v[64:79], v[20:23], v[140:143], v[64:79]
  ds_read_b64_tr_b16 v[16:17], v6 offset:12288
  ds_read_b64_tr_b16 v[18:19], v6 offset:12544
  v_mul_f32 v13, v13, v83
  v_exp_f32 v10, v10
  v_mfma_f32_32x32x16_bf16 v[64:79], v[24:27], v[144:147], v[64:79]
  ds_read_b64_tr_b16 v[20:21], v6 offset:13312
  ds_read_b64_tr_b16 v[22:23], v6 offset:13568
  buffer_load_dwordx4 v2, s[20:23], s68 offen offset:2048 lds
  v_exp_f32 v11, v11
  s_waitcnt lgkmcnt(4)
  v_mfma_f32_32x32x16_bf16 v[64:79], v[28:31], v[148:151], v[64:79]
  ds_read_b64_tr_b16 v[24:25], v6 offset:14336
  ds_read_b64_tr_b16 v[26:27], v6 offset:14592
  v_exp_f32 v12, v12
  v_mfma_f32_32x32x16_bf16 v[64:79], v[32:35], v[152:155], v[64:79]
  ds_read_b64_tr_b16 v[28:29], v6 offset:15360
  ds_read_b64_tr_b16 v[30:31], v6 offset:15616
  v_exp_f32 v13, v13
  v_add_f32 v10, 1.0, v10
  v_add_f32 v11, 1.0, v11
  v_mfma_f32_32x32x16_bf16 v[64:79], v[36:39], v[156:159], v[64:79]
  ds_read_b64_tr_b16 v[32:33], v6 offset:16384
  ds_read_b64_tr_b16 v[34:35], v6 offset:16640
  buffer_load_dwordx4 v2, s[20:23], s69 offen offset:3072 lds
  v_add_f32 v12, 1.0, v12
  s_waitcnt lgkmcnt(4)
  v_mfma_f32_32x32x16_bf16 v[64:79], v[16:19], v[160:163], v[64:79]
  ds_read_b64_tr_b16 v[36:37], v6 offset:17408
  ds_read_b64_tr_b16 v[38:39], v6 offset:17664
  v_add_f32 v13, 1.0, v13
  v_rcp_f32 v10, v10
  v_mfma_f32_32x32x16_bf16 v[64:79], v[20:23], v[164:167], v[64:79]
  ds_read_b64_tr_b16 v[16:17], v6 offset:18432
  ds_read_b64_tr_b16 v[18:19], v6 offset:18688
  v_rcp_f32 v11, v11
  v_rcp_f32 v12, v12
  s_add_u32 m0, s30, 40960
  v_mfma_f32_32x32x16_bf16 v[64:79], v[24:27], v[168:171], v[64:79]
  ds_read_b64_tr_b16 v[20:21], v6 offset:19456
  ds_read_b64_tr_b16 v[22:23], v6 offset:19712
  buffer_load_dwordx4 v2, s[20:23], s70 offen offset:0 lds
  s_waitcnt lgkmcnt(4)
  v_mfma_f32_32x32x16_bf16 v[64:79], v[28:31], v[172:175], v[64:79]
  ds_read_b64_tr_b16 v[24:25], v6 offset:20480
  ds_read_b64_tr_b16 v[26:27], v6 offset:20736
  v_rcp_f32 v13, v13
  v_mfma_f32_32x32x16_bf16 v[64:79], v[32:35], v[176:179], v[64:79]
  ds_read_b64_tr_b16 v[28:29], v6 offset:21504
  ds_read_b64_tr_b16 v[30:31], v6 offset:21760
  v_mul_f32 v80, v80, v10
  v_mul_f32 v81, v81, v11
  v_mul_f32 v82, v82, v12
  v_mul_f32 v83, v83, v13
  v_mul_f32 v10, v84, v84
  v_mfma_f32_32x32x16_bf16 v[64:79], v[36:39], v[180:183], v[64:79]
  ds_read_b64_tr_b16 v[32:33], v6 offset:22528
  ds_read_b64_tr_b16 v[34:35], v6 offset:22784
  buffer_load_dwordx4 v2, s[20:23], s71 offen offset:1024 lds
  s_waitcnt lgkmcnt(4)
  v_mfma_f32_32x32x16_bf16 v[64:79], v[16:19], v[184:187], v[64:79]
  ds_read_b64_tr_b16 v[36:37], v6 offset:23552
  ds_read_b64_tr_b16 v[38:39], v6 offset:23808
  v_mul_f32 v11, v85, v85
  v_mul_f32 v12, v86, v86
  v_mul_f32 v13, v87, v87
  v_mfma_f32_32x32x16_bf16 v[64:79], v[20:23], v[188:191], v[64:79]
  ds_read_b64_tr_b16 v[16:17], v6 offset:24576
  ds_read_b64_tr_b16 v[18:19], v6 offset:24832
  v_fmaak_f32 v10, v10, v8, 0xc0135761
  v_fmaak_f32 v11, v11, v8, 0xc0135761
  v_fmaak_f32 v12, v12, v8, 0xc0135761
  v_fmaak_f32 v13, v13, v8, 0xc0135761
  v_mfma_f32_32x32x16_bf16 v[64:79], v[24:27], v[192:195], v[64:79]
  ds_read_b64_tr_b16 v[20:21], v6 offset:25600
  ds_read_b64_tr_b16 v[22:23], v6 offset:25856
  buffer_load_dwordx4 v2, s[20:23], s72 offen offset:2048 lds
  s_waitcnt lgkmcnt(4)
  v_mfma_f32_32x32x16_bf16 v[64:79], v[28:31], v[196:199], v[64:79]
  ds_read_b64_tr_b16 v[24:25], v6 offset:26624
  ds_read_b64_tr_b16 v[26:27], v6 offset:26880
  v_mul_f32 v10, v10, v84
  v_mul_f32 v11, v11, v85
  v_mul_f32 v12, v12, v86
  v_mfma_f32_32x32x16_bf16 v[64:79], v[32:35], v[200:203], v[64:79]
  ds_read_b64_tr_b16 v[28:29], v6 offset:27648
  ds_read_b64_tr_b16 v[30:31], v6 offset:27904
  v_mul_f32 v13, v13, v87
  v_exp_f32 v10, v10
  v_exp_f32 v11, v11
  v_mfma_f32_32x32x16_bf16 v[64:79], v[36:39], v[204:207], v[64:79]
  ds_read_b64_tr_b16 v[32:33], v6 offset:28672
  ds_read_b64_tr_b16 v[34:35], v6 offset:28928
  buffer_load_dwordx4 v2, s[20:23], s73 offen offset:3072 lds
  s_waitcnt lgkmcnt(4)
  v_mfma_f32_32x32x16_bf16 v[64:79], v[16:19], v[208:211], v[64:79]
  ds_read_b64_tr_b16 v[36:37], v6 offset:29696
  ds_read_b64_tr_b16 v[38:39], v6 offset:29952
  v_exp_f32 v12, v12
  v_exp_f32 v13, v13
  v_mfma_f32_32x32x16_bf16 v[64:79], v[20:23], v[212:215], v[64:79]
  ds_read_b64_tr_b16 v[16:17], v6 offset:30720
  ds_read_b64_tr_b16 v[18:19], v6 offset:30976
  v_add_f32 v10, 1.0, v10
  v_add_f32 v11, 1.0, v11
  s_add_u32 m0, s30, 45056
  v_mfma_f32_32x32x16_bf16 v[64:79], v[24:27], v[216:219], v[64:79]
  ds_read_b64_tr_b16 v[20:21], v6 offset:31744
  ds_read_b64_tr_b16 v[22:23], v6 offset:32000
  buffer_load_dwordx4 v2, s[20:23], s74 offen offset:0 lds
  s_waitcnt lgkmcnt(4)
  v_mfma_f32_32x32x16_bf16 v[64:79], v[28:31], v[220:223], v[64:79]
  ds_read_b64_tr_b16 v[24:25], v6 offset:32768
  ds_read_b64_tr_b16 v[26:27], v6 offset:33024
  v_add_f32 v12, 1.0, v12
  v_add_f32 v13, 1.0, v13
  v_add_u32 v2, 64, v2
  v_mfma_f32_32x32x16_bf16 v[64:79], v[32:35], v[224:227], v[64:79]
  ds_read_b64_tr_b16 v[28:29], v6 offset:33792
  ds_read_b64_tr_b16 v[30:31], v6 offset:34048
  v_rcp_f32 v10, v10
  v_rcp_f32 v11, v11
  v_mfma_f32_32x32x16_bf16 v[64:79], v[36:39], v[228:231], v[64:79]
  ds_read_b64_tr_b16 v[32:33], v6 offset:34816
  ds_read_b64_tr_b16 v[34:35], v6 offset:35072
  buffer_load_dword a253, v7, s[20:23], 0 offen offset:896
  v_rcp_f32 v12, v12
  v_rcp_f32 v13, v13
  s_waitcnt lgkmcnt(4)
  v_mfma_f32_32x32x16_bf16 v[64:79], v[16:19], v[232:235], v[64:79]
  ds_read_b64_tr_b16 v[36:37], v6 offset:35840
  ds_read_b64_tr_b16 v[38:39], v6 offset:36096
  v_mul_f32 v84, v84, v10
  v_mul_f32 v85, v85, v11
  v_mul_f32 v86, v86, v12
  v_mfma_f32_32x32x16_bf16 v[64:79], v[20:23], v[236:239], v[64:79]
  s_waitcnt vmcnt(11)
  s_barrier
  v_add_u32 v6, 0, v4
  ds_read_b64_tr_b16 v[16:17], v6 offset:0
  ds_read_b64_tr_b16 v[18:19], v6 offset:256
  v_mul_f32 v87, v87, v13
  v_mfma_f32_32x32x16_bf16 v[64:79], v[24:27], v[240:243], v[64:79]
  ds_read_b64_tr_b16 v[20:21], v6 offset:1024
  ds_read_b64_tr_b16 v[22:23], v6 offset:1280
  v_mul_f32 v10, v88, v88
  v_mul_f32 v11, v89, v89
  v_mul_f32 v12, v90, v90
  v_mul_f32 v13, v91, v91
  s_waitcnt lgkmcnt(4)
  v_mfma_f32_32x32x16_bf16 v[64:79], v[28:31], v[244:247], v[64:79]
  ds_read_b64_tr_b16 v[24:25], v6 offset:2048
  ds_read_b64_tr_b16 v[26:27], v6 offset:2304
  v_fmaak_f32 v10, v10, v8, 0xc0135761
  v_fmaak_f32 v11, v11, v8, 0xc0135761
  v_fmaak_f32 v12, v12, v8, 0xc0135761
  v_fmaak_f32 v13, v13, v8, 0xc0135761
  v_mfma_f32_32x32x16_bf16 v[64:79], v[32:35], v[248:251], v[64:79]
  ds_read_b64_tr_b16 v[28:29], v6 offset:3072
  ds_read_b64_tr_b16 v[30:31], v6 offset:3328
  v_mul_f32 v10, v10, v88
  v_mul_f32 v11, v11, v89
  v_mul_f32 v12, v12, v90
  v_mul_f32 v13, v13, v91
  v_mfma_f32_32x32x16_bf16 v[64:79], v[36:39], v[252:255], v[64:79]
  ds_read_b64_tr_b16 v[32:33], v6 offset:4096
  ds_read_b64_tr_b16 v[34:35], v6 offset:4352
  v_exp_f32 v10, v10
  v_exp_f32 v11, v11
  s_waitcnt lgkmcnt(4)
  v_mfma_f32_32x32x16_bf16 v[48:63], v[16:19], v[112:115], 0
  ds_read_b64_tr_b16 v[36:37], v6 offset:5120
  ds_read_b64_tr_b16 v[38:39], v6 offset:5376
  v_mfma_f32_32x32x16_bf16 v[48:63], v[20:23], v[116:119], v[48:63]
  ds_read_b64_tr_b16 v[16:17], v6 offset:6144
  ds_read_b64_tr_b16 v[18:19], v6 offset:6400
  v_exp_f32 v12, v12
  v_exp_f32 v13, v13
  s_add_u32 m0, s30, 73728
  v_mfma_f32_32x32x16_bf16 v[48:63], v[24:27], v[120:123], v[48:63]
  ds_read_b64_tr_b16 v[20:21], v6 offset:7168
  ds_read_b64_tr_b16 v[22:23], v6 offset:7424
  buffer_load_dwordx4 v2, s[16:19], 0 offen offset:0 lds
  s_waitcnt lgkmcnt(4)
  v_mfma_f32_32x32x16_bf16 v[48:63], v[28:31], v[124:127], v[48:63]
  ds_read_b64_tr_b16 v[24:25], v6 offset:8192
  ds_read_b64_tr_b16 v[26:27], v6 offset:8448
  v_add_f32 v10, 1.0, v10
  v_add_f32 v11, 1.0, v11
  v_mfma_f32_32x32x16_bf16 v[48:63], v[32:35], v[128:131], v[48:63]
  ds_read_b64_tr_b16 v[28:29], v6 offset:9216
  ds_read_b64_tr_b16 v[30:31], v6 offset:9472
  v_add_f32 v12, 1.0, v12
  v_add_f32 v13, 1.0, v13
  v_rcp_f32 v10, v10
  v_mfma_f32_32x32x16_bf16 v[48:63], v[36:39], v[132:135], v[48:63]
  ds_read_b64_tr_b16 v[32:33], v6 offset:10240
  ds_read_b64_tr_b16 v[34:35], v6 offset:10496
  buffer_load_dwordx4 v2, s[16:19], s67 offen offset:1024 lds
  s_waitcnt lgkmcnt(4)
  v_mfma_f32_32x32x16_bf16 v[48:63], v[16:19], v[136:139], v[48:63]
  ds_read_b64_tr_b16 v[36:37], v6 offset:11264
  ds_read_b64_tr_b16 v[38:39], v6 offset:11520
  v_rcp_f32 v11, v11
  v_rcp_f32 v12, v12
  v_mfma_f32_32x32x16_bf16 v[48:63], v[20:23], v[140:143], v[48:63]
  ds_read_b64_tr_b16 v[16:17], v6 offset:12288
  ds_read_b64_tr_b16 v[18:19], v6 offset:12544
  v_rcp_f32 v13, v13
  v_mul_f32 v88, v88, v10
  v_mfma_f32_32x32x16_bf16 v[48:63], v[24:27], v[144:147], v[48:63]
  ds_read_b64_tr_b16 v[20:21], v6 offset:13312
  ds_read_b64_tr_b16 v[22:23], v6 offset:13568
  buffer_load_dwordx4 v2, s[16:19], s68 offen offset:2048 lds
  s_waitcnt lgkmcnt(4)
  v_mfma_f32_32x32x16_bf16 v[48:63], v[28:31], v[148:151], v[48:63]
  ds_read_b64_tr_b16 v[24:25], v6 offset:14336
  ds_read_b64_tr_b16 v[26:27], v6 offset:14592
  v_mul_f32 v89, v89, v11
  v_mul_f32 v90, v90, v12
  v_mul_f32 v91, v91, v13
  v_mfma_f32_32x32x16_bf16 v[48:63], v[32:35], v[152:155], v[48:63]
  ds_read_b64_tr_b16 v[28:29], v6 offset:15360
  ds_read_b64_tr_b16 v[30:31], v6 offset:15616
  v_mul_f32 v10, v92, v92
  v_mul_f32 v11, v93, v93
  v_mul_f32 v12, v94, v94
  v_mul_f32 v13, v95, v95
  v_mfma_f32_32x32x16_bf16 v[48:63], v[36:39], v[156:159], v[48:63]
  ds_read_b64_tr_b16 v[32:33], v6 offset:16384
  ds_read_b64_tr_b16 v[34:35], v6 offset:16640
  buffer_load_dwordx4 v2, s[16:19], s69 offen offset:3072 lds
  s_waitcnt lgkmcnt(4)
  v_mfma_f32_32x32x16_bf16 v[48:63], v[16:19], v[160:163], v[48:63]
  ds_read_b64_tr_b16 v[36:37], v6 offset:17408
  ds_read_b64_tr_b16 v[38:39], v6 offset:17664
  v_fmaak_f32 v10, v10, v8, 0xc0135761
  v_fmaak_f32 v11, v11, v8, 0xc0135761
  v_fmaak_f32 v12, v12, v8, 0xc0135761
  v_mfma_f32_32x32x16_bf16 v[48:63], v[20:23], v[164:167], v[48:63]
  ds_read_b64_tr_b16 v[16:17], v6 offset:18432
  ds_read_b64_tr_b16 v[18:19], v6 offset:18688
  v_fmaak_f32 v13, v13, v8, 0xc0135761
  v_mul_f32 v10, v10, v92
  v_mul_f32 v11, v11, v93
  s_add_u32 m0, s30, 77824
  v_mfma_f32_32x32x16_bf16 v[48:63], v[24:27], v[168:171], v[48:63]
  ds_read_b64_tr_b16 v[20:21], v6 offset:19456
  ds_read_b64_tr_b16 v[22:23], v6 offset:19712
  buffer_load_dwordx4 v2, s[16:19], s70 offen offset:0 lds
  s_waitcnt lgkmcnt(4)
  v_mfma_f32_32x32x16_bf16 v[48:63], v[28:31], v[172:175], v[48:63]
  ds_read_b64_tr_b16 v[24:25], v6 offset:20480
  ds_read_b64_tr_b16 v[26:27], v6 offset:20736
  v_mul_f32 v12, v12, v94
  v_mul_f32 v13, v13, v95
  v_exp_f32 v10, v10
  v_mfma_f32_32x32x16_bf16 v[48:63], v[32:35], v[176:179], v[48:63]
  ds_read_b64_tr_b16 v[28:29], v6 offset:21504
  ds_read_b64_tr_b16 v[30:31], v6 offset:21760
  v_exp_f32 v11, v11
  v_exp_f32 v12, v12
  v_mfma_f32_32x32x16_bf16 v[48:63], v[36:39], v[180:183], v[48:63]
  ds_read_b64_tr_b16 v[32:33], v6 offset:22528
  ds_read_b64_tr_b16 v[34:35], v6 offset:22784
  buffer_load_dwordx4 v2, s[16:19], s71 offen offset:1024 lds
  s_waitcnt lgkmcnt(4)
  v_mfma_f32_32x32x16_bf16 v[48:63], v[16:19], v[184:187], v[48:63]
  ds_read_b64_tr_b16 v[36:37], v6 offset:23552
  ds_read_b64_tr_b16 v[38:39], v6 offset:23808
  v_exp_f32 v13, v13
  v_add_f32 v10, 1.0, v10
  v_mfma_f32_32x32x16_bf16 v[48:63], v[20:23], v[188:191], v[48:63]
  ds_read_b64_tr_b16 v[16:17], v6 offset:24576
  ds_read_b64_tr_b16 v[18:19], v6 offset:24832
  v_add_f32 v11, 1.0, v11
  v_add_f32 v12, 1.0, v12
  v_add_f32 v13, 1.0, v13
  v_mfma_f32_32x32x16_bf16 v[48:63], v[24:27], v[192:195], v[48:63]
  ds_read_b64_tr_b16 v[20:21], v6 offset:25600
  ds_read_b64_tr_b16 v[22:23], v6 offset:25856
  buffer_load_dwordx4 v2, s[16:19], s72 offen offset:2048 lds
  s_waitcnt lgkmcnt(4)
  v_mfma_f32_32x32x16_bf16 v[48:63], v[28:31], v[196:199], v[48:63]
  ds_read_b64_tr_b16 v[24:25], v6 offset:26624
  ds_read_b64_tr_b16 v[26:27], v6 offset:26880
  v_rcp_f32 v10, v10
  v_rcp_f32 v11, v11
  v_mfma_f32_32x32x16_bf16 v[48:63], v[32:35], v[200:203], v[48:63]
  ds_read_b64_tr_b16 v[28:29], v6 offset:27648
  ds_read_b64_tr_b16 v[30:31], v6 offset:27904
  v_rcp_f32 v12, v12
  v_rcp_f32 v13, v13
  v_mfma_f32_32x32x16_bf16 v[48:63], v[36:39], v[204:207], v[48:63]
  ds_read_b64_tr_b16 v[32:33], v6 offset:28672
  ds_read_b64_tr_b16 v[34:35], v6 offset:28928
  buffer_load_dwordx4 v2, s[16:19], s73 offen offset:3072 lds
  s_waitcnt lgkmcnt(4)
  v_mfma_f32_32x32x16_bf16 v[48:63], v[16:19], v[208:211], v[48:63]
  ds_read_b64_tr_b16 v[36:37], v6 offset:29696
  ds_read_b64_tr_b16 v[38:39], v6 offset:29952
  v_mul_f32 v92, v92, v10
  v_mul_f32 v93, v93, v11
  v_mul_f32 v94, v94, v12
  v_mfma_f32_32x32x16_bf16 v[48:63], v[20:23], v[212:215], v[48:63]
  ds_read_b64_tr_b16 v[16:17], v6 offset:30720
  ds_read_b64_tr_b16 v[18:19], v6 offset:30976
  v_mul_f32 v95, v95, v13
  v_mul_f32 v64, v64, v80
  v_mul_f32 v65, v65, v81
  s_add_u32 m0, s30, 81920
  v_mfma_f32_32x32x16_bf16 v[48:63], v[24:27], v[216:219], v[48:63]
  ds_read_b64_tr_b16 v[20:21], v6 offset:31744
  ds_read_b64_tr_b16 v[22:23], v6 offset:32000
  buffer_load_dwordx4 v2, s[16:19], s74 offen offset:0 lds
  s_waitcnt lgkmcnt(4)
  v_mfma_f32_32x32x16_bf16 v[48:63], v[28:31], v[220:223], v[48:63]
  ds_read_b64_tr_b16 v[24:25], v6 offset:32768
  ds_read_b64_tr_b16 v[26:27], v6 offset:33024
  v_mul_f32 v66, v66, v82
  v_mul_f32 v67, v67, v83
  v_mul_f32 v68, v68, v84
  v_mfma_f32_32x32x16_bf16 v[48:63], v[32:35], v[224:227], v[48:63]
  ds_read_b64_tr_b16 v[28:29], v6 offset:33792
  ds_read_b64_tr_b16 v[30:31], v6 offset:34048
  v_mul_f32 v69, v69, v85
  v_mul_f32 v70, v70, v86
  v_mul_f32 v71, v71, v87
  v_mul_f32 v72, v72, v88
  v_mfma_f32_32x32x16_bf16 v[48:63], v[36:39], v[228:231], v[48:63]
  ds_read_b64_tr_b16 v[32:33], v6 offset:34816
  ds_read_b64_tr_b16 v[34:35], v6 offset:35072
  v_mul_f32 v73, v73, v89
  v_mul_f32 v74, v74, v90
  v_mul_f32 v75, v75, v91
  v_mul_f32 v76, v76, v92
  s_waitcnt lgkmcnt(4)
  v_mfma_f32_32x32x16_bf16 v[48:63], v[16:19], v[232:235], v[48:63]
  ds_read_b64_tr_b16 v[36:37], v6 offset:35840
  ds_read_b64_tr_b16 v[38:39], v6 offset:36096
  v_mul_f32 v77, v77, v93
  v_mul_f32 v78, v78, v94
  v_mul_f32 v79, v79, v95
  v_mfma_f32_32x32x16_bf16 v[48:63], v[20:23], v[236:239], v[48:63]
  s_waitcnt vmcnt(10)
  s_barrier
  v_add_u32 v6, 36864, v4
  ds_read_b64_tr_b16 v[16:17], v6 offset:0
  ds_read_b64_tr_b16 v[18:19], v6 offset:256
  v_cvt_pk_bf16_f32 v40, v64, v65
  v_mfma_f32_32x32x16_bf16 v[48:63], v[24:27], v[240:243], v[48:63]
  ds_read_b64_tr_b16 v[20:21], v6 offset:1024
  ds_read_b64_tr_b16 v[22:23], v6 offset:1280
  v_cvt_pk_bf16_f32 v41, v66, v67
  v_cvt_pk_bf16_f32 v42, v68, v69
  v_cvt_pk_bf16_f32 v43, v70, v71
  v_cvt_pk_bf16_f32 v44, v72, v73
  s_waitcnt lgkmcnt(4)
  v_mfma_f32_32x32x16_bf16 v[48:63], v[28:31], v[244:247], v[48:63]
  ds_read_b64_tr_b16 v[24:25], v6 offset:2048
  ds_read_b64_tr_b16 v[26:27], v6 offset:2304
  v_cvt_pk_bf16_f32 v45, v74, v75
  v_cvt_pk_bf16_f32 v46, v76, v77
  v_cvt_pk_bf16_f32 v47, v78, v79
  v_mfma_f32_32x32x16_bf16 v[48:63], v[32:35], v[248:251], v[48:63]
  ds_read_b64_tr_b16 v[28:29], v6 offset:3072
  ds_read_b64_tr_b16 v[30:31], v6 offset:3328
  v_accvgpr_write_b32 a72, v40
  v_accvgpr_write_b32 a73, v41
  v_accvgpr_write_b32 a74, v42
  v_accvgpr_write_b32 a75, v43
  v_mfma_f32_32x32x16_bf16 v[48:63], v[36:39], v[252:255], v[48:63]
  ds_read_b64_tr_b16 v[32:33], v6 offset:4096
  ds_read_b64_tr_b16 v[34:35], v6 offset:4352
  v_accvgpr_write_b32 a76, v44
  v_accvgpr_write_b32 a77, v45
  v_accvgpr_write_b32 a78, v46
  v_accvgpr_write_b32 a79, v47
  s_waitcnt lgkmcnt(4)
  v_mfma_f32_32x32x16_bf16 v[64:79], v[16:19], v[112:115], 0
  ds_read_b64_tr_b16 v[36:37], v6 offset:5120
  ds_read_b64_tr_b16 v[38:39], v6 offset:5376
  v_mfma_f32_32x32x16_bf16 v[64:79], v[20:23], v[116:119], v[64:79]
  ds_read_b64_tr_b16 v[16:17], v6 offset:6144
  ds_read_b64_tr_b16 v[18:19], v6 offset:6400
  s_add_u32 m0, s30, 110592
  v_mfma_f32_32x32x16_bf16 v[64:79], v[24:27], v[120:123], v[64:79]
  ds_read_b64_tr_b16 v[20:21], v6 offset:7168
  ds_read_b64_tr_b16 v[22:23], v6 offset:7424
  buffer_load_dwordx4 v2, s[20:23], 0 offen offset:0 lds
  s_waitcnt lgkmcnt(4)
  v_mfma_f32_32x32x16_bf16 v[64:79], v[28:31], v[124:127], v[64:79]
  ds_read_b64_tr_b16 v[24:25], v6 offset:8192
  ds_read_b64_tr_b16 v[26:27], v6 offset:8448
  v_mul_f32 v10, v48, v48
  v_mul_f32 v11, v49, v49
  v_mul_f32 v12, v50, v50
  v_mfma_f32_32x32x16_bf16 v[64:79], v[32:35], v[128:131], v[64:79]
  ds_read_b64_tr_b16 v[28:29], v6 offset:9216
  ds_read_b64_tr_b16 v[30:31], v6 offset:9472
  v_mul_f32 v13, v51, v51
  v_fmaak_f32 v10, v10, v8, 0xc0135761
  v_fmaak_f32 v11, v11, v8, 0xc0135761
  v_fmaak_f32 v12, v12, v8, 0xc0135761
  v_mfma_f32_32x32x16_bf16 v[64:79], v[36:39], v[132:135], v[64:79]
  ds_read_b64_tr_b16 v[32:33], v6 offset:10240
  ds_read_b64_tr_b16 v[34:35], v6 offset:10496
  buffer_load_dwordx4 v2, s[20:23], s67 offen offset:1024 lds
  v_fmaak_f32 v13, v13, v8, 0xc0135761
  s_waitcnt lgkmcnt(4)
  v_mfma_f32_32x32x16_bf16 v[64:79], v[16:19], v[136:139], v[64:79]
  ds_read_b64_tr_b16 v[36:37], v6 offset:11264
  ds_read_b64_tr_b16 v[38:39], v6 offset:11520
  v_mul_f32 v10, v10, v48
  v_mul_f32 v11, v11, v49
  v_mul_f32 v12, v12, v50
  v_mfma_f32_32x32x16_bf16 v[64:79], v[20:23], v[140:143], v[64:79]
  ds_read_b64_tr_b16 v[16:17], v6 offset:12288
  ds_read_b64_tr_b16 v[18:19], v6 offset:12544
  v_mul_f32 v13, v13, v51
  v_exp_f32 v10, v10
  v_mfma_f32_32x32x16_bf16 v[64:79], v[24:27], v[144:147], v[64:79]
  ds_read_b64_tr_b16 v[20:21], v6 offset:13312
  ds_read_b64_tr_b16 v[22:23], v6 offset:13568
  buffer_load_dwordx4 v2, s[20:23], s68 offen offset:2048 lds
  v_exp_f32 v11, v11
  s_waitcnt lgkmcnt(4)
  v_mfma_f32_32x32x16_bf16 v[64:79], v[28:31], v[148:151], v[64:79]
  ds_read_b64_tr_b16 v[24:25], v6 offset:14336
  ds_read_b64_tr_b16 v[26:27], v6 offset:14592
  v_exp_f32 v12, v12
  v_mfma_f32_32x32x16_bf16 v[64:79], v[32:35], v[152:155], v[64:79]
  ds_read_b64_tr_b16 v[28:29], v6 offset:15360
  ds_read_b64_tr_b16 v[30:31], v6 offset:15616
  v_exp_f32 v13, v13
  v_add_f32 v10, 1.0, v10
  v_add_f32 v11, 1.0, v11
  v_add_f32 v12, 1.0, v12
  v_mfma_f32_32x32x16_bf16 v[64:79], v[36:39], v[156:159], v[64:79]
  ds_read_b64_tr_b16 v[32:33], v6 offset:16384
  ds_read_b64_tr_b16 v[34:35], v6 offset:16640
  buffer_load_dwordx4 v2, s[20:23], s69 offen offset:3072 lds
  s_waitcnt lgkmcnt(4)
  v_mfma_f32_32x32x16_bf16 v[64:79], v[16:19], v[160:163], v[64:79]
  ds_read_b64_tr_b16 v[36:37], v6 offset:17408
  ds_read_b64_tr_b16 v[38:39], v6 offset:17664
  v_add_f32 v13, 1.0, v13
  v_rcp_f32 v10, v10
  v_mfma_f32_32x32x16_bf16 v[64:79], v[20:23], v[164:167], v[64:79]
  ds_read_b64_tr_b16 v[16:17], v6 offset:18432
  ds_read_b64_tr_b16 v[18:19], v6 offset:18688
  v_rcp_f32 v11, v11
  v_rcp_f32 v12, v12
  s_add_u32 m0, s30, 114688
  v_mfma_f32_32x32x16_bf16 v[64:79], v[24:27], v[168:171], v[64:79]
  ds_read_b64_tr_b16 v[20:21], v6 offset:19456
  ds_read_b64_tr_b16 v[22:23], v6 offset:19712
  buffer_load_dwordx4 v2, s[20:23], s70 offen offset:0 lds
  s_waitcnt lgkmcnt(4)
  v_mfma_f32_32x32x16_bf16 v[64:79], v[28:31], v[172:175], v[64:79]
  ds_read_b64_tr_b16 v[24:25], v6 offset:20480
  ds_read_b64_tr_b16 v[26:27], v6 offset:20736
  v_rcp_f32 v13, v13
  v_mfma_f32_32x32x16_bf16 v[64:79], v[32:35], v[176:179], v[64:79]
  ds_read_b64_tr_b16 v[28:29], v6 offset:21504
  ds_read_b64_tr_b16 v[30:31], v6 offset:21760
  v_mul_f32 v48, v48, v10
  v_mul_f32 v49, v49, v11
  v_mul_f32 v50, v50, v12
  v_mul_f32 v51, v51, v13
  v_mul_f32 v10, v52, v52
  v_mfma_f32_32x32x16_bf16 v[64:79], v[36:39], v[180:183], v[64:79]
  ds_read_b64_tr_b16 v[32:33], v6 offset:22528
  ds_read_b64_tr_b16 v[34:35], v6 offset:22784
  buffer_load_dwordx4 v2, s[20:23], s71 offen offset:1024 lds
  s_waitcnt lgkmcnt(4)
  v_mfma_f32_32x32x16_bf16 v[64:79], v[16:19], v[184:187], v[64:79]
  ds_read_b64_tr_b16 v[36:37], v6 offset:23552
  ds_read_b64_tr_b16 v[38:39], v6 offset:23808
  v_mul_f32 v11, v53, v53
  v_mul_f32 v12, v54, v54
  v_mul_f32 v13, v55, v55
  v_mfma_f32_32x32x16_bf16 v[64:79], v[20:23], v[188:191], v[64:79]
  ds_read_b64_tr_b16 v[16:17], v6 offset:24576
  ds_read_b64_tr_b16 v[18:19], v6 offset:24832
  v_fmaak_f32 v10, v10, v8, 0xc0135761
  v_fmaak_f32 v11, v11, v8, 0xc0135761
  v_fmaak_f32 v12, v12, v8, 0xc0135761
  v_fmaak_f32 v13, v13, v8, 0xc0135761
  v_mfma_f32_32x32x16_bf16 v[64:79], v[24:27], v[192:195], v[64:79]
  ds_read_b64_tr_b16 v[20:21], v6 offset:25600
  ds_read_b64_tr_b16 v[22:23], v6 offset:25856
  buffer_load_dwordx4 v2, s[20:23], s72 offen offset:2048 lds
  s_waitcnt lgkmcnt(4)
  v_mfma_f32_32x32x16_bf16 v[64:79], v[28:31], v[196:199], v[64:79]
  ds_read_b64_tr_b16 v[24:25], v6 offset:26624
  ds_read_b64_tr_b16 v[26:27], v6 offset:26880
  v_mul_f32 v10, v10, v52
  v_mul_f32 v11, v11, v53
  v_mul_f32 v12, v12, v54
  v_mul_f32 v13, v13, v55
  v_mfma_f32_32x32x16_bf16 v[64:79], v[32:35], v[200:203], v[64:79]
  ds_read_b64_tr_b16 v[28:29], v6 offset:27648
  ds_read_b64_tr_b16 v[30:31], v6 offset:27904
  v_exp_f32 v10, v10
  v_exp_f32 v11, v11
  v_mfma_f32_32x32x16_bf16 v[64:79], v[36:39], v[204:207], v[64:79]
  ds_read_b64_tr_b16 v[32:33], v6 offset:28672
  ds_read_b64_tr_b16 v[34:35], v6 offset:28928
  buffer_load_dwordx4 v2, s[20:23], s73 offen offset:3072 lds
  s_waitcnt lgkmcnt(4)
  v_mfma_f32_32x32x16_bf16 v[64:79], v[16:19], v[208:211], v[64:79]
  ds_read_b64_tr_b16 v[36:37], v6 offset:29696
  ds_read_b64_tr_b16 v[38:39], v6 offset:29952
  v_exp_f32 v12, v12
  v_exp_f32 v13, v13
  v_mfma_f32_32x32x16_bf16 v[64:79], v[20:23], v[212:215], v[64:79]
  ds_read_b64_tr_b16 v[16:17], v6 offset:30720
  ds_read_b64_tr_b16 v[18:19], v6 offset:30976
  v_add_f32 v10, 1.0, v10
  v_add_f32 v11, 1.0, v11
  s_add_u32 m0, s30, 118784
  v_mfma_f32_32x32x16_bf16 v[64:79], v[24:27], v[216:219], v[64:79]
  ds_read_b64_tr_b16 v[20:21], v6 offset:31744
  ds_read_b64_tr_b16 v[22:23], v6 offset:32000
  buffer_load_dwordx4 v2, s[20:23], s74 offen offset:0 lds
  v_add_f32 v12, 1.0, v12
  s_waitcnt lgkmcnt(4)
  v_mfma_f32_32x32x16_bf16 v[64:79], v[28:31], v[220:223], v[64:79]
  ds_read_b64_tr_b16 v[24:25], v6 offset:32768
  ds_read_b64_tr_b16 v[26:27], v6 offset:33024
  v_add_f32 v13, 1.0, v13
  v_add_u32 v2, 64, v2
  v_mfma_f32_32x32x16_bf16 v[64:79], v[32:35], v[224:227], v[64:79]
  ds_read_b64_tr_b16 v[28:29], v6 offset:33792
  ds_read_b64_tr_b16 v[30:31], v6 offset:34048
  v_rcp_f32 v10, v10
  v_rcp_f32 v11, v11
  v_mfma_f32_32x32x16_bf16 v[64:79], v[36:39], v[228:231], v[64:79]
  ds_read_b64_tr_b16 v[32:33], v6 offset:34816
  ds_read_b64_tr_b16 v[34:35], v6 offset:35072
  v_rcp_f32 v12, v12
  v_rcp_f32 v13, v13
  v_mul_f32 v52, v52, v10
  s_waitcnt lgkmcnt(4)
  v_mfma_f32_32x32x16_bf16 v[64:79], v[16:19], v[232:235], v[64:79]
  ds_read_b64_tr_b16 v[36:37], v6 offset:35840
  ds_read_b64_tr_b16 v[38:39], v6 offset:36096
  v_mul_f32 v53, v53, v11
  v_mul_f32 v54, v54, v12
  v_mul_f32 v55, v55, v13
  v_mfma_f32_32x32x16_bf16 v[64:79], v[20:23], v[236:239], v[64:79]
  s_waitcnt vmcnt(9)
  s_barrier
  v_add_u32 v6, 73728, v4
  ds_read_b64_tr_b16 v[16:17], v6 offset:0
  ds_read_b64_tr_b16 v[18:19], v6 offset:256
  global_load_dword a255, v[96:97], off
  v_add_co_u32 v96, vcc, 0x2000, v96
  v_addc_co_u32 v97, vcc, 0, v97, vcc
  v_mfma_f32_32x32x16_bf16 v[64:79], v[24:27], v[240:243], v[64:79]
  ds_read_b64_tr_b16 v[20:21], v6 offset:1024
  ds_read_b64_tr_b16 v[22:23], v6 offset:1280
  v_mul_f32 v10, v56, v56
  v_mul_f32 v11, v57, v57
  v_mul_f32 v12, v58, v58
  v_mul_f32 v13, v59, v59
  s_waitcnt lgkmcnt(4)
  v_mfma_f32_32x32x16_bf16 v[64:79], v[28:31], v[244:247], v[64:79]
  ds_read_b64_tr_b16 v[24:25], v6 offset:2048
  ds_read_b64_tr_b16 v[26:27], v6 offset:2304
  v_fmaak_f32 v10, v10, v8, 0xc0135761
  v_fmaak_f32 v11, v11, v8, 0xc0135761
  v_fmaak_f32 v12, v12, v8, 0xc0135761
  v_fmaak_f32 v13, v13, v8, 0xc0135761
  v_mfma_f32_32x32x16_bf16 v[64:79], v[32:35], v[248:251], v[64:79]
  ds_read_b64_tr_b16 v[28:29], v6 offset:3072
  ds_read_b64_tr_b16 v[30:31], v6 offset:3328
  v_mul_f32 v10, v10, v56
  v_mul_f32 v11, v11, v57
  v_mul_f32 v12, v12, v58
  v_mul_f32 v13, v13, v59
  v_mfma_f32_32x32x16_bf16 v[64:79], v[36:39], v[252:255], v[64:79]
  ds_read_b64_tr_b16 v[32:33], v6 offset:4096
  ds_read_b64_tr_b16 v[34:35], v6 offset:4352
  v_exp_f32 v10, v10
  v_exp_f32 v11, v11
  s_waitcnt lgkmcnt(4)
  v_mfma_f32_32x32x16_bf16 v[80:95], v[16:19], v[112:115], 0
  ds_read_b64_tr_b16 v[36:37], v6 offset:5120
  ds_read_b64_tr_b16 v[38:39], v6 offset:5376
  v_mfma_f32_32x32x16_bf16 v[80:95], v[20:23], v[116:119], v[80:95]
  ds_read_b64_tr_b16 v[16:17], v6 offset:6144
  ds_read_b64_tr_b16 v[18:19], v6 offset:6400
  v_exp_f32 v12, v12
  v_exp_f32 v13, v13
  s_add_u32 m0, s30, 0
  v_mfma_f32_32x32x16_bf16 v[80:95], v[24:27], v[120:123], v[80:95]
  ds_read_b64_tr_b16 v[20:21], v6 offset:7168
  ds_read_b64_tr_b16 v[22:23], v6 offset:7424
  buffer_load_dwordx4 v2, s[16:19], 0 offen offset:0 lds
  s_waitcnt lgkmcnt(4)
  v_mfma_f32_32x32x16_bf16 v[80:95], v[28:31], v[124:127], v[80:95]
  ds_read_b64_tr_b16 v[24:25], v6 offset:8192
  ds_read_b64_tr_b16 v[26:27], v6 offset:8448
  v_add_f32 v10, 1.0, v10
  v_add_f32 v11, 1.0, v11
  v_mfma_f32_32x32x16_bf16 v[80:95], v[32:35], v[128:131], v[80:95]
  ds_read_b64_tr_b16 v[28:29], v6 offset:9216
  ds_read_b64_tr_b16 v[30:31], v6 offset:9472
  v_add_f32 v12, 1.0, v12
  v_add_f32 v13, 1.0, v13
  v_rcp_f32 v10, v10
  v_mfma_f32_32x32x16_bf16 v[80:95], v[36:39], v[132:135], v[80:95]
  ds_read_b64_tr_b16 v[32:33], v6 offset:10240
  ds_read_b64_tr_b16 v[34:35], v6 offset:10496
  buffer_load_dwordx4 v2, s[16:19], s67 offen offset:1024 lds
  s_waitcnt lgkmcnt(4)
  v_mfma_f32_32x32x16_bf16 v[80:95], v[16:19], v[136:139], v[80:95]
  ds_read_b64_tr_b16 v[36:37], v6 offset:11264
  ds_read_b64_tr_b16 v[38:39], v6 offset:11520
  v_rcp_f32 v11, v11
  v_rcp_f32 v12, v12
  v_mfma_f32_32x32x16_bf16 v[80:95], v[20:23], v[140:143], v[80:95]
  ds_read_b64_tr_b16 v[16:17], v6 offset:12288
  ds_read_b64_tr_b16 v[18:19], v6 offset:12544
  v_rcp_f32 v13, v13
  v_mul_f32 v56, v56, v10
  v_mfma_f32_32x32x16_bf16 v[80:95], v[24:27], v[144:147], v[80:95]
  ds_read_b64_tr_b16 v[20:21], v6 offset:13312
  ds_read_b64_tr_b16 v[22:23], v6 offset:13568
  buffer_load_dwordx4 v2, s[16:19], s68 offen offset:2048 lds
  s_waitcnt lgkmcnt(4)
  v_mfma_f32_32x32x16_bf16 v[80:95], v[28:31], v[148:151], v[80:95]
  ds_read_b64_tr_b16 v[24:25], v6 offset:14336
  ds_read_b64_tr_b16 v[26:27], v6 offset:14592
  v_mul_f32 v57, v57, v11
  v_mul_f32 v58, v58, v12
  v_mul_f32 v59, v59, v13
  v_mul_f32 v10, v60, v60
  v_mfma_f32_32x32x16_bf16 v[80:95], v[32:35], v[152:155], v[80:95]
  ds_read_b64_tr_b16 v[28:29], v6 offset:15360
  ds_read_b64_tr_b16 v[30:31], v6 offset:15616
  v_mul_f32 v11, v61, v61
  v_mul_f32 v12, v62, v62
  v_mul_f32 v13, v63, v63
  v_fmaak_f32 v10, v10, v8, 0xc0135761
  v_mfma_f32_32x32x16_bf16 v[80:95], v[36:39], v[156:159], v[80:95]
  ds_read_b64_tr_b16 v[32:33], v6 offset:16384
  ds_read_b64_tr_b16 v[34:35], v6 offset:16640
  buffer_load_dwordx4 v2, s[16:19], s69 offen offset:3072 lds
  s_waitcnt lgkmcnt(4)
  v_mfma_f32_32x32x16_bf16 v[80:95], v[16:19], v[160:163], v[80:95]
  ds_read_b64_tr_b16 v[36:37], v6 offset:17408
  ds_read_b64_tr_b16 v[38:39], v6 offset:17664
  v_fmaak_f32 v11, v11, v8, 0xc0135761
  v_fmaak_f32 v12, v12, v8, 0xc0135761
  v_fmaak_f32 v13, v13, v8, 0xc0135761
  v_mfma_f32_32x32x16_bf16 v[80:95], v[20:23], v[164:167], v[80:95]
  ds_read_b64_tr_b16 v[16:17], v6 offset:18432
  ds_read_b64_tr_b16 v[18:19], v6 offset:18688
  v_mul_f32 v10, v10, v60
  v_mul_f32 v11, v11, v61
  v_mul_f32 v12, v12, v62
  s_add_u32 m0, s30, 4096
  v_mfma_f32_32x32x16_bf16 v[80:95], v[24:27], v[168:171], v[80:95]
  ds_read_b64_tr_b16 v[20:21], v6 offset:19456
  ds_read_b64_tr_b16 v[22:23], v6 offset:19712
  buffer_load_dwordx4 v2, s[16:19], s70 offen offset:0 lds
  s_waitcnt lgkmcnt(4)
  v_mfma_f32_32x32x16_bf16 v[80:95], v[28:31], v[172:175], v[80:95]
  ds_read_b64_tr_b16 v[24:25], v6 offset:20480
  ds_read_b64_tr_b16 v[26:27], v6 offset:20736
  v_mul_f32 v13, v13, v63
  v_exp_f32 v10, v10
  v_mfma_f32_32x32x16_bf16 v[80:95], v[32:35], v[176:179], v[80:95]
  ds_read_b64_tr_b16 v[28:29], v6 offset:21504
  ds_read_b64_tr_b16 v[30:31], v6 offset:21760
  v_exp_f32 v11, v11
  v_exp_f32 v12, v12
  v_mfma_f32_32x32x16_bf16 v[80:95], v[36:39], v[180:183], v[80:95]
  ds_read_b64_tr_b16 v[32:33], v6 offset:22528
  ds_read_b64_tr_b16 v[34:35], v6 offset:22784
  buffer_load_dwordx4 v2, s[16:19], s71 offen offset:1024 lds
  s_waitcnt lgkmcnt(4)
  v_mfma_f32_32x32x16_bf16 v[80:95], v[16:19], v[184:187], v[80:95]
  ds_read_b64_tr_b16 v[36:37], v6 offset:23552
  ds_read_b64_tr_b16 v[38:39], v6 offset:23808
  v_exp_f32 v13, v13
  v_add_f32 v10, 1.0, v10
  v_mfma_f32_32x32x16_bf16 v[80:95], v[20:23], v[188:191], v[80:95]
  ds_read_b64_tr_b16 v[16:17], v6 offset:24576
  ds_read_b64_tr_b16 v[18:19], v6 offset:24832
  v_add_f32 v11, 1.0, v11
  v_add_f32 v12, 1.0, v12
  v_add_f32 v13, 1.0, v13
  v_rcp_f32 v10, v10
  v_mfma_f32_32x32x16_bf16 v[80:95], v[24:27], v[192:195], v[80:95]
  ds_read_b64_tr_b16 v[20:21], v6 offset:25600
  ds_read_b64_tr_b16 v[22:23], v6 offset:25856
  buffer_load_dwordx4 v2, s[16:19], s72 offen offset:2048 lds
  s_waitcnt lgkmcnt(4)
  v_mfma_f32_32x32x16_bf16 v[80:95], v[28:31], v[196:199], v[80:95]
  ds_read_b64_tr_b16 v[24:25], v6 offset:26624
  ds_read_b64_tr_b16 v[26:27], v6 offset:26880
  v_rcp_f32 v11, v11
  v_mfma_f32_32x32x16_bf16 v[80:95], v[32:35], v[200:203], v[80:95]
  ds_read_b64_tr_b16 v[28:29], v6 offset:27648
  ds_read_b64_tr_b16 v[30:31], v6 offset:27904
  v_rcp_f32 v12, v12
  v_rcp_f32 v13, v13
  v_mfma_f32_32x32x16_bf16 v[80:95], v[36:39], v[204:207], v[80:95]
  ds_read_b64_tr_b16 v[32:33], v6 offset:28672
  ds_read_b64_tr_b16 v[34:35], v6 offset:28928
  buffer_load_dwordx4 v2, s[16:19], s73 offen offset:3072 lds
  s_waitcnt lgkmcnt(4)
  v_mfma_f32_32x32x16_bf16 v[80:95], v[16:19], v[208:211], v[80:95]
  ds_read_b64_tr_b16 v[36:37], v6 offset:29696
  ds_read_b64_tr_b16 v[38:39], v6 offset:29952
  v_mul_f32 v60, v60, v10
  v_mul_f32 v61, v61, v11
  v_mul_f32 v62, v62, v12
  v_mfma_f32_32x32x16_bf16 v[80:95], v[20:23], v[212:215], v[80:95]
  ds_read_b64_tr_b16 v[16:17], v6 offset:30720
  ds_read_b64_tr_b16 v[18:19], v6 offset:30976
  v_mul_f32 v63, v63, v13
  v_mul_f32 v64, v64, v48
  v_mul_f32 v65, v65, v49
  s_add_u32 m0, s30, 8192
  v_mfma_f32_32x32x16_bf16 v[80:95], v[24:27], v[216:219], v[80:95]
  ds_read_b64_tr_b16 v[20:21], v6 offset:31744
  ds_read_b64_tr_b16 v[22:23], v6 offset:32000
  buffer_load_dwordx4 v2, s[16:19], s74 offen offset:0 lds
  s_waitcnt lgkmcnt(4)
  v_mfma_f32_32x32x16_bf16 v[80:95], v[28:31], v[220:223], v[80:95]
  ds_read_b64_tr_b16 v[24:25], v6 offset:32768
  ds_read_b64_tr_b16 v[26:27], v6 offset:33024
  v_mul_f32 v66, v66, v50
  v_mul_f32 v67, v67, v51
  v_mul_f32 v68, v68, v52
  v_mul_f32 v69, v69, v53
  v_mfma_f32_32x32x16_bf16 v[80:95], v[32:35], v[224:227], v[80:95]
  ds_read_b64_tr_b16 v[28:29], v6 offset:33792
  ds_read_b64_tr_b16 v[30:31], v6 offset:34048
  v_mul_f32 v70, v70, v54
  v_mul_f32 v71, v71, v55
  v_mul_f32 v72, v72, v56
  v_mul_f32 v73, v73, v57
  v_mfma_f32_32x32x16_bf16 v[80:95], v[36:39], v[228:231], v[80:95]
  ds_read_b64_tr_b16 v[32:33], v6 offset:34816
  ds_read_b64_tr_b16 v[34:35], v6 offset:35072
  buffer_load_dword a253, v7, s[16:19], 0 offen offset:1024
  v_mul_f32 v74, v74, v58
  v_mul_f32 v75, v75, v59
  v_mul_f32 v76, v76, v60
  s_waitcnt lgkmcnt(4)
  v_mfma_f32_32x32x16_bf16 v[80:95], v[16:19], v[232:235], v[80:95]
  ds_read_b64_tr_b16 v[36:37], v6 offset:35840
  ds_read_b64_tr_b16 v[38:39], v6 offset:36096
  v_mul_f32 v77, v77, v61
  v_mul_f32 v78, v78, v62
  v_mul_f32 v79, v79, v63
  v_mfma_f32_32x32x16_bf16 v[80:95], v[20:23], v[236:239], v[80:95]
  s_waitcnt vmcnt(11)
  s_barrier
  v_add_u32 v6, 110592, v4
  ds_read_b64_tr_b16 v[16:17], v6 offset:0
  ds_read_b64_tr_b16 v[18:19], v6 offset:256
  v_cvt_pk_bf16_f32 v40, v64, v65
  v_mfma_f32_32x32x16_bf16 v[80:95], v[24:27], v[240:243], v[80:95]
  ds_read_b64_tr_b16 v[20:21], v6 offset:1024
  ds_read_b64_tr_b16 v[22:23], v6 offset:1280
  v_cvt_pk_bf16_f32 v41, v66, v67
  v_cvt_pk_bf16_f32 v42, v68, v69
  v_cvt_pk_bf16_f32 v43, v70, v71
  v_cvt_pk_bf16_f32 v44, v72, v73
  s_waitcnt lgkmcnt(4)
  v_mfma_f32_32x32x16_bf16 v[80:95], v[28:31], v[244:247], v[80:95]
  ds_read_b64_tr_b16 v[24:25], v6 offset:2048
  ds_read_b64_tr_b16 v[26:27], v6 offset:2304
  v_cvt_pk_bf16_f32 v45, v74, v75
  v_cvt_pk_bf16_f32 v46, v76, v77
  v_cvt_pk_bf16_f32 v47, v78, v79
  v_mfma_f32_32x32x16_bf16 v[80:95], v[32:35], v[248:251], v[80:95]
  ds_read_b64_tr_b16 v[28:29], v6 offset:3072
  ds_read_b64_tr_b16 v[30:31], v6 offset:3328
  v_accvgpr_write_b32 a80, v40
  v_accvgpr_write_b32 a81, v41
  v_accvgpr_write_b32 a82, v42
  v_accvgpr_write_b32 a83, v43
  v_mfma_f32_32x32x16_bf16 v[80:95], v[36:39], v[252:255], v[80:95]
  ds_read_b64_tr_b16 v[32:33], v6 offset:4096
  ds_read_b64_tr_b16 v[34:35], v6 offset:4352
  v_accvgpr_write_b32 a84, v44
  v_accvgpr_write_b32 a85, v45
  v_accvgpr_write_b32 a86, v46
  v_accvgpr_write_b32 a87, v47
  s_waitcnt lgkmcnt(4)
  v_mfma_f32_32x32x16_bf16 v[64:79], v[16:19], v[112:115], 0
  ds_read_b64_tr_b16 v[36:37], v6 offset:5120
  ds_read_b64_tr_b16 v[38:39], v6 offset:5376
  v_mfma_f32_32x32x16_bf16 v[64:79], v[20:23], v[116:119], v[64:79]
  ds_read_b64_tr_b16 v[16:17], v6 offset:6144
  ds_read_b64_tr_b16 v[18:19], v6 offset:6400
  s_add_u32 m0, s30, 36864
  v_mfma_f32_32x32x16_bf16 v[64:79], v[24:27], v[120:123], v[64:79]
  ds_read_b64_tr_b16 v[20:21], v6 offset:7168
  ds_read_b64_tr_b16 v[22:23], v6 offset:7424
  buffer_load_dwordx4 v2, s[20:23], 0 offen offset:0 lds
  s_waitcnt lgkmcnt(4)
  v_mfma_f32_32x32x16_bf16 v[64:79], v[28:31], v[124:127], v[64:79]
  ds_read_b64_tr_b16 v[24:25], v6 offset:8192
  ds_read_b64_tr_b16 v[26:27], v6 offset:8448
  v_mul_f32 v10, v80, v80
  v_mul_f32 v11, v81, v81
  v_mul_f32 v12, v82, v82
  v_mfma_f32_32x32x16_bf16 v[64:79], v[32:35], v[128:131], v[64:79]
  ds_read_b64_tr_b16 v[28:29], v6 offset:9216
  ds_read_b64_tr_b16 v[30:31], v6 offset:9472
  v_mul_f32 v13, v83, v83
  v_fmaak_f32 v10, v10, v8, 0xc0135761
  v_fmaak_f32 v11, v11, v8, 0xc0135761
  v_fmaak_f32 v12, v12, v8, 0xc0135761
  v_mfma_f32_32x32x16_bf16 v[64:79], v[36:39], v[132:135], v[64:79]
  ds_read_b64_tr_b16 v[32:33], v6 offset:10240
  ds_read_b64_tr_b16 v[34:35], v6 offset:10496
  buffer_load_dwordx4 v2, s[20:23], s67 offen offset:1024 lds
  v_fmaak_f32 v13, v13, v8, 0xc0135761
  s_waitcnt lgkmcnt(4)
  v_mfma_f32_32x32x16_bf16 v[64:79], v[16:19], v[136:139], v[64:79]
  ds_read_b64_tr_b16 v[36:37], v6 offset:11264
  ds_read_b64_tr_b16 v[38:39], v6 offset:11520
  v_mul_f32 v10, v10, v80
  v_mul_f32 v11, v11, v81
  v_mul_f32 v12, v12, v82
  v_mfma_f32_32x32x16_bf16 v[64:79], v[20:23], v[140:143], v[64:79]
  ds_read_b64_tr_b16 v[16:17], v6 offset:12288
  ds_read_b64_tr_b16 v[18:19], v6 offset:12544
  v_mul_f32 v13, v13, v83
  v_exp_f32 v10, v10
  v_mfma_f32_32x32x16_bf16 v[64:79], v[24:27], v[144:147], v[64:79]
  ds_read_b64_tr_b16 v[20:21], v6 offset:13312
  ds_read_b64_tr_b16 v[22:23], v6 offset:13568
  buffer_load_dwordx4 v2, s[20:23], s68 offen offset:2048 lds
  v_exp_f32 v11, v11
  s_waitcnt lgkmcnt(4)
  v_mfma_f32_32x32x16_bf16 v[64:79], v[28:31], v[148:151], v[64:79]
  ds_read_b64_tr_b16 v[24:25], v6 offset:14336
  ds_read_b64_tr_b16 v[26:27], v6 offset:14592
  v_exp_f32 v12, v12
  v_mfma_f32_32x32x16_bf16 v[64:79], v[32:35], v[152:155], v[64:79]
  ds_read_b64_tr_b16 v[28:29], v6 offset:15360
  ds_read_b64_tr_b16 v[30:31], v6 offset:15616
  v_exp_f32 v13, v13
  v_add_f32 v10, 1.0, v10
  v_add_f32 v11, 1.0, v11
  v_mfma_f32_32x32x16_bf16 v[64:79], v[36:39], v[156:159], v[64:79]
  ds_read_b64_tr_b16 v[32:33], v6 offset:16384
  ds_read_b64_tr_b16 v[34:35], v6 offset:16640
  buffer_load_dwordx4 v2, s[20:23], s69 offen offset:3072 lds
  v_add_f32 v12, 1.0, v12
  s_waitcnt lgkmcnt(4)
  v_mfma_f32_32x32x16_bf16 v[64:79], v[16:19], v[160:163], v[64:79]
  ds_read_b64_tr_b16 v[36:37], v6 offset:17408
  ds_read_b64_tr_b16 v[38:39], v6 offset:17664
  v_add_f32 v13, 1.0, v13
  v_rcp_f32 v10, v10
  v_mfma_f32_32x32x16_bf16 v[64:79], v[20:23], v[164:167], v[64:79]
  ds_read_b64_tr_b16 v[16:17], v6 offset:18432
  ds_read_b64_tr_b16 v[18:19], v6 offset:18688
  v_rcp_f32 v11, v11
  v_rcp_f32 v12, v12
  s_add_u32 m0, s30, 40960
  v_mfma_f32_32x32x16_bf16 v[64:79], v[24:27], v[168:171], v[64:79]
  ds_read_b64_tr_b16 v[20:21], v6 offset:19456
  ds_read_b64_tr_b16 v[22:23], v6 offset:19712
  buffer_load_dwordx4 v2, s[20:23], s70 offen offset:0 lds
  s_waitcnt lgkmcnt(4)
  v_mfma_f32_32x32x16_bf16 v[64:79], v[28:31], v[172:175], v[64:79]
  ds_read_b64_tr_b16 v[24:25], v6 offset:20480
  ds_read_b64_tr_b16 v[26:27], v6 offset:20736
  v_rcp_f32 v13, v13
  v_mfma_f32_32x32x16_bf16 v[64:79], v[32:35], v[176:179], v[64:79]
  ds_read_b64_tr_b16 v[28:29], v6 offset:21504
  ds_read_b64_tr_b16 v[30:31], v6 offset:21760
  v_mul_f32 v80, v80, v10
  v_mul_f32 v81, v81, v11
  v_mul_f32 v82, v82, v12
  v_mul_f32 v83, v83, v13
  v_mul_f32 v10, v84, v84
  v_mfma_f32_32x32x16_bf16 v[64:79], v[36:39], v[180:183], v[64:79]
  ds_read_b64_tr_b16 v[32:33], v6 offset:22528
  ds_read_b64_tr_b16 v[34:35], v6 offset:22784
  buffer_load_dwordx4 v2, s[20:23], s71 offen offset:1024 lds
  s_waitcnt lgkmcnt(4)
  v_mfma_f32_32x32x16_bf16 v[64:79], v[16:19], v[184:187], v[64:79]
  ds_read_b64_tr_b16 v[36:37], v6 offset:23552
  ds_read_b64_tr_b16 v[38:39], v6 offset:23808
  v_mul_f32 v11, v85, v85
  v_mul_f32 v12, v86, v86
  v_mul_f32 v13, v87, v87
  v_mfma_f32_32x32x16_bf16 v[64:79], v[20:23], v[188:191], v[64:79]
  ds_read_b64_tr_b16 v[16:17], v6 offset:24576
  ds_read_b64_tr_b16 v[18:19], v6 offset:24832
  v_fmaak_f32 v10, v10, v8, 0xc0135761
  v_fmaak_f32 v11, v11, v8, 0xc0135761
  v_fmaak_f32 v12, v12, v8, 0xc0135761
  v_fmaak_f32 v13, v13, v8, 0xc0135761
  v_mfma_f32_32x32x16_bf16 v[64:79], v[24:27], v[192:195], v[64:79]
  ds_read_b64_tr_b16 v[20:21], v6 offset:25600
  ds_read_b64_tr_b16 v[22:23], v6 offset:25856
  buffer_load_dwordx4 v2, s[20:23], s72 offen offset:2048 lds
  s_waitcnt lgkmcnt(4)
  v_mfma_f32_32x32x16_bf16 v[64:79], v[28:31], v[196:199], v[64:79]
  ds_read_b64_tr_b16 v[24:25], v6 offset:26624
  ds_read_b64_tr_b16 v[26:27], v6 offset:26880
  v_mul_f32 v10, v10, v84
  v_mul_f32 v11, v11, v85
  v_mul_f32 v12, v12, v86
  v_mfma_f32_32x32x16_bf16 v[64:79], v[32:35], v[200:203], v[64:79]
  ds_read_b64_tr_b16 v[28:29], v6 offset:27648
  ds_read_b64_tr_b16 v[30:31], v6 offset:27904
  v_mul_f32 v13, v13, v87
  v_exp_f32 v10, v10
  v_exp_f32 v11, v11
  v_mfma_f32_32x32x16_bf16 v[64:79], v[36:39], v[204:207], v[64:79]
  ds_read_b64_tr_b16 v[32:33], v6 offset:28672
  ds_read_b64_tr_b16 v[34:35], v6 offset:28928
  buffer_load_dwordx4 v2, s[20:23], s73 offen offset:3072 lds
  s_waitcnt lgkmcnt(4)
  v_mfma_f32_32x32x16_bf16 v[64:79], v[16:19], v[208:211], v[64:79]
  ds_read_b64_tr_b16 v[36:37], v6 offset:29696
  ds_read_b64_tr_b16 v[38:39], v6 offset:29952
  v_exp_f32 v12, v12
  v_exp_f32 v13, v13
  v_mfma_f32_32x32x16_bf16 v[64:79], v[20:23], v[212:215], v[64:79]
  ds_read_b64_tr_b16 v[16:17], v6 offset:30720
  ds_read_b64_tr_b16 v[18:19], v6 offset:30976
  v_add_f32 v10, 1.0, v10
  v_add_f32 v11, 1.0, v11
  s_add_u32 m0, s30, 45056
  v_mfma_f32_32x32x16_bf16 v[64:79], v[24:27], v[216:219], v[64:79]
  ds_read_b64_tr_b16 v[20:21], v6 offset:31744
  ds_read_b64_tr_b16 v[22:23], v6 offset:32000
  buffer_load_dwordx4 v2, s[20:23], s74 offen offset:0 lds
  s_waitcnt lgkmcnt(4)
  v_mfma_f32_32x32x16_bf16 v[64:79], v[28:31], v[220:223], v[64:79]
  ds_read_b64_tr_b16 v[24:25], v6 offset:32768
  ds_read_b64_tr_b16 v[26:27], v6 offset:33024
  v_add_f32 v12, 1.0, v12
  v_add_f32 v13, 1.0, v13
  v_add_u32 v2, 64, v2
  v_mfma_f32_32x32x16_bf16 v[64:79], v[32:35], v[224:227], v[64:79]
  ds_read_b64_tr_b16 v[28:29], v6 offset:33792
  ds_read_b64_tr_b16 v[30:31], v6 offset:34048
  v_rcp_f32 v10, v10
  v_rcp_f32 v11, v11
  v_mfma_f32_32x32x16_bf16 v[64:79], v[36:39], v[228:231], v[64:79]
  ds_read_b64_tr_b16 v[32:33], v6 offset:34816
  ds_read_b64_tr_b16 v[34:35], v6 offset:35072
  buffer_load_dword a253, v7, s[20:23], 0 offen offset:1024
  v_rcp_f32 v12, v12
  v_rcp_f32 v13, v13
  s_waitcnt lgkmcnt(4)
  v_mfma_f32_32x32x16_bf16 v[64:79], v[16:19], v[232:235], v[64:79]
  ds_read_b64_tr_b16 v[36:37], v6 offset:35840
  ds_read_b64_tr_b16 v[38:39], v6 offset:36096
  v_mul_f32 v84, v84, v10
  v_mul_f32 v85, v85, v11
  v_mul_f32 v86, v86, v12
  v_mfma_f32_32x32x16_bf16 v[64:79], v[20:23], v[236:239], v[64:79]
  s_waitcnt vmcnt(11)
  s_barrier
  v_add_u32 v6, 0, v4
  ds_read_b64_tr_b16 v[16:17], v6 offset:0
  ds_read_b64_tr_b16 v[18:19], v6 offset:256
  v_mul_f32 v87, v87, v13
  v_mfma_f32_32x32x16_bf16 v[64:79], v[24:27], v[240:243], v[64:79]
  ds_read_b64_tr_b16 v[20:21], v6 offset:1024
  ds_read_b64_tr_b16 v[22:23], v6 offset:1280
  v_mul_f32 v10, v88, v88
  v_mul_f32 v11, v89, v89
  v_mul_f32 v12, v90, v90
  v_mul_f32 v13, v91, v91
  s_waitcnt lgkmcnt(4)
  v_mfma_f32_32x32x16_bf16 v[64:79], v[28:31], v[244:247], v[64:79]
  ds_read_b64_tr_b16 v[24:25], v6 offset:2048
  ds_read_b64_tr_b16 v[26:27], v6 offset:2304
  v_fmaak_f32 v10, v10, v8, 0xc0135761
  v_fmaak_f32 v11, v11, v8, 0xc0135761
  v_fmaak_f32 v12, v12, v8, 0xc0135761
  v_fmaak_f32 v13, v13, v8, 0xc0135761
  v_mfma_f32_32x32x16_bf16 v[64:79], v[32:35], v[248:251], v[64:79]
  ds_read_b64_tr_b16 v[28:29], v6 offset:3072
  ds_read_b64_tr_b16 v[30:31], v6 offset:3328
  v_mul_f32 v10, v10, v88
  v_mul_f32 v11, v11, v89
  v_mul_f32 v12, v12, v90
  v_mul_f32 v13, v13, v91
  v_mfma_f32_32x32x16_bf16 v[64:79], v[36:39], v[252:255], v[64:79]
  ds_read_b64_tr_b16 v[32:33], v6 offset:4096
  ds_read_b64_tr_b16 v[34:35], v6 offset:4352
  v_exp_f32 v10, v10
  v_exp_f32 v11, v11
  s_waitcnt lgkmcnt(4)
  v_mfma_f32_32x32x16_bf16 v[48:63], v[16:19], v[112:115], 0
  ds_read_b64_tr_b16 v[36:37], v6 offset:5120
  ds_read_b64_tr_b16 v[38:39], v6 offset:5376
  v_mfma_f32_32x32x16_bf16 v[48:63], v[20:23], v[116:119], v[48:63]
  ds_read_b64_tr_b16 v[16:17], v6 offset:6144
  ds_read_b64_tr_b16 v[18:19], v6 offset:6400
  v_exp_f32 v12, v12
  v_exp_f32 v13, v13
  s_add_u32 m0, s30, 73728
  v_mfma_f32_32x32x16_bf16 v[48:63], v[24:27], v[120:123], v[48:63]
  ds_read_b64_tr_b16 v[20:21], v6 offset:7168
  ds_read_b64_tr_b16 v[22:23], v6 offset:7424
  buffer_load_dwordx4 v2, s[16:19], 0 offen offset:0 lds
  s_waitcnt lgkmcnt(4)
  v_mfma_f32_32x32x16_bf16 v[48:63], v[28:31], v[124:127], v[48:63]
  ds_read_b64_tr_b16 v[24:25], v6 offset:8192
  ds_read_b64_tr_b16 v[26:27], v6 offset:8448
  v_add_f32 v10, 1.0, v10
  v_add_f32 v11, 1.0, v11
  v_mfma_f32_32x32x16_bf16 v[48:63], v[32:35], v[128:131], v[48:63]
  ds_read_b64_tr_b16 v[28:29], v6 offset:9216
  ds_read_b64_tr_b16 v[30:31], v6 offset:9472
  v_add_f32 v12, 1.0, v12
  v_add_f32 v13, 1.0, v13
  v_rcp_f32 v10, v10
  v_mfma_f32_32x32x16_bf16 v[48:63], v[36:39], v[132:135], v[48:63]
  ds_read_b64_tr_b16 v[32:33], v6 offset:10240
  ds_read_b64_tr_b16 v[34:35], v6 offset:10496
  buffer_load_dwordx4 v2, s[16:19], s67 offen offset:1024 lds
  s_waitcnt lgkmcnt(4)
  v_mfma_f32_32x32x16_bf16 v[48:63], v[16:19], v[136:139], v[48:63]
  ds_read_b64_tr_b16 v[36:37], v6 offset:11264
  ds_read_b64_tr_b16 v[38:39], v6 offset:11520
  v_rcp_f32 v11, v11
  v_rcp_f32 v12, v12
  v_mfma_f32_32x32x16_bf16 v[48:63], v[20:23], v[140:143], v[48:63]
  ds_read_b64_tr_b16 v[16:17], v6 offset:12288
  ds_read_b64_tr_b16 v[18:19], v6 offset:12544
  v_rcp_f32 v13, v13
  v_mul_f32 v88, v88, v10
  v_mfma_f32_32x32x16_bf16 v[48:63], v[24:27], v[144:147], v[48:63]
  ds_read_b64_tr_b16 v[20:21], v6 offset:13312
  ds_read_b64_tr_b16 v[22:23], v6 offset:13568
  buffer_load_dwordx4 v2, s[16:19], s68 offen offset:2048 lds
  s_waitcnt lgkmcnt(4)
  v_mfma_f32_32x32x16_bf16 v[48:63], v[28:31], v[148:151], v[48:63]
  ds_read_b64_tr_b16 v[24:25], v6 offset:14336
  ds_read_b64_tr_b16 v[26:27], v6 offset:14592
  v_mul_f32 v89, v89, v11
  v_mul_f32 v90, v90, v12
  v_mul_f32 v91, v91, v13
  v_mfma_f32_32x32x16_bf16 v[48:63], v[32:35], v[152:155], v[48:63]
  ds_read_b64_tr_b16 v[28:29], v6 offset:15360
  ds_read_b64_tr_b16 v[30:31], v6 offset:15616
  v_mul_f32 v10, v92, v92
  v_mul_f32 v11, v93, v93
  v_mul_f32 v12, v94, v94
  v_mul_f32 v13, v95, v95
  v_mfma_f32_32x32x16_bf16 v[48:63], v[36:39], v[156:159], v[48:63]
  ds_read_b64_tr_b16 v[32:33], v6 offset:16384
  ds_read_b64_tr_b16 v[34:35], v6 offset:16640
  buffer_load_dwordx4 v2, s[16:19], s69 offen offset:3072 lds
  s_waitcnt lgkmcnt(4)
  v_mfma_f32_32x32x16_bf16 v[48:63], v[16:19], v[160:163], v[48:63]
  ds_read_b64_tr_b16 v[36:37], v6 offset:17408
  ds_read_b64_tr_b16 v[38:39], v6 offset:17664
  v_fmaak_f32 v10, v10, v8, 0xc0135761
  v_fmaak_f32 v11, v11, v8, 0xc0135761
  v_fmaak_f32 v12, v12, v8, 0xc0135761
  v_mfma_f32_32x32x16_bf16 v[48:63], v[20:23], v[164:167], v[48:63]
  ds_read_b64_tr_b16 v[16:17], v6 offset:18432
  ds_read_b64_tr_b16 v[18:19], v6 offset:18688
  v_fmaak_f32 v13, v13, v8, 0xc0135761
  v_mul_f32 v10, v10, v92
  v_mul_f32 v11, v11, v93
  s_add_u32 m0, s30, 77824
  v_mfma_f32_32x32x16_bf16 v[48:63], v[24:27], v[168:171], v[48:63]
  ds_read_b64_tr_b16 v[20:21], v6 offset:19456
  ds_read_b64_tr_b16 v[22:23], v6 offset:19712
  buffer_load_dwordx4 v2, s[16:19], s70 offen offset:0 lds
  s_waitcnt lgkmcnt(4)
  v_mfma_f32_32x32x16_bf16 v[48:63], v[28:31], v[172:175], v[48:63]
  ds_read_b64_tr_b16 v[24:25], v6 offset:20480
  ds_read_b64_tr_b16 v[26:27], v6 offset:20736
  v_mul_f32 v12, v12, v94
  v_mul_f32 v13, v13, v95
  v_exp_f32 v10, v10
  v_mfma_f32_32x32x16_bf16 v[48:63], v[32:35], v[176:179], v[48:63]
  ds_read_b64_tr_b16 v[28:29], v6 offset:21504
  ds_read_b64_tr_b16 v[30:31], v6 offset:21760
  v_exp_f32 v11, v11
  v_exp_f32 v12, v12
  v_mfma_f32_32x32x16_bf16 v[48:63], v[36:39], v[180:183], v[48:63]
  ds_read_b64_tr_b16 v[32:33], v6 offset:22528
  ds_read_b64_tr_b16 v[34:35], v6 offset:22784
  buffer_load_dwordx4 v2, s[16:19], s71 offen offset:1024 lds
  s_waitcnt lgkmcnt(4)
  v_mfma_f32_32x32x16_bf16 v[48:63], v[16:19], v[184:187], v[48:63]
  ds_read_b64_tr_b16 v[36:37], v6 offset:23552
  ds_read_b64_tr_b16 v[38:39], v6 offset:23808
  v_exp_f32 v13, v13
  v_add_f32 v10, 1.0, v10
  v_mfma_f32_32x32x16_bf16 v[48:63], v[20:23], v[188:191], v[48:63]
  ds_read_b64_tr_b16 v[16:17], v6 offset:24576
  ds_read_b64_tr_b16 v[18:19], v6 offset:24832
  v_add_f32 v11, 1.0, v11
  v_add_f32 v12, 1.0, v12
  v_add_f32 v13, 1.0, v13
  v_mfma_f32_32x32x16_bf16 v[48:63], v[24:27], v[192:195], v[48:63]
  ds_read_b64_tr_b16 v[20:21], v6 offset:25600
  ds_read_b64_tr_b16 v[22:23], v6 offset:25856
  buffer_load_dwordx4 v2, s[16:19], s72 offen offset:2048 lds
  s_waitcnt lgkmcnt(4)
  v_mfma_f32_32x32x16_bf16 v[48:63], v[28:31], v[196:199], v[48:63]
  ds_read_b64_tr_b16 v[24:25], v6 offset:26624
  ds_read_b64_tr_b16 v[26:27], v6 offset:26880
  v_rcp_f32 v10, v10
  v_rcp_f32 v11, v11
  v_mfma_f32_32x32x16_bf16 v[48:63], v[32:35], v[200:203], v[48:63]
  ds_read_b64_tr_b16 v[28:29], v6 offset:27648
  ds_read_b64_tr_b16 v[30:31], v6 offset:27904
  v_rcp_f32 v12, v12
  v_rcp_f32 v13, v13
  v_mfma_f32_32x32x16_bf16 v[48:63], v[36:39], v[204:207], v[48:63]
  ds_read_b64_tr_b16 v[32:33], v6 offset:28672
  ds_read_b64_tr_b16 v[34:35], v6 offset:28928
  buffer_load_dwordx4 v2, s[16:19], s73 offen offset:3072 lds
  s_waitcnt lgkmcnt(4)
  v_mfma_f32_32x32x16_bf16 v[48:63], v[16:19], v[208:211], v[48:63]
  ds_read_b64_tr_b16 v[36:37], v6 offset:29696
  ds_read_b64_tr_b16 v[38:39], v6 offset:29952
  v_mul_f32 v92, v92, v10
  v_mul_f32 v93, v93, v11
  v_mul_f32 v94, v94, v12
  v_mfma_f32_32x32x16_bf16 v[48:63], v[20:23], v[212:215], v[48:63]
  ds_read_b64_tr_b16 v[16:17], v6 offset:30720
  ds_read_b64_tr_b16 v[18:19], v6 offset:30976
  v_mul_f32 v95, v95, v13
  v_mul_f32 v64, v64, v80
  v_mul_f32 v65, v65, v81
  s_add_u32 m0, s30, 81920
  v_mfma_f32_32x32x16_bf16 v[48:63], v[24:27], v[216:219], v[48:63]
  ds_read_b64_tr_b16 v[20:21], v6 offset:31744
  ds_read_b64_tr_b16 v[22:23], v6 offset:32000
  buffer_load_dwordx4 v2, s[16:19], s74 offen offset:0 lds
  s_waitcnt lgkmcnt(4)
  v_mfma_f32_32x32x16_bf16 v[48:63], v[28:31], v[220:223], v[48:63]
  ds_read_b64_tr_b16 v[24:25], v6 offset:32768
  ds_read_b64_tr_b16 v[26:27], v6 offset:33024
  v_mul_f32 v66, v66, v82
  v_mul_f32 v67, v67, v83
  v_mul_f32 v68, v68, v84
  v_mfma_f32_32x32x16_bf16 v[48:63], v[32:35], v[224:227], v[48:63]
  ds_read_b64_tr_b16 v[28:29], v6 offset:33792
  ds_read_b64_tr_b16 v[30:31], v6 offset:34048
  v_mul_f32 v69, v69, v85
  v_mul_f32 v70, v70, v86
  v_mul_f32 v71, v71, v87
  v_mul_f32 v72, v72, v88
  v_mfma_f32_32x32x16_bf16 v[48:63], v[36:39], v[228:231], v[48:63]
  ds_read_b64_tr_b16 v[32:33], v6 offset:34816
  ds_read_b64_tr_b16 v[34:35], v6 offset:35072
  v_mul_f32 v73, v73, v89
  v_mul_f32 v74, v74, v90
  v_mul_f32 v75, v75, v91
  v_mul_f32 v76, v76, v92
  s_waitcnt lgkmcnt(4)
  v_mfma_f32_32x32x16_bf16 v[48:63], v[16:19], v[232:235], v[48:63]
  ds_read_b64_tr_b16 v[36:37], v6 offset:35840
  ds_read_b64_tr_b16 v[38:39], v6 offset:36096
  v_mul_f32 v77, v77, v93
  v_mul_f32 v78, v78, v94
  v_mul_f32 v79, v79, v95
  v_mfma_f32_32x32x16_bf16 v[48:63], v[20:23], v[236:239], v[48:63]
  s_waitcnt vmcnt(10)
  s_barrier
  v_add_u32 v6, 36864, v4
  ds_read_b64_tr_b16 v[16:17], v6 offset:0
  ds_read_b64_tr_b16 v[18:19], v6 offset:256
  v_cvt_pk_bf16_f32 v40, v64, v65
  v_mfma_f32_32x32x16_bf16 v[48:63], v[24:27], v[240:243], v[48:63]
  ds_read_b64_tr_b16 v[20:21], v6 offset:1024
  ds_read_b64_tr_b16 v[22:23], v6 offset:1280
  v_cvt_pk_bf16_f32 v41, v66, v67
  v_cvt_pk_bf16_f32 v42, v68, v69
  v_cvt_pk_bf16_f32 v43, v70, v71
  v_cvt_pk_bf16_f32 v44, v72, v73
  s_waitcnt lgkmcnt(4)
  v_mfma_f32_32x32x16_bf16 v[48:63], v[28:31], v[244:247], v[48:63]
  ds_read_b64_tr_b16 v[24:25], v6 offset:2048
  ds_read_b64_tr_b16 v[26:27], v6 offset:2304
  v_cvt_pk_bf16_f32 v45, v74, v75
  v_cvt_pk_bf16_f32 v46, v76, v77
  v_cvt_pk_bf16_f32 v47, v78, v79
  v_mfma_f32_32x32x16_bf16 v[48:63], v[32:35], v[248:251], v[48:63]
  ds_read_b64_tr_b16 v[28:29], v6 offset:3072
  ds_read_b64_tr_b16 v[30:31], v6 offset:3328
  v_accvgpr_write_b32 a88, v40
  v_accvgpr_write_b32 a89, v41
  v_accvgpr_write_b32 a90, v42
  v_accvgpr_write_b32 a91, v43
  v_mfma_f32_32x32x16_bf16 v[48:63], v[36:39], v[252:255], v[48:63]
  ds_read_b64_tr_b16 v[32:33], v6 offset:4096
  ds_read_b64_tr_b16 v[34:35], v6 offset:4352
  v_accvgpr_write_b32 a92, v44
  v_accvgpr_write_b32 a93, v45
  v_accvgpr_write_b32 a94, v46
  v_accvgpr_write_b32 a95, v47
  s_waitcnt lgkmcnt(4)
  v_mfma_f32_32x32x16_bf16 v[64:79], v[16:19], v[112:115], 0
  ds_read_b64_tr_b16 v[36:37], v6 offset:5120
  ds_read_b64_tr_b16 v[38:39], v6 offset:5376
  v_mfma_f32_32x32x16_bf16 v[64:79], v[20:23], v[116:119], v[64:79]
  ds_read_b64_tr_b16 v[16:17], v6 offset:6144
  ds_read_b64_tr_b16 v[18:19], v6 offset:6400
  s_add_u32 m0, s30, 110592
  v_mfma_f32_32x32x16_bf16 v[64:79], v[24:27], v[120:123], v[64:79]
  ds_read_b64_tr_b16 v[20:21], v6 offset:7168
  ds_read_b64_tr_b16 v[22:23], v6 offset:7424
  buffer_load_dwordx4 v2, s[20:23], 0 offen offset:0 lds
  s_waitcnt lgkmcnt(4)
  v_mfma_f32_32x32x16_bf16 v[64:79], v[28:31], v[124:127], v[64:79]
  ds_read_b64_tr_b16 v[24:25], v6 offset:8192
  ds_read_b64_tr_b16 v[26:27], v6 offset:8448
  v_mul_f32 v10, v48, v48
  v_mul_f32 v11, v49, v49
  v_mul_f32 v12, v50, v50
  v_mfma_f32_32x32x16_bf16 v[64:79], v[32:35], v[128:131], v[64:79]
  ds_read_b64_tr_b16 v[28:29], v6 offset:9216
  ds_read_b64_tr_b16 v[30:31], v6 offset:9472
  v_mul_f32 v13, v51, v51
  v_fmaak_f32 v10, v10, v8, 0xc0135761
  v_fmaak_f32 v11, v11, v8, 0xc0135761
  v_fmaak_f32 v12, v12, v8, 0xc0135761
  v_mfma_f32_32x32x16_bf16 v[64:79], v[36:39], v[132:135], v[64:79]
  ds_read_b64_tr_b16 v[32:33], v6 offset:10240
  ds_read_b64_tr_b16 v[34:35], v6 offset:10496
  buffer_load_dwordx4 v2, s[20:23], s67 offen offset:1024 lds
  v_fmaak_f32 v13, v13, v8, 0xc0135761
  s_waitcnt lgkmcnt(4)
  v_mfma_f32_32x32x16_bf16 v[64:79], v[16:19], v[136:139], v[64:79]
  ds_read_b64_tr_b16 v[36:37], v6 offset:11264
  ds_read_b64_tr_b16 v[38:39], v6 offset:11520
  v_mul_f32 v10, v10, v48
  v_mul_f32 v11, v11, v49
  v_mul_f32 v12, v12, v50
  v_mfma_f32_32x32x16_bf16 v[64:79], v[20:23], v[140:143], v[64:79]
  ds_read_b64_tr_b16 v[16:17], v6 offset:12288
  ds_read_b64_tr_b16 v[18:19], v6 offset:12544
  v_mul_f32 v13, v13, v51
  v_exp_f32 v10, v10
  v_mfma_f32_32x32x16_bf16 v[64:79], v[24:27], v[144:147], v[64:79]
  ds_read_b64_tr_b16 v[20:21], v6 offset:13312
  ds_read_b64_tr_b16 v[22:23], v6 offset:13568
  buffer_load_dwordx4 v2, s[20:23], s68 offen offset:2048 lds
  v_exp_f32 v11, v11
  s_waitcnt lgkmcnt(4)
  v_mfma_f32_32x32x16_bf16 v[64:79], v[28:31], v[148:151], v[64:79]
  ds_read_b64_tr_b16 v[24:25], v6 offset:14336
  ds_read_b64_tr_b16 v[26:27], v6 offset:14592
  v_exp_f32 v12, v12
  v_mfma_f32_32x32x16_bf16 v[64:79], v[32:35], v[152:155], v[64:79]
  ds_read_b64_tr_b16 v[28:29], v6 offset:15360
  ds_read_b64_tr_b16 v[30:31], v6 offset:15616
  v_exp_f32 v13, v13
  v_add_f32 v10, 1.0, v10
  v_add_f32 v11, 1.0, v11
  v_add_f32 v12, 1.0, v12
  v_mfma_f32_32x32x16_bf16 v[64:79], v[36:39], v[156:159], v[64:79]
  ds_read_b64_tr_b16 v[32:33], v6 offset:16384
  ds_read_b64_tr_b16 v[34:35], v6 offset:16640
  buffer_load_dwordx4 v2, s[20:23], s69 offen offset:3072 lds
  s_waitcnt lgkmcnt(4)
  v_mfma_f32_32x32x16_bf16 v[64:79], v[16:19], v[160:163], v[64:79]
  ds_read_b64_tr_b16 v[36:37], v6 offset:17408
  ds_read_b64_tr_b16 v[38:39], v6 offset:17664
  v_add_f32 v13, 1.0, v13
  v_rcp_f32 v10, v10
  v_mfma_f32_32x32x16_bf16 v[64:79], v[20:23], v[164:167], v[64:79]
  ds_read_b64_tr_b16 v[16:17], v6 offset:18432
  ds_read_b64_tr_b16 v[18:19], v6 offset:18688
  v_rcp_f32 v11, v11
  v_rcp_f32 v12, v12
  s_add_u32 m0, s30, 114688
  v_mfma_f32_32x32x16_bf16 v[64:79], v[24:27], v[168:171], v[64:79]
  ds_read_b64_tr_b16 v[20:21], v6 offset:19456
  ds_read_b64_tr_b16 v[22:23], v6 offset:19712
  buffer_load_dwordx4 v2, s[20:23], s70 offen offset:0 lds
  s_waitcnt lgkmcnt(4)
  v_mfma_f32_32x32x16_bf16 v[64:79], v[28:31], v[172:175], v[64:79]
  ds_read_b64_tr_b16 v[24:25], v6 offset:20480
  ds_read_b64_tr_b16 v[26:27], v6 offset:20736
  v_rcp_f32 v13, v13
  v_mfma_f32_32x32x16_bf16 v[64:79], v[32:35], v[176:179], v[64:79]
  ds_read_b64_tr_b16 v[28:29], v6 offset:21504
  ds_read_b64_tr_b16 v[30:31], v6 offset:21760
  v_mul_f32 v48, v48, v10
  v_mul_f32 v49, v49, v11
  v_mul_f32 v50, v50, v12
  v_mul_f32 v51, v51, v13
  v_mul_f32 v10, v52, v52
  v_mfma_f32_32x32x16_bf16 v[64:79], v[36:39], v[180:183], v[64:79]
  ds_read_b64_tr_b16 v[32:33], v6 offset:22528
  ds_read_b64_tr_b16 v[34:35], v6 offset:22784
  buffer_load_dwordx4 v2, s[20:23], s71 offen offset:1024 lds
  s_waitcnt lgkmcnt(4)
  v_mfma_f32_32x32x16_bf16 v[64:79], v[16:19], v[184:187], v[64:79]
  ds_read_b64_tr_b16 v[36:37], v6 offset:23552
  ds_read_b64_tr_b16 v[38:39], v6 offset:23808
  v_mul_f32 v11, v53, v53
  v_mul_f32 v12, v54, v54
  v_mul_f32 v13, v55, v55
  v_mfma_f32_32x32x16_bf16 v[64:79], v[20:23], v[188:191], v[64:79]
  ds_read_b64_tr_b16 v[16:17], v6 offset:24576
  ds_read_b64_tr_b16 v[18:19], v6 offset:24832
  v_fmaak_f32 v10, v10, v8, 0xc0135761
  v_fmaak_f32 v11, v11, v8, 0xc0135761
  v_fmaak_f32 v12, v12, v8, 0xc0135761
  v_fmaak_f32 v13, v13, v8, 0xc0135761
  v_mfma_f32_32x32x16_bf16 v[64:79], v[24:27], v[192:195], v[64:79]
  ds_read_b64_tr_b16 v[20:21], v6 offset:25600
  ds_read_b64_tr_b16 v[22:23], v6 offset:25856
  buffer_load_dwordx4 v2, s[20:23], s72 offen offset:2048 lds
  s_waitcnt lgkmcnt(4)
  v_mfma_f32_32x32x16_bf16 v[64:79], v[28:31], v[196:199], v[64:79]
  ds_read_b64_tr_b16 v[24:25], v6 offset:26624
  ds_read_b64_tr_b16 v[26:27], v6 offset:26880
  v_mul_f32 v10, v10, v52
  v_mul_f32 v11, v11, v53
  v_mul_f32 v12, v12, v54
  v_mul_f32 v13, v13, v55
  v_mfma_f32_32x32x16_bf16 v[64:79], v[32:35], v[200:203], v[64:79]
  ds_read_b64_tr_b16 v[28:29], v6 offset:27648
  ds_read_b64_tr_b16 v[30:31], v6 offset:27904
  v_exp_f32 v10, v10
  v_exp_f32 v11, v11
  v_mfma_f32_32x32x16_bf16 v[64:79], v[36:39], v[204:207], v[64:79]
  ds_read_b64_tr_b16 v[32:33], v6 offset:28672
  ds_read_b64_tr_b16 v[34:35], v6 offset:28928
  buffer_load_dwordx4 v2, s[20:23], s73 offen offset:3072 lds
  s_waitcnt lgkmcnt(4)
  v_mfma_f32_32x32x16_bf16 v[64:79], v[16:19], v[208:211], v[64:79]
  ds_read_b64_tr_b16 v[36:37], v6 offset:29696
  ds_read_b64_tr_b16 v[38:39], v6 offset:29952
  v_exp_f32 v12, v12
  v_exp_f32 v13, v13
  v_mfma_f32_32x32x16_bf16 v[64:79], v[20:23], v[212:215], v[64:79]
  ds_read_b64_tr_b16 v[16:17], v6 offset:30720
  ds_read_b64_tr_b16 v[18:19], v6 offset:30976
  v_add_f32 v10, 1.0, v10
  v_add_f32 v11, 1.0, v11
  s_add_u32 m0, s30, 118784
  v_mfma_f32_32x32x16_bf16 v[64:79], v[24:27], v[216:219], v[64:79]
  ds_read_b64_tr_b16 v[20:21], v6 offset:31744
  ds_read_b64_tr_b16 v[22:23], v6 offset:32000
  buffer_load_dwordx4 v2, s[20:23], s74 offen offset:0 lds
  v_add_f32 v12, 1.0, v12
  s_waitcnt lgkmcnt(4)
  v_mfma_f32_32x32x16_bf16 v[64:79], v[28:31], v[220:223], v[64:79]
  ds_read_b64_tr_b16 v[24:25], v6 offset:32768
  ds_read_b64_tr_b16 v[26:27], v6 offset:33024
  v_add_f32 v13, 1.0, v13
  v_add_u32 v2, 64, v2
  v_mfma_f32_32x32x16_bf16 v[64:79], v[32:35], v[224:227], v[64:79]
  ds_read_b64_tr_b16 v[28:29], v6 offset:33792
  ds_read_b64_tr_b16 v[30:31], v6 offset:34048
  v_rcp_f32 v10, v10
  v_rcp_f32 v11, v11
  v_mfma_f32_32x32x16_bf16 v[64:79], v[36:39], v[228:231], v[64:79]
  ds_read_b64_tr_b16 v[32:33], v6 offset:34816
  ds_read_b64_tr_b16 v[34:35], v6 offset:35072
  v_rcp_f32 v12, v12
  v_rcp_f32 v13, v13
  v_mul_f32 v52, v52, v10
  s_waitcnt lgkmcnt(4)
  v_mfma_f32_32x32x16_bf16 v[64:79], v[16:19], v[232:235], v[64:79]
  ds_read_b64_tr_b16 v[36:37], v6 offset:35840
  ds_read_b64_tr_b16 v[38:39], v6 offset:36096
  v_mul_f32 v53, v53, v11
  v_mul_f32 v54, v54, v12
  v_mul_f32 v55, v55, v13
  v_mfma_f32_32x32x16_bf16 v[64:79], v[20:23], v[236:239], v[64:79]
  s_waitcnt vmcnt(9)
  s_barrier
  v_add_u32 v6, 73728, v4
  ds_read_b64_tr_b16 v[16:17], v6 offset:0
  ds_read_b64_tr_b16 v[18:19], v6 offset:256
  global_load_dword a255, v[96:97], off
  v_add_co_u32 v96, vcc, 0x2000, v96
  v_addc_co_u32 v97, vcc, 0, v97, vcc
  v_mfma_f32_32x32x16_bf16 v[64:79], v[24:27], v[240:243], v[64:79]
  ds_read_b64_tr_b16 v[20:21], v6 offset:1024
  ds_read_b64_tr_b16 v[22:23], v6 offset:1280
  v_mul_f32 v10, v56, v56
  v_mul_f32 v11, v57, v57
  v_mul_f32 v12, v58, v58
  v_mul_f32 v13, v59, v59
  s_waitcnt lgkmcnt(4)
  v_mfma_f32_32x32x16_bf16 v[64:79], v[28:31], v[244:247], v[64:79]
  ds_read_b64_tr_b16 v[24:25], v6 offset:2048
  ds_read_b64_tr_b16 v[26:27], v6 offset:2304
  v_fmaak_f32 v10, v10, v8, 0xc0135761
  v_fmaak_f32 v11, v11, v8, 0xc0135761
  v_fmaak_f32 v12, v12, v8, 0xc0135761
  v_fmaak_f32 v13, v13, v8, 0xc0135761
  v_mfma_f32_32x32x16_bf16 v[64:79], v[32:35], v[248:251], v[64:79]
  ds_read_b64_tr_b16 v[28:29], v6 offset:3072
  ds_read_b64_tr_b16 v[30:31], v6 offset:3328
  v_mul_f32 v10, v10, v56
  v_mul_f32 v11, v11, v57
  v_mul_f32 v12, v12, v58
  v_mul_f32 v13, v13, v59
  v_mfma_f32_32x32x16_bf16 v[64:79], v[36:39], v[252:255], v[64:79]
  ds_read_b64_tr_b16 v[32:33], v6 offset:4096
  ds_read_b64_tr_b16 v[34:35], v6 offset:4352
  v_exp_f32 v10, v10
  v_exp_f32 v11, v11
  s_waitcnt lgkmcnt(4)
  v_mfma_f32_32x32x16_bf16 v[80:95], v[16:19], v[112:115], 0
  ds_read_b64_tr_b16 v[36:37], v6 offset:5120
  ds_read_b64_tr_b16 v[38:39], v6 offset:5376
  v_mfma_f32_32x32x16_bf16 v[80:95], v[20:23], v[116:119], v[80:95]
  ds_read_b64_tr_b16 v[16:17], v6 offset:6144
  ds_read_b64_tr_b16 v[18:19], v6 offset:6400
  v_exp_f32 v12, v12
  v_exp_f32 v13, v13
  s_add_u32 m0, s30, 0
  v_mfma_f32_32x32x16_bf16 v[80:95], v[24:27], v[120:123], v[80:95]
  ds_read_b64_tr_b16 v[20:21], v6 offset:7168
  ds_read_b64_tr_b16 v[22:23], v6 offset:7424
  buffer_load_dwordx4 v2, s[16:19], 0 offen offset:0 lds
  s_waitcnt lgkmcnt(4)
  v_mfma_f32_32x32x16_bf16 v[80:95], v[28:31], v[124:127], v[80:95]
  ds_read_b64_tr_b16 v[24:25], v6 offset:8192
  ds_read_b64_tr_b16 v[26:27], v6 offset:8448
  v_add_f32 v10, 1.0, v10
  v_add_f32 v11, 1.0, v11
  v_mfma_f32_32x32x16_bf16 v[80:95], v[32:35], v[128:131], v[80:95]
  ds_read_b64_tr_b16 v[28:29], v6 offset:9216
  ds_read_b64_tr_b16 v[30:31], v6 offset:9472
  v_add_f32 v12, 1.0, v12
  v_add_f32 v13, 1.0, v13
  v_rcp_f32 v10, v10
  v_mfma_f32_32x32x16_bf16 v[80:95], v[36:39], v[132:135], v[80:95]
  ds_read_b64_tr_b16 v[32:33], v6 offset:10240
  ds_read_b64_tr_b16 v[34:35], v6 offset:10496
  buffer_load_dwordx4 v2, s[16:19], s67 offen offset:1024 lds
  s_waitcnt lgkmcnt(4)
  v_mfma_f32_32x32x16_bf16 v[80:95], v[16:19], v[136:139], v[80:95]
  ds_read_b64_tr_b16 v[36:37], v6 offset:11264
  ds_read_b64_tr_b16 v[38:39], v6 offset:11520
  v_rcp_f32 v11, v11
  v_rcp_f32 v12, v12
  v_mfma_f32_32x32x16_bf16 v[80:95], v[20:23], v[140:143], v[80:95]
  ds_read_b64_tr_b16 v[16:17], v6 offset:12288
  ds_read_b64_tr_b16 v[18:19], v6 offset:12544
  v_rcp_f32 v13, v13
  v_mul_f32 v56, v56, v10
  v_mfma_f32_32x32x16_bf16 v[80:95], v[24:27], v[144:147], v[80:95]
  ds_read_b64_tr_b16 v[20:21], v6 offset:13312
  ds_read_b64_tr_b16 v[22:23], v6 offset:13568
  buffer_load_dwordx4 v2, s[16:19], s68 offen offset:2048 lds
  s_waitcnt lgkmcnt(4)
  v_mfma_f32_32x32x16_bf16 v[80:95], v[28:31], v[148:151], v[80:95]
  ds_read_b64_tr_b16 v[24:25], v6 offset:14336
  ds_read_b64_tr_b16 v[26:27], v6 offset:14592
  v_mul_f32 v57, v57, v11
  v_mul_f32 v58, v58, v12
  v_mul_f32 v59, v59, v13
  v_mul_f32 v10, v60, v60
  v_mfma_f32_32x32x16_bf16 v[80:95], v[32:35], v[152:155], v[80:95]
  ds_read_b64_tr_b16 v[28:29], v6 offset:15360
  ds_read_b64_tr_b16 v[30:31], v6 offset:15616
  v_mul_f32 v11, v61, v61
  v_mul_f32 v12, v62, v62
  v_mul_f32 v13, v63, v63
  v_fmaak_f32 v10, v10, v8, 0xc0135761
  v_mfma_f32_32x32x16_bf16 v[80:95], v[36:39], v[156:159], v[80:95]
  ds_read_b64_tr_b16 v[32:33], v6 offset:16384
  ds_read_b64_tr_b16 v[34:35], v6 offset:16640
  buffer_load_dwordx4 v2, s[16:19], s69 offen offset:3072 lds
  s_waitcnt lgkmcnt(4)
  v_mfma_f32_32x32x16_bf16 v[80:95], v[16:19], v[160:163], v[80:95]
  ds_read_b64_tr_b16 v[36:37], v6 offset:17408
  ds_read_b64_tr_b16 v[38:39], v6 offset:17664
  v_fmaak_f32 v11, v11, v8, 0xc0135761
  v_fmaak_f32 v12, v12, v8, 0xc0135761
  v_fmaak_f32 v13, v13, v8, 0xc0135761
  v_mfma_f32_32x32x16_bf16 v[80:95], v[20:23], v[164:167], v[80:95]
  ds_read_b64_tr_b16 v[16:17], v6 offset:18432
  ds_read_b64_tr_b16 v[18:19], v6 offset:18688
  v_mul_f32 v10, v10, v60
  v_mul_f32 v11, v11, v61
  v_mul_f32 v12, v12, v62
  s_add_u32 m0, s30, 4096
  v_mfma_f32_32x32x16_bf16 v[80:95], v[24:27], v[168:171], v[80:95]
  ds_read_b64_tr_b16 v[20:21], v6 offset:19456
  ds_read_b64_tr_b16 v[22:23], v6 offset:19712
  buffer_load_dwordx4 v2, s[16:19], s70 offen offset:0 lds
  s_waitcnt lgkmcnt(4)
  v_mfma_f32_32x32x16_bf16 v[80:95], v[28:31], v[172:175], v[80:95]
  ds_read_b64_tr_b16 v[24:25], v6 offset:20480
  ds_read_b64_tr_b16 v[26:27], v6 offset:20736
  v_mul_f32 v13, v13, v63
  v_exp_f32 v10, v10
  v_mfma_f32_32x32x16_bf16 v[80:95], v[32:35], v[176:179], v[80:95]
  ds_read_b64_tr_b16 v[28:29], v6 offset:21504
  ds_read_b64_tr_b16 v[30:31], v6 offset:21760
  v_exp_f32 v11, v11
  v_exp_f32 v12, v12
  v_mfma_f32_32x32x16_bf16 v[80:95], v[36:39], v[180:183], v[80:95]
  ds_read_b64_tr_b16 v[32:33], v6 offset:22528
  ds_read_b64_tr_b16 v[34:35], v6 offset:22784
  buffer_load_dwordx4 v2, s[16:19], s71 offen offset:1024 lds
  s_waitcnt lgkmcnt(4)
  v_mfma_f32_32x32x16_bf16 v[80:95], v[16:19], v[184:187], v[80:95]
  ds_read_b64_tr_b16 v[36:37], v6 offset:23552
  ds_read_b64_tr_b16 v[38:39], v6 offset:23808
  v_exp_f32 v13, v13
  v_add_f32 v10, 1.0, v10
  v_mfma_f32_32x32x16_bf16 v[80:95], v[20:23], v[188:191], v[80:95]
  ds_read_b64_tr_b16 v[16:17], v6 offset:24576
  ds_read_b64_tr_b16 v[18:19], v6 offset:24832
  v_add_f32 v11, 1.0, v11
  v_add_f32 v12, 1.0, v12
  v_add_f32 v13, 1.0, v13
  v_rcp_f32 v10, v10
  v_mfma_f32_32x32x16_bf16 v[80:95], v[24:27], v[192:195], v[80:95]
  ds_read_b64_tr_b16 v[20:21], v6 offset:25600
  ds_read_b64_tr_b16 v[22:23], v6 offset:25856
  buffer_load_dwordx4 v2, s[16:19], s72 offen offset:2048 lds
  s_waitcnt lgkmcnt(4)
  v_mfma_f32_32x32x16_bf16 v[80:95], v[28:31], v[196:199], v[80:95]
  ds_read_b64_tr_b16 v[24:25], v6 offset:26624
  ds_read_b64_tr_b16 v[26:27], v6 offset:26880
  v_rcp_f32 v11, v11
  v_mfma_f32_32x32x16_bf16 v[80:95], v[32:35], v[200:203], v[80:95]
  ds_read_b64_tr_b16 v[28:29], v6 offset:27648
  ds_read_b64_tr_b16 v[30:31], v6 offset:27904
  v_rcp_f32 v12, v12
  v_rcp_f32 v13, v13
  v_mfma_f32_32x32x16_bf16 v[80:95], v[36:39], v[204:207], v[80:95]
  ds_read_b64_tr_b16 v[32:33], v6 offset:28672
  ds_read_b64_tr_b16 v[34:35], v6 offset:28928
  buffer_load_dwordx4 v2, s[16:19], s73 offen offset:3072 lds
  s_waitcnt lgkmcnt(4)
  v_mfma_f32_32x32x16_bf16 v[80:95], v[16:19], v[208:211], v[80:95]
  ds_read_b64_tr_b16 v[36:37], v6 offset:29696
  ds_read_b64_tr_b16 v[38:39], v6 offset:29952
  v_mul_f32 v60, v60, v10
  v_mul_f32 v61, v61, v11
  v_mul_f32 v62, v62, v12
  v_mfma_f32_32x32x16_bf16 v[80:95], v[20:23], v[212:215], v[80:95]
  ds_read_b64_tr_b16 v[16:17], v6 offset:30720
  ds_read_b64_tr_b16 v[18:19], v6 offset:30976
  v_mul_f32 v63, v63, v13
  v_mul_f32 v64, v64, v48
  v_mul_f32 v65, v65, v49
  s_add_u32 m0, s30, 8192
  v_mfma_f32_32x32x16_bf16 v[80:95], v[24:27], v[216:219], v[80:95]
  ds_read_b64_tr_b16 v[20:21], v6 offset:31744
  ds_read_b64_tr_b16 v[22:23], v6 offset:32000
  buffer_load_dwordx4 v2, s[16:19], s74 offen offset:0 lds
  s_waitcnt lgkmcnt(4)
  v_mfma_f32_32x32x16_bf16 v[80:95], v[28:31], v[220:223], v[80:95]
  ds_read_b64_tr_b16 v[24:25], v6 offset:32768
  ds_read_b64_tr_b16 v[26:27], v6 offset:33024
  v_mul_f32 v66, v66, v50
  v_mul_f32 v67, v67, v51
  v_mul_f32 v68, v68, v52
  v_mul_f32 v69, v69, v53
  v_mfma_f32_32x32x16_bf16 v[80:95], v[32:35], v[224:227], v[80:95]
  ds_read_b64_tr_b16 v[28:29], v6 offset:33792
  ds_read_b64_tr_b16 v[30:31], v6 offset:34048
  v_mul_f32 v70, v70, v54
  v_mul_f32 v71, v71, v55
  v_mul_f32 v72, v72, v56
  v_mul_f32 v73, v73, v57
  v_mfma_f32_32x32x16_bf16 v[80:95], v[36:39], v[228:231], v[80:95]
  ds_read_b64_tr_b16 v[32:33], v6 offset:34816
  ds_read_b64_tr_b16 v[34:35], v6 offset:35072
  v_mul_f32 v74, v74, v58
  v_mul_f32 v75, v75, v59
  v_mul_f32 v76, v76, v60
  v_mul_f32 v77, v77, v61
  s_waitcnt lgkmcnt(4)
  v_mfma_f32_32x32x16_bf16 v[80:95], v[16:19], v[232:235], v[80:95]
  ds_read_b64_tr_b16 v[36:37], v6 offset:35840
  ds_read_b64_tr_b16 v[38:39], v6 offset:36096
  buffer_load_dword a253, v9, s[24:27], 0 offen offset:0
  v_mul_f32 v78, v78, v62
  v_mul_f32 v79, v79, v63
  v_mfma_f32_32x32x16_bf16 v[80:95], v[20:23], v[236:239], v[80:95]
  s_waitcnt vmcnt(11)
  s_barrier
  v_add_u32 v6, 110592, v4
  ds_read_b64_tr_b16 v[16:17], v6 offset:0
  ds_read_b64_tr_b16 v[18:19], v6 offset:256
  v_cvt_pk_bf16_f32 v40, v64, v65
  v_mfma_f32_32x32x16_bf16 v[80:95], v[24:27], v[240:243], v[80:95]
  ds_read_b64_tr_b16 v[20:21], v6 offset:1024
  ds_read_b64_tr_b16 v[22:23], v6 offset:1280
  v_cvt_pk_bf16_f32 v41, v66, v67
  v_cvt_pk_bf16_f32 v42, v68, v69
  v_cvt_pk_bf16_f32 v43, v70, v71
  v_cvt_pk_bf16_f32 v44, v72, v73
  s_waitcnt lgkmcnt(4)
  v_mfma_f32_32x32x16_bf16 v[80:95], v[28:31], v[244:247], v[80:95]
  ds_read_b64_tr_b16 v[24:25], v6 offset:2048
  ds_read_b64_tr_b16 v[26:27], v6 offset:2304
  v_cvt_pk_bf16_f32 v45, v74, v75
  v_cvt_pk_bf16_f32 v46, v76, v77
  v_cvt_pk_bf16_f32 v47, v78, v79
  v_mfma_f32_32x32x16_bf16 v[80:95], v[32:35], v[248:251], v[80:95]
  ds_read_b64_tr_b16 v[28:29], v6 offset:3072
  ds_read_b64_tr_b16 v[30:31], v6 offset:3328
  v_accvgpr_write_b32 a96, v40
  v_accvgpr_write_b32 a97, v41
  v_accvgpr_write_b32 a98, v42
  v_accvgpr_write_b32 a99, v43
  v_mfma_f32_32x32x16_bf16 v[80:95], v[36:39], v[252:255], v[80:95]
  ds_read_b64_tr_b16 v[32:33], v6 offset:4096
  ds_read_b64_tr_b16 v[34:35], v6 offset:4352
  v_accvgpr_write_b32 a100, v44
  v_accvgpr_write_b32 a101, v45
  v_accvgpr_write_b32 a102, v46
  v_accvgpr_write_b32 a103, v47
  s_waitcnt lgkmcnt(4)
  v_mfma_f32_32x32x16_bf16 v[64:79], v[16:19], v[112:115], 0
  ds_read_b64_tr_b16 v[36:37], v6 offset:5120
  ds_read_b64_tr_b16 v[38:39], v6 offset:5376
  v_mfma_f32_32x32x16_bf16 v[64:79], v[20:23], v[116:119], v[64:79]
  ds_read_b64_tr_b16 v[16:17], v6 offset:6144
  ds_read_b64_tr_b16 v[18:19], v6 offset:6400
  s_add_u32 m0, s30, 36864
  v_mfma_f32_32x32x16_bf16 v[64:79], v[24:27], v[120:123], v[64:79]
  ds_read_b64_tr_b16 v[20:21], v6 offset:7168
  ds_read_b64_tr_b16 v[22:23], v6 offset:7424
  buffer_load_dwordx4 v2, s[20:23], 0 offen offset:0 lds
  s_waitcnt lgkmcnt(4)
  v_mfma_f32_32x32x16_bf16 v[64:79], v[28:31], v[124:127], v[64:79]
  ds_read_b64_tr_b16 v[24:25], v6 offset:8192
  ds_read_b64_tr_b16 v[26:27], v6 offset:8448
  v_mul_f32 v10, v80, v80
  v_mul_f32 v11, v81, v81
  v_mul_f32 v12, v82, v82
  v_mfma_f32_32x32x16_bf16 v[64:79], v[32:35], v[128:131], v[64:79]
  ds_read_b64_tr_b16 v[28:29], v6 offset:9216
  ds_read_b64_tr_b16 v[30:31], v6 offset:9472
  v_mul_f32 v13, v83, v83
  v_fmaak_f32 v10, v10, v8, 0xc0135761
  v_fmaak_f32 v11, v11, v8, 0xc0135761
  v_fmaak_f32 v12, v12, v8, 0xc0135761
  v_mfma_f32_32x32x16_bf16 v[64:79], v[36:39], v[132:135], v[64:79]
  ds_read_b64_tr_b16 v[32:33], v6 offset:10240
  ds_read_b64_tr_b16 v[34:35], v6 offset:10496
  buffer_load_dwordx4 v2, s[20:23], s67 offen offset:1024 lds
  v_fmaak_f32 v13, v13, v8, 0xc0135761
  s_waitcnt lgkmcnt(4)
  v_mfma_f32_32x32x16_bf16 v[64:79], v[16:19], v[136:139], v[64:79]
  ds_read_b64_tr_b16 v[36:37], v6 offset:11264
  ds_read_b64_tr_b16 v[38:39], v6 offset:11520
  v_mul_f32 v10, v10, v80
  v_mul_f32 v11, v11, v81
  v_mul_f32 v12, v12, v82
  v_mfma_f32_32x32x16_bf16 v[64:79], v[20:23], v[140:143], v[64:79]
  ds_read_b64_tr_b16 v[16:17], v6 offset:12288
  ds_read_b64_tr_b16 v[18:19], v6 offset:12544
  v_mul_f32 v13, v13, v83
  v_exp_f32 v10, v10
  v_mfma_f32_32x32x16_bf16 v[64:79], v[24:27], v[144:147], v[64:79]
  ds_read_b64_tr_b16 v[20:21], v6 offset:13312
  ds_read_b64_tr_b16 v[22:23], v6 offset:13568
  buffer_load_dwordx4 v2, s[20:23], s68 offen offset:2048 lds
  v_exp_f32 v11, v11
  s_waitcnt lgkmcnt(4)
  v_mfma_f32_32x32x16_bf16 v[64:79], v[28:31], v[148:151], v[64:79]
  ds_read_b64_tr_b16 v[24:25], v6 offset:14336
  ds_read_b64_tr_b16 v[26:27], v6 offset:14592
  v_exp_f32 v12, v12
  v_mfma_f32_32x32x16_bf16 v[64:79], v[32:35], v[152:155], v[64:79]
  ds_read_b64_tr_b16 v[28:29], v6 offset:15360
  ds_read_b64_tr_b16 v[30:31], v6 offset:15616
  v_exp_f32 v13, v13
  v_add_f32 v10, 1.0, v10
  v_add_f32 v11, 1.0, v11
  v_mfma_f32_32x32x16_bf16 v[64:79], v[36:39], v[156:159], v[64:79]
  ds_read_b64_tr_b16 v[32:33], v6 offset:16384
  ds_read_b64_tr_b16 v[34:35], v6 offset:16640
  buffer_load_dwordx4 v2, s[20:23], s69 offen offset:3072 lds
  v_add_f32 v12, 1.0, v12
  s_waitcnt lgkmcnt(4)
  v_mfma_f32_32x32x16_bf16 v[64:79], v[16:19], v[160:163], v[64:79]
  ds_read_b64_tr_b16 v[36:37], v6 offset:17408
  ds_read_b64_tr_b16 v[38:39], v6 offset:17664
  v_add_f32 v13, 1.0, v13
  v_rcp_f32 v10, v10
  v_mfma_f32_32x32x16_bf16 v[64:79], v[20:23], v[164:167], v[64:79]
  ds_read_b64_tr_b16 v[16:17], v6 offset:18432
  ds_read_b64_tr_b16 v[18:19], v6 offset:18688
  v_rcp_f32 v11, v11
  v_rcp_f32 v12, v12
  s_add_u32 m0, s30, 40960
  v_mfma_f32_32x32x16_bf16 v[64:79], v[24:27], v[168:171], v[64:79]
  ds_read_b64_tr_b16 v[20:21], v6 offset:19456
  ds_read_b64_tr_b16 v[22:23], v6 offset:19712
  buffer_load_dwordx4 v2, s[20:23], s70 offen offset:0 lds
  s_waitcnt lgkmcnt(4)
  v_mfma_f32_32x32x16_bf16 v[64:79], v[28:31], v[172:175], v[64:79]
  ds_read_b64_tr_b16 v[24:25], v6 offset:20480
  ds_read_b64_tr_b16 v[26:27], v6 offset:20736
  v_rcp_f32 v13, v13
  v_mfma_f32_32x32x16_bf16 v[64:79], v[32:35], v[176:179], v[64:79]
  ds_read_b64_tr_b16 v[28:29], v6 offset:21504
  ds_read_b64_tr_b16 v[30:31], v6 offset:21760
  v_mul_f32 v80, v80, v10
  v_mul_f32 v81, v81, v11
  v_mul_f32 v82, v82, v12
  v_mul_f32 v83, v83, v13
  v_mul_f32 v10, v84, v84
  v_mfma_f32_32x32x16_bf16 v[64:79], v[36:39], v[180:183], v[64:79]
  ds_read_b64_tr_b16 v[32:33], v6 offset:22528
  ds_read_b64_tr_b16 v[34:35], v6 offset:22784
  buffer_load_dwordx4 v2, s[20:23], s71 offen offset:1024 lds
  s_waitcnt lgkmcnt(4)
  v_mfma_f32_32x32x16_bf16 v[64:79], v[16:19], v[184:187], v[64:79]
  ds_read_b64_tr_b16 v[36:37], v6 offset:23552
  ds_read_b64_tr_b16 v[38:39], v6 offset:23808
  v_mul_f32 v11, v85, v85
  v_mul_f32 v12, v86, v86
  v_mul_f32 v13, v87, v87
  v_mfma_f32_32x32x16_bf16 v[64:79], v[20:23], v[188:191], v[64:79]
  ds_read_b64_tr_b16 v[16:17], v6 offset:24576
  ds_read_b64_tr_b16 v[18:19], v6 offset:24832
  v_fmaak_f32 v10, v10, v8, 0xc0135761
  v_fmaak_f32 v11, v11, v8, 0xc0135761
  v_fmaak_f32 v12, v12, v8, 0xc0135761
  v_fmaak_f32 v13, v13, v8, 0xc0135761
  v_mfma_f32_32x32x16_bf16 v[64:79], v[24:27], v[192:195], v[64:79]
  ds_read_b64_tr_b16 v[20:21], v6 offset:25600
  ds_read_b64_tr_b16 v[22:23], v6 offset:25856
  buffer_load_dwordx4 v2, s[20:23], s72 offen offset:2048 lds
  s_waitcnt lgkmcnt(4)
  v_mfma_f32_32x32x16_bf16 v[64:79], v[28:31], v[196:199], v[64:79]
  ds_read_b64_tr_b16 v[24:25], v6 offset:26624
  ds_read_b64_tr_b16 v[26:27], v6 offset:26880
  v_mul_f32 v10, v10, v84
  v_mul_f32 v11, v11, v85
  v_mul_f32 v12, v12, v86
  v_mfma_f32_32x32x16_bf16 v[64:79], v[32:35], v[200:203], v[64:79]
  ds_read_b64_tr_b16 v[28:29], v6 offset:27648
  ds_read_b64_tr_b16 v[30:31], v6 offset:27904
  v_mul_f32 v13, v13, v87
  v_exp_f32 v10, v10
  v_exp_f32 v11, v11
  v_mfma_f32_32x32x16_bf16 v[64:79], v[36:39], v[204:207], v[64:79]
  ds_read_b64_tr_b16 v[32:33], v6 offset:28672
  ds_read_b64_tr_b16 v[34:35], v6 offset:28928
  buffer_load_dwordx4 v2, s[20:23], s73 offen offset:3072 lds
  s_waitcnt lgkmcnt(4)
  v_mfma_f32_32x32x16_bf16 v[64:79], v[16:19], v[208:211], v[64:79]
  ds_read_b64_tr_b16 v[36:37], v6 offset:29696
  ds_read_b64_tr_b16 v[38:39], v6 offset:29952
  v_exp_f32 v12, v12
  v_exp_f32 v13, v13
  v_mfma_f32_32x32x16_bf16 v[64:79], v[20:23], v[212:215], v[64:79]
  ds_read_b64_tr_b16 v[16:17], v6 offset:30720
  ds_read_b64_tr_b16 v[18:19], v6 offset:30976
  v_add_f32 v10, 1.0, v10
  v_add_f32 v11, 1.0, v11
  s_add_u32 m0, s30, 45056
  v_mfma_f32_32x32x16_bf16 v[64:79], v[24:27], v[216:219], v[64:79]
  ds_read_b64_tr_b16 v[20:21], v6 offset:31744
  ds_read_b64_tr_b16 v[22:23], v6 offset:32000
  buffer_load_dwordx4 v2, s[20:23], s74 offen offset:0 lds
  s_waitcnt lgkmcnt(4)
  v_mfma_f32_32x32x16_bf16 v[64:79], v[28:31], v[220:223], v[64:79]
  ds_read_b64_tr_b16 v[24:25], v6 offset:32768
  ds_read_b64_tr_b16 v[26:27], v6 offset:33024
  v_add_f32 v12, 1.0, v12
  v_add_f32 v13, 1.0, v13
  v_add_u32 v2, 64, v2
  v_mfma_f32_32x32x16_bf16 v[64:79], v[32:35], v[224:227], v[64:79]
  ds_read_b64_tr_b16 v[28:29], v6 offset:33792
  ds_read_b64_tr_b16 v[30:31], v6 offset:34048
  v_rcp_f32 v10, v10
  v_rcp_f32 v11, v11
  v_mfma_f32_32x32x16_bf16 v[64:79], v[36:39], v[228:231], v[64:79]
  ds_read_b64_tr_b16 v[32:33], v6 offset:34816
  ds_read_b64_tr_b16 v[34:35], v6 offset:35072
  v_rcp_f32 v12, v12
  v_rcp_f32 v13, v13
  v_mul_f32 v84, v84, v10
  s_waitcnt lgkmcnt(4)
  v_mfma_f32_32x32x16_bf16 v[64:79], v[16:19], v[232:235], v[64:79]
  ds_read_b64_tr_b16 v[36:37], v6 offset:35840
  ds_read_b64_tr_b16 v[38:39], v6 offset:36096
  buffer_load_dword a253, v9, s[24:27], 0 offen offset:128
  v_mul_f32 v85, v85, v11
  v_mul_f32 v86, v86, v12
  v_mfma_f32_32x32x16_bf16 v[64:79], v[20:23], v[236:239], v[64:79]
  s_waitcnt vmcnt(11)
  s_barrier
  v_add_u32 v6, 0, v4
  ds_read_b64_tr_b16 v[16:17], v6 offset:0
  ds_read_b64_tr_b16 v[18:19], v6 offset:256
  v_mul_f32 v87, v87, v13
  v_mfma_f32_32x32x16_bf16 v[64:79], v[24:27], v[240:243], v[64:79]
  ds_read_b64_tr_b16 v[20:21], v6 offset:1024
  ds_read_b64_tr_b16 v[22:23], v6 offset:1280
  v_mul_f32 v10, v88, v88
  v_mul_f32 v11, v89, v89
  v_mul_f32 v12, v90, v90
  v_mul_f32 v13, v91, v91
  s_waitcnt lgkmcnt(4)
  v_mfma_f32_32x32x16_bf16 v[64:79], v[28:31], v[244:247], v[64:79]
  ds_read_b64_tr_b16 v[24:25], v6 offset:2048
  ds_read_b64_tr_b16 v[26:27], v6 offset:2304
  v_fmaak_f32 v10, v10, v8, 0xc0135761
  v_fmaak_f32 v11, v11, v8, 0xc0135761
  v_fmaak_f32 v12, v12, v8, 0xc0135761
  v_fmaak_f32 v13, v13, v8, 0xc0135761
  v_mfma_f32_32x32x16_bf16 v[64:79], v[32:35], v[248:251], v[64:79]
  ds_read_b64_tr_b16 v[28:29], v6 offset:3072
  ds_read_b64_tr_b16 v[30:31], v6 offset:3328
  v_mul_f32 v10, v10, v88
  v_mul_f32 v11, v11, v89
  v_mul_f32 v12, v12, v90
  v_mul_f32 v13, v13, v91
  v_mfma_f32_32x32x16_bf16 v[64:79], v[36:39], v[252:255], v[64:79]
  ds_read_b64_tr_b16 v[32:33], v6 offset:4096
  ds_read_b64_tr_b16 v[34:35], v6 offset:4352
  v_exp_f32 v10, v10
  v_exp_f32 v11, v11
  s_waitcnt lgkmcnt(4)
  v_mfma_f32_32x32x16_bf16 v[48:63], v[16:19], v[112:115], 0
  ds_read_b64_tr_b16 v[36:37], v6 offset:5120
  ds_read_b64_tr_b16 v[38:39], v6 offset:5376
  v_mfma_f32_32x32x16_bf16 v[48:63], v[20:23], v[116:119], v[48:63]
  ds_read_b64_tr_b16 v[16:17], v6 offset:6144
  ds_read_b64_tr_b16 v[18:19], v6 offset:6400
  v_exp_f32 v12, v12
  v_exp_f32 v13, v13
  s_add_u32 m0, s30, 73728
  v_mfma_f32_32x32x16_bf16 v[48:63], v[24:27], v[120:123], v[48:63]
  ds_read_b64_tr_b16 v[20:21], v6 offset:7168
  ds_read_b64_tr_b16 v[22:23], v6 offset:7424
  buffer_load_dwordx4 v2, s[16:19], 0 offen offset:0 lds
  s_waitcnt lgkmcnt(4)
  v_mfma_f32_32x32x16_bf16 v[48:63], v[28:31], v[124:127], v[48:63]
  ds_read_b64_tr_b16 v[24:25], v6 offset:8192
  ds_read_b64_tr_b16 v[26:27], v6 offset:8448
  v_add_f32 v10, 1.0, v10
  v_add_f32 v11, 1.0, v11
  v_mfma_f32_32x32x16_bf16 v[48:63], v[32:35], v[128:131], v[48:63]
  ds_read_b64_tr_b16 v[28:29], v6 offset:9216
  ds_read_b64_tr_b16 v[30:31], v6 offset:9472
  v_add_f32 v12, 1.0, v12
  v_add_f32 v13, 1.0, v13
  v_rcp_f32 v10, v10
  v_mfma_f32_32x32x16_bf16 v[48:63], v[36:39], v[132:135], v[48:63]
  ds_read_b64_tr_b16 v[32:33], v6 offset:10240
  ds_read_b64_tr_b16 v[34:35], v6 offset:10496
  buffer_load_dwordx4 v2, s[16:19], s67 offen offset:1024 lds
  s_waitcnt lgkmcnt(4)
  v_mfma_f32_32x32x16_bf16 v[48:63], v[16:19], v[136:139], v[48:63]
  ds_read_b64_tr_b16 v[36:37], v6 offset:11264
  ds_read_b64_tr_b16 v[38:39], v6 offset:11520
  v_rcp_f32 v11, v11
  v_rcp_f32 v12, v12
  v_mfma_f32_32x32x16_bf16 v[48:63], v[20:23], v[140:143], v[48:63]
  ds_read_b64_tr_b16 v[16:17], v6 offset:12288
  ds_read_b64_tr_b16 v[18:19], v6 offset:12544
  v_rcp_f32 v13, v13
  v_mul_f32 v88, v88, v10
  v_mfma_f32_32x32x16_bf16 v[48:63], v[24:27], v[144:147], v[48:63]
  ds_read_b64_tr_b16 v[20:21], v6 offset:13312
  ds_read_b64_tr_b16 v[22:23], v6 offset:13568
  buffer_load_dwordx4 v2, s[16:19], s68 offen offset:2048 lds
  s_waitcnt lgkmcnt(4)
  v_mfma_f32_32x32x16_bf16 v[48:63], v[28:31], v[148:151], v[48:63]
  ds_read_b64_tr_b16 v[24:25], v6 offset:14336
  ds_read_b64_tr_b16 v[26:27], v6 offset:14592
  v_mul_f32 v89, v89, v11
  v_mul_f32 v90, v90, v12
  v_mul_f32 v91, v91, v13
  v_mul_f32 v10, v92, v92
  v_mfma_f32_32x32x16_bf16 v[48:63], v[32:35], v[152:155], v[48:63]
  ds_read_b64_tr_b16 v[28:29], v6 offset:15360
  ds_read_b64_tr_b16 v[30:31], v6 offset:15616
  v_mul_f32 v11, v93, v93
  v_mul_f32 v12, v94, v94
  v_mul_f32 v13, v95, v95
  v_fmaak_f32 v10, v10, v8, 0xc0135761
  v_mfma_f32_32x32x16_bf16 v[48:63], v[36:39], v[156:159], v[48:63]
  ds_read_b64_tr_b16 v[32:33], v6 offset:16384
  ds_read_b64_tr_b16 v[34:35], v6 offset:16640
  buffer_load_dwordx4 v2, s[16:19], s69 offen offset:3072 lds
  s_waitcnt lgkmcnt(4)
  v_mfma_f32_32x32x16_bf16 v[48:63], v[16:19], v[160:163], v[48:63]
  ds_read_b64_tr_b16 v[36:37], v6 offset:17408
  ds_read_b64_tr_b16 v[38:39], v6 offset:17664
  v_fmaak_f32 v11, v11, v8, 0xc0135761
  v_fmaak_f32 v12, v12, v8, 0xc0135761
  v_fmaak_f32 v13, v13, v8, 0xc0135761
  v_mfma_f32_32x32x16_bf16 v[48:63], v[20:23], v[164:167], v[48:63]
  ds_read_b64_tr_b16 v[16:17], v6 offset:18432
  ds_read_b64_tr_b16 v[18:19], v6 offset:18688
  v_mul_f32 v10, v10, v92
  v_mul_f32 v11, v11, v93
  v_mul_f32 v12, v12, v94
  s_add_u32 m0, s30, 77824
  v_mfma_f32_32x32x16_bf16 v[48:63], v[24:27], v[168:171], v[48:63]
  ds_read_b64_tr_b16 v[20:21], v6 offset:19456
  ds_read_b64_tr_b16 v[22:23], v6 offset:19712
  buffer_load_dwordx4 v2, s[16:19], s70 offen offset:0 lds
  s_waitcnt lgkmcnt(4)
  v_mfma_f32_32x32x16_bf16 v[48:63], v[28:31], v[172:175], v[48:63]
  ds_read_b64_tr_b16 v[24:25], v6 offset:20480
  ds_read_b64_tr_b16 v[26:27], v6 offset:20736
  v_mul_f32 v13, v13, v95
  v_exp_f32 v10, v10
  v_mfma_f32_32x32x16_bf16 v[48:63], v[32:35], v[176:179], v[48:63]
  ds_read_b64_tr_b16 v[28:29], v6 offset:21504
  ds_read_b64_tr_b16 v[30:31], v6 offset:21760
  v_exp_f32 v11, v11
  v_exp_f32 v12, v12
  v_mfma_f32_32x32x16_bf16 v[48:63], v[36:39], v[180:183], v[48:63]
  ds_read_b64_tr_b16 v[32:33], v6 offset:22528
  ds_read_b64_tr_b16 v[34:35], v6 offset:22784
  buffer_load_dwordx4 v2, s[16:19], s71 offen offset:1024 lds
  s_waitcnt lgkmcnt(4)
  v_mfma_f32_32x32x16_bf16 v[48:63], v[16:19], v[184:187], v[48:63]
  ds_read_b64_tr_b16 v[36:37], v6 offset:23552
  ds_read_b64_tr_b16 v[38:39], v6 offset:23808
  v_exp_f32 v13, v13
  v_add_f32 v10, 1.0, v10
  v_mfma_f32_32x32x16_bf16 v[48:63], v[20:23], v[188:191], v[48:63]
  ds_read_b64_tr_b16 v[16:17], v6 offset:24576
  ds_read_b64_tr_b16 v[18:19], v6 offset:24832
  v_add_f32 v11, 1.0, v11
  v_add_f32 v12, 1.0, v12
  v_add_f32 v13, 1.0, v13
  v_rcp_f32 v10, v10
  v_mfma_f32_32x32x16_bf16 v[48:63], v[24:27], v[192:195], v[48:63]
  ds_read_b64_tr_b16 v[20:21], v6 offset:25600
  ds_read_b64_tr_b16 v[22:23], v6 offset:25856
  buffer_load_dwordx4 v2, s[16:19], s72 offen offset:2048 lds
  s_waitcnt lgkmcnt(4)
  v_mfma_f32_32x32x16_bf16 v[48:63], v[28:31], v[196:199], v[48:63]
  ds_read_b64_tr_b16 v[24:25], v6 offset:26624
  ds_read_b64_tr_b16 v[26:27], v6 offset:26880
  v_rcp_f32 v11, v11
  v_mfma_f32_32x32x16_bf16 v[48:63], v[32:35], v[200:203], v[48:63]
  ds_read_b64_tr_b16 v[28:29], v6 offset:27648
  ds_read_b64_tr_b16 v[30:31], v6 offset:27904
  v_rcp_f32 v12, v12
  v_rcp_f32 v13, v13
  v_mfma_f32_32x32x16_bf16 v[48:63], v[36:39], v[204:207], v[48:63]
  ds_read_b64_tr_b16 v[32:33], v6 offset:28672
  ds_read_b64_tr_b16 v[34:35], v6 offset:28928
  buffer_load_dwordx4 v2, s[16:19], s73 offen offset:3072 lds
  s_waitcnt lgkmcnt(4)
  v_mfma_f32_32x32x16_bf16 v[48:63], v[16:19], v[208:211], v[48:63]
  ds_read_b64_tr_b16 v[36:37], v6 offset:29696
  ds_read_b64_tr_b16 v[38:39], v6 offset:29952
  v_mul_f32 v92, v92, v10
  v_mul_f32 v93, v93, v11
  v_mul_f32 v94, v94, v12
  v_mfma_f32_32x32x16_bf16 v[48:63], v[20:23], v[212:215], v[48:63]
  ds_read_b64_tr_b16 v[16:17], v6 offset:30720
  ds_read_b64_tr_b16 v[18:19], v6 offset:30976
  v_mul_f32 v95, v95, v13
  v_mul_f32 v64, v64, v80
  v_mul_f32 v65, v65, v81
  s_add_u32 m0, s30, 81920
  v_mfma_f32_32x32x16_bf16 v[48:63], v[24:27], v[216:219], v[48:63]
  ds_read_b64_tr_b16 v[20:21], v6 offset:31744
  ds_read_b64_tr_b16 v[22:23], v6 offset:32000
  buffer_load_dwordx4 v2, s[16:19], s74 offen offset:0 lds
  s_waitcnt lgkmcnt(4)
  v_mfma_f32_32x32x16_bf16 v[48:63], v[28:31], v[220:223], v[48:63]
  ds_read_b64_tr_b16 v[24:25], v6 offset:32768
  ds_read_b64_tr_b16 v[26:27], v6 offset:33024
  v_mul_f32 v66, v66, v82
  v_mul_f32 v67, v67, v83
  v_mul_f32 v68, v68, v84
  v_mul_f32 v69, v69, v85
  v_mfma_f32_32x32x16_bf16 v[48:63], v[32:35], v[224:227], v[48:63]
  ds_read_b64_tr_b16 v[28:29], v6 offset:33792
  ds_read_b64_tr_b16 v[30:31], v6 offset:34048
  v_mul_f32 v70, v70, v86
  v_mul_f32 v71, v71, v87
  v_mul_f32 v72, v72, v88
  v_mul_f32 v73, v73, v89
  v_mfma_f32_32x32x16_bf16 v[48:63], v[36:39], v[228:231], v[48:63]
  ds_read_b64_tr_b16 v[32:33], v6 offset:34816
  ds_read_b64_tr_b16 v[34:35], v6 offset:35072
  v_mul_f32 v74, v74, v90
  v_mul_f32 v75, v75, v91
  v_mul_f32 v76, v76, v92
  v_mul_f32 v77, v77, v93
  s_waitcnt lgkmcnt(4)
  v_mfma_f32_32x32x16_bf16 v[48:63], v[16:19], v[232:235], v[48:63]
  ds_read_b64_tr_b16 v[36:37], v6 offset:35840
  ds_read_b64_tr_b16 v[38:39], v6 offset:36096
  buffer_load_dword a253, v9, s[24:27], 0 offen offset:256
  v_mul_f32 v78, v78, v94
  v_mul_f32 v79, v79, v95
  v_mfma_f32_32x32x16_bf16 v[48:63], v[20:23], v[236:239], v[48:63]
  s_waitcnt vmcnt(11)
  s_barrier
  v_add_u32 v6, 36864, v4
  ds_read_b64_tr_b16 v[16:17], v6 offset:0
  ds_read_b64_tr_b16 v[18:19], v6 offset:256
  v_cvt_pk_bf16_f32 v40, v64, v65
  v_mfma_f32_32x32x16_bf16 v[48:63], v[24:27], v[240:243], v[48:63]
  ds_read_b64_tr_b16 v[20:21], v6 offset:1024
  ds_read_b64_tr_b16 v[22:23], v6 offset:1280
  v_cvt_pk_bf16_f32 v41, v66, v67
  v_cvt_pk_bf16_f32 v42, v68, v69
  v_cvt_pk_bf16_f32 v43, v70, v71
  v_cvt_pk_bf16_f32 v44, v72, v73
  s_waitcnt lgkmcnt(4)
  v_mfma_f32_32x32x16_bf16 v[48:63], v[28:31], v[244:247], v[48:63]
  ds_read_b64_tr_b16 v[24:25], v6 offset:2048
  ds_read_b64_tr_b16 v[26:27], v6 offset:2304
  v_cvt_pk_bf16_f32 v45, v74, v75
  v_cvt_pk_bf16_f32 v46, v76, v77
  v_cvt_pk_bf16_f32 v47, v78, v79
  v_mfma_f32_32x32x16_bf16 v[48:63], v[32:35], v[248:251], v[48:63]
  ds_read_b64_tr_b16 v[28:29], v6 offset:3072
  ds_read_b64_tr_b16 v[30:31], v6 offset:3328
  v_accvgpr_write_b32 a104, v40
  v_accvgpr_write_b32 a105, v41
  v_accvgpr_write_b32 a106, v42
  v_accvgpr_write_b32 a107, v43
  v_mfma_f32_32x32x16_bf16 v[48:63], v[36:39], v[252:255], v[48:63]
  ds_read_b64_tr_b16 v[32:33], v6 offset:4096
  ds_read_b64_tr_b16 v[34:35], v6 offset:4352
  v_accvgpr_write_b32 a108, v44
  v_accvgpr_write_b32 a109, v45
  v_accvgpr_write_b32 a110, v46
  v_accvgpr_write_b32 a111, v47
  s_waitcnt lgkmcnt(4)
  v_mfma_f32_32x32x16_bf16 v[64:79], v[16:19], v[112:115], 0
  ds_read_b64_tr_b16 v[36:37], v6 offset:5120
  ds_read_b64_tr_b16 v[38:39], v6 offset:5376
  v_mfma_f32_32x32x16_bf16 v[64:79], v[20:23], v[116:119], v[64:79]
  ds_read_b64_tr_b16 v[16:17], v6 offset:6144
  ds_read_b64_tr_b16 v[18:19], v6 offset:6400
  s_add_u32 m0, s30, 110592
  v_mfma_f32_32x32x16_bf16 v[64:79], v[24:27], v[120:123], v[64:79]
  ds_read_b64_tr_b16 v[20:21], v6 offset:7168
  ds_read_b64_tr_b16 v[22:23], v6 offset:7424
  buffer_load_dwordx4 v2, s[20:23], 0 offen offset:0 lds
  s_waitcnt lgkmcnt(4)
  v_mfma_f32_32x32x16_bf16 v[64:79], v[28:31], v[124:127], v[64:79]
  ds_read_b64_tr_b16 v[24:25], v6 offset:8192
  ds_read_b64_tr_b16 v[26:27], v6 offset:8448
  v_mul_f32 v10, v48, v48
  v_mul_f32 v11, v49, v49
  v_mul_f32 v12, v50, v50
  v_mfma_f32_32x32x16_bf16 v[64:79], v[32:35], v[128:131], v[64:79]
  ds_read_b64_tr_b16 v[28:29], v6 offset:9216
  ds_read_b64_tr_b16 v[30:31], v6 offset:9472
  v_mul_f32 v13, v51, v51
  v_fmaak_f32 v10, v10, v8, 0xc0135761
  v_fmaak_f32 v11, v11, v8, 0xc0135761
  v_fmaak_f32 v12, v12, v8, 0xc0135761
  v_mfma_f32_32x32x16_bf16 v[64:79], v[36:39], v[132:135], v[64:79]
  ds_read_b64_tr_b16 v[32:33], v6 offset:10240
  ds_read_b64_tr_b16 v[34:35], v6 offset:10496
  buffer_load_dwordx4 v2, s[20:23], s67 offen offset:1024 lds
  v_fmaak_f32 v13, v13, v8, 0xc0135761
  s_waitcnt lgkmcnt(4)
  v_mfma_f32_32x32x16_bf16 v[64:79], v[16:19], v[136:139], v[64:79]
  ds_read_b64_tr_b16 v[36:37], v6 offset:11264
  ds_read_b64_tr_b16 v[38:39], v6 offset:11520
  v_mul_f32 v10, v10, v48
  v_mul_f32 v11, v11, v49
  v_mul_f32 v12, v12, v50
  v_mfma_f32_32x32x16_bf16 v[64:79], v[20:23], v[140:143], v[64:79]
  ds_read_b64_tr_b16 v[16:17], v6 offset:12288
  ds_read_b64_tr_b16 v[18:19], v6 offset:12544
  v_mul_f32 v13, v13, v51
  v_exp_f32 v10, v10
  v_exp_f32 v11, v11
  v_mfma_f32_32x32x16_bf16 v[64:79], v[24:27], v[144:147], v[64:79]
  ds_read_b64_tr_b16 v[20:21], v6 offset:13312
  ds_read_b64_tr_b16 v[22:23], v6 offset:13568
  buffer_load_dwordx4 v2, s[20:23], s68 offen offset:2048 lds
  s_waitcnt lgkmcnt(4)
  v_mfma_f32_32x32x16_bf16 v[64:79], v[28:31], v[148:151], v[64:79]
  ds_read_b64_tr_b16 v[24:25], v6 offset:14336
  ds_read_b64_tr_b16 v[26:27], v6 offset:14592
  v_exp_f32 v12, v12
  v_mfma_f32_32x32x16_bf16 v[64:79], v[32:35], v[152:155], v[64:79]
  ds_read_b64_tr_b16 v[28:29], v6 offset:15360
  ds_read_b64_tr_b16 v[30:31], v6 offset:15616
  v_exp_f32 v13, v13
  v_add_f32 v10, 1.0, v10
  v_add_f32 v11, 1.0, v11
  v_add_f32 v12, 1.0, v12
  v_mfma_f32_32x32x16_bf16 v[64:79], v[36:39], v[156:159], v[64:79]
  ds_read_b64_tr_b16 v[32:33], v6 offset:16384
  ds_read_b64_tr_b16 v[34:35], v6 offset:16640
  buffer_load_dwordx4 v2, s[20:23], s69 offen offset:3072 lds
  s_waitcnt lgkmcnt(4)
  v_mfma_f32_32x32x16_bf16 v[64:79], v[16:19], v[160:163], v[64:79]
  ds_read_b64_tr_b16 v[36:37], v6 offset:17408
  ds_read_b64_tr_b16 v[38:39], v6 offset:17664
  v_add_f32 v13, 1.0, v13
  v_rcp_f32 v10, v10
  v_mfma_f32_32x32x16_bf16 v[64:79], v[20:23], v[164:167], v[64:79]
  ds_read_b64_tr_b16 v[16:17], v6 offset:18432
  ds_read_b64_tr_b16 v[18:19], v6 offset:18688
  v_rcp_f32 v11, v11
  v_rcp_f32 v12, v12
  s_add_u32 m0, s30, 114688
  v_mfma_f32_32x32x16_bf16 v[64:79], v[24:27], v[168:171], v[64:79]
  ds_read_b64_tr_b16 v[20:21], v6 offset:19456
  ds_read_b64_tr_b16 v[22:23], v6 offset:19712
  buffer_load_dwordx4 v2, s[20:23], s70 offen offset:0 lds
  s_waitcnt lgkmcnt(4)
  v_mfma_f32_32x32x16_bf16 v[64:79], v[28:31], v[172:175], v[64:79]
  ds_read_b64_tr_b16 v[24:25], v6 offset:20480
  ds_read_b64_tr_b16 v[26:27], v6 offset:20736
  v_rcp_f32 v13, v13
  v_mul_f32 v48, v48, v10
  v_mfma_f32_32x32x16_bf16 v[64:79], v[32:35], v[176:179], v[64:79]
  ds_read_b64_tr_b16 v[28:29], v6 offset:21504
  ds_read_b64_tr_b16 v[30:31], v6 offset:21760
  v_mul_f32 v49, v49, v11
  v_mul_f32 v50, v50, v12
  v_mul_f32 v51, v51, v13
  v_mul_f32 v10, v52, v52
  v_mfma_f32_32x32x16_bf16 v[64:79], v[36:39], v[180:183], v[64:79]
  ds_read_b64_tr_b16 v[32:33], v6 offset:22528
  ds_read_b64_tr_b16 v[34:35], v6 offset:22784
  buffer_load_dwordx4 v2, s[20:23], s71 offen offset:1024 lds
  s_waitcnt lgkmcnt(4)
  v_mfma_f32_32x32x16_bf16 v[64:79], v[16:19], v[184:187], v[64:79]
  ds_read_b64_tr_b16 v[36:37], v6 offset:23552
  ds_read_b64_tr_b16 v[38:39], v6 offset:23808
  v_mul_f32 v11, v53, v53
  v_mul_f32 v12, v54, v54
  v_mul_f32 v13, v55, v55
  v_fmaak_f32 v10, v10, v8, 0xc0135761
  v_mfma_f32_32x32x16_bf16 v[64:79], v[20:23], v[188:191], v[64:79]
  ds_read_b64_tr_b16 v[16:17], v6 offset:24576
  ds_read_b64_tr_b16 v[18:19], v6 offset:24832
  v_fmaak_f32 v11, v11, v8, 0xc0135761
  v_fmaak_f32 v12, v12, v8, 0xc0135761
  v_fmaak_f32 v13, v13, v8, 0xc0135761
  v_mul_f32 v10, v10, v52
  v_mfma_f32_32x32x16_bf16 v[64:79], v[24:27], v[192:195], v[64:79]
  ds_read_b64_tr_b16 v[20:21], v6 offset:25600
  ds_read_b64_tr_b16 v[22:23], v6 offset:25856
  buffer_load_dwordx4 v2, s[20:23], s72 offen offset:2048 lds
  s_waitcnt lgkmcnt(4)
  v_mfma_f32_32x32x16_bf16 v[64:79], v[28:31], v[196:199], v[64:79]
  ds_read_b64_tr_b16 v[24:25], v6 offset:26624
  ds_read_b64_tr_b16 v[26:27], v6 offset:26880
  v_mul_f32 v11, v11, v53
  v_mul_f32 v12, v12, v54
  v_mul_f32 v13, v13, v55
  v_mfma_f32_32x32x16_bf16 v[64:79], v[32:35], v[200:203], v[64:79]
  ds_read_b64_tr_b16 v[28:29], v6 offset:27648
  ds_read_b64_tr_b16 v[30:31], v6 offset:27904
  v_exp_f32 v10, v10
  v_exp_f32 v11, v11
  v_mfma_f32_32x32x16_bf16 v[64:79], v[36:39], v[204:207], v[64:79]
  ds_read_b64_tr_b16 v[32:33], v6 offset:28672
  ds_read_b64_tr_b16 v[34:35], v6 offset:28928
  buffer_load_dwordx4 v2, s[20:23], s73 offen offset:3072 lds
  s_waitcnt lgkmcnt(4)
  v_mfma_f32_32x32x16_bf16 v[64:79], v[16:19], v[208:211], v[64:79]
  ds_read_b64_tr_b16 v[36:37], v6 offset:29696
  ds_read_b64_tr_b16 v[38:39], v6 offset:29952
  v_exp_f32 v12, v12
  v_exp_f32 v13, v13
  v_mfma_f32_32x32x16_bf16 v[64:79], v[20:23], v[212:215], v[64:79]
  ds_read_b64_tr_b16 v[16:17], v6 offset:30720
  ds_read_b64_tr_b16 v[18:19], v6 offset:30976
  v_add_f32 v10, 1.0, v10
  v_add_f32 v11, 1.0, v11
  v_add_f32 v12, 1.0, v12
  s_add_u32 m0, s30, 118784
  v_mfma_f32_32x32x16_bf16 v[64:79], v[24:27], v[216:219], v[64:79]
  ds_read_b64_tr_b16 v[20:21], v6 offset:31744
  ds_read_b64_tr_b16 v[22:23], v6 offset:32000
  buffer_load_dwordx4 v2, s[20:23], s74 offen offset:0 lds
  s_waitcnt lgkmcnt(4)
  v_mfma_f32_32x32x16_bf16 v[64:79], v[28:31], v[220:223], v[64:79]
  ds_read_b64_tr_b16 v[24:25], v6 offset:32768
  ds_read_b64_tr_b16 v[26:27], v6 offset:33024
  v_add_f32 v13, 1.0, v13
  v_rcp_f32 v10, v10
  v_add_u32 v2, 64, v2
  v_mfma_f32_32x32x16_bf16 v[64:79], v[32:35], v[224:227], v[64:79]
  ds_read_b64_tr_b16 v[28:29], v6 offset:33792
  ds_read_b64_tr_b16 v[30:31], v6 offset:34048
  v_rcp_f32 v11, v11
  v_rcp_f32 v12, v12
  v_mfma_f32_32x32x16_bf16 v[64:79], v[36:39], v[228:231], v[64:79]
  ds_read_b64_tr_b16 v[32:33], v6 offset:34816
  ds_read_b64_tr_b16 v[34:35], v6 offset:35072
  v_rcp_f32 v13, v13
  v_mul_f32 v52, v52, v10
  v_mul_f32 v53, v53, v11
  s_waitcnt lgkmcnt(4)
  v_mfma_f32_32x32x16_bf16 v[64:79], v[16:19], v[232:235], v[64:79]
  ds_read_b64_tr_b16 v[36:37], v6 offset:35840
  ds_read_b64_tr_b16 v[38:39], v6 offset:36096
  buffer_load_dword a253, v9, s[24:27], 0 offen offset:384
  v_mul_f32 v54, v54, v12
  v_mul_f32 v55, v55, v13
  v_mfma_f32_32x32x16_bf16 v[64:79], v[20:23], v[236:239], v[64:79]
  s_waitcnt vmcnt(11)
  s_barrier
  v_add_u32 v6, 73728, v4
  ds_read_b64_tr_b16 v[16:17], v6 offset:0
  ds_read_b64_tr_b16 v[18:19], v6 offset:256
  global_load_dword a255, v[96:97], off
  v_add_co_u32 v96, vcc, 0x2000, v96
  v_addc_co_u32 v97, vcc, 0, v97, vcc
  v_mfma_f32_32x32x16_bf16 v[64:79], v[24:27], v[240:243], v[64:79]
  ds_read_b64_tr_b16 v[20:21], v6 offset:1024
  ds_read_b64_tr_b16 v[22:23], v6 offset:1280
  v_mul_f32 v10, v56, v56
  v_mul_f32 v11, v57, v57
  v_mul_f32 v12, v58, v58
  v_mul_f32 v13, v59, v59
  s_waitcnt lgkmcnt(4)
  v_mfma_f32_32x32x16_bf16 v[64:79], v[28:31], v[244:247], v[64:79]
  ds_read_b64_tr_b16 v[24:25], v6 offset:2048
  ds_read_b64_tr_b16 v[26:27], v6 offset:2304
  v_fmaak_f32 v10, v10, v8, 0xc0135761
  v_fmaak_f32 v11, v11, v8, 0xc0135761
  v_fmaak_f32 v12, v12, v8, 0xc0135761
  v_fmaak_f32 v13, v13, v8, 0xc0135761
  v_mfma_f32_32x32x16_bf16 v[64:79], v[32:35], v[248:251], v[64:79]
  ds_read_b64_tr_b16 v[28:29], v6 offset:3072
  ds_read_b64_tr_b16 v[30:31], v6 offset:3328
  v_mul_f32 v10, v10, v56
  v_mul_f32 v11, v11, v57
  v_mul_f32 v12, v12, v58
  v_mul_f32 v13, v13, v59
  v_mfma_f32_32x32x16_bf16 v[64:79], v[36:39], v[252:255], v[64:79]
  ds_read_b64_tr_b16 v[32:33], v6 offset:4096
  ds_read_b64_tr_b16 v[34:35], v6 offset:4352
  v_exp_f32 v10, v10
  v_exp_f32 v11, v11
  s_waitcnt lgkmcnt(4)
  v_mfma_f32_32x32x16_bf16 v[80:95], v[16:19], v[112:115], 0
  ds_read_b64_tr_b16 v[36:37], v6 offset:5120
  ds_read_b64_tr_b16 v[38:39], v6 offset:5376
  v_mfma_f32_32x32x16_bf16 v[80:95], v[20:23], v[116:119], v[80:95]
  ds_read_b64_tr_b16 v[16:17], v6 offset:6144
  ds_read_b64_tr_b16 v[18:19], v6 offset:6400
  v_exp_f32 v12, v12
  v_exp_f32 v13, v13
  s_add_u32 m0, s30, 0
  v_mfma_f32_32x32x16_bf16 v[80:95], v[24:27], v[120:123], v[80:95]
  ds_read_b64_tr_b16 v[20:21], v6 offset:7168
  ds_read_b64_tr_b16 v[22:23], v6 offset:7424
  buffer_load_dwordx4 v2, s[16:19], 0 offen offset:0 lds
  s_waitcnt lgkmcnt(4)
  v_mfma_f32_32x32x16_bf16 v[80:95], v[28:31], v[124:127], v[80:95]
  ds_read_b64_tr_b16 v[24:25], v6 offset:8192
  ds_read_b64_tr_b16 v[26:27], v6 offset:8448
  v_add_f32 v10, 1.0, v10
  v_add_f32 v11, 1.0, v11
  v_mfma_f32_32x32x16_bf16 v[80:95], v[32:35], v[128:131], v[80:95]
  ds_read_b64_tr_b16 v[28:29], v6 offset:9216
  ds_read_b64_tr_b16 v[30:31], v6 offset:9472
  v_add_f32 v12, 1.0, v12
  v_add_f32 v13, 1.0, v13
  v_rcp_f32 v10, v10
  v_mfma_f32_32x32x16_bf16 v[80:95], v[36:39], v[132:135], v[80:95]
  ds_read_b64_tr_b16 v[32:33], v6 offset:10240
  ds_read_b64_tr_b16 v[34:35], v6 offset:10496
  buffer_load_dwordx4 v2, s[16:19], s67 offen offset:1024 lds
  s_waitcnt lgkmcnt(4)
  v_mfma_f32_32x32x16_bf16 v[80:95], v[16:19], v[136:139], v[80:95]
  ds_read_b64_tr_b16 v[36:37], v6 offset:11264
  ds_read_b64_tr_b16 v[38:39], v6 offset:11520
  v_rcp_f32 v11, v11
  v_rcp_f32 v12, v12
  v_mfma_f32_32x32x16_bf16 v[80:95], v[20:23], v[140:143], v[80:95]
  ds_read_b64_tr_b16 v[16:17], v6 offset:12288
  ds_read_b64_tr_b16 v[18:19], v6 offset:12544
  v_rcp_f32 v13, v13
  v_mul_f32 v56, v56, v10
  v_mfma_f32_32x32x16_bf16 v[80:95], v[24:27], v[144:147], v[80:95]
  ds_read_b64_tr_b16 v[20:21], v6 offset:13312
  ds_read_b64_tr_b16 v[22:23], v6 offset:13568
  buffer_load_dwordx4 v2, s[16:19], s68 offen offset:2048 lds
  s_waitcnt lgkmcnt(4)
  v_mfma_f32_32x32x16_bf16 v[80:95], v[28:31], v[148:151], v[80:95]
  ds_read_b64_tr_b16 v[24:25], v6 offset:14336
  ds_read_b64_tr_b16 v[26:27], v6 offset:14592
  v_mul_f32 v57, v57, v11
  v_mul_f32 v58, v58, v12
  v_mul_f32 v59, v59, v13
  v_mul_f32 v10, v60, v60
  v_mfma_f32_32x32x16_bf16 v[80:95], v[32:35], v[152:155], v[80:95]
  ds_read_b64_tr_b16 v[28:29], v6 offset:15360
  ds_read_b64_tr_b16 v[30:31], v6 offset:15616
  v_mul_f32 v11, v61, v61
  v_mul_f32 v12, v62, v62
  v_mul_f32 v13, v63, v63
  v_fmaak_f32 v10, v10, v8, 0xc0135761
  v_mfma_f32_32x32x16_bf16 v[80:95], v[36:39], v[156:159], v[80:95]
  ds_read_b64_tr_b16 v[32:33], v6 offset:16384
  ds_read_b64_tr_b16 v[34:35], v6 offset:16640
  buffer_load_dwordx4 v2, s[16:19], s69 offen offset:3072 lds
  s_waitcnt lgkmcnt(4)
  v_mfma_f32_32x32x16_bf16 v[80:95], v[16:19], v[160:163], v[80:95]
  ds_read_b64_tr_b16 v[36:37], v6 offset:17408
  ds_read_b64_tr_b16 v[38:39], v6 offset:17664
  v_fmaak_f32 v11, v11, v8, 0xc0135761
  v_fmaak_f32 v12, v12, v8, 0xc0135761
  v_fmaak_f32 v13, v13, v8, 0xc0135761
  v_mfma_f32_32x32x16_bf16 v[80:95], v[20:23], v[164:167], v[80:95]
  ds_read_b64_tr_b16 v[16:17], v6 offset:18432
  ds_read_b64_tr_b16 v[18:19], v6 offset:18688
  v_mul_f32 v10, v10, v60
  v_mul_f32 v11, v11, v61
  v_mul_f32 v12, v12, v62
  s_add_u32 m0, s30, 4096
  v_mfma_f32_32x32x16_bf16 v[80:95], v[24:27], v[168:171], v[80:95]
  ds_read_b64_tr_b16 v[20:21], v6 offset:19456
  ds_read_b64_tr_b16 v[22:23], v6 offset:19712
  buffer_load_dwordx4 v2, s[16:19], s70 offen offset:0 lds
  s_waitcnt lgkmcnt(4)
  v_mfma_f32_32x32x16_bf16 v[80:95], v[28:31], v[172:175], v[80:95]
  ds_read_b64_tr_b16 v[24:25], v6 offset:20480
  ds_read_b64_tr_b16 v[26:27], v6 offset:20736
  v_mul_f32 v13, v13, v63
  v_exp_f32 v10, v10
  v_mfma_f32_32x32x16_bf16 v[80:95], v[32:35], v[176:179], v[80:95]
  ds_read_b64_tr_b16 v[28:29], v6 offset:21504
  ds_read_b64_tr_b16 v[30:31], v6 offset:21760
  v_exp_f32 v11, v11
  v_exp_f32 v12, v12
  v_mfma_f32_32x32x16_bf16 v[80:95], v[36:39], v[180:183], v[80:95]
  ds_read_b64_tr_b16 v[32:33], v6 offset:22528
  ds_read_b64_tr_b16 v[34:35], v6 offset:22784
  buffer_load_dwordx4 v2, s[16:19], s71 offen offset:1024 lds
  s_waitcnt lgkmcnt(4)
  v_mfma_f32_32x32x16_bf16 v[80:95], v[16:19], v[184:187], v[80:95]
  ds_read_b64_tr_b16 v[36:37], v6 offset:23552
  ds_read_b64_tr_b16 v[38:39], v6 offset:23808
  v_exp_f32 v13, v13
  v_add_f32 v10, 1.0, v10
  v_mfma_f32_32x32x16_bf16 v[80:95], v[20:23], v[188:191], v[80:95]
  ds_read_b64_tr_b16 v[16:17], v6 offset:24576
  ds_read_b64_tr_b16 v[18:19], v6 offset:24832
  v_add_f32 v11, 1.0, v11
  v_add_f32 v12, 1.0, v12
  v_add_f32 v13, 1.0, v13
  v_rcp_f32 v10, v10
  v_mfma_f32_32x32x16_bf16 v[80:95], v[24:27], v[192:195], v[80:95]
  ds_read_b64_tr_b16 v[20:21], v6 offset:25600
  ds_read_b64_tr_b16 v[22:23], v6 offset:25856
  buffer_load_dwordx4 v2, s[16:19], s72 offen offset:2048 lds
  s_waitcnt lgkmcnt(4)
  v_mfma_f32_32x32x16_bf16 v[80:95], v[28:31], v[196:199], v[80:95]
  ds_read_b64_tr_b16 v[24:25], v6 offset:26624
  ds_read_b64_tr_b16 v[26:27], v6 offset:26880
  v_rcp_f32 v11, v11
  v_mfma_f32_32x32x16_bf16 v[80:95], v[32:35], v[200:203], v[80:95]
  ds_read_b64_tr_b16 v[28:29], v6 offset:27648
  ds_read_b64_tr_b16 v[30:31], v6 offset:27904
  v_rcp_f32 v12, v12
  v_rcp_f32 v13, v13
  v_mfma_f32_32x32x16_bf16 v[80:95], v[36:39], v[204:207], v[80:95]
  ds_read_b64_tr_b16 v[32:33], v6 offset:28672
  ds_read_b64_tr_b16 v[34:35], v6 offset:28928
  buffer_load_dwordx4 v2, s[16:19], s73 offen offset:3072 lds
  s_waitcnt lgkmcnt(4)
  v_mfma_f32_32x32x16_bf16 v[80:95], v[16:19], v[208:211], v[80:95]
  ds_read_b64_tr_b16 v[36:37], v6 offset:29696
  ds_read_b64_tr_b16 v[38:39], v6 offset:29952
  v_mul_f32 v60, v60, v10
  v_mul_f32 v61, v61, v11
  v_mul_f32 v62, v62, v12
  v_mfma_f32_32x32x16_bf16 v[80:95], v[20:23], v[212:215], v[80:95]
  ds_read_b64_tr_b16 v[16:17], v6 offset:30720
  ds_read_b64_tr_b16 v[18:19], v6 offset:30976
  v_mul_f32 v63, v63, v13
  v_mul_f32 v64, v64, v48
  v_mul_f32 v65, v65, v49
  s_add_u32 m0, s30, 8192
  v_mfma_f32_32x32x16_bf16 v[80:95], v[24:27], v[216:219], v[80:95]
  ds_read_b64_tr_b16 v[20:21], v6 offset:31744
  ds_read_b64_tr_b16 v[22:23], v6 offset:32000
  buffer_load_dwordx4 v2, s[16:19], s74 offen offset:0 lds
  s_waitcnt lgkmcnt(4)
  v_mfma_f32_32x32x16_bf16 v[80:95], v[28:31], v[220:223], v[80:95]
  ds_read_b64_tr_b16 v[24:25], v6 offset:32768
  ds_read_b64_tr_b16 v[26:27], v6 offset:33024
  v_mul_f32 v66, v66, v50
  v_mul_f32 v67, v67, v51
  v_mul_f32 v68, v68, v52
  v_mul_f32 v69, v69, v53
  v_mfma_f32_32x32x16_bf16 v[80:95], v[32:35], v[224:227], v[80:95]
  ds_read_b64_tr_b16 v[28:29], v6 offset:33792
  ds_read_b64_tr_b16 v[30:31], v6 offset:34048
  v_mul_f32 v70, v70, v54
  v_mul_f32 v71, v71, v55
  v_mul_f32 v72, v72, v56
  v_mul_f32 v73, v73, v57
  v_mfma_f32_32x32x16_bf16 v[80:95], v[36:39], v[228:231], v[80:95]
  ds_read_b64_tr_b16 v[32:33], v6 offset:34816
  ds_read_b64_tr_b16 v[34:35], v6 offset:35072
  v_mul_f32 v74, v74, v58
  v_mul_f32 v75, v75, v59
  v_mul_f32 v76, v76, v60
  v_mul_f32 v77, v77, v61
  s_waitcnt lgkmcnt(4)
  v_mfma_f32_32x32x16_bf16 v[80:95], v[16:19], v[232:235], v[80:95]
  ds_read_b64_tr_b16 v[36:37], v6 offset:35840
  ds_read_b64_tr_b16 v[38:39], v6 offset:36096
  buffer_load_dword a253, v9, s[24:27], 0 offen offset:512
  v_mul_f32 v78, v78, v62
  v_mul_f32 v79, v79, v63
  v_mfma_f32_32x32x16_bf16 v[80:95], v[20:23], v[236:239], v[80:95]
  s_waitcnt vmcnt(12)
  s_barrier
  v_add_u32 v6, 110592, v4
  ds_read_b64_tr_b16 v[16:17], v6 offset:0
  ds_read_b64_tr_b16 v[18:19], v6 offset:256
  v_cvt_pk_bf16_f32 v40, v64, v65
  v_mfma_f32_32x32x16_bf16 v[80:95], v[24:27], v[240:243], v[80:95]
  ds_read_b64_tr_b16 v[20:21], v6 offset:1024
  ds_read_b64_tr_b16 v[22:23], v6 offset:1280
  v_cvt_pk_bf16_f32 v41, v66, v67
  v_cvt_pk_bf16_f32 v42, v68, v69
  v_cvt_pk_bf16_f32 v43, v70, v71
  v_cvt_pk_bf16_f32 v44, v72, v73
  s_waitcnt lgkmcnt(4)
  v_mfma_f32_32x32x16_bf16 v[80:95], v[28:31], v[244:247], v[80:95]
  ds_read_b64_tr_b16 v[24:25], v6 offset:2048
  ds_read_b64_tr_b16 v[26:27], v6 offset:2304
  v_cvt_pk_bf16_f32 v45, v74, v75
  v_cvt_pk_bf16_f32 v46, v76, v77
  v_cvt_pk_bf16_f32 v47, v78, v79
  v_mfma_f32_32x32x16_bf16 v[80:95], v[32:35], v[248:251], v[80:95]
  ds_read_b64_tr_b16 v[28:29], v6 offset:3072
  ds_read_b64_tr_b16 v[30:31], v6 offset:3328
  v_accvgpr_write_b32 a112, v40
  v_accvgpr_write_b32 a113, v41
  v_accvgpr_write_b32 a114, v42
  v_accvgpr_write_b32 a115, v43
  v_mfma_f32_32x32x16_bf16 v[80:95], v[36:39], v[252:255], v[80:95]
  ds_read_b64_tr_b16 v[32:33], v6 offset:4096
  ds_read_b64_tr_b16 v[34:35], v6 offset:4352
  v_accvgpr_write_b32 a116, v44
  v_accvgpr_write_b32 a117, v45
  v_accvgpr_write_b32 a118, v46
  v_accvgpr_write_b32 a119, v47
  s_waitcnt lgkmcnt(4)
  v_mfma_f32_32x32x16_bf16 v[64:79], v[16:19], v[112:115], 0
  ds_read_b64_tr_b16 v[36:37], v6 offset:5120
  ds_read_b64_tr_b16 v[38:39], v6 offset:5376
  v_mfma_f32_32x32x16_bf16 v[64:79], v[20:23], v[116:119], v[64:79]
  ds_read_b64_tr_b16 v[16:17], v6 offset:6144
  ds_read_b64_tr_b16 v[18:19], v6 offset:6400
  s_add_u32 m0, s30, 36864
  v_mfma_f32_32x32x16_bf16 v[64:79], v[24:27], v[120:123], v[64:79]
  ds_read_b64_tr_b16 v[20:21], v6 offset:7168
  ds_read_b64_tr_b16 v[22:23], v6 offset:7424
  buffer_load_dwordx4 v2, s[20:23], 0 offen offset:0 lds
  s_waitcnt lgkmcnt(4)
  v_mfma_f32_32x32x16_bf16 v[64:79], v[28:31], v[124:127], v[64:79]
  ds_read_b64_tr_b16 v[24:25], v6 offset:8192
  ds_read_b64_tr_b16 v[26:27], v6 offset:8448
  v_mul_f32 v10, v80, v80
  v_mul_f32 v11, v81, v81
  v_mul_f32 v12, v82, v82
  v_mfma_f32_32x32x16_bf16 v[64:79], v[32:35], v[128:131], v[64:79]
  ds_read_b64_tr_b16 v[28:29], v6 offset:9216
  ds_read_b64_tr_b16 v[30:31], v6 offset:9472
  v_mul_f32 v13, v83, v83
  v_fmaak_f32 v10, v10, v8, 0xc0135761
  v_fmaak_f32 v11, v11, v8, 0xc0135761
  v_fmaak_f32 v12, v12, v8, 0xc0135761
  v_mfma_f32_32x32x16_bf16 v[64:79], v[36:39], v[132:135], v[64:79]
  ds_read_b64_tr_b16 v[32:33], v6 offset:10240
  ds_read_b64_tr_b16 v[34:35], v6 offset:10496
  buffer_load_dwordx4 v2, s[20:23], s67 offen offset:1024 lds
  v_fmaak_f32 v13, v13, v8, 0xc0135761
  s_waitcnt lgkmcnt(4)
  v_mfma_f32_32x32x16_bf16 v[64:79], v[16:19], v[136:139], v[64:79]
  ds_read_b64_tr_b16 v[36:37], v6 offset:11264
  ds_read_b64_tr_b16 v[38:39], v6 offset:11520
  v_mul_f32 v10, v10, v80
  v_mul_f32 v11, v11, v81
  v_mul_f32 v12, v12, v82
  v_mfma_f32_32x32x16_bf16 v[64:79], v[20:23], v[140:143], v[64:79]
  ds_read_b64_tr_b16 v[16:17], v6 offset:12288
  ds_read_b64_tr_b16 v[18:19], v6 offset:12544
  v_mul_f32 v13, v13, v83
  v_exp_f32 v10, v10
  v_exp_f32 v11, v11
  v_mfma_f32_32x32x16_bf16 v[64:79], v[24:27], v[144:147], v[64:79]
  ds_read_b64_tr_b16 v[20:21], v6 offset:13312
  ds_read_b64_tr_b16 v[22:23], v6 offset:13568
  buffer_load_dwordx4 v2, s[20:23], s68 offen offset:2048 lds
  s_waitcnt lgkmcnt(4)
  v_mfma_f32_32x32x16_bf16 v[64:79], v[28:31], v[148:151], v[64:79]
  ds_read_b64_tr_b16 v[24:25], v6 offset:14336
  ds_read_b64_tr_b16 v[26:27], v6 offset:14592
  v_exp_f32 v12, v12
  v_mfma_f32_32x32x16_bf16 v[64:79], v[32:35], v[152:155], v[64:79]
  ds_read_b64_tr_b16 v[28:29], v6 offset:15360
  ds_read_b64_tr_b16 v[30:31], v6 offset:15616
  v_exp_f32 v13, v13
  v_add_f32 v10, 1.0, v10
  v_add_f32 v11, 1.0, v11
  v_add_f32 v12, 1.0, v12
  v_mfma_f32_32x32x16_bf16 v[64:79], v[36:39], v[156:159], v[64:79]
  ds_read_b64_tr_b16 v[32:33], v6 offset:16384
  ds_read_b64_tr_b16 v[34:35], v6 offset:16640
  buffer_load_dwordx4 v2, s[20:23], s69 offen offset:3072 lds
  s_waitcnt lgkmcnt(4)
  v_mfma_f32_32x32x16_bf16 v[64:79], v[16:19], v[160:163], v[64:79]
  ds_read_b64_tr_b16 v[36:37], v6 offset:17408
  ds_read_b64_tr_b16 v[38:39], v6 offset:17664
  v_add_f32 v13, 1.0, v13
  v_rcp_f32 v10, v10
  v_mfma_f32_32x32x16_bf16 v[64:79], v[20:23], v[164:167], v[64:79]
  ds_read_b64_tr_b16 v[16:17], v6 offset:18432
  ds_read_b64_tr_b16 v[18:19], v6 offset:18688
  v_rcp_f32 v11, v11
  v_rcp_f32 v12, v12
  s_add_u32 m0, s30, 40960
  v_mfma_f32_32x32x16_bf16 v[64:79], v[24:27], v[168:171], v[64:79]
  ds_read_b64_tr_b16 v[20:21], v6 offset:19456
  ds_read_b64_tr_b16 v[22:23], v6 offset:19712
  buffer_load_dwordx4 v2, s[20:23], s70 offen offset:0 lds
  s_waitcnt lgkmcnt(4)
  v_mfma_f32_32x32x16_bf16 v[64:79], v[28:31], v[172:175], v[64:79]
  ds_read_b64_tr_b16 v[24:25], v6 offset:20480
  ds_read_b64_tr_b16 v[26:27], v6 offset:20736
  v_rcp_f32 v13, v13
  v_mul_f32 v80, v80, v10
  v_mfma_f32_32x32x16_bf16 v[64:79], v[32:35], v[176:179], v[64:79]
  ds_read_b64_tr_b16 v[28:29], v6 offset:21504
  ds_read_b64_tr_b16 v[30:31], v6 offset:21760
  v_mul_f32 v81, v81, v11
  v_mul_f32 v82, v82, v12
  v_mul_f32 v83, v83, v13
  v_mul_f32 v10, v84, v84
  v_mfma_f32_32x32x16_bf16 v[64:79], v[36:39], v[180:183], v[64:79]
  ds_read_b64_tr_b16 v[32:33], v6 offset:22528
  ds_read_b64_tr_b16 v[34:35], v6 offset:22784
  buffer_load_dwordx4 v2, s[20:23], s71 offen offset:1024 lds
  s_waitcnt lgkmcnt(4)
  v_mfma_f32_32x32x16_bf16 v[64:79], v[16:19], v[184:187], v[64:79]
  ds_read_b64_tr_b16 v[36:37], v6 offset:23552
  ds_read_b64_tr_b16 v[38:39], v6 offset:23808
  v_mul_f32 v11, v85, v85
  v_mul_f32 v12, v86, v86
  v_mul_f32 v13, v87, v87
  v_mfma_f32_32x32x16_bf16 v[64:79], v[20:23], v[188:191], v[64:79]
  ds_read_b64_tr_b16 v[16:17], v6 offset:24576
  ds_read_b64_tr_b16 v[18:19], v6 offset:24832
  v_fmaak_f32 v10, v10, v8, 0xc0135761
  v_fmaak_f32 v11, v11, v8, 0xc0135761
  v_fmaak_f32 v12, v12, v8, 0xc0135761
  v_fmaak_f32 v13, v13, v8, 0xc0135761
  v_mul_f32 v10, v10, v84
  v_mfma_f32_32x32x16_bf16 v[64:79], v[24:27], v[192:195], v[64:79]
  ds_read_b64_tr_b16 v[20:21], v6 offset:25600
  ds_read_b64_tr_b16 v[22:23], v6 offset:25856
  buffer_load_dwordx4 v2, s[20:23], s72 offen offset:2048 lds
  s_waitcnt lgkmcnt(4)
  v_mfma_f32_32x32x16_bf16 v[64:79], v[28:31], v[196:199], v[64:79]
  ds_read_b64_tr_b16 v[24:25], v6 offset:26624
  ds_read_b64_tr_b16 v[26:27], v6 offset:26880
  v_mul_f32 v11, v11, v85
  v_mul_f32 v12, v12, v86
  v_mul_f32 v13, v13, v87
  v_mfma_f32_32x32x16_bf16 v[64:79], v[32:35], v[200:203], v[64:79]
  ds_read_b64_tr_b16 v[28:29], v6 offset:27648
  ds_read_b64_tr_b16 v[30:31], v6 offset:27904
  v_exp_f32 v10, v10
  v_exp_f32 v11, v11
  v_mfma_f32_32x32x16_bf16 v[64:79], v[36:39], v[204:207], v[64:79]
  ds_read_b64_tr_b16 v[32:33], v6 offset:28672
  ds_read_b64_tr_b16 v[34:35], v6 offset:28928
  buffer_load_dwordx4 v2, s[20:23], s73 offen offset:3072 lds
  s_waitcnt lgkmcnt(4)
  v_mfma_f32_32x32x16_bf16 v[64:79], v[16:19], v[208:211], v[64:79]
  ds_read_b64_tr_b16 v[36:37], v6 offset:29696
  ds_read_b64_tr_b16 v[38:39], v6 offset:29952
  v_exp_f32 v12, v12
  v_exp_f32 v13, v13
  v_mfma_f32_32x32x16_bf16 v[64:79], v[20:23], v[212:215], v[64:79]
  ds_read_b64_tr_b16 v[16:17], v6 offset:30720
  ds_read_b64_tr_b16 v[18:19], v6 offset:30976
  v_add_f32 v10, 1.0, v10
  v_add_f32 v11, 1.0, v11
  v_add_f32 v12, 1.0, v12
  s_add_u32 m0, s30, 45056
  v_mfma_f32_32x32x16_bf16 v[64:79], v[24:27], v[216:219], v[64:79]
  ds_read_b64_tr_b16 v[20:21], v6 offset:31744
  ds_read_b64_tr_b16 v[22:23], v6 offset:32000
  buffer_load_dwordx4 v2, s[20:23], s74 offen offset:0 lds
  s_waitcnt lgkmcnt(4)
  v_mfma_f32_32x32x16_bf16 v[64:79], v[28:31], v[220:223], v[64:79]
  ds_read_b64_tr_b16 v[24:25], v6 offset:32768
  ds_read_b64_tr_b16 v[26:27], v6 offset:33024
  v_add_f32 v13, 1.0, v13
  v_rcp_f32 v10, v10
  v_add_u32 v2, 64, v2
  v_mfma_f32_32x32x16_bf16 v[64:79], v[32:35], v[224:227], v[64:79]
  ds_read_b64_tr_b16 v[28:29], v6 offset:33792
  ds_read_b64_tr_b16 v[30:31], v6 offset:34048
  v_rcp_f32 v11, v11
  v_rcp_f32 v12, v12
  v_mfma_f32_32x32x16_bf16 v[64:79], v[36:39], v[228:231], v[64:79]
  ds_read_b64_tr_b16 v[32:33], v6 offset:34816
  ds_read_b64_tr_b16 v[34:35], v6 offset:35072
  v_rcp_f32 v13, v13
  v_mul_f32 v84, v84, v10
  v_mul_f32 v85, v85, v11
  s_waitcnt lgkmcnt(4)
  v_mfma_f32_32x32x16_bf16 v[64:79], v[16:19], v[232:235], v[64:79]
  ds_read_b64_tr_b16 v[36:37], v6 offset:35840
  ds_read_b64_tr_b16 v[38:39], v6 offset:36096
  buffer_load_dword a253, v9, s[24:27], 0 offen offset:640
  v_mul_f32 v86, v86, v12
  v_mul_f32 v87, v87, v13
  v_mfma_f32_32x32x16_bf16 v[64:79], v[20:23], v[236:239], v[64:79]
  s_waitcnt vmcnt(11)
  s_barrier
  v_add_u32 v6, 0, v4
  ds_read_b64_tr_b16 v[16:17], v6 offset:0
  ds_read_b64_tr_b16 v[18:19], v6 offset:256
  v_mul_f32 v10, v88, v88
  v_mfma_f32_32x32x16_bf16 v[64:79], v[24:27], v[240:243], v[64:79]
  ds_read_b64_tr_b16 v[20:21], v6 offset:1024
  ds_read_b64_tr_b16 v[22:23], v6 offset:1280
  buffer_load_dword a254, off, s[52:55], s49
  v_mul_f32 v11, v89, v89
  v_mul_f32 v12, v90, v90
  v_mul_f32 v13, v91, v91
  s_waitcnt lgkmcnt(4)
  v_mfma_f32_32x32x16_bf16 v[64:79], v[28:31], v[244:247], v[64:79]
  ds_read_b64_tr_b16 v[24:25], v6 offset:2048
  ds_read_b64_tr_b16 v[26:27], v6 offset:2304
  v_fmaak_f32 v10, v10, v8, 0xc0135761
  v_fmaak_f32 v11, v11, v8, 0xc0135761
  v_fmaak_f32 v12, v12, v8, 0xc0135761
  v_fmaak_f32 v13, v13, v8, 0xc0135761
  v_mfma_f32_32x32x16_bf16 v[64:79], v[32:35], v[248:251], v[64:79]
  ds_read_b64_tr_b16 v[28:29], v6 offset:3072
  ds_read_b64_tr_b16 v[30:31], v6 offset:3328
  v_mul_f32 v10, v10, v88
  v_mul_f32 v11, v11, v89
  v_mul_f32 v12, v12, v90
  v_mul_f32 v13, v13, v91
  v_mfma_f32_32x32x16_bf16 v[64:79], v[36:39], v[252:255], v[64:79]
  ds_read_b64_tr_b16 v[32:33], v6 offset:4096
  ds_read_b64_tr_b16 v[34:35], v6 offset:4352
  v_exp_f32 v10, v10
  v_exp_f32 v11, v11
  s_waitcnt lgkmcnt(4)
  v_mfma_f32_32x32x16_bf16 v[48:63], v[16:19], v[112:115], 0
  ds_read_b64_tr_b16 v[36:37], v6 offset:5120
  ds_read_b64_tr_b16 v[38:39], v6 offset:5376
  v_mfma_f32_32x32x16_bf16 v[48:63], v[20:23], v[116:119], v[48:63]
  ds_read_b64_tr_b16 v[16:17], v6 offset:6144
  ds_read_b64_tr_b16 v[18:19], v6 offset:6400
  v_exp_f32 v12, v12
  v_exp_f32 v13, v13
  s_add_u32 m0, s30, 73728
  v_mfma_f32_32x32x16_bf16 v[48:63], v[24:27], v[120:123], v[48:63]
  ds_read_b64_tr_b16 v[20:21], v6 offset:7168
  ds_read_b64_tr_b16 v[22:23], v6 offset:7424
  buffer_load_dwordx4 v2, s[16:19], 0 offen offset:0 lds
  s_waitcnt lgkmcnt(4)
  v_mfma_f32_32x32x16_bf16 v[48:63], v[28:31], v[124:127], v[48:63]
  ds_read_b64_tr_b16 v[24:25], v6 offset:8192
  ds_read_b64_tr_b16 v[26:27], v6 offset:8448
  v_add_f32 v10, 1.0, v10
  v_add_f32 v11, 1.0, v11
  v_mfma_f32_32x32x16_bf16 v[48:63], v[32:35], v[128:131], v[48:63]
  ds_read_b64_tr_b16 v[28:29], v6 offset:9216
  ds_read_b64_tr_b16 v[30:31], v6 offset:9472
  v_add_f32 v12, 1.0, v12
  v_add_f32 v13, 1.0, v13
  v_rcp_f32 v10, v10
  v_mfma_f32_32x32x16_bf16 v[48:63], v[36:39], v[132:135], v[48:63]
  ds_read_b64_tr_b16 v[32:33], v6 offset:10240
  ds_read_b64_tr_b16 v[34:35], v6 offset:10496
  buffer_load_dwordx4 v2, s[16:19], s67 offen offset:1024 lds
  s_waitcnt lgkmcnt(4)
  v_mfma_f32_32x32x16_bf16 v[48:63], v[16:19], v[136:139], v[48:63]
  ds_read_b64_tr_b16 v[36:37], v6 offset:11264
  ds_read_b64_tr_b16 v[38:39], v6 offset:11520
  v_rcp_f32 v11, v11
  v_rcp_f32 v12, v12
  v_mfma_f32_32x32x16_bf16 v[48:63], v[20:23], v[140:143], v[48:63]
  ds_read_b64_tr_b16 v[16:17], v6 offset:12288
  ds_read_b64_tr_b16 v[18:19], v6 offset:12544
  v_rcp_f32 v13, v13
  v_mul_f32 v88, v88, v10
  v_mfma_f32_32x32x16_bf16 v[48:63], v[24:27], v[144:147], v[48:63]
  ds_read_b64_tr_b16 v[20:21], v6 offset:13312
  ds_read_b64_tr_b16 v[22:23], v6 offset:13568
  buffer_load_dwordx4 v2, s[16:19], s68 offen offset:2048 lds
  s_waitcnt lgkmcnt(4)
  v_mfma_f32_32x32x16_bf16 v[48:63], v[28:31], v[148:151], v[48:63]
  ds_read_b64_tr_b16 v[24:25], v6 offset:14336
  ds_read_b64_tr_b16 v[26:27], v6 offset:14592
  v_mul_f32 v89, v89, v11
  v_mul_f32 v90, v90, v12
  v_mul_f32 v91, v91, v13
  v_mul_f32 v10, v92, v92
  v_mfma_f32_32x32x16_bf16 v[48:63], v[32:35], v[152:155], v[48:63]
  ds_read_b64_tr_b16 v[28:29], v6 offset:15360
  ds_read_b64_tr_b16 v[30:31], v6 offset:15616
  v_mul_f32 v11, v93, v93
  v_mul_f32 v12, v94, v94
  v_mul_f32 v13, v95, v95
  v_fmaak_f32 v10, v10, v8, 0xc0135761
  v_mfma_f32_32x32x16_bf16 v[48:63], v[36:39], v[156:159], v[48:63]
  ds_read_b64_tr_b16 v[32:33], v6 offset:16384
  ds_read_b64_tr_b16 v[34:35], v6 offset:16640
  buffer_load_dwordx4 v2, s[16:19], s69 offen offset:3072 lds
  s_waitcnt lgkmcnt(4)
  v_mfma_f32_32x32x16_bf16 v[48:63], v[16:19], v[160:163], v[48:63]
  ds_read_b64_tr_b16 v[36:37], v6 offset:17408
  ds_read_b64_tr_b16 v[38:39], v6 offset:17664
  v_fmaak_f32 v11, v11, v8, 0xc0135761
  v_fmaak_f32 v12, v12, v8, 0xc0135761
  v_fmaak_f32 v13, v13, v8, 0xc0135761
  v_mfma_f32_32x32x16_bf16 v[48:63], v[20:23], v[164:167], v[48:63]
  ds_read_b64_tr_b16 v[16:17], v6 offset:18432
  ds_read_b64_tr_b16 v[18:19], v6 offset:18688
  v_mul_f32 v10, v10, v92
  v_mul_f32 v11, v11, v93
  v_mul_f32 v12, v12, v94
  s_add_u32 m0, s30, 77824
  v_mfma_f32_32x32x16_bf16 v[48:63], v[24:27], v[168:171], v[48:63]
  ds_read_b64_tr_b16 v[20:21], v6 offset:19456
  ds_read_b64_tr_b16 v[22:23], v6 offset:19712
  buffer_load_dwordx4 v2, s[16:19], s70 offen offset:0 lds
  s_waitcnt lgkmcnt(4)
  v_mfma_f32_32x32x16_bf16 v[48:63], v[28:31], v[172:175], v[48:63]
  ds_read_b64_tr_b16 v[24:25], v6 offset:20480
  ds_read_b64_tr_b16 v[26:27], v6 offset:20736
  v_mul_f32 v13, v13, v95
  v_exp_f32 v10, v10
  v_mfma_f32_32x32x16_bf16 v[48:63], v[32:35], v[176:179], v[48:63]
  ds_read_b64_tr_b16 v[28:29], v6 offset:21504
  ds_read_b64_tr_b16 v[30:31], v6 offset:21760
  v_exp_f32 v11, v11
  v_exp_f32 v12, v12
  v_mfma_f32_32x32x16_bf16 v[48:63], v[36:39], v[180:183], v[48:63]
  ds_read_b64_tr_b16 v[32:33], v6 offset:22528
  ds_read_b64_tr_b16 v[34:35], v6 offset:22784
  buffer_load_dwordx4 v2, s[16:19], s71 offen offset:1024 lds
  s_waitcnt lgkmcnt(4)
  v_mfma_f32_32x32x16_bf16 v[48:63], v[16:19], v[184:187], v[48:63]
  ds_read_b64_tr_b16 v[36:37], v6 offset:23552
  ds_read_b64_tr_b16 v[38:39], v6 offset:23808
  v_exp_f32 v13, v13
  v_add_f32 v10, 1.0, v10
  v_mfma_f32_32x32x16_bf16 v[48:63], v[20:23], v[188:191], v[48:63]
  ds_read_b64_tr_b16 v[16:17], v6 offset:24576
  ds_read_b64_tr_b16 v[18:19], v6 offset:24832
  v_add_f32 v11, 1.0, v11
  v_add_f32 v12, 1.0, v12
  v_add_f32 v13, 1.0, v13
  v_rcp_f32 v10, v10
  v_mfma_f32_32x32x16_bf16 v[48:63], v[24:27], v[192:195], v[48:63]
  ds_read_b64_tr_b16 v[20:21], v6 offset:25600
  ds_read_b64_tr_b16 v[22:23], v6 offset:25856
  buffer_load_dwordx4 v2, s[16:19], s72 offen offset:2048 lds
  s_waitcnt lgkmcnt(4)
  v_mfma_f32_32x32x16_bf16 v[48:63], v[28:31], v[196:199], v[48:63]
  ds_read_b64_tr_b16 v[24:25], v6 offset:26624
  ds_read_b64_tr_b16 v[26:27], v6 offset:26880
  v_rcp_f32 v11, v11
  v_mfma_f32_32x32x16_bf16 v[48:63], v[32:35], v[200:203], v[48:63]
  ds_read_b64_tr_b16 v[28:29], v6 offset:27648
  ds_read_b64_tr_b16 v[30:31], v6 offset:27904
  v_rcp_f32 v12, v12
  v_rcp_f32 v13, v13
  v_mfma_f32_32x32x16_bf16 v[48:63], v[36:39], v[204:207], v[48:63]
  ds_read_b64_tr_b16 v[32:33], v6 offset:28672
  ds_read_b64_tr_b16 v[34:35], v6 offset:28928
  buffer_load_dwordx4 v2, s[16:19], s73 offen offset:3072 lds
  s_waitcnt lgkmcnt(4)
  v_mfma_f32_32x32x16_bf16 v[48:63], v[16:19], v[208:211], v[48:63]
  ds_read_b64_tr_b16 v[36:37], v6 offset:29696
  ds_read_b64_tr_b16 v[38:39], v6 offset:29952
  v_mul_f32 v92, v92, v10
  v_mul_f32 v93, v93, v11
  v_mul_f32 v94, v94, v12
  v_mfma_f32_32x32x16_bf16 v[48:63], v[20:23], v[212:215], v[48:63]
  ds_read_b64_tr_b16 v[16:17], v6 offset:30720
  ds_read_b64_tr_b16 v[18:19], v6 offset:30976
  v_mul_f32 v95, v95, v13
  v_mul_f32 v64, v64, v80
  v_mul_f32 v65, v65, v81
  s_add_u32 m0, s30, 81920
  v_mfma_f32_32x32x16_bf16 v[48:63], v[24:27], v[216:219], v[48:63]
  ds_read_b64_tr_b16 v[20:21], v6 offset:31744
  ds_read_b64_tr_b16 v[22:23], v6 offset:32000
  buffer_load_dwordx4 v2, s[16:19], s74 offen offset:0 lds
  s_waitcnt lgkmcnt(4)
  v_mfma_f32_32x32x16_bf16 v[48:63], v[28:31], v[220:223], v[48:63]
  ds_read_b64_tr_b16 v[24:25], v6 offset:32768
  ds_read_b64_tr_b16 v[26:27], v6 offset:33024
  v_mul_f32 v66, v66, v82
  v_mul_f32 v67, v67, v83
  v_mul_f32 v68, v68, v84
  v_mul_f32 v69, v69, v85
  v_mfma_f32_32x32x16_bf16 v[48:63], v[32:35], v[224:227], v[48:63]
  ds_read_b64_tr_b16 v[28:29], v6 offset:33792
  ds_read_b64_tr_b16 v[30:31], v6 offset:34048
  v_mul_f32 v70, v70, v86
  v_mul_f32 v71, v71, v87
  v_mul_f32 v72, v72, v88
  v_mul_f32 v73, v73, v89
  v_mfma_f32_32x32x16_bf16 v[48:63], v[36:39], v[228:231], v[48:63]
  ds_read_b64_tr_b16 v[32:33], v6 offset:34816
  ds_read_b64_tr_b16 v[34:35], v6 offset:35072
  v_mul_f32 v74, v74, v90
  v_mul_f32 v75, v75, v91
  v_mul_f32 v76, v76, v92
  v_mul_f32 v77, v77, v93
  s_waitcnt lgkmcnt(4)
  v_mfma_f32_32x32x16_bf16 v[48:63], v[16:19], v[232:235], v[48:63]
  ds_read_b64_tr_b16 v[36:37], v6 offset:35840
  ds_read_b64_tr_b16 v[38:39], v6 offset:36096
  buffer_load_dword a253, v9, s[24:27], 0 offen offset:768
  v_mul_f32 v78, v78, v94
  v_mul_f32 v79, v79, v95
  v_mfma_f32_32x32x16_bf16 v[48:63], v[20:23], v[236:239], v[48:63]
  s_waitcnt vmcnt(12)
  s_barrier
  v_add_u32 v6, 36864, v4
  ds_read_b64_tr_b16 v[16:17], v6 offset:0
  ds_read_b64_tr_b16 v[18:19], v6 offset:256
  v_cvt_pk_bf16_f32 v40, v64, v65
  v_mfma_f32_32x32x16_bf16 v[48:63], v[24:27], v[240:243], v[48:63]
  ds_read_b64_tr_b16 v[20:21], v6 offset:1024
  ds_read_b64_tr_b16 v[22:23], v6 offset:1280
  v_cvt_pk_bf16_f32 v41, v66, v67
  v_cvt_pk_bf16_f32 v42, v68, v69
  v_cvt_pk_bf16_f32 v43, v70, v71
  v_cvt_pk_bf16_f32 v44, v72, v73
  s_waitcnt lgkmcnt(4)
  v_mfma_f32_32x32x16_bf16 v[48:63], v[28:31], v[244:247], v[48:63]
  ds_read_b64_tr_b16 v[24:25], v6 offset:2048
  ds_read_b64_tr_b16 v[26:27], v6 offset:2304
  v_cvt_pk_bf16_f32 v45, v74, v75
  v_cvt_pk_bf16_f32 v46, v76, v77
  v_cvt_pk_bf16_f32 v47, v78, v79
  v_mfma_f32_32x32x16_bf16 v[48:63], v[32:35], v[248:251], v[48:63]
  ds_read_b64_tr_b16 v[28:29], v6 offset:3072
  ds_read_b64_tr_b16 v[30:31], v6 offset:3328
  v_accvgpr_write_b32 a120, v40
  v_accvgpr_write_b32 a121, v41
  v_accvgpr_write_b32 a122, v42
  v_accvgpr_write_b32 a123, v43
  v_mfma_f32_32x32x16_bf16 v[48:63], v[36:39], v[252:255], v[48:63]
  ds_read_b64_tr_b16 v[32:33], v6 offset:4096
  ds_read_b64_tr_b16 v[34:35], v6 offset:4352
  v_accvgpr_write_b32 a124, v44
  v_accvgpr_write_b32 a125, v45
  v_accvgpr_write_b32 a126, v46
  v_accvgpr_write_b32 a127, v47
  s_waitcnt lgkmcnt(4)
  v_mfma_f32_32x32x16_bf16 v[64:79], v[16:19], v[112:115], 0
  ds_read_b64_tr_b16 v[36:37], v6 offset:5120
  ds_read_b64_tr_b16 v[38:39], v6 offset:5376
  v_mfma_f32_32x32x16_bf16 v[64:79], v[20:23], v[116:119], v[64:79]
  ds_read_b64_tr_b16 v[16:17], v6 offset:6144
  ds_read_b64_tr_b16 v[18:19], v6 offset:6400
  s_add_u32 m0, s30, 110592
  v_mfma_f32_32x32x16_bf16 v[64:79], v[24:27], v[120:123], v[64:79]
  ds_read_b64_tr_b16 v[20:21], v6 offset:7168
  ds_read_b64_tr_b16 v[22:23], v6 offset:7424
  buffer_load_dwordx4 v2, s[20:23], 0 offen offset:0 lds
  s_waitcnt lgkmcnt(4)
  v_mfma_f32_32x32x16_bf16 v[64:79], v[28:31], v[124:127], v[64:79]
  ds_read_b64_tr_b16 v[24:25], v6 offset:8192
  ds_read_b64_tr_b16 v[26:27], v6 offset:8448
  v_mul_f32 v10, v48, v48
  v_mul_f32 v11, v49, v49
  v_mul_f32 v12, v50, v50
  v_mfma_f32_32x32x16_bf16 v[64:79], v[32:35], v[128:131], v[64:79]
  ds_read_b64_tr_b16 v[28:29], v6 offset:9216
  ds_read_b64_tr_b16 v[30:31], v6 offset:9472
  v_mul_f32 v13, v51, v51
  v_fmaak_f32 v10, v10, v8, 0xc0135761
  v_fmaak_f32 v11, v11, v8, 0xc0135761
  v_fmaak_f32 v12, v12, v8, 0xc0135761
  v_mfma_f32_32x32x16_bf16 v[64:79], v[36:39], v[132:135], v[64:79]
  ds_read_b64_tr_b16 v[32:33], v6 offset:10240
  ds_read_b64_tr_b16 v[34:35], v6 offset:10496
  buffer_load_dwordx4 v2, s[20:23], s67 offen offset:1024 lds
  v_fmaak_f32 v13, v13, v8, 0xc0135761
  s_waitcnt lgkmcnt(4)
  v_mfma_f32_32x32x16_bf16 v[64:79], v[16:19], v[136:139], v[64:79]
  ds_read_b64_tr_b16 v[36:37], v6 offset:11264
  ds_read_b64_tr_b16 v[38:39], v6 offset:11520
  v_mul_f32 v10, v10, v48
  v_mul_f32 v11, v11, v49
  v_mul_f32 v12, v12, v50
  v_mfma_f32_32x32x16_bf16 v[64:79], v[20:23], v[140:143], v[64:79]
  ds_read_b64_tr_b16 v[16:17], v6 offset:12288
  ds_read_b64_tr_b16 v[18:19], v6 offset:12544
  v_mul_f32 v13, v13, v51
  v_exp_f32 v10, v10
  v_exp_f32 v11, v11
  v_mfma_f32_32x32x16_bf16 v[64:79], v[24:27], v[144:147], v[64:79]
  ds_read_b64_tr_b16 v[20:21], v6 offset:13312
  ds_read_b64_tr_b16 v[22:23], v6 offset:13568
  buffer_load_dwordx4 v2, s[20:23], s68 offen offset:2048 lds
  s_waitcnt lgkmcnt(4)
  v_mfma_f32_32x32x16_bf16 v[64:79], v[28:31], v[148:151], v[64:79]
  ds_read_b64_tr_b16 v[24:25], v6 offset:14336
  ds_read_b64_tr_b16 v[26:27], v6 offset:14592
  v_exp_f32 v12, v12
  v_mfma_f32_32x32x16_bf16 v[64:79], v[32:35], v[152:155], v[64:79]
  ds_read_b64_tr_b16 v[28:29], v6 offset:15360
  ds_read_b64_tr_b16 v[30:31], v6 offset:15616
  v_exp_f32 v13, v13
  v_add_f32 v10, 1.0, v10
  v_add_f32 v11, 1.0, v11
  v_add_f32 v12, 1.0, v12
  v_mfma_f32_32x32x16_bf16 v[64:79], v[36:39], v[156:159], v[64:79]
  ds_read_b64_tr_b16 v[32:33], v6 offset:16384
  ds_read_b64_tr_b16 v[34:35], v6 offset:16640
  buffer_load_dwordx4 v2, s[20:23], s69 offen offset:3072 lds
  s_waitcnt lgkmcnt(4)
  v_mfma_f32_32x32x16_bf16 v[64:79], v[16:19], v[160:163], v[64:79]
  ds_read_b64_tr_b16 v[36:37], v6 offset:17408
  ds_read_b64_tr_b16 v[38:39], v6 offset:17664
  v_add_f32 v13, 1.0, v13
  v_rcp_f32 v10, v10
  v_mfma_f32_32x32x16_bf16 v[64:79], v[20:23], v[164:167], v[64:79]
  ds_read_b64_tr_b16 v[16:17], v6 offset:18432
  ds_read_b64_tr_b16 v[18:19], v6 offset:18688
  v_rcp_f32 v11, v11
  v_rcp_f32 v12, v12
  s_add_u32 m0, s30, 114688
  v_mfma_f32_32x32x16_bf16 v[64:79], v[24:27], v[168:171], v[64:79]
  ds_read_b64_tr_b16 v[20:21], v6 offset:19456
  ds_read_b64_tr_b16 v[22:23], v6 offset:19712
  buffer_load_dwordx4 v2, s[20:23], s70 offen offset:0 lds
  s_waitcnt lgkmcnt(4)
  v_mfma_f32_32x32x16_bf16 v[64:79], v[28:31], v[172:175], v[64:79]
  ds_read_b64_tr_b16 v[24:25], v6 offset:20480
  ds_read_b64_tr_b16 v[26:27], v6 offset:20736
  v_rcp_f32 v13, v13
  v_mul_f32 v48, v48, v10
  v_mfma_f32_32x32x16_bf16 v[64:79], v[32:35], v[176:179], v[64:79]
  ds_read_b64_tr_b16 v[28:29], v6 offset:21504
  ds_read_b64_tr_b16 v[30:31], v6 offset:21760
  v_mul_f32 v49, v49, v11
  v_mul_f32 v50, v50, v12
  v_mul_f32 v51, v51, v13
  v_mul_f32 v10, v52, v52
  v_mfma_f32_32x32x16_bf16 v[64:79], v[36:39], v[180:183], v[64:79]
  ds_read_b64_tr_b16 v[32:33], v6 offset:22528
  ds_read_b64_tr_b16 v[34:35], v6 offset:22784
  buffer_load_dwordx4 v2, s[20:23], s71 offen offset:1024 lds
  s_waitcnt lgkmcnt(4)
  v_mfma_f32_32x32x16_bf16 v[64:79], v[16:19], v[184:187], v[64:79]
  ds_read_b64_tr_b16 v[36:37], v6 offset:23552
  ds_read_b64_tr_b16 v[38:39], v6 offset:23808
  v_mul_f32 v11, v53, v53
  v_mul_f32 v12, v54, v54
  v_mul_f32 v13, v55, v55
  v_fmaak_f32 v10, v10, v8, 0xc0135761
  v_mfma_f32_32x32x16_bf16 v[64:79], v[20:23], v[188:191], v[64:79]
  ds_read_b64_tr_b16 v[16:17], v6 offset:24576
  ds_read_b64_tr_b16 v[18:19], v6 offset:24832
  v_fmaak_f32 v11, v11, v8, 0xc0135761
  v_fmaak_f32 v12, v12, v8, 0xc0135761
  v_fmaak_f32 v13, v13, v8, 0xc0135761
  v_mul_f32 v10, v10, v52
  v_mfma_f32_32x32x16_bf16 v[64:79], v[24:27], v[192:195], v[64:79]
  ds_read_b64_tr_b16 v[20:21], v6 offset:25600
  ds_read_b64_tr_b16 v[22:23], v6 offset:25856
  buffer_load_dwordx4 v2, s[20:23], s72 offen offset:2048 lds
  s_waitcnt lgkmcnt(4)
  v_mfma_f32_32x32x16_bf16 v[64:79], v[28:31], v[196:199], v[64:79]
  ds_read_b64_tr_b16 v[24:25], v6 offset:26624
  ds_read_b64_tr_b16 v[26:27], v6 offset:26880
  v_mul_f32 v11, v11, v53
  v_mul_f32 v12, v12, v54
  v_mul_f32 v13, v13, v55
  v_mfma_f32_32x32x16_bf16 v[64:79], v[32:35], v[200:203], v[64:79]
  ds_read_b64_tr_b16 v[28:29], v6 offset:27648
  ds_read_b64_tr_b16 v[30:31], v6 offset:27904
  v_exp_f32 v10, v10
  v_exp_f32 v11, v11
  v_mfma_f32_32x32x16_bf16 v[64:79], v[36:39], v[204:207], v[64:79]
  ds_read_b64_tr_b16 v[32:33], v6 offset:28672
  ds_read_b64_tr_b16 v[34:35], v6 offset:28928
  buffer_load_dwordx4 v2, s[20:23], s73 offen offset:3072 lds
  s_waitcnt lgkmcnt(4)
  v_mfma_f32_32x32x16_bf16 v[64:79], v[16:19], v[208:211], v[64:79]
  ds_read_b64_tr_b16 v[36:37], v6 offset:29696
  ds_read_b64_tr_b16 v[38:39], v6 offset:29952
  v_exp_f32 v12, v12
  v_exp_f32 v13, v13
  v_mfma_f32_32x32x16_bf16 v[64:79], v[20:23], v[212:215], v[64:79]
  ds_read_b64_tr_b16 v[16:17], v6 offset:30720
  ds_read_b64_tr_b16 v[18:19], v6 offset:30976
  v_add_f32 v10, 1.0, v10
  v_add_f32 v11, 1.0, v11
  v_add_f32 v12, 1.0, v12
  s_add_u32 m0, s30, 118784
  v_mfma_f32_32x32x16_bf16 v[64:79], v[24:27], v[216:219], v[64:79]
  ds_read_b64_tr_b16 v[20:21], v6 offset:31744
  ds_read_b64_tr_b16 v[22:23], v6 offset:32000
  buffer_load_dwordx4 v2, s[20:23], s74 offen offset:0 lds
  s_waitcnt lgkmcnt(4)
  v_mfma_f32_32x32x16_bf16 v[64:79], v[28:31], v[220:223], v[64:79]
  ds_read_b64_tr_b16 v[24:25], v6 offset:32768
  ds_read_b64_tr_b16 v[26:27], v6 offset:33024
  v_add_f32 v13, 1.0, v13
  v_rcp_f32 v10, v10
  v_add_u32 v2, 64, v2
  v_mfma_f32_32x32x16_bf16 v[64:79], v[32:35], v[224:227], v[64:79]
  ds_read_b64_tr_b16 v[28:29], v6 offset:33792
  ds_read_b64_tr_b16 v[30:31], v6 offset:34048
  v_rcp_f32 v11, v11
  v_rcp_f32 v12, v12
  v_mfma_f32_32x32x16_bf16 v[64:79], v[36:39], v[228:231], v[64:79]
  ds_read_b64_tr_b16 v[32:33], v6 offset:34816
  ds_read_b64_tr_b16 v[34:35], v6 offset:35072
  v_rcp_f32 v13, v13
  v_mul_f32 v52, v52, v10
  v_mul_f32 v53, v53, v11
  s_waitcnt lgkmcnt(4)
  v_mfma_f32_32x32x16_bf16 v[64:79], v[16:19], v[232:235], v[64:79]
  ds_read_b64_tr_b16 v[36:37], v6 offset:35840
  ds_read_b64_tr_b16 v[38:39], v6 offset:36096
  buffer_load_dword a253, v9, s[24:27], 0 offen offset:896
  v_mul_f32 v54, v54, v12
  v_mul_f32 v55, v55, v13
  v_mfma_f32_32x32x16_bf16 v[64:79], v[20:23], v[236:239], v[64:79]
  s_waitcnt vmcnt(11)
  s_barrier
  v_add_u32 v6, 73728, v4
  ds_read_b64_tr_b16 v[16:17], v6 offset:0
  ds_read_b64_tr_b16 v[18:19], v6 offset:256
  global_load_dword a255, v[96:97], off
  v_add_co_u32 v96, vcc, 0x2000, v96
  v_addc_co_u32 v97, vcc, 0, v97, vcc
  v_mfma_f32_32x32x16_bf16 v[64:79], v[24:27], v[240:243], v[64:79]
  ds_read_b64_tr_b16 v[20:21], v6 offset:1024
  ds_read_b64_tr_b16 v[22:23], v6 offset:1280
  v_mul_f32 v10, v56, v56
  v_mul_f32 v11, v57, v57
  v_mul_f32 v12, v58, v58
  v_mul_f32 v13, v59, v59
  s_waitcnt lgkmcnt(4)
  v_mfma_f32_32x32x16_bf16 v[64:79], v[28:31], v[244:247], v[64:79]
  ds_read_b64_tr_b16 v[24:25], v6 offset:2048
  ds_read_b64_tr_b16 v[26:27], v6 offset:2304
  v_fmaak_f32 v10, v10, v8, 0xc0135761
  v_fmaak_f32 v11, v11, v8, 0xc0135761
  v_fmaak_f32 v12, v12, v8, 0xc0135761
  v_fmaak_f32 v13, v13, v8, 0xc0135761
  v_mfma_f32_32x32x16_bf16 v[64:79], v[32:35], v[248:251], v[64:79]
  ds_read_b64_tr_b16 v[28:29], v6 offset:3072
  ds_read_b64_tr_b16 v[30:31], v6 offset:3328
  v_mul_f32 v10, v10, v56
  v_mul_f32 v11, v11, v57
  v_mul_f32 v12, v12, v58
  v_mul_f32 v13, v13, v59
  v_mfma_f32_32x32x16_bf16 v[64:79], v[36:39], v[252:255], v[64:79]
  ds_read_b64_tr_b16 v[32:33], v6 offset:4096
  ds_read_b64_tr_b16 v[34:35], v6 offset:4352
  v_exp_f32 v10, v10
  v_exp_f32 v11, v11
  s_waitcnt lgkmcnt(4)
  v_mfma_f32_32x32x16_bf16 v[80:95], v[16:19], v[112:115], 0
  ds_read_b64_tr_b16 v[36:37], v6 offset:5120
  ds_read_b64_tr_b16 v[38:39], v6 offset:5376
  v_mfma_f32_32x32x16_bf16 v[80:95], v[20:23], v[116:119], v[80:95]
  ds_read_b64_tr_b16 v[16:17], v6 offset:6144
  ds_read_b64_tr_b16 v[18:19], v6 offset:6400
  v_exp_f32 v12, v12
  v_exp_f32 v13, v13
  s_add_u32 m0, s30, 0
  v_mfma_f32_32x32x16_bf16 v[80:95], v[24:27], v[120:123], v[80:95]
  ds_read_b64_tr_b16 v[20:21], v6 offset:7168
  ds_read_b64_tr_b16 v[22:23], v6 offset:7424
  buffer_load_dwordx4 v3, s[24:27], 0 offen offset:0 lds
  s_waitcnt lgkmcnt(4)
  v_mfma_f32_32x32x16_bf16 v[80:95], v[28:31], v[124:127], v[80:95]
  ds_read_b64_tr_b16 v[24:25], v6 offset:8192
  ds_read_b64_tr_b16 v[26:27], v6 offset:8448
  v_add_f32 v10, 1.0, v10
  v_add_f32 v11, 1.0, v11
  v_mfma_f32_32x32x16_bf16 v[80:95], v[32:35], v[128:131], v[80:95]
  ds_read_b64_tr_b16 v[28:29], v6 offset:9216
  ds_read_b64_tr_b16 v[30:31], v6 offset:9472
  v_add_f32 v12, 1.0, v12
  v_add_f32 v13, 1.0, v13
  v_rcp_f32 v10, v10
  v_mfma_f32_32x32x16_bf16 v[80:95], v[36:39], v[132:135], v[80:95]
  ds_read_b64_tr_b16 v[32:33], v6 offset:10240
  ds_read_b64_tr_b16 v[34:35], v6 offset:10496
  buffer_load_dwordx4 v3, s[24:27], s41 offen offset:1024 lds
  s_waitcnt lgkmcnt(4)
  v_mfma_f32_32x32x16_bf16 v[80:95], v[16:19], v[136:139], v[80:95]
  ds_read_b64_tr_b16 v[36:37], v6 offset:11264
  ds_read_b64_tr_b16 v[38:39], v6 offset:11520
  v_rcp_f32 v11, v11
  v_rcp_f32 v12, v12
  v_mfma_f32_32x32x16_bf16 v[80:95], v[20:23], v[140:143], v[80:95]
  ds_read_b64_tr_b16 v[16:17], v6 offset:12288
  ds_read_b64_tr_b16 v[18:19], v6 offset:12544
  v_rcp_f32 v13, v13
  v_mul_f32 v56, v56, v10
  v_mul_f32 v57, v57, v11
  v_mfma_f32_32x32x16_bf16 v[80:95], v[24:27], v[144:147], v[80:95]
  ds_read_b64_tr_b16 v[20:21], v6 offset:13312
  ds_read_b64_tr_b16 v[22:23], v6 offset:13568
  buffer_load_dwordx4 v3, s[24:27], s42 offen offset:2048 lds
  s_waitcnt lgkmcnt(4)
  v_mfma_f32_32x32x16_bf16 v[80:95], v[28:31], v[148:151], v[80:95]
  ds_read_b64_tr_b16 v[24:25], v6 offset:14336
  ds_read_b64_tr_b16 v[26:27], v6 offset:14592
  v_mul_f32 v58, v58, v12
  v_mul_f32 v59, v59, v13
  v_mul_f32 v10, v60, v60
  v_mfma_f32_32x32x16_bf16 v[80:95], v[32:35], v[152:155], v[80:95]
  ds_read_b64_tr_b16 v[28:29], v6 offset:15360
  ds_read_b64_tr_b16 v[30:31], v6 offset:15616
  v_mul_f32 v11, v61, v61
  v_mul_f32 v12, v62, v62
  v_mul_f32 v13, v63, v63
  v_fmaak_f32 v10, v10, v8, 0xc0135761
  v_mfma_f32_32x32x16_bf16 v[80:95], v[36:39], v[156:159], v[80:95]
  ds_read_b64_tr_b16 v[32:33], v6 offset:16384
  ds_read_b64_tr_b16 v[34:35], v6 offset:16640
  buffer_load_dwordx4 v3, s[24:27], s43 offen offset:3072 lds
  s_waitcnt lgkmcnt(4)
  v_mfma_f32_32x32x16_bf16 v[80:95], v[16:19], v[160:163], v[80:95]
  ds_read_b64_tr_b16 v[36:37], v6 offset:17408
  ds_read_b64_tr_b16 v[38:39], v6 offset:17664
  v_fmaak_f32 v11, v11, v8, 0xc0135761
  v_fmaak_f32 v12, v12, v8, 0xc0135761
  v_fmaak_f32 v13, v13, v8, 0xc0135761
  v_mfma_f32_32x32x16_bf16 v[80:95], v[20:23], v[164:167], v[80:95]
  ds_read_b64_tr_b16 v[16:17], v6 offset:18432
  ds_read_b64_tr_b16 v[18:19], v6 offset:18688
  v_mul_f32 v10, v10, v60
  v_mul_f32 v11, v11, v61
  v_mul_f32 v12, v12, v62
  s_add_u32 m0, s30, 4096
  v_mfma_f32_32x32x16_bf16 v[80:95], v[24:27], v[168:171], v[80:95]
  ds_read_b64_tr_b16 v[20:21], v6 offset:19456
  ds_read_b64_tr_b16 v[22:23], v6 offset:19712
  buffer_load_dwordx4 v3, s[24:27], s44 offen offset:0 lds
  s_waitcnt lgkmcnt(4)
  v_mfma_f32_32x32x16_bf16 v[80:95], v[28:31], v[172:175], v[80:95]
  ds_read_b64_tr_b16 v[24:25], v6 offset:20480
  ds_read_b64_tr_b16 v[26:27], v6 offset:20736
  v_mul_f32 v13, v13, v63
  v_exp_f32 v10, v10
  v_mfma_f32_32x32x16_bf16 v[80:95], v[32:35], v[176:179], v[80:95]
  ds_read_b64_tr_b16 v[28:29], v6 offset:21504
  ds_read_b64_tr_b16 v[30:31], v6 offset:21760
  v_exp_f32 v11, v11
  v_exp_f32 v12, v12
  v_mfma_f32_32x32x16_bf16 v[80:95], v[36:39], v[180:183], v[80:95]
  ds_read_b64_tr_b16 v[32:33], v6 offset:22528
  ds_read_b64_tr_b16 v[34:35], v6 offset:22784
  buffer_load_dwordx4 v3, s[24:27], s45 offen offset:1024 lds
  s_waitcnt lgkmcnt(4)
  v_mfma_f32_32x32x16_bf16 v[80:95], v[16:19], v[184:187], v[80:95]
  ds_read_b64_tr_b16 v[36:37], v6 offset:23552
  ds_read_b64_tr_b16 v[38:39], v6 offset:23808
  v_exp_f32 v13, v13
  v_add_f32 v10, 1.0, v10
  v_add_f32 v11, 1.0, v11
  v_mfma_f32_32x32x16_bf16 v[80:95], v[20:23], v[188:191], v[80:95]
  ds_read_b64_tr_b16 v[16:17], v6 offset:24576
  ds_read_b64_tr_b16 v[18:19], v6 offset:24832
  v_add_f32 v12, 1.0, v12
  v_add_f32 v13, 1.0, v13
  v_rcp_f32 v10, v10
  v_mfma_f32_32x32x16_bf16 v[80:95], v[24:27], v[192:195], v[80:95]
  ds_read_b64_tr_b16 v[20:21], v6 offset:25600
  ds_read_b64_tr_b16 v[22:23], v6 offset:25856
  buffer_load_dwordx4 v3, s[24:27], s46 offen offset:2048 lds
  s_waitcnt lgkmcnt(4)
  v_mfma_f32_32x32x16_bf16 v[80:95], v[28:31], v[196:199], v[80:95]
  ds_read_b64_tr_b16 v[24:25], v6 offset:26624
  ds_read_b64_tr_b16 v[26:27], v6 offset:26880
  v_rcp_f32 v11, v11
  v_mfma_f32_32x32x16_bf16 v[80:95], v[32:35], v[200:203], v[80:95]
  ds_read_b64_tr_b16 v[28:29], v6 offset:27648
  ds_read_b64_tr_b16 v[30:31], v6 offset:27904
  v_rcp_f32 v12, v12
  v_rcp_f32 v13, v13
  v_mul_f32 v60, v60, v10
  v_mfma_f32_32x32x16_bf16 v[80:95], v[36:39], v[204:207], v[80:95]
  ds_read_b64_tr_b16 v[32:33], v6 offset:28672
  ds_read_b64_tr_b16 v[34:35], v6 offset:28928
  buffer_load_dwordx4 v3, s[24:27], s47 offen offset:3072 lds
  s_waitcnt lgkmcnt(4)
  v_mfma_f32_32x32x16_bf16 v[80:95], v[16:19], v[208:211], v[80:95]
  ds_read_b64_tr_b16 v[36:37], v6 offset:29696
  ds_read_b64_tr_b16 v[38:39], v6 offset:29952
  v_mul_f32 v61, v61, v11
  v_mul_f32 v62, v62, v12
  v_mul_f32 v63, v63, v13
  v_mfma_f32_32x32x16_bf16 v[80:95], v[20:23], v[212:215], v[80:95]
  ds_read_b64_tr_b16 v[16:17], v6 offset:30720
  ds_read_b64_tr_b16 v[18:19], v6 offset:30976
  v_mul_f32 v64, v64, v48
  v_mul_f32 v65, v65, v49
  v_mul_f32 v66, v66, v50
  s_add_u32 m0, s30, 8192
  v_mfma_f32_32x32x16_bf16 v[80:95], v[24:27], v[216:219], v[80:95]
  ds_read_b64_tr_b16 v[20:21], v6 offset:31744
  ds_read_b64_tr_b16 v[22:23], v6 offset:32000
  buffer_load_dwordx4 v3, s[24:27], s48 offen offset:0 lds
  s_waitcnt lgkmcnt(4)
  v_mfma_f32_32x32x16_bf16 v[80:95], v[28:31], v[220:223], v[80:95]
  ds_read_b64_tr_b16 v[24:25], v6 offset:32768
  ds_read_b64_tr_b16 v[26:27], v6 offset:33024
  v_mul_f32 v67, v67, v51
  v_mul_f32 v68, v68, v52
  v_add_u32 v3, 128, v3
  v_mfma_f32_32x32x16_bf16 v[80:95], v[32:35], v[224:227], v[80:95]
  ds_read_b64_tr_b16 v[28:29], v6 offset:33792
  ds_read_b64_tr_b16 v[30:31], v6 offset:34048
  v_mul_f32 v69, v69, v53
  v_mul_f32 v70, v70, v54
  v_mul_f32 v71, v71, v55
  v_mul_f32 v72, v72, v56
  v_mfma_f32_32x32x16_bf16 v[80:95], v[36:39], v[228:231], v[80:95]
  ds_read_b64_tr_b16 v[32:33], v6 offset:34816
  ds_read_b64_tr_b16 v[34:35], v6 offset:35072
  v_mul_f32 v73, v73, v57
  v_mul_f32 v74, v74, v58
  v_mul_f32 v75, v75, v59
  v_mul_f32 v76, v76, v60
  s_waitcnt lgkmcnt(4)
  v_mfma_f32_32x32x16_bf16 v[80:95], v[16:19], v[232:235], v[80:95]
  ds_read_b64_tr_b16 v[36:37], v6 offset:35840
  ds_read_b64_tr_b16 v[38:39], v6 offset:36096
  buffer_load_dword a253, v9, s[24:27], 0 offen offset:1024
  v_mul_f32 v77, v77, v61
  v_mul_f32 v78, v78, v62
  v_mul_f32 v79, v79, v63
  v_mfma_f32_32x32x16_bf16 v[80:95], v[20:23], v[236:239], v[80:95]
  s_waitcnt vmcnt(12)
  s_barrier
  v_add_u32 v6, 110592, v4
  ds_read_b64_tr_b16 v[16:17], v6 offset:0
  ds_read_b64_tr_b16 v[18:19], v6 offset:256
  v_cvt_pk_bf16_f32 v40, v64, v65
  v_mfma_f32_32x32x16_bf16 v[80:95], v[24:27], v[240:243], v[80:95]
  ds_read_b64_tr_b16 v[20:21], v6 offset:1024
  ds_read_b64_tr_b16 v[22:23], v6 offset:1280
  v_cvt_pk_bf16_f32 v41, v66, v67
  v_cvt_pk_bf16_f32 v42, v68, v69
  v_cvt_pk_bf16_f32 v43, v70, v71
  v_cvt_pk_bf16_f32 v44, v72, v73
  s_waitcnt lgkmcnt(4)
  v_mfma_f32_32x32x16_bf16 v[80:95], v[28:31], v[244:247], v[80:95]
  ds_read_b64_tr_b16 v[24:25], v6 offset:2048
  ds_read_b64_tr_b16 v[26:27], v6 offset:2304
  v_cvt_pk_bf16_f32 v45, v74, v75
  v_cvt_pk_bf16_f32 v46, v76, v77
  v_cvt_pk_bf16_f32 v47, v78, v79
  v_mfma_f32_32x32x16_bf16 v[80:95], v[32:35], v[248:251], v[80:95]
  ds_read_b64_tr_b16 v[28:29], v6 offset:3072
  ds_read_b64_tr_b16 v[30:31], v6 offset:3328
  v_accvgpr_write_b32 a128, v40
  v_accvgpr_write_b32 a129, v41
  v_accvgpr_write_b32 a130, v42
  v_accvgpr_write_b32 a131, v43
  v_mfma_f32_32x32x16_bf16 v[80:95], v[36:39], v[252:255], v[80:95]
  ds_read_b64_tr_b16 v[32:33], v6 offset:4096
  ds_read_b64_tr_b16 v[34:35], v6 offset:4352
  v_accvgpr_write_b32 a132, v44
  v_accvgpr_write_b32 a133, v45
  v_accvgpr_write_b32 a134, v46
  v_accvgpr_write_b32 a135, v47
  s_waitcnt lgkmcnt(4)
  v_mfma_f32_32x32x16_bf16 v[64:79], v[16:19], v[112:115], 0
  ds_read_b64_tr_b16 v[36:37], v6 offset:5120
  ds_read_b64_tr_b16 v[38:39], v6 offset:5376
  v_mfma_f32_32x32x16_bf16 v[64:79], v[20:23], v[116:119], v[64:79]
  ds_read_b64_tr_b16 v[16:17], v6 offset:6144
  ds_read_b64_tr_b16 v[18:19], v6 offset:6400
  s_add_u32 m0, s30, 36864
  v_mfma_f32_32x32x16_bf16 v[64:79], v[24:27], v[120:123], v[64:79]
  ds_read_b64_tr_b16 v[20:21], v6 offset:7168
  ds_read_b64_tr_b16 v[22:23], v6 offset:7424
  buffer_load_dwordx4 v3, s[24:27], 0 offen offset:0 lds
  s_waitcnt lgkmcnt(4)
  v_mfma_f32_32x32x16_bf16 v[64:79], v[28:31], v[124:127], v[64:79]
  ds_read_b64_tr_b16 v[24:25], v6 offset:8192
  ds_read_b64_tr_b16 v[26:27], v6 offset:8448
  v_mul_f32 v10, v80, v80
  v_mul_f32 v11, v81, v81
  v_mul_f32 v12, v82, v82
  v_mfma_f32_32x32x16_bf16 v[64:79], v[32:35], v[128:131], v[64:79]
  ds_read_b64_tr_b16 v[28:29], v6 offset:9216
  ds_read_b64_tr_b16 v[30:31], v6 offset:9472
  v_mul_f32 v13, v83, v83
  v_fmaak_f32 v10, v10, v8, 0xc0135761
  v_fmaak_f32 v11, v11, v8, 0xc0135761
  v_fmaak_f32 v12, v12, v8, 0xc0135761
  v_mfma_f32_32x32x16_bf16 v[64:79], v[36:39], v[132:135], v[64:79]
  ds_read_b64_tr_b16 v[32:33], v6 offset:10240
  ds_read_b64_tr_b16 v[34:35], v6 offset:10496
  buffer_load_dwordx4 v3, s[24:27], s41 offen offset:1024 lds
  v_fmaak_f32 v13, v13, v8, 0xc0135761
  s_waitcnt lgkmcnt(4)
  v_mfma_f32_32x32x16_bf16 v[64:79], v[16:19], v[136:139], v[64:79]
  ds_read_b64_tr_b16 v[36:37], v6 offset:11264
  ds_read_b64_tr_b16 v[38:39], v6 offset:11520
  v_mul_f32 v10, v10, v80
  v_mul_f32 v11, v11, v81
  v_mul_f32 v12, v12, v82
  v_mfma_f32_32x32x16_bf16 v[64:79], v[20:23], v[140:143], v[64:79]
  ds_read_b64_tr_b16 v[16:17], v6 offset:12288
  ds_read_b64_tr_b16 v[18:19], v6 offset:12544
  v_mul_f32 v13, v13, v83
  v_exp_f32 v10, v10
  v_mfma_f32_32x32x16_bf16 v[64:79], v[24:27], v[144:147], v[64:79]
  ds_read_b64_tr_b16 v[20:21], v6 offset:13312
  ds_read_b64_tr_b16 v[22:23], v6 offset:13568
  buffer_load_dwordx4 v3, s[24:27], s42 offen offset:2048 lds
  v_exp_f32 v11, v11
  s_waitcnt lgkmcnt(4)
  v_mfma_f32_32x32x16_bf16 v[64:79], v[28:31], v[148:151], v[64:79]
  ds_read_b64_tr_b16 v[24:25], v6 offset:14336
  ds_read_b64_tr_b16 v[26:27], v6 offset:14592
  v_exp_f32 v12, v12
  v_mfma_f32_32x32x16_bf16 v[64:79], v[32:35], v[152:155], v[64:79]
  ds_read_b64_tr_b16 v[28:29], v6 offset:15360
  ds_read_b64_tr_b16 v[30:31], v6 offset:15616
  v_exp_f32 v13, v13
  v_add_f32 v10, 1.0, v10
  v_add_f32 v11, 1.0, v11
  v_add_f32 v12, 1.0, v12
  v_mfma_f32_32x32x16_bf16 v[64:79], v[36:39], v[156:159], v[64:79]
  ds_read_b64_tr_b16 v[32:33], v6 offset:16384
  ds_read_b64_tr_b16 v[34:35], v6 offset:16640
  buffer_load_dwordx4 v3, s[24:27], s43 offen offset:3072 lds
  s_waitcnt lgkmcnt(4)
  v_mfma_f32_32x32x16_bf16 v[64:79], v[16:19], v[160:163], v[64:79]
  ds_read_b64_tr_b16 v[36:37], v6 offset:17408
  ds_read_b64_tr_b16 v[38:39], v6 offset:17664
  v_add_f32 v13, 1.0, v13
  v_rcp_f32 v10, v10
  v_mfma_f32_32x32x16_bf16 v[64:79], v[20:23], v[164:167], v[64:79]
  ds_read_b64_tr_b16 v[16:17], v6 offset:18432
  ds_read_b64_tr_b16 v[18:19], v6 offset:18688
  v_rcp_f32 v11, v11
  v_rcp_f32 v12, v12
  s_add_u32 m0, s30, 40960
  v_mfma_f32_32x32x16_bf16 v[64:79], v[24:27], v[168:171], v[64:79]
  ds_read_b64_tr_b16 v[20:21], v6 offset:19456
  ds_read_b64_tr_b16 v[22:23], v6 offset:19712
  buffer_load_dwordx4 v3, s[24:27], s44 offen offset:0 lds
  s_waitcnt lgkmcnt(4)
  v_mfma_f32_32x32x16_bf16 v[64:79], v[28:31], v[172:175], v[64:79]
  ds_read_b64_tr_b16 v[24:25], v6 offset:20480
  ds_read_b64_tr_b16 v[26:27], v6 offset:20736
  v_rcp_f32 v13, v13
  v_mfma_f32_32x32x16_bf16 v[64:79], v[32:35], v[176:179], v[64:79]
  ds_read_b64_tr_b16 v[28:29], v6 offset:21504
  ds_read_b64_tr_b16 v[30:31], v6 offset:21760
  v_mul_f32 v80, v80, v10
  v_mul_f32 v81, v81, v11
  v_mul_f32 v82, v82, v12
  v_mul_f32 v83, v83, v13
  v_mul_f32 v10, v84, v84
  v_mfma_f32_32x32x16_bf16 v[64:79], v[36:39], v[180:183], v[64:79]
  ds_read_b64_tr_b16 v[32:33], v6 offset:22528
  ds_read_b64_tr_b16 v[34:35], v6 offset:22784
  buffer_load_dwordx4 v3, s[24:27], s45 offen offset:1024 lds
  s_waitcnt lgkmcnt(4)
  v_mfma_f32_32x32x16_bf16 v[64:79], v[16:19], v[184:187], v[64:79]
  ds_read_b64_tr_b16 v[36:37], v6 offset:23552
  ds_read_b64_tr_b16 v[38:39], v6 offset:23808
  v_mul_f32 v11, v85, v85
  v_mul_f32 v12, v86, v86
  v_mul_f32 v13, v87, v87
  v_mfma_f32_32x32x16_bf16 v[64:79], v[20:23], v[188:191], v[64:79]
  ds_read_b64_tr_b16 v[16:17], v6 offset:24576
  ds_read_b64_tr_b16 v[18:19], v6 offset:24832
  v_fmaak_f32 v10, v10, v8, 0xc0135761
  v_fmaak_f32 v11, v11, v8, 0xc0135761
  v_fmaak_f32 v12, v12, v8, 0xc0135761
  v_fmaak_f32 v13, v13, v8, 0xc0135761
  v_mfma_f32_32x32x16_bf16 v[64:79], v[24:27], v[192:195], v[64:79]
  ds_read_b64_tr_b16 v[20:21], v6 offset:25600
  ds_read_b64_tr_b16 v[22:23], v6 offset:25856
  buffer_load_dwordx4 v3, s[24:27], s46 offen offset:2048 lds
  s_waitcnt lgkmcnt(4)
  v_mfma_f32_32x32x16_bf16 v[64:79], v[28:31], v[196:199], v[64:79]
  ds_read_b64_tr_b16 v[24:25], v6 offset:26624
  ds_read_b64_tr_b16 v[26:27], v6 offset:26880
  v_mul_f32 v10, v10, v84
  v_mul_f32 v11, v11, v85
  v_mul_f32 v12, v12, v86
  v_mul_f32 v13, v13, v87
  v_mfma_f32_32x32x16_bf16 v[64:79], v[32:35], v[200:203], v[64:79]
  ds_read_b64_tr_b16 v[28:29], v6 offset:27648
  ds_read_b64_tr_b16 v[30:31], v6 offset:27904
  v_exp_f32 v10, v10
  v_exp_f32 v11, v11
  v_mfma_f32_32x32x16_bf16 v[64:79], v[36:39], v[204:207], v[64:79]
  ds_read_b64_tr_b16 v[32:33], v6 offset:28672
  ds_read_b64_tr_b16 v[34:35], v6 offset:28928
  buffer_load_dwordx4 v3, s[24:27], s47 offen offset:3072 lds
  s_waitcnt lgkmcnt(4)
  v_mfma_f32_32x32x16_bf16 v[64:79], v[16:19], v[208:211], v[64:79]
  ds_read_b64_tr_b16 v[36:37], v6 offset:29696
  ds_read_b64_tr_b16 v[38:39], v6 offset:29952
  v_exp_f32 v12, v12
  v_exp_f32 v13, v13
  v_mfma_f32_32x32x16_bf16 v[64:79], v[20:23], v[212:215], v[64:79]
  ds_read_b64_tr_b16 v[16:17], v6 offset:30720
  ds_read_b64_tr_b16 v[18:19], v6 offset:30976
  v_add_f32 v10, 1.0, v10
  v_add_f32 v11, 1.0, v11
  s_add_u32 m0, s30, 45056
  v_mfma_f32_32x32x16_bf16 v[64:79], v[24:27], v[216:219], v[64:79]
  ds_read_b64_tr_b16 v[20:21], v6 offset:31744
  ds_read_b64_tr_b16 v[22:23], v6 offset:32000
  buffer_load_dwordx4 v3, s[24:27], s48 offen offset:0 lds
  v_add_f32 v12, 1.0, v12
  s_waitcnt lgkmcnt(4)
  v_mfma_f32_32x32x16_bf16 v[64:79], v[28:31], v[220:223], v[64:79]
  ds_read_b64_tr_b16 v[24:25], v6 offset:32768
  ds_read_b64_tr_b16 v[26:27], v6 offset:33024
  v_add_f32 v13, 1.0, v13
  v_add_u32 v3, 128, v3
  v_mfma_f32_32x32x16_bf16 v[64:79], v[32:35], v[224:227], v[64:79]
  ds_read_b64_tr_b16 v[28:29], v6 offset:33792
  ds_read_b64_tr_b16 v[30:31], v6 offset:34048
  v_rcp_f32 v10, v10
  v_rcp_f32 v11, v11
  v_mfma_f32_32x32x16_bf16 v[64:79], v[36:39], v[228:231], v[64:79]
  ds_read_b64_tr_b16 v[32:33], v6 offset:34816
  ds_read_b64_tr_b16 v[34:35], v6 offset:35072
  v_rcp_f32 v12, v12
  v_rcp_f32 v13, v13
  v_mul_f32 v84, v84, v10
  s_waitcnt lgkmcnt(4)
  v_mfma_f32_32x32x16_bf16 v[64:79], v[16:19], v[232:235], v[64:79]
  ds_read_b64_tr_b16 v[36:37], v6 offset:35840
  ds_read_b64_tr_b16 v[38:39], v6 offset:36096
  v_mul_f32 v85, v85, v11
  v_mul_f32 v86, v86, v12
  v_mul_f32 v87, v87, v13
  v_mfma_f32_32x32x16_bf16 v[64:79], v[20:23], v[236:239], v[64:79]
  s_waitcnt vmcnt(10)
  s_barrier
  v_add_u32 v6, 0, v5
  ds_read_b64_tr_b16 v[16:17], v6 offset:0
  ds_read_b64_tr_b16 v[18:19], v6 offset:512
  global_load_dword a255, v[96:97], off
  v_add_co_u32 v96, vcc, 0x2000, v96
  v_addc_co_u32 v97, vcc, 0, v97, vcc
  v_mfma_f32_32x32x16_bf16 v[64:79], v[24:27], v[240:243], v[64:79]
  ds_read_b64_tr_b16 v[20:21], v6 offset:1024
  ds_read_b64_tr_b16 v[22:23], v6 offset:1536
  v_mul_f32 v10, v88, v88
  v_mul_f32 v11, v89, v89
  v_mul_f32 v12, v90, v90
  v_mul_f32 v13, v91, v91
  s_waitcnt lgkmcnt(4)
  v_mfma_f32_32x32x16_bf16 v[64:79], v[28:31], v[244:247], v[64:79]
  ds_read_b64_tr_b16 v[24:25], v6 offset:2048
  ds_read_b64_tr_b16 v[26:27], v6 offset:2560
  v_fmaak_f32 v10, v10, v8, 0xc0135761
  v_fmaak_f32 v11, v11, v8, 0xc0135761
  v_fmaak_f32 v12, v12, v8, 0xc0135761
  v_fmaak_f32 v13, v13, v8, 0xc0135761
  v_mfma_f32_32x32x16_bf16 v[64:79], v[32:35], v[248:251], v[64:79]
  ds_read_b64_tr_b16 v[28:29], v6 offset:3072
  ds_read_b64_tr_b16 v[30:31], v6 offset:3584
  v_mul_f32 v10, v10, v88
  v_mul_f32 v11, v11, v89
  v_mul_f32 v12, v12, v90
  v_mul_f32 v13, v13, v91
  v_mfma_f32_32x32x16_bf16 v[64:79], v[36:39], v[252:255], v[64:79]
  ds_read_b64_tr_b16 v[32:33], v6 offset:4096
  ds_read_b64_tr_b16 v[34:35], v6 offset:4608
  v_exp_f32 v10, v10
  v_exp_f32 v11, v11
  s_waitcnt lgkmcnt(4)
  v_mfma_f32_32x32x16_bf16 v[48:63], v[16:19], a[0:3], 0
  ds_read_b64_tr_b16 v[36:37], v6 offset:5120
  ds_read_b64_tr_b16 v[38:39], v6 offset:5632
  v_mfma_f32_32x32x16_bf16 v[48:63], v[20:23], a[4:7], v[48:63]
  ds_read_b64_tr_b16 v[16:17], v6 offset:6144
  ds_read_b64_tr_b16 v[18:19], v6 offset:6656
  v_exp_f32 v12, v12
  v_exp_f32 v13, v13
  s_add_u32 m0, s30, 73728
  v_mfma_f32_32x32x16_bf16 v[48:63], v[24:27], a[8:11], v[48:63]
  ds_read_b64_tr_b16 v[20:21], v6 offset:7168
  ds_read_b64_tr_b16 v[22:23], v6 offset:7680
  buffer_load_dwordx4 v3, s[24:27], 0 offen offset:0 lds
  s_waitcnt lgkmcnt(4)
  v_mfma_f32_32x32x16_bf16 v[48:63], v[28:31], a[12:15], v[48:63]
  ds_read_b64_tr_b16 v[24:25], v6 offset:8192
  ds_read_b64_tr_b16 v[26:27], v6 offset:8704
  v_add_f32 v10, 1.0, v10
  v_add_f32 v11, 1.0, v11
  v_add_f32 v12, 1.0, v12
  v_add_f32 v13, 1.0, v13
  v_mfma_f32_32x32x16_bf16 v[48:63], v[32:35], a[16:19], v[48:63]
  ds_read_b64_tr_b16 v[28:29], v6 offset:9216
  ds_read_b64_tr_b16 v[30:31], v6 offset:9728
  v_rcp_f32 v10, v10
  v_rcp_f32 v11, v11
  v_mfma_f32_32x32x16_bf16 v[48:63], v[36:39], a[20:23], v[48:63]
  ds_read_b64_tr_b16 v[32:33], v6 offset:10240
  ds_read_b64_tr_b16 v[34:35], v6 offset:10752
  buffer_load_dwordx4 v3, s[24:27], s41 offen offset:1024 lds
  s_waitcnt lgkmcnt(4)
  v_mfma_f32_32x32x16_bf16 v[48:63], v[16:19], a[24:27], v[48:63]
  ds_read_b64_tr_b16 v[36:37], v6 offset:11264
  ds_read_b64_tr_b16 v[38:39], v6 offset:11776
  v_rcp_f32 v12, v12
  v_rcp_f32 v13, v13
  v_mfma_f32_32x32x16_bf16 v[48:63], v[20:23], a[28:31], v[48:63]
  ds_read_b64_tr_b16 v[16:17], v6 offset:12288
  ds_read_b64_tr_b16 v[18:19], v6 offset:12800
  v_mul_f32 v88, v88, v10
  v_mul_f32 v89, v89, v11
  v_mul_f32 v90, v90, v12
  v_mul_f32 v91, v91, v13
  v_mul_f32 v10, v92, v92
  v_mfma_f32_32x32x16_bf16 v[48:63], v[24:27], a[32:35], v[48:63]
  ds_read_b64_tr_b16 v[20:21], v6 offset:13312
  ds_read_b64_tr_b16 v[22:23], v6 offset:13824
  buffer_load_dwordx4 v3, s[24:27], s42 offen offset:2048 lds
  s_waitcnt lgkmcnt(4)
  v_mfma_f32_32x32x16_bf16 v[48:63], v[28:31], a[36:39], v[48:63]
  ds_read_b64_tr_b16 v[24:25], v6 offset:14336
  ds_read_b64_tr_b16 v[26:27], v6 offset:14848
  v_mul_f32 v11, v93, v93
  v_mul_f32 v12, v94, v94
  v_mul_f32 v13, v95, v95
  v_fmaak_f32 v10, v10, v8, 0xc0135761
  v_mfma_f32_32x32x16_bf16 v[48:63], v[32:35], a[40:43], v[48:63]
  ds_read_b64_tr_b16 v[28:29], v6 offset:15360
  ds_read_b64_tr_b16 v[30:31], v6 offset:15872
  v_fmaak_f32 v11, v11, v8, 0xc0135761
  v_fmaak_f32 v12, v12, v8, 0xc0135761
  v_fmaak_f32 v13, v13, v8, 0xc0135761
  v_mul_f32 v10, v10, v92
  v_mfma_f32_32x32x16_bf16 v[48:63], v[36:39], a[44:47], v[48:63]
  ds_read_b64_tr_b16 v[32:33], v6 offset:16384
  ds_read_b64_tr_b16 v[34:35], v6 offset:16896
  buffer_load_dwordx4 v3, s[24:27], s43 offen offset:3072 lds
  v_mul_f32 v11, v11, v93
  s_waitcnt lgkmcnt(4)
  v_mfma_f32_32x32x16_bf16 v[48:63], v[16:19], a[48:51], v[48:63]
  ds_read_b64_tr_b16 v[36:37], v6 offset:17408
  ds_read_b64_tr_b16 v[38:39], v6 offset:17920
  v_mul_f32 v12, v12, v94
  v_mul_f32 v13, v13, v95
  v_exp_f32 v10, v10
  v_mfma_f32_32x32x16_bf16 v[48:63], v[20:23], a[52:55], v[48:63]
  ds_read_b64_tr_b16 v[16:17], v6 offset:18432
  ds_read_b64_tr_b16 v[18:19], v6 offset:18944
  v_exp_f32 v11, v11
  v_exp_f32 v12, v12
  s_add_u32 m0, s30, 77824
  v_mfma_f32_32x32x16_bf16 v[48:63], v[24:27], a[56:59], v[48:63]
  ds_read_b64_tr_b16 v[20:21], v6 offset:19456
  ds_read_b64_tr_b16 v[22:23], v6 offset:19968
  buffer_load_dwordx4 v3, s[24:27], s44 offen offset:0 lds
  s_waitcnt lgkmcnt(4)
  v_mfma_f32_32x32x16_bf16 v[48:63], v[28:31], a[60:63], v[48:63]
  ds_read_b64_tr_b16 v[24:25], v6 offset:20480
  ds_read_b64_tr_b16 v[26:27], v6 offset:20992
  v_exp_f32 v13, v13
  v_add_f32 v10, 1.0, v10
  v_mfma_f32_32x32x16_bf16 v[48:63], v[32:35], a[64:67], v[48:63]
  ds_read_b64_tr_b16 v[28:29], v6 offset:21504
  ds_read_b64_tr_b16 v[30:31], v6 offset:22016
  v_add_f32 v11, 1.0, v11
  v_add_f32 v12, 1.0, v12
  v_add_f32 v13, 1.0, v13
  v_rcp_f32 v10, v10
  v_mfma_f32_32x32x16_bf16 v[48:63], v[36:39], a[68:71], v[48:63]
  ds_read_b64_tr_b16 v[32:33], v6 offset:22528
  ds_read_b64_tr_b16 v[34:35], v6 offset:23040
  buffer_load_dwordx4 v3, s[24:27], s45 offen offset:1024 lds
  s_waitcnt lgkmcnt(4)
  v_mfma_f32_32x32x16_bf16 v[48:63], v[16:19], a[72:75], v[48:63]
  ds_read_b64_tr_b16 v[36:37], v6 offset:23552
  ds_read_b64_tr_b16 v[38:39], v6 offset:24064
  v_rcp_f32 v11, v11
  v_rcp_f32 v12, v12
  v_mfma_f32_32x32x16_bf16 v[48:63], v[20:23], a[76:79], v[48:63]
  ds_read_b64_tr_b16 v[16:17], v6 offset:24576
  ds_read_b64_tr_b16 v[18:19], v6 offset:25088
  v_rcp_f32 v13, v13
  v_mul_f32 v92, v92, v10
  v_mul_f32 v93, v93, v11
  v_mfma_f32_32x32x16_bf16 v[48:63], v[24:27], a[80:83], v[48:63]
  ds_read_b64_tr_b16 v[20:21], v6 offset:25600
  ds_read_b64_tr_b16 v[22:23], v6 offset:26112
  buffer_load_dwordx4 v3, s[24:27], s46 offen offset:2048 lds
  v_mul_f32 v94, v94, v12
  s_waitcnt lgkmcnt(4)
  v_mfma_f32_32x32x16_bf16 v[48:63], v[28:31], a[84:87], v[48:63]
  ds_read_b64_tr_b16 v[24:25], v6 offset:26624
  ds_read_b64_tr_b16 v[26:27], v6 offset:27136
  v_mul_f32 v95, v95, v13
  v_mul_f32 v64, v64, v80
  v_mul_f32 v65, v65, v81
  v_mul_f32 v66, v66, v82
  v_mfma_f32_32x32x16_bf16 v[48:63], v[32:35], a[88:91], v[48:63]
  ds_read_b64_tr_b16 v[28:29], v6 offset:27648
  ds_read_b64_tr_b16 v[30:31], v6 offset:28160
  v_mul_f32 v67, v67, v83
  v_mul_f32 v68, v68, v84
  v_mul_f32 v69, v69, v85
  v_mul_f32 v70, v70, v86
  v_mfma_f32_32x32x16_bf16 v[48:63], v[36:39], a[92:95], v[48:63]
  ds_read_b64_tr_b16 v[32:33], v6 offset:28672
  ds_read_b64_tr_b16 v[34:35], v6 offset:29184
  buffer_load_dwordx4 v3, s[24:27], s47 offen offset:3072 lds
  v_mul_f32 v71, v71, v87
  s_waitcnt lgkmcnt(4)
  v_mfma_f32_32x32x16_bf16 v[48:63], v[16:19], a[96:99], v[48:63]
  ds_read_b64_tr_b16 v[36:37], v6 offset:29696
  ds_read_b64_tr_b16 v[38:39], v6 offset:30208
  v_mul_f32 v72, v72, v88
  v_mul_f32 v73, v73, v89
  v_mul_f32 v74, v74, v90
  v_mfma_f32_32x32x16_bf16 v[48:63], v[20:23], a[100:103], v[48:63]
  ds_read_b64_tr_b16 v[16:17], v6 offset:30720
  ds_read_b64_tr_b16 v[18:19], v6 offset:31232
  v_mul_f32 v75, v75, v91
  v_mul_f32 v76, v76, v92
  v_mul_f32 v77, v77, v93
  v_mul_f32 v78, v78, v94
  s_add_u32 m0, s30, 81920
  v_mfma_f32_32x32x16_bf16 v[48:63], v[24:27], a[104:107], v[48:63]
  ds_read_b64_tr_b16 v[20:21], v6 offset:31744
  ds_read_b64_tr_b16 v[22:23], v6 offset:32256
  buffer_load_dwordx4 v3, s[24:27], s48 offen offset:0 lds
  s_waitcnt lgkmcnt(4)
  v_mfma_f32_32x32x16_bf16 v[48:63], v[28:31], a[108:111], v[48:63]
  ds_read_b64_tr_b16 v[24:25], v6 offset:32768
  ds_read_b64_tr_b16 v[26:27], v6 offset:33280
  v_mul_f32 v79, v79, v95
  v_cvt_pk_bf16_f32 v40, v64, v65
  v_cvt_pk_bf16_f32 v41, v66, v67
  v_add_u32 v3, 128, v3
  v_mfma_f32_32x32x16_bf16 v[48:63], v[32:35], a[112:115], v[48:63]
  ds_read_b64_tr_b16 v[28:29], v6 offset:33792
  ds_read_b64_tr_b16 v[30:31], v6 offset:34304
  v_cvt_pk_bf16_f32 v42, v68, v69
  v_cvt_pk_bf16_f32 v43, v70, v71
  v_cvt_pk_bf16_f32 v44, v72, v73
  v_cvt_pk_bf16_f32 v45, v74, v75
  v_mfma_f32_32x32x16_bf16 v[48:63], v[36:39], a[116:119], v[48:63]
  ds_read_b64_tr_b16 v[32:33], v6 offset:34816
  ds_read_b64_tr_b16 v[34:35], v6 offset:35328
  v_cvt_pk_bf16_f32 v46, v76, v77
  v_cvt_pk_bf16_f32 v47, v78, v79
  v_accvgpr_write_b32 a136, v40
  v_accvgpr_write_b32 a137, v41
  v_accvgpr_write_b32 a138, v42
  s_waitcnt lgkmcnt(4)
  v_mfma_f32_32x32x16_bf16 v[48:63], v[16:19], a[120:123], v[48:63]
  ds_read_b64_tr_b16 v[36:37], v6 offset:35840
  ds_read_b64_tr_b16 v[38:39], v6 offset:36352
  v_accvgpr_write_b32 a139, v43
  v_accvgpr_write_b32 a140, v44
  v_accvgpr_write_b32 a141, v45
  v_mfma_f32_32x32x16_bf16 v[48:63], v[20:23], a[124:127], v[48:63]
  s_waitcnt vmcnt(10)
  s_barrier
  v_add_u32 v6, 36864, v5
  ds_read_b64_tr_b16 v[16:17], v6 offset:0
  ds_read_b64_tr_b16 v[18:19], v6 offset:512
  v_accvgpr_write_b32 a142, v46
  v_accvgpr_write_b32 a143, v47
  v_mfma_f32_32x32x16_bf16 v[48:63], v[24:27], a[128:131], v[48:63]
  ds_read_b64_tr_b16 v[20:21], v6 offset:1024
  ds_read_b64_tr_b16 v[22:23], v6 offset:1536
  s_waitcnt lgkmcnt(4)
  v_mfma_f32_32x32x16_bf16 v[48:63], v[28:31], a[132:135], v[48:63]
  ds_read_b64_tr_b16 v[24:25], v6 offset:2048
  ds_read_b64_tr_b16 v[26:27], v6 offset:2560
  v_mfma_f32_32x32x16_bf16 v[48:63], v[32:35], a[136:139], v[48:63]
  ds_read_b64_tr_b16 v[28:29], v6 offset:3072
  ds_read_b64_tr_b16 v[30:31], v6 offset:3584
  v_mfma_f32_32x32x16_bf16 v[48:63], v[36:39], a[140:143], v[48:63]
  ds_read_b64_tr_b16 v[32:33], v6 offset:4096
  ds_read_b64_tr_b16 v[34:35], v6 offset:4608
  s_waitcnt lgkmcnt(4)
  v_mfma_f32_32x32x16_bf16 v[80:95], v[16:19], a[0:3], 0
  ds_read_b64_tr_b16 v[36:37], v6 offset:5120
  ds_read_b64_tr_b16 v[38:39], v6 offset:5632
  v_mfma_f32_32x32x16_bf16 v[80:95], v[20:23], a[4:7], v[80:95]
  ds_read_b64_tr_b16 v[16:17], v6 offset:6144
  ds_read_b64_tr_b16 v[18:19], v6 offset:6656
  s_add_u32 m0, s30, 110592
  v_mfma_f32_32x32x16_bf16 v[80:95], v[24:27], a[8:11], v[80:95]
  ds_read_b64_tr_b16 v[20:21], v6 offset:7168
  ds_read_b64_tr_b16 v[22:23], v6 offset:7680
  buffer_load_dwordx4 v3, s[24:27], 0 offen offset:0 lds
  s_waitcnt lgkmcnt(4)
  v_mfma_f32_32x32x16_bf16 v[80:95], v[28:31], a[12:15], v[80:95]
  ds_read_b64_tr_b16 v[24:25], v6 offset:8192
  ds_read_b64_tr_b16 v[26:27], v6 offset:8704
  v_mfma_f32_32x32x16_bf16 v[80:95], v[32:35], a[16:19], v[80:95]
  ds_read_b64_tr_b16 v[28:29], v6 offset:9216
  ds_read_b64_tr_b16 v[30:31], v6 offset:9728
  v_cvt_pk_bf16_f32 v96, v48, v49
  v_mfma_f32_32x32x16_bf16 v[80:95], v[36:39], a[20:23], v[80:95]
  ds_read_b64_tr_b16 v[32:33], v6 offset:10240
  ds_read_b64_tr_b16 v[34:35], v6 offset:10752
  buffer_load_dwordx4 v3, s[24:27], s41 offen offset:1024 lds
  s_waitcnt lgkmcnt(4)
  v_mfma_f32_32x32x16_bf16 v[80:95], v[16:19], a[24:27], v[80:95]
  ds_read_b64_tr_b16 v[36:37], v6 offset:11264
  ds_read_b64_tr_b16 v[38:39], v6 offset:11776
  v_mfma_f32_32x32x16_bf16 v[80:95], v[20:23], a[28:31], v[80:95]
  ds_read_b64_tr_b16 v[16:17], v6 offset:12288
  ds_read_b64_tr_b16 v[18:19], v6 offset:12800
  v_cvt_pk_bf16_f32 v97, v50, v51
  v_cvt_pk_bf16_f32 v98, v52, v53
  v_mfma_f32_32x32x16_bf16 v[80:95], v[24:27], a[32:35], v[80:95]
  ds_read_b64_tr_b16 v[20:21], v6 offset:13312
  ds_read_b64_tr_b16 v[22:23], v6 offset:13824
  buffer_load_dwordx4 v3, s[24:27], s42 offen offset:2048 lds
  s_waitcnt lgkmcnt(4)
  v_mfma_f32_32x32x16_bf16 v[80:95], v[28:31], a[36:39], v[80:95]
  ds_read_b64_tr_b16 v[24:25], v6 offset:14336
  ds_read_b64_tr_b16 v[26:27], v6 offset:14848
  v_mfma_f32_32x32x16_bf16 v[80:95], v[32:35], a[40:43], v[80:95]
  ds_read_b64_tr_b16 v[28:29], v6 offset:15360
  ds_read_b64_tr_b16 v[30:31], v6 offset:15872
  v_cvt_pk_bf16_f32 v99, v54, v55
  v_mfma_f32_32x32x16_bf16 v[80:95], v[36:39], a[44:47], v[80:95]
  ds_read_b64_tr_b16 v[32:33], v6 offset:16384
  ds_read_b64_tr_b16 v[34:35], v6 offset:16896
  buffer_load_dwordx4 v3, s[24:27], s43 offen offset:3072 lds
  s_waitcnt lgkmcnt(4)
  v_mfma_f32_32x32x16_bf16 v[80:95], v[16:19], a[48:51], v[80:95]
  ds_read_b64_tr_b16 v[36:37], v6 offset:17408
  ds_read_b64_tr_b16 v[38:39], v6 offset:17920
  v_mfma_f32_32x32x16_bf16 v[80:95], v[20:23], a[52:55], v[80:95]
  ds_read_b64_tr_b16 v[16:17], v6 offset:18432
  ds_read_b64_tr_b16 v[18:19], v6 offset:18944
  s_add_u32 m0, s30, 114688
  v_mfma_f32_32x32x16_bf16 v[80:95], v[24:27], a[56:59], v[80:95]
  ds_read_b64_tr_b16 v[20:21], v6 offset:19456
  ds_read_b64_tr_b16 v[22:23], v6 offset:19968
  buffer_load_dwordx4 v3, s[24:27], s44 offen offset:0 lds
  s_waitcnt lgkmcnt(4)
  v_mfma_f32_32x32x16_bf16 v[80:95], v[28:31], a[60:63], v[80:95]
  ds_read_b64_tr_b16 v[24:25], v6 offset:20480
  ds_read_b64_tr_b16 v[26:27], v6 offset:20992
  v_mfma_f32_32x32x16_bf16 v[80:95], v[32:35], a[64:67], v[80:95]
  ds_read_b64_tr_b16 v[28:29], v6 offset:21504
  ds_read_b64_tr_b16 v[30:31], v6 offset:22016
  v_cvt_pk_bf16_f32 v100, v56, v57
  v_mfma_f32_32x32x16_bf16 v[80:95], v[36:39], a[68:71], v[80:95]
  ds_read_b64_tr_b16 v[32:33], v6 offset:22528
  ds_read_b64_tr_b16 v[34:35], v6 offset:23040
  buffer_load_dwordx4 v3, s[24:27], s45 offen offset:1024 lds
  s_waitcnt lgkmcnt(4)
  v_mfma_f32_32x32x16_bf16 v[80:95], v[16:19], a[72:75], v[80:95]
  ds_read_b64_tr_b16 v[36:37], v6 offset:23552
  ds_read_b64_tr_b16 v[38:39], v6 offset:24064
  v_mfma_f32_32x32x16_bf16 v[80:95], v[20:23], a[76:79], v[80:95]
  ds_read_b64_tr_b16 v[16:17], v6 offset:24576
  ds_read_b64_tr_b16 v[18:19], v6 offset:25088
  v_cvt_pk_bf16_f32 v101, v58, v59
  v_cvt_pk_bf16_f32 v102, v60, v61
  v_mfma_f32_32x32x16_bf16 v[80:95], v[24:27], a[80:83], v[80:95]
  ds_read_b64_tr_b16 v[20:21], v6 offset:25600
  ds_read_b64_tr_b16 v[22:23], v6 offset:26112
  buffer_load_dwordx4 v3, s[24:27], s46 offen offset:2048 lds
  s_waitcnt lgkmcnt(4)
  v_mfma_f32_32x32x16_bf16 v[80:95], v[28:31], a[84:87], v[80:95]
  ds_read_b64_tr_b16 v[24:25], v6 offset:26624
  ds_read_b64_tr_b16 v[26:27], v6 offset:27136
  v_mfma_f32_32x32x16_bf16 v[80:95], v[32:35], a[88:91], v[80:95]
  ds_read_b64_tr_b16 v[28:29], v6 offset:27648
  ds_read_b64_tr_b16 v[30:31], v6 offset:28160
  v_cvt_pk_bf16_f32 v103, v62, v63
  v_mfma_f32_32x32x16_bf16 v[80:95], v[36:39], a[92:95], v[80:95]
  ds_read_b64_tr_b16 v[32:33], v6 offset:28672
  ds_read_b64_tr_b16 v[34:35], v6 offset:29184
  buffer_load_dwordx4 v3, s[24:27], s47 offen offset:3072 lds
  s_waitcnt lgkmcnt(4)
  v_mfma_f32_32x32x16_bf16 v[80:95], v[16:19], a[96:99], v[80:95]
  ds_read_b64_tr_b16 v[36:37], v6 offset:29696
  ds_read_b64_tr_b16 v[38:39], v6 offset:30208
  v_mfma_f32_32x32x16_bf16 v[80:95], v[20:23], a[100:103], v[80:95]
  ds_read_b64_tr_b16 v[16:17], v6 offset:30720
  ds_read_b64_tr_b16 v[18:19], v6 offset:31232
  s_add_u32 m0, s30, 118784
  v_mfma_f32_32x32x16_bf16 v[80:95], v[24:27], a[104:107], v[80:95]
  ds_read_b64_tr_b16 v[20:21], v6 offset:31744
  ds_read_b64_tr_b16 v[22:23], v6 offset:32256
  buffer_load_dwordx4 v3, s[24:27], s48 offen offset:0 lds
  s_waitcnt lgkmcnt(4)
  v_mfma_f32_32x32x16_bf16 v[80:95], v[28:31], a[108:111], v[80:95]
  ds_read_b64_tr_b16 v[24:25], v6 offset:32768
  ds_read_b64_tr_b16 v[26:27], v6 offset:33280
  s_add_u32 s38, s49, 0
  buffer_store_dwordx4 v[96:99], v1, s[52:55], s38 offen sc1
  buffer_store_dwordx4 v[100:103], v1, s[52:55], s38 offen offset:1024 sc1
  v_add_u32 v3, 128, v3
  v_mfma_f32_32x32x16_bf16 v[80:95], v[32:35], a[112:115], v[80:95]
  ds_read_b64_tr_b16 v[28:29], v6 offset:33792
  ds_read_b64_tr_b16 v[30:31], v6 offset:34304
  v_mfma_f32_32x32x16_bf16 v[80:95], v[36:39], a[116:119], v[80:95]
  ds_read_b64_tr_b16 v[32:33], v6 offset:34816
  ds_read_b64_tr_b16 v[34:35], v6 offset:35328
  s_waitcnt lgkmcnt(4)
  v_mfma_f32_32x32x16_bf16 v[80:95], v[16:19], a[120:123], v[80:95]
  ds_read_b64_tr_b16 v[36:37], v6 offset:35840
  ds_read_b64_tr_b16 v[38:39], v6 offset:36352
  v_mfma_f32_32x32x16_bf16 v[80:95], v[20:23], a[124:127], v[80:95]
  s_waitcnt vmcnt(11)
  s_barrier
  v_add_u32 v6, 73728, v5
  ds_read_b64_tr_b16 v[16:17], v6 offset:0
  ds_read_b64_tr_b16 v[18:19], v6 offset:512
  v_mfma_f32_32x32x16_bf16 v[80:95], v[24:27], a[128:131], v[80:95]
  ds_read_b64_tr_b16 v[20:21], v6 offset:1024
  ds_read_b64_tr_b16 v[22:23], v6 offset:1536
  s_waitcnt lgkmcnt(4)
  v_mfma_f32_32x32x16_bf16 v[80:95], v[28:31], a[132:135], v[80:95]
  ds_read_b64_tr_b16 v[24:25], v6 offset:2048
  ds_read_b64_tr_b16 v[26:27], v6 offset:2560
  v_mfma_f32_32x32x16_bf16 v[80:95], v[32:35], a[136:139], v[80:95]
  ds_read_b64_tr_b16 v[28:29], v6 offset:3072
  ds_read_b64_tr_b16 v[30:31], v6 offset:3584
  v_mfma_f32_32x32x16_bf16 v[80:95], v[36:39], a[140:143], v[80:95]
  ds_read_b64_tr_b16 v[32:33], v6 offset:4096
  ds_read_b64_tr_b16 v[34:35], v6 offset:4608
  s_waitcnt lgkmcnt(4)
  v_mfma_f32_32x32x16_bf16 v[48:63], v[16:19], a[0:3], 0
  ds_read_b64_tr_b16 v[36:37], v6 offset:5120
  ds_read_b64_tr_b16 v[38:39], v6 offset:5632
  v_mfma_f32_32x32x16_bf16 v[48:63], v[20:23], a[4:7], v[48:63]
  ds_read_b64_tr_b16 v[16:17], v6 offset:6144
  ds_read_b64_tr_b16 v[18:19], v6 offset:6656
  s_add_u32 m0, s30, 0
  v_mfma_f32_32x32x16_bf16 v[48:63], v[24:27], a[8:11], v[48:63]
  ds_read_b64_tr_b16 v[20:21], v6 offset:7168
  ds_read_b64_tr_b16 v[22:23], v6 offset:7680
  buffer_load_dwordx4 v3, s[24:27], 0 offen offset:0 lds
  s_waitcnt lgkmcnt(4)
  v_mfma_f32_32x32x16_bf16 v[48:63], v[28:31], a[12:15], v[48:63]
  ds_read_b64_tr_b16 v[24:25], v6 offset:8192
  ds_read_b64_tr_b16 v[26:27], v6 offset:8704
  s_mov_b32 s16, s34
  s_mov_b32 s17, s35
  s_mov_b32 s18, 663552
  s_mov_b32 s19, 0x20000
  v_mfma_f32_32x32x16_bf16 v[48:63], v[32:35], a[16:19], v[48:63]
  ds_read_b64_tr_b16 v[28:29], v6 offset:9216
  ds_read_b64_tr_b16 v[30:31], v6 offset:9728
  v_cvt_pk_bf16_f32 v104, v80, v81
  s_mov_b32 s20, s64
  s_mov_b32 s21, s65
  s_mov_b32 s22, 2359296
  v_mfma_f32_32x32x16_bf16 v[48:63], v[36:39], a[20:23], v[48:63]
  ds_read_b64_tr_b16 v[32:33], v6 offset:10240
  ds_read_b64_tr_b16 v[34:35], v6 offset:10752
  buffer_load_dwordx4 v3, s[24:27], s41 offen offset:1024 lds
  s_mov_b32 s23, 0x20000
  s_waitcnt lgkmcnt(4)
  v_mfma_f32_32x32x16_bf16 v[48:63], v[16:19], a[24:27], v[48:63]
  ds_read_b64_tr_b16 v[36:37], v6 offset:11264
  ds_read_b64_tr_b16 v[38:39], v6 offset:11776
  s_lshr_b32 s38, s36, 1
  s_and_b32 s38, s38, 2
  s_xor_b32 s38, s38, 2
  v_mfma_f32_32x32x16_bf16 v[48:63], v[20:23], a[28:31], v[48:63]
  ds_read_b64_tr_b16 v[16:17], v6 offset:12288
  ds_read_b64_tr_b16 v[18:19], v6 offset:12800
  v_cvt_pk_bf16_f32 v105, v82, v83
  v_cvt_pk_bf16_f32 v106, v84, v85
  s_lshr_b32 s63, s28, 1
  s_add_u32 s63, s63, s38
  s_lshl_b32 s38, s37, 2
  v_mfma_f32_32x32x16_bf16 v[48:63], v[24:27], a[32:35], v[48:63]
  ds_read_b64_tr_b16 v[20:21], v6 offset:13312
  ds_read_b64_tr_b16 v[22:23], v6 offset:13824
  buffer_load_dwordx4 v3, s[24:27], s42 offen offset:2048 lds
  s_waitcnt lgkmcnt(4)
  v_mfma_f32_32x32x16_bf16 v[48:63], v[28:31], a[36:39], v[48:63]
  ds_read_b64_tr_b16 v[24:25], v6 offset:14336
  ds_read_b64_tr_b16 v[26:27], v6 offset:14848
  s_add_u32 s63, s63, s38
  s_and_b32 s38, s28, 1
  s_lshl_b32 s38, s38, 6
  s_mul_i32 s62, s63, 36864
  v_mfma_f32_32x32x16_bf16 v[48:63], v[32:35], a[40:43], v[48:63]
  ds_read_b64_tr_b16 v[28:29], v6 offset:15360
  ds_read_b64_tr_b16 v[30:31], v6 offset:15872
  v_cvt_pk_bf16_f32 v107, v86, v87
  s_add_u32 s62, s62, s38
  s_lshl_b32 s38, s36, 7
  s_add_u32 s62, s62, s38
  v_mfma_f32_32x32x16_bf16 v[48:63], v[36:39], a[44:47], v[48:63]
  ds_read_b64_tr_b16 v[32:33], v6 offset:16384
  ds_read_b64_tr_b16 v[34:35], v6 offset:16896
  buffer_load_dwordx4 v3, s[24:27], s43 offen offset:3072 lds
  v_lshrrev_b32 v10, 2, v0
  s_waitcnt lgkmcnt(4)
  v_mfma_f32_32x32x16_bf16 v[48:63], v[16:19], a[48:51], v[48:63]
  ds_read_b64_tr_b16 v[36:37], v6 offset:17408
  ds_read_b64_tr_b16 v[38:39], v6 offset:17920
  v_mul_u32_u24 v200, 1152, v10
  v_and_b32 v11, 3, v0
  s_mul_i32 s38, s28, 186624
  v_mfma_f32_32x32x16_bf16 v[48:63], v[20:23], a[52:55], v[48:63]
  ds_read_b64_tr_b16 v[16:17], v6 offset:18432
  ds_read_b64_tr_b16 v[18:19], v6 offset:18944
  s_lshl_b32 s39, s36, 7
  v_lshl_add_u32 v11, v11, 4, s39
  v_add3_u32 v200, v200, v11, s38
  v_bfe_u32 v201, v0, 3, 1
  s_add_u32 m0, s30, 4096
  v_mfma_f32_32x32x16_bf16 v[48:63], v[24:27], a[56:59], v[48:63]
  ds_read_b64_tr_b16 v[20:21], v6 offset:19456
  ds_read_b64_tr_b16 v[22:23], v6 offset:19968
  buffer_load_dwordx4 v3, s[24:27], s44 offen offset:0 lds
  s_waitcnt lgkmcnt(4)
  v_mfma_f32_32x32x16_bf16 v[48:63], v[28:31], a[60:63], v[48:63]
  ds_read_b64_tr_b16 v[24:25], v6 offset:20480
  ds_read_b64_tr_b16 v[26:27], v6 offset:20992
  v_bfe_u32 v10, v0, 4, 1
  v_lshl_add_u32 v201, v10, 2, v201
  v_lshrrev_b32 v10, 5, v0
  v_lshl_add_u32 v201, v10, 1, v201
  v_mfma_f32_32x32x16_bf16 v[48:63], v[32:35], a[64:67], v[48:63]
  ds_read_b64_tr_b16 v[28:29], v6 offset:21504
  ds_read_b64_tr_b16 v[30:31], v6 offset:22016
  v_cvt_pk_bf16_f32 v108, v88, v89
  v_mul_u32_u24 v10, 18, v201
  v_bfe_u32 v201, v0, 2, 1
  v_add3_u32 v10, v10, v201, 16
  v_mfma_f32_32x32x16_bf16 v[48:63], v[36:39], a[68:71], v[48:63]
  ds_read_b64_tr_b16 v[32:33], v6 offset:22528
  ds_read_b64_tr_b16 v[34:35], v6 offset:23040
  buffer_load_dwordx4 v3, s[24:27], s45 offen offset:1024 lds
  v_mul_u32_u24 v10, 1152, v10
  s_waitcnt lgkmcnt(4)
  v_mfma_f32_32x32x16_bf16 v[48:63], v[16:19], a[72:75], v[48:63]
  ds_read_b64_tr_b16 v[36:37], v6 offset:23552
  ds_read_b64_tr_b16 v[38:39], v6 offset:24064
  v_add_u32 v10, v10, v11
  v_subrev_u32 v10, 3072, v10
  s_cmp_eq_u32 s28, 3
  s_cselect_b64 s[32:33], -1, 0
  v_mfma_f32_32x32x16_bf16 v[48:63], v[20:23], a[76:79], v[48:63]
  ds_read_b64_tr_b16 v[16:17], v6 offset:24576
  ds_read_b64_tr_b16 v[18:19], v6 offset:25088
  v_cvt_pk_bf16_f32 v109, v90, v91
  v_cvt_pk_bf16_f32 v110, v92, v93
  v_cndmask_b32 v201, v200, v10, s[32:33]
  s_mov_b32 s67, 19712
  s_mov_b32 s68, 39424
  v_mfma_f32_32x32x16_bf16 v[48:63], v[24:27], a[80:83], v[48:63]
  ds_read_b64_tr_b16 v[20:21], v6 offset:25600
  ds_read_b64_tr_b16 v[22:23], v6 offset:26112
  buffer_load_dwordx4 v3, s[24:27], s46 offen offset:2048 lds
  s_waitcnt lgkmcnt(4)
  v_mfma_f32_32x32x16_bf16 v[48:63], v[28:31], a[84:87], v[48:63]
  ds_read_b64_tr_b16 v[24:25], v6 offset:26624
  ds_read_b64_tr_b16 v[26:27], v6 offset:27136
  s_mov_b32 s69, 59136
  s_mov_b32 s70, 82944
  s_mov_b32 s71, 102656
  s_cmp_eq_u32 s28, 3
  s_cmov_b32 s71, 2048
  s_mov_b32 s72, 122368
  s_cmp_eq_u32 s28, 3
  s_cmov_b32 s72, 166912
  v_mfma_f32_32x32x16_bf16 v[48:63], v[32:35], a[88:91], v[48:63]
  ds_read_b64_tr_b16 v[28:29], v6 offset:27648
  ds_read_b64_tr_b16 v[30:31], v6 offset:28160
  v_cvt_pk_bf16_f32 v111, v94, v95
  s_mov_b32 s73, 142080
  s_cmp_eq_u32 s28, 3
  s_cmov_b32 s73, 331776
  s_mov_b32 s74, 165888
  s_cmp_eq_u32 s28, 3
  s_cmov_b32 s74, 500736
  s_and_b32 s38, s28, 1
  v_mfma_f32_32x32x16_bf16 v[48:63], v[36:39], a[92:95], v[48:63]
  ds_read_b64_tr_b16 v[32:33], v6 offset:28672
  ds_read_b64_tr_b16 v[34:35], v6 offset:29184
  buffer_load_dwordx4 v3, s[24:27], s47 offen offset:3072 lds
  s_mul_i32 s38, s38, 18432
  s_waitcnt lgkmcnt(4)
  v_mfma_f32_32x32x16_bf16 v[48:63], v[16:19], a[96:99], v[48:63]
  ds_read_b64_tr_b16 v[36:37], v6 offset:29696
  ds_read_b64_tr_b16 v[38:39], v6 offset:30208
  s_mul_i32 s61, s63, 36864
  s_add_u32 s61, s61, s38
  s_add_u32 s61, s61, 8388608
  v_mfma_f32_32x32x16_bf16 v[48:63], v[20:23], a[100:103], v[48:63]
  ds_read_b64_tr_b16 v[16:17], v6 offset:30720
  ds_read_b64_tr_b16 v[18:19], v6 offset:31232
  v_and_b32 v12, 31, v0
  v_mul_u32_u24 v9, 1152, v12
  v_lshrrev_b32 v12, 5, v0
  v_lshl_add_u32 v9, v12, 3, v9
  s_add_u32 m0, s30, 8192
  v_mfma_f32_32x32x16_bf16 v[48:63], v[24:27], a[104:107], v[48:63]
  ds_read_b64_tr_b16 v[20:21], v6 offset:31744
  ds_read_b64_tr_b16 v[22:23], v6 offset:32256
  buffer_load_dwordx4 v3, s[24:27], s48 offen offset:0 lds
  s_waitcnt lgkmcnt(4)
  v_mfma_f32_32x32x16_bf16 v[48:63], v[28:31], a[108:111], v[48:63]
  ds_read_b64_tr_b16 v[24:25], v6 offset:32768
  ds_read_b64_tr_b16 v[26:27], v6 offset:33280
  s_add_u32 s38, s49, 4096
  buffer_store_dwordx4 v[104:107], v1, s[52:55], s38 offen sc1
  buffer_store_dwordx4 v[108:111], v1, s[52:55], s38 offen offset:1024 sc1
  v_add_u32 v3, 128, v3
  v_mfma_f32_32x32x16_bf16 v[48:63], v[32:35], a[112:115], v[48:63]
  ds_read_b64_tr_b16 v[28:29], v6 offset:33792
  ds_read_b64_tr_b16 v[30:31], v6 offset:34304
  v_mfma_f32_32x32x16_bf16 v[48:63], v[36:39], a[116:119], v[48:63]
  ds_read_b64_tr_b16 v[32:33], v6 offset:34816
  ds_read_b64_tr_b16 v[34:35], v6 offset:35328
  s_waitcnt lgkmcnt(4)
  v_mfma_f32_32x32x16_bf16 v[48:63], v[16:19], a[120:123], v[48:63]
  ds_read_b64_tr_b16 v[36:37], v6 offset:35840
  ds_read_b64_tr_b16 v[38:39], v6 offset:36352
  v_mfma_f32_32x32x16_bf16 v[48:63], v[20:23], a[124:127], v[48:63]
  s_waitcnt vmcnt(13)
  s_barrier
  v_add_u32 v6, 110592, v5
  ds_read_b64_tr_b16 v[16:17], v6 offset:0
  ds_read_b64_tr_b16 v[18:19], v6 offset:512
  v_mfma_f32_32x32x16_bf16 v[48:63], v[24:27], a[128:131], v[48:63]
  ds_read_b64_tr_b16 v[20:21], v6 offset:1024
  ds_read_b64_tr_b16 v[22:23], v6 offset:1536
  s_waitcnt lgkmcnt(4)
  v_mfma_f32_32x32x16_bf16 v[48:63], v[28:31], a[132:135], v[48:63]
  ds_read_b64_tr_b16 v[24:25], v6 offset:2048
  ds_read_b64_tr_b16 v[26:27], v6 offset:2560
  v_mfma_f32_32x32x16_bf16 v[48:63], v[32:35], a[136:139], v[48:63]
  ds_read_b64_tr_b16 v[28:29], v6 offset:3072
  ds_read_b64_tr_b16 v[30:31], v6 offset:3584
  v_mfma_f32_32x32x16_bf16 v[48:63], v[36:39], a[140:143], v[48:63]
  ds_read_b64_tr_b16 v[32:33], v6 offset:4096
  ds_read_b64_tr_b16 v[34:35], v6 offset:4608
  s_waitcnt lgkmcnt(4)
  v_mfma_f32_32x32x16_bf16 v[80:95], v[16:19], a[0:3], 0
  ds_read_b64_tr_b16 v[36:37], v6 offset:5120
  ds_read_b64_tr_b16 v[38:39], v6 offset:5632
  v_mfma_f32_32x32x16_bf16 v[80:95], v[20:23], a[4:7], v[80:95]
  ds_read_b64_tr_b16 v[16:17], v6 offset:6144
  ds_read_b64_tr_b16 v[18:19], v6 offset:6656
  s_add_u32 m0, s30, 36864
  v_mfma_f32_32x32x16_bf16 v[80:95], v[24:27], a[8:11], v[80:95]
  ds_read_b64_tr_b16 v[20:21], v6 offset:7168
  ds_read_b64_tr_b16 v[22:23], v6 offset:7680
  buffer_load_dwordx4 v3, s[24:27], 0 offen offset:0 lds
  s_waitcnt lgkmcnt(4)
  v_mfma_f32_32x32x16_bf16 v[80:95], v[28:31], a[12:15], v[80:95]
  ds_read_b64_tr_b16 v[24:25], v6 offset:8192
  ds_read_b64_tr_b16 v[26:27], v6 offset:8704
  v_mfma_f32_32x32x16_bf16 v[80:95], v[32:35], a[16:19], v[80:95]
  ds_read_b64_tr_b16 v[28:29], v6 offset:9216
  ds_read_b64_tr_b16 v[30:31], v6 offset:9728
  v_cvt_pk_bf16_f32 v96, v48, v49
  v_mfma_f32_32x32x16_bf16 v[80:95], v[36:39], a[20:23], v[80:95]
  ds_read_b64_tr_b16 v[32:33], v6 offset:10240
  ds_read_b64_tr_b16 v[34:35], v6 offset:10752
  buffer_load_dwordx4 v3, s[24:27], s41 offen offset:1024 lds
  s_waitcnt lgkmcnt(4)
  v_mfma_f32_32x32x16_bf16 v[80:95], v[16:19], a[24:27], v[80:95]
  ds_read_b64_tr_b16 v[36:37], v6 offset:11264
  ds_read_b64_tr_b16 v[38:39], v6 offset:11776
  v_mfma_f32_32x32x16_bf16 v[80:95], v[20:23], a[28:31], v[80:95]
  ds_read_b64_tr_b16 v[16:17], v6 offset:12288
  ds_read_b64_tr_b16 v[18:19], v6 offset:12800
  v_cvt_pk_bf16_f32 v97, v50, v51
  v_cvt_pk_bf16_f32 v98, v52, v53
  v_mfma_f32_32x32x16_bf16 v[80:95], v[24:27], a[32:35], v[80:95]
  ds_read_b64_tr_b16 v[20:21], v6 offset:13312
  ds_read_b64_tr_b16 v[22:23], v6 offset:13824
  buffer_load_dwordx4 v3, s[24:27], s42 offen offset:2048 lds
  s_waitcnt lgkmcnt(4)
  v_mfma_f32_32x32x16_bf16 v[80:95], v[28:31], a[36:39], v[80:95]
  ds_read_b64_tr_b16 v[24:25], v6 offset:14336
  ds_read_b64_tr_b16 v[26:27], v6 offset:14848
  v_mfma_f32_32x32x16_bf16 v[80:95], v[32:35], a[40:43], v[80:95]
  ds_read_b64_tr_b16 v[28:29], v6 offset:15360
  ds_read_b64_tr_b16 v[30:31], v6 offset:15872
  v_cvt_pk_bf16_f32 v99, v54, v55
  v_mfma_f32_32x32x16_bf16 v[80:95], v[36:39], a[44:47], v[80:95]
  ds_read_b64_tr_b16 v[32:33], v6 offset:16384
  ds_read_b64_tr_b16 v[34:35], v6 offset:16896
  buffer_load_dwordx4 v3, s[24:27], s43 offen offset:3072 lds
  s_waitcnt lgkmcnt(4)
  v_mfma_f32_32x32x16_bf16 v[80:95], v[16:19], a[48:51], v[80:95]
  ds_read_b64_tr_b16 v[36:37], v6 offset:17408
  ds_read_b64_tr_b16 v[38:39], v6 offset:17920
  v_mfma_f32_32x32x16_bf16 v[80:95], v[20:23], a[52:55], v[80:95]
  ds_read_b64_tr_b16 v[16:17], v6 offset:18432
  ds_read_b64_tr_b16 v[18:19], v6 offset:18944
  s_add_u32 m0, s30, 40960
  v_mfma_f32_32x32x16_bf16 v[80:95], v[24:27], a[56:59], v[80:95]
  ds_read_b64_tr_b16 v[20:21], v6 offset:19456
  ds_read_b64_tr_b16 v[22:23], v6 offset:19968
  buffer_load_dwordx4 v3, s[24:27], s44 offen offset:0 lds
  s_waitcnt lgkmcnt(4)
  v_mfma_f32_32x32x16_bf16 v[80:95], v[28:31], a[60:63], v[80:95]
  ds_read_b64_tr_b16 v[24:25], v6 offset:20480
  ds_read_b64_tr_b16 v[26:27], v6 offset:20992
  v_mfma_f32_32x32x16_bf16 v[80:95], v[32:35], a[64:67], v[80:95]
  ds_read_b64_tr_b16 v[28:29], v6 offset:21504
  ds_read_b64_tr_b16 v[30:31], v6 offset:22016
  v_cvt_pk_bf16_f32 v100, v56, v57
  v_mfma_f32_32x32x16_bf16 v[80:95], v[36:39], a[68:71], v[80:95]
  ds_read_b64_tr_b16 v[32:33], v6 offset:22528
  ds_read_b64_tr_b16 v[34:35], v6 offset:23040
  buffer_load_dwordx4 v3, s[24:27], s45 offen offset:1024 lds
  s_waitcnt lgkmcnt(4)
  v_mfma_f32_32x32x16_bf16 v[80:95], v[16:19], a[72:75], v[80:95]
  ds_read_b64_tr_b16 v[36:37], v6 offset:23552
  ds_read_b64_tr_b16 v[38:39], v6 offset:24064
  v_mfma_f32_32x32x16_bf16 v[80:95], v[20:23], a[76:79], v[80:95]
  ds_read_b64_tr_b16 v[16:17], v6 offset:24576
  ds_read_b64_tr_b16 v[18:19], v6 offset:25088
  v_cvt_pk_bf16_f32 v101, v58, v59
  v_cvt_pk_bf16_f32 v102, v60, v61
  v_mfma_f32_32x32x16_bf16 v[80:95], v[24:27], a[80:83], v[80:95]
  ds_read_b64_tr_b16 v[20:21], v6 offset:25600
  ds_read_b64_tr_b16 v[22:23], v6 offset:26112
  buffer_load_dwordx4 v3, s[24:27], s46 offen offset:2048 lds
  s_waitcnt lgkmcnt(4)
  v_mfma_f32_32x32x16_bf16 v[80:95], v[28:31], a[84:87], v[80:95]
  ds_read_b64_tr_b16 v[24:25], v6 offset:26624
  ds_read_b64_tr_b16 v[26:27], v6 offset:27136
  v_mfma_f32_32x32x16_bf16 v[80:95], v[32:35], a[88:91], v[80:95]
  ds_read_b64_tr_b16 v[28:29], v6 offset:27648
  ds_read_b64_tr_b16 v[30:31], v6 offset:28160
  v_cvt_pk_bf16_f32 v103, v62, v63
  v_mfma_f32_32x32x16_bf16 v[80:95], v[36:39], a[92:95], v[80:95]
  ds_read_b64_tr_b16 v[32:33], v6 offset:28672
  ds_read_b64_tr_b16 v[34:35], v6 offset:29184
  buffer_load_dwordx4 v3, s[24:27], s47 offen offset:3072 lds
  s_waitcnt lgkmcnt(4)
  v_mfma_f32_32x32x16_bf16 v[80:95], v[16:19], a[96:99], v[80:95]
  ds_read_b64_tr_b16 v[36:37], v6 offset:29696
  ds_read_b64_tr_b16 v[38:39], v6 offset:30208
  v_mfma_f32_32x32x16_bf16 v[80:95], v[20:23], a[100:103], v[80:95]
  ds_read_b64_tr_b16 v[16:17], v6 offset:30720
  ds_read_b64_tr_b16 v[18:19], v6 offset:31232
  s_add_u32 m0, s30, 45056
  v_mfma_f32_32x32x16_bf16 v[80:95], v[24:27], a[104:107], v[80:95]
  ds_read_b64_tr_b16 v[20:21], v6 offset:31744
  ds_read_b64_tr_b16 v[22:23], v6 offset:32256
  buffer_load_dwordx4 v3, s[24:27], s48 offen offset:0 lds
  s_waitcnt lgkmcnt(4)
  v_mfma_f32_32x32x16_bf16 v[80:95], v[28:31], a[108:111], v[80:95]
  ds_read_b64_tr_b16 v[24:25], v6 offset:32768
  ds_read_b64_tr_b16 v[26:27], v6 offset:33280
  s_add_u32 s38, s49, 8192
  buffer_store_dwordx4 v[96:99], v1, s[52:55], s38 offen sc1
  buffer_store_dwordx4 v[100:103], v1, s[52:55], s38 offen offset:1024 sc1
  v_add_u32 v3, 128, v3
  v_mfma_f32_32x32x16_bf16 v[80:95], v[32:35], a[112:115], v[80:95]
  ds_read_b64_tr_b16 v[28:29], v6 offset:33792
  ds_read_b64_tr_b16 v[30:31], v6 offset:34304
  v_mfma_f32_32x32x16_bf16 v[80:95], v[36:39], a[116:119], v[80:95]
  ds_read_b64_tr_b16 v[32:33], v6 offset:34816
  ds_read_b64_tr_b16 v[34:35], v6 offset:35328
  s_waitcnt lgkmcnt(4)
  v_mfma_f32_32x32x16_bf16 v[80:95], v[16:19], a[120:123], v[80:95]
  ds_read_b64_tr_b16 v[36:37], v6 offset:35840
  ds_read_b64_tr_b16 v[38:39], v6 offset:36352
  v_mfma_f32_32x32x16_bf16 v[80:95], v[20:23], a[124:127], v[80:95]
  s_waitcnt vmcnt(13)
  s_barrier
  v_add_u32 v6, 0, v5
  ds_read_b64_tr_b16 v[16:17], v6 offset:0
  ds_read_b64_tr_b16 v[18:19], v6 offset:512
  v_mfma_f32_32x32x16_bf16 v[80:95], v[24:27], a[128:131], v[80:95]
  ds_read_b64_tr_b16 v[20:21], v6 offset:1024
  ds_read_b64_tr_b16 v[22:23], v6 offset:1536
  s_waitcnt lgkmcnt(4)
  v_mfma_f32_32x32x16_bf16 v[80:95], v[28:31], a[132:135], v[80:95]
  ds_read_b64_tr_b16 v[24:25], v6 offset:2048
  ds_read_b64_tr_b16 v[26:27], v6 offset:2560
  v_mfma_f32_32x32x16_bf16 v[80:95], v[32:35], a[136:139], v[80:95]
  ds_read_b64_tr_b16 v[28:29], v6 offset:3072
  ds_read_b64_tr_b16 v[30:31], v6 offset:3584
  v_mfma_f32_32x32x16_bf16 v[80:95], v[36:39], a[140:143], v[80:95]
  ds_read_b64_tr_b16 v[32:33], v6 offset:4096
  ds_read_b64_tr_b16 v[34:35], v6 offset:4608
  s_waitcnt lgkmcnt(4)
  v_mfma_f32_32x32x16_bf16 v[48:63], v[16:19], a[0:3], 0
  ds_read_b64_tr_b16 v[36:37], v6 offset:5120
  ds_read_b64_tr_b16 v[38:39], v6 offset:5632
  v_mfma_f32_32x32x16_bf16 v[48:63], v[20:23], a[4:7], v[48:63]
  ds_read_b64_tr_b16 v[16:17], v6 offset:6144
  ds_read_b64_tr_b16 v[18:19], v6 offset:6656
  s_add_u32 m0, s30, 73728
  v_mfma_f32_32x32x16_bf16 v[48:63], v[24:27], a[8:11], v[48:63]
  ds_read_b64_tr_b16 v[20:21], v6 offset:7168
  ds_read_b64_tr_b16 v[22:23], v6 offset:7680
  buffer_load_dwordx4 v3, s[24:27], 0 offen offset:0 lds
  s_waitcnt lgkmcnt(4)
  v_mfma_f32_32x32x16_bf16 v[48:63], v[28:31], a[12:15], v[48:63]
  ds_read_b64_tr_b16 v[24:25], v6 offset:8192
  ds_read_b64_tr_b16 v[26:27], v6 offset:8704
  v_mfma_f32_32x32x16_bf16 v[48:63], v[32:35], a[16:19], v[48:63]
  ds_read_b64_tr_b16 v[28:29], v6 offset:9216
  ds_read_b64_tr_b16 v[30:31], v6 offset:9728
  v_cvt_pk_bf16_f32 v104, v80, v81
  v_mfma_f32_32x32x16_bf16 v[48:63], v[36:39], a[20:23], v[48:63]
  ds_read_b64_tr_b16 v[32:33], v6 offset:10240
  ds_read_b64_tr_b16 v[34:35], v6 offset:10752
  buffer_load_dwordx4 v3, s[24:27], s41 offen offset:1024 lds
  s_waitcnt lgkmcnt(4)
  v_mfma_f32_32x32x16_bf16 v[48:63], v[16:19], a[24:27], v[48:63]
  ds_read_b64_tr_b16 v[36:37], v6 offset:11264
  ds_read_b64_tr_b16 v[38:39], v6 offset:11776
  v_mfma_f32_32x32x16_bf16 v[48:63], v[20:23], a[28:31], v[48:63]
  ds_read_b64_tr_b16 v[16:17], v6 offset:12288
  ds_read_b64_tr_b16 v[18:19], v6 offset:12800
  v_cvt_pk_bf16_f32 v105, v82, v83
  v_cvt_pk_bf16_f32 v106, v84, v85
  v_mfma_f32_32x32x16_bf16 v[48:63], v[24:27], a[32:35], v[48:63]
  ds_read_b64_tr_b16 v[20:21], v6 offset:13312
  ds_read_b64_tr_b16 v[22:23], v6 offset:13824
  buffer_load_dwordx4 v3, s[24:27], s42 offen offset:2048 lds
  s_waitcnt lgkmcnt(4)
  v_mfma_f32_32x32x16_bf16 v[48:63], v[28:31], a[36:39], v[48:63]
  ds_read_b64_tr_b16 v[24:25], v6 offset:14336
  ds_read_b64_tr_b16 v[26:27], v6 offset:14848
  v_mfma_f32_32x32x16_bf16 v[48:63], v[32:35], a[40:43], v[48:63]
  ds_read_b64_tr_b16 v[28:29], v6 offset:15360
  ds_read_b64_tr_b16 v[30:31], v6 offset:15872
  v_cvt_pk_bf16_f32 v107, v86, v87
  v_mfma_f32_32x32x16_bf16 v[48:63], v[36:39], a[44:47], v[48:63]
  ds_read_b64_tr_b16 v[32:33], v6 offset:16384
  ds_read_b64_tr_b16 v[34:35], v6 offset:16896
  buffer_load_dwordx4 v3, s[24:27], s43 offen offset:3072 lds
  s_waitcnt lgkmcnt(4)
  v_mfma_f32_32x32x16_bf16 v[48:63], v[16:19], a[48:51], v[48:63]
  ds_read_b64_tr_b16 v[36:37], v6 offset:17408
  ds_read_b64_tr_b16 v[38:39], v6 offset:17920
  v_mfma_f32_32x32x16_bf16 v[48:63], v[20:23], a[52:55], v[48:63]
  ds_read_b64_tr_b16 v[16:17], v6 offset:18432
  ds_read_b64_tr_b16 v[18:19], v6 offset:18944
  s_add_u32 m0, s30, 77824
  v_mfma_f32_32x32x16_bf16 v[48:63], v[24:27], a[56:59], v[48:63]
  ds_read_b64_tr_b16 v[20:21], v6 offset:19456
  ds_read_b64_tr_b16 v[22:23], v6 offset:19968
  buffer_load_dwordx4 v3, s[24:27], s44 offen offset:0 lds
  s_waitcnt lgkmcnt(4)
  v_mfma_f32_32x32x16_bf16 v[48:63], v[28:31], a[60:63], v[48:63]
  ds_read_b64_tr_b16 v[24:25], v6 offset:20480
  ds_read_b64_tr_b16 v[26:27], v6 offset:20992
  v_mfma_f32_32x32x16_bf16 v[48:63], v[32:35], a[64:67], v[48:63]
  ds_read_b64_tr_b16 v[28:29], v6 offset:21504
  ds_read_b64_tr_b16 v[30:31], v6 offset:22016
  v_cvt_pk_bf16_f32 v108, v88, v89
  v_mfma_f32_32x32x16_bf16 v[48:63], v[36:39], a[68:71], v[48:63]
  ds_read_b64_tr_b16 v[32:33], v6 offset:22528
  ds_read_b64_tr_b16 v[34:35], v6 offset:23040
  buffer_load_dwordx4 v3, s[24:27], s45 offen offset:1024 lds
  s_waitcnt lgkmcnt(4)
  v_mfma_f32_32x32x16_bf16 v[48:63], v[16:19], a[72:75], v[48:63]
  ds_read_b64_tr_b16 v[36:37], v6 offset:23552
  ds_read_b64_tr_b16 v[38:39], v6 offset:24064
  v_mfma_f32_32x32x16_bf16 v[48:63], v[20:23], a[76:79], v[48:63]
  ds_read_b64_tr_b16 v[16:17], v6 offset:24576
  ds_read_b64_tr_b16 v[18:19], v6 offset:25088
  v_cvt_pk_bf16_f32 v109, v90, v91
  v_cvt_pk_bf16_f32 v110, v92, v93
  v_mfma_f32_32x32x16_bf16 v[48:63], v[24:27], a[80:83], v[48:63]
  ds_read_b64_tr_b16 v[20:21], v6 offset:25600
  ds_read_b64_tr_b16 v[22:23], v6 offset:26112
  buffer_load_dwordx4 v3, s[24:27], s46 offen offset:2048 lds
  s_waitcnt lgkmcnt(4)
  v_mfma_f32_32x32x16_bf16 v[48:63], v[28:31], a[84:87], v[48:63]
  ds_read_b64_tr_b16 v[24:25], v6 offset:26624
  ds_read_b64_tr_b16 v[26:27], v6 offset:27136
  v_mfma_f32_32x32x16_bf16 v[48:63], v[32:35], a[88:91], v[48:63]
  ds_read_b64_tr_b16 v[28:29], v6 offset:27648
  ds_read_b64_tr_b16 v[30:31], v6 offset:28160
  v_cvt_pk_bf16_f32 v111, v94, v95
  v_mfma_f32_32x32x16_bf16 v[48:63], v[36:39], a[92:95], v[48:63]
  ds_read_b64_tr_b16 v[32:33], v6 offset:28672
  ds_read_b64_tr_b16 v[34:35], v6 offset:29184
  buffer_load_dwordx4 v3, s[24:27], s47 offen offset:3072 lds
  s_waitcnt lgkmcnt(4)
  v_mfma_f32_32x32x16_bf16 v[48:63], v[16:19], a[96:99], v[48:63]
  ds_read_b64_tr_b16 v[36:37], v6 offset:29696
  ds_read_b64_tr_b16 v[38:39], v6 offset:30208
  v_mfma_f32_32x32x16_bf16 v[48:63], v[20:23], a[100:103], v[48:63]
  ds_read_b64_tr_b16 v[16:17], v6 offset:30720
  ds_read_b64_tr_b16 v[18:19], v6 offset:31232
  s_add_u32 m0, s30, 81920
  v_mfma_f32_32x32x16_bf16 v[48:63], v[24:27], a[104:107], v[48:63]
  ds_read_b64_tr_b16 v[20:21], v6 offset:31744
  ds_read_b64_tr_b16 v[22:23], v6 offset:32256
  buffer_load_dwordx4 v3, s[24:27], s48 offen offset:0 lds
  s_waitcnt lgkmcnt(4)
  v_mfma_f32_32x32x16_bf16 v[48:63], v[28:31], a[108:111], v[48:63]
  ds_read_b64_tr_b16 v[24:25], v6 offset:32768
  ds_read_b64_tr_b16 v[26:27], v6 offset:33280
  s_add_u32 s38, s49, 12288
  buffer_store_dwordx4 v[104:107], v1, s[52:55], s38 offen sc1
  buffer_store_dwordx4 v[108:111], v1, s[52:55], s38 offen offset:1024 sc1
  v_add_u32 v3, 128, v3
  v_mfma_f32_32x32x16_bf16 v[48:63], v[32:35], a[112:115], v[48:63]
  ds_read_b64_tr_b16 v[28:29], v6 offset:33792
  ds_read_b64_tr_b16 v[30:31], v6 offset:34304
  v_mfma_f32_32x32x16_bf16 v[48:63], v[36:39], a[116:119], v[48:63]
  ds_read_b64_tr_b16 v[32:33], v6 offset:34816
  ds_read_b64_tr_b16 v[34:35], v6 offset:35328
  s_waitcnt lgkmcnt(4)
  v_mfma_f32_32x32x16_bf16 v[48:63], v[16:19], a[120:123], v[48:63]
  ds_read_b64_tr_b16 v[36:37], v6 offset:35840
  ds_read_b64_tr_b16 v[38:39], v6 offset:36352
  v_mfma_f32_32x32x16_bf16 v[48:63], v[20:23], a[124:127], v[48:63]
  s_waitcnt vmcnt(13)
  s_barrier
  v_add_u32 v6, 36864, v5
  ds_read_b64_tr_b16 v[16:17], v6 offset:0
  ds_read_b64_tr_b16 v[18:19], v6 offset:512
  v_mfma_f32_32x32x16_bf16 v[48:63], v[24:27], a[128:131], v[48:63]
  ds_read_b64_tr_b16 v[20:21], v6 offset:1024
  ds_read_b64_tr_b16 v[22:23], v6 offset:1536
  s_waitcnt lgkmcnt(4)
  v_mfma_f32_32x32x16_bf16 v[48:63], v[28:31], a[132:135], v[48:63]
  ds_read_b64_tr_b16 v[24:25], v6 offset:2048
  ds_read_b64_tr_b16 v[26:27], v6 offset:2560
  v_mfma_f32_32x32x16_bf16 v[48:63], v[32:35], a[136:139], v[48:63]
  ds_read_b64_tr_b16 v[28:29], v6 offset:3072
  ds_read_b64_tr_b16 v[30:31], v6 offset:3584
  v_mfma_f32_32x32x16_bf16 v[48:63], v[36:39], a[140:143], v[48:63]
  ds_read_b64_tr_b16 v[32:33], v6 offset:4096
  ds_read_b64_tr_b16 v[34:35], v6 offset:4608
  s_waitcnt lgkmcnt(4)
  v_mfma_f32_32x32x16_bf16 v[80:95], v[16:19], a[0:3], 0
  ds_read_b64_tr_b16 v[36:37], v6 offset:5120
  ds_read_b64_tr_b16 v[38:39], v6 offset:5632
  v_mfma_f32_32x32x16_bf16 v[80:95], v[20:23], a[4:7], v[80:95]
  ds_read_b64_tr_b16 v[16:17], v6 offset:6144
  ds_read_b64_tr_b16 v[18:19], v6 offset:6656
  s_add_u32 m0, s30, 110592
  v_mfma_f32_32x32x16_bf16 v[80:95], v[24:27], a[8:11], v[80:95]
  ds_read_b64_tr_b16 v[20:21], v6 offset:7168
  ds_read_b64_tr_b16 v[22:23], v6 offset:7680
  buffer_load_dwordx4 v3, s[24:27], 0 offen offset:0 lds
  s_waitcnt lgkmcnt(4)
  v_mfma_f32_32x32x16_bf16 v[80:95], v[28:31], a[12:15], v[80:95]
  ds_read_b64_tr_b16 v[24:25], v6 offset:8192
  ds_read_b64_tr_b16 v[26:27], v6 offset:8704
  v_mfma_f32_32x32x16_bf16 v[80:95], v[32:35], a[16:19], v[80:95]
  ds_read_b64_tr_b16 v[28:29], v6 offset:9216
  ds_read_b64_tr_b16 v[30:31], v6 offset:9728
  v_cvt_pk_bf16_f32 v96, v48, v49
  v_mfma_f32_32x32x16_bf16 v[80:95], v[36:39], a[20:23], v[80:95]
  ds_read_b64_tr_b16 v[32:33], v6 offset:10240
  ds_read_b64_tr_b16 v[34:35], v6 offset:10752
  buffer_load_dwordx4 v3, s[24:27], s41 offen offset:1024 lds
  s_waitcnt lgkmcnt(4)
  v_mfma_f32_32x32x16_bf16 v[80:95], v[16:19], a[24:27], v[80:95]
  ds_read_b64_tr_b16 v[36:37], v6 offset:11264
  ds_read_b64_tr_b16 v[38:39], v6 offset:11776
  v_mfma_f32_32x32x16_bf16 v[80:95], v[20:23], a[28:31], v[80:95]
  ds_read_b64_tr_b16 v[16:17], v6 offset:12288
  ds_read_b64_tr_b16 v[18:19], v6 offset:12800
  v_cvt_pk_bf16_f32 v97, v50, v51
  v_cvt_pk_bf16_f32 v98, v52, v53
  v_mfma_f32_32x32x16_bf16 v[80:95], v[24:27], a[32:35], v[80:95]
  ds_read_b64_tr_b16 v[20:21], v6 offset:13312
  ds_read_b64_tr_b16 v[22:23], v6 offset:13824
  buffer_load_dwordx4 v3, s[24:27], s42 offen offset:2048 lds
  s_waitcnt lgkmcnt(4)
  v_mfma_f32_32x32x16_bf16 v[80:95], v[28:31], a[36:39], v[80:95]
  ds_read_b64_tr_b16 v[24:25], v6 offset:14336
  ds_read_b64_tr_b16 v[26:27], v6 offset:14848
  v_mfma_f32_32x32x16_bf16 v[80:95], v[32:35], a[40:43], v[80:95]
  ds_read_b64_tr_b16 v[28:29], v6 offset:15360
  ds_read_b64_tr_b16 v[30:31], v6 offset:15872
  v_cvt_pk_bf16_f32 v99, v54, v55
  v_mfma_f32_32x32x16_bf16 v[80:95], v[36:39], a[44:47], v[80:95]
  ds_read_b64_tr_b16 v[32:33], v6 offset:16384
  ds_read_b64_tr_b16 v[34:35], v6 offset:16896
  buffer_load_dwordx4 v3, s[24:27], s43 offen offset:3072 lds
  s_waitcnt lgkmcnt(4)
  v_mfma_f32_32x32x16_bf16 v[80:95], v[16:19], a[48:51], v[80:95]
  ds_read_b64_tr_b16 v[36:37], v6 offset:17408
  ds_read_b64_tr_b16 v[38:39], v6 offset:17920
  v_mfma_f32_32x32x16_bf16 v[80:95], v[20:23], a[52:55], v[80:95]
  ds_read_b64_tr_b16 v[16:17], v6 offset:18432
  ds_read_b64_tr_b16 v[18:19], v6 offset:18944
  s_add_u32 m0, s30, 114688
  v_mfma_f32_32x32x16_bf16 v[80:95], v[24:27], a[56:59], v[80:95]
  ds_read_b64_tr_b16 v[20:21], v6 offset:19456
  ds_read_b64_tr_b16 v[22:23], v6 offset:19968
  buffer_load_dwordx4 v3, s[24:27], s44 offen offset:0 lds
  s_waitcnt lgkmcnt(4)
  v_mfma_f32_32x32x16_bf16 v[80:95], v[28:31], a[60:63], v[80:95]
  ds_read_b64_tr_b16 v[24:25], v6 offset:20480
  ds_read_b64_tr_b16 v[26:27], v6 offset:20992
  v_mfma_f32_32x32x16_bf16 v[80:95], v[32:35], a[64:67], v[80:95]
  ds_read_b64_tr_b16 v[28:29], v6 offset:21504
  ds_read_b64_tr_b16 v[30:31], v6 offset:22016
  v_cvt_pk_bf16_f32 v100, v56, v57
  v_mfma_f32_32x32x16_bf16 v[80:95], v[36:39], a[68:71], v[80:95]
  ds_read_b64_tr_b16 v[32:33], v6 offset:22528
  ds_read_b64_tr_b16 v[34:35], v6 offset:23040
  buffer_load_dwordx4 v3, s[24:27], s45 offen offset:1024 lds
  s_waitcnt lgkmcnt(4)
  v_mfma_f32_32x32x16_bf16 v[80:95], v[16:19], a[72:75], v[80:95]
  ds_read_b64_tr_b16 v[36:37], v6 offset:23552
  ds_read_b64_tr_b16 v[38:39], v6 offset:24064
  v_mfma_f32_32x32x16_bf16 v[80:95], v[20:23], a[76:79], v[80:95]
  ds_read_b64_tr_b16 v[16:17], v6 offset:24576
  ds_read_b64_tr_b16 v[18:19], v6 offset:25088
  v_cvt_pk_bf16_f32 v101, v58, v59
  v_cvt_pk_bf16_f32 v102, v60, v61
  v_mfma_f32_32x32x16_bf16 v[80:95], v[24:27], a[80:83], v[80:95]
  ds_read_b64_tr_b16 v[20:21], v6 offset:25600
  ds_read_b64_tr_b16 v[22:23], v6 offset:26112
  buffer_load_dwordx4 v3, s[24:27], s46 offen offset:2048 lds
  s_waitcnt lgkmcnt(4)
  v_mfma_f32_32x32x16_bf16 v[80:95], v[28:31], a[84:87], v[80:95]
  ds_read_b64_tr_b16 v[24:25], v6 offset:26624
  ds_read_b64_tr_b16 v[26:27], v6 offset:27136
  v_mfma_f32_32x32x16_bf16 v[80:95], v[32:35], a[88:91], v[80:95]
  ds_read_b64_tr_b16 v[28:29], v6 offset:27648
  ds_read_b64_tr_b16 v[30:31], v6 offset:28160
  v_cvt_pk_bf16_f32 v103, v62, v63
  v_mfma_f32_32x32x16_bf16 v[80:95], v[36:39], a[92:95], v[80:95]
  ds_read_b64_tr_b16 v[32:33], v6 offset:28672
  ds_read_b64_tr_b16 v[34:35], v6 offset:29184
  buffer_load_dwordx4 v3, s[24:27], s47 offen offset:3072 lds
  s_waitcnt lgkmcnt(4)
  v_mfma_f32_32x32x16_bf16 v[80:95], v[16:19], a[96:99], v[80:95]
  ds_read_b64_tr_b16 v[36:37], v6 offset:29696
  ds_read_b64_tr_b16 v[38:39], v6 offset:30208
  v_mfma_f32_32x32x16_bf16 v[80:95], v[20:23], a[100:103], v[80:95]
  ds_read_b64_tr_b16 v[16:17], v6 offset:30720
  ds_read_b64_tr_b16 v[18:19], v6 offset:31232
  s_add_u32 m0, s30, 118784
  v_mfma_f32_32x32x16_bf16 v[80:95], v[24:27], a[104:107], v[80:95]
  ds_read_b64_tr_b16 v[20:21], v6 offset:31744
  ds_read_b64_tr_b16 v[22:23], v6 offset:32256
  buffer_load_dwordx4 v3, s[24:27], s48 offen offset:0 lds
  s_waitcnt lgkmcnt(4)
  v_mfma_f32_32x32x16_bf16 v[80:95], v[28:31], a[108:111], v[80:95]
  ds_read_b64_tr_b16 v[24:25], v6 offset:32768
  ds_read_b64_tr_b16 v[26:27], v6 offset:33280
  s_add_u32 s38, s49, 16384
  buffer_store_dwordx4 v[96:99], v1, s[52:55], s38 offen sc1
  buffer_store_dwordx4 v[100:103], v1, s[52:55], s38 offen offset:1024 sc1
  v_add_u32 v3, 128, v3
  v_mfma_f32_32x32x16_bf16 v[80:95], v[32:35], a[112:115], v[80:95]
  ds_read_b64_tr_b16 v[28:29], v6 offset:33792
  ds_read_b64_tr_b16 v[30:31], v6 offset:34304
  v_mfma_f32_32x32x16_bf16 v[80:95], v[36:39], a[116:119], v[80:95]
  ds_read_b64_tr_b16 v[32:33], v6 offset:34816
  ds_read_b64_tr_b16 v[34:35], v6 offset:35328
  s_waitcnt lgkmcnt(4)
  v_mfma_f32_32x32x16_bf16 v[80:95], v[16:19], a[120:123], v[80:95]
  ds_read_b64_tr_b16 v[36:37], v6 offset:35840
  ds_read_b64_tr_b16 v[38:39], v6 offset:36352
  v_mfma_f32_32x32x16_bf16 v[80:95], v[20:23], a[124:127], v[80:95]
  s_waitcnt vmcnt(13)
  s_barrier
  v_add_u32 v6, 73728, v5
  ds_read_b64_tr_b16 v[16:17], v6 offset:0
  ds_read_b64_tr_b16 v[18:19], v6 offset:512
  v_mfma_f32_32x32x16_bf16 v[80:95], v[24:27], a[128:131], v[80:95]
  ds_read_b64_tr_b16 v[20:21], v6 offset:1024
  ds_read_b64_tr_b16 v[22:23], v6 offset:1536
  s_waitcnt lgkmcnt(4)
  v_mfma_f32_32x32x16_bf16 v[80:95], v[28:31], a[132:135], v[80:95]
  ds_read_b64_tr_b16 v[24:25], v6 offset:2048
  ds_read_b64_tr_b16 v[26:27], v6 offset:2560
  v_mfma_f32_32x32x16_bf16 v[80:95], v[32:35], a[136:139], v[80:95]
  ds_read_b64_tr_b16 v[28:29], v6 offset:3072
  ds_read_b64_tr_b16 v[30:31], v6 offset:3584
  v_mfma_f32_32x32x16_bf16 v[80:95], v[36:39], a[140:143], v[80:95]
  ds_read_b64_tr_b16 v[32:33], v6 offset:4096
  ds_read_b64_tr_b16 v[34:35], v6 offset:4608
  s_waitcnt lgkmcnt(4)
  v_mfma_f32_32x32x16_bf16 v[48:63], v[16:19], a[0:3], 0
  ds_read_b64_tr_b16 v[36:37], v6 offset:5120
  ds_read_b64_tr_b16 v[38:39], v6 offset:5632
  v_mfma_f32_32x32x16_bf16 v[48:63], v[20:23], a[4:7], v[48:63]
  ds_read_b64_tr_b16 v[16:17], v6 offset:6144
  ds_read_b64_tr_b16 v[18:19], v6 offset:6656
  s_add_u32 m0, s30, 0
  v_mfma_f32_32x32x16_bf16 v[48:63], v[24:27], a[8:11], v[48:63]
  ds_read_b64_tr_b16 v[20:21], v6 offset:7168
  ds_read_b64_tr_b16 v[22:23], v6 offset:7680
  buffer_load_dwordx4 v3, s[24:27], 0 offen offset:0 lds
  s_waitcnt lgkmcnt(4)
  v_mfma_f32_32x32x16_bf16 v[48:63], v[28:31], a[12:15], v[48:63]
  ds_read_b64_tr_b16 v[24:25], v6 offset:8192
  ds_read_b64_tr_b16 v[26:27], v6 offset:8704
  v_mfma_f32_32x32x16_bf16 v[48:63], v[32:35], a[16:19], v[48:63]
  ds_read_b64_tr_b16 v[28:29], v6 offset:9216
  ds_read_b64_tr_b16 v[30:31], v6 offset:9728
  v_cvt_pk_bf16_f32 v104, v80, v81
  v_mfma_f32_32x32x16_bf16 v[48:63], v[36:39], a[20:23], v[48:63]
  ds_read_b64_tr_b16 v[32:33], v6 offset:10240
  ds_read_b64_tr_b16 v[34:35], v6 offset:10752
  buffer_load_dwordx4 v3, s[24:27], s41 offen offset:1024 lds
  s_waitcnt lgkmcnt(4)
  v_mfma_f32_32x32x16_bf16 v[48:63], v[16:19], a[24:27], v[48:63]
  ds_read_b64_tr_b16 v[36:37], v6 offset:11264
  ds_read_b64_tr_b16 v[38:39], v6 offset:11776
  v_mfma_f32_32x32x16_bf16 v[48:63], v[20:23], a[28:31], v[48:63]
  ds_read_b64_tr_b16 v[16:17], v6 offset:12288
  ds_read_b64_tr_b16 v[18:19], v6 offset:12800
  v_cvt_pk_bf16_f32 v105, v82, v83
  v_cvt_pk_bf16_f32 v106, v84, v85
  v_mfma_f32_32x32x16_bf16 v[48:63], v[24:27], a[32:35], v[48:63]
  ds_read_b64_tr_b16 v[20:21], v6 offset:13312
  ds_read_b64_tr_b16 v[22:23], v6 offset:13824
  buffer_load_dwordx4 v3, s[24:27], s42 offen offset:2048 lds
  s_waitcnt lgkmcnt(4)
  v_mfma_f32_32x32x16_bf16 v[48:63], v[28:31], a[36:39], v[48:63]
  ds_read_b64_tr_b16 v[24:25], v6 offset:14336
  ds_read_b64_tr_b16 v[26:27], v6 offset:14848
  v_mfma_f32_32x32x16_bf16 v[48:63], v[32:35], a[40:43], v[48:63]
  ds_read_b64_tr_b16 v[28:29], v6 offset:15360
  ds_read_b64_tr_b16 v[30:31], v6 offset:15872
  v_cvt_pk_bf16_f32 v107, v86, v87
  v_mfma_f32_32x32x16_bf16 v[48:63], v[36:39], a[44:47], v[48:63]
  ds_read_b64_tr_b16 v[32:33], v6 offset:16384
  ds_read_b64_tr_b16 v[34:35], v6 offset:16896
  buffer_load_dwordx4 v3, s[24:27], s43 offen offset:3072 lds
  s_waitcnt lgkmcnt(4)
  v_mfma_f32_32x32x16_bf16 v[48:63], v[16:19], a[48:51], v[48:63]
  ds_read_b64_tr_b16 v[36:37], v6 offset:17408
  ds_read_b64_tr_b16 v[38:39], v6 offset:17920
  v_mfma_f32_32x32x16_bf16 v[48:63], v[20:23], a[52:55], v[48:63]
  ds_read_b64_tr_b16 v[16:17], v6 offset:18432
  ds_read_b64_tr_b16 v[18:19], v6 offset:18944
  s_add_u32 m0, s30, 4096
  v_mfma_f32_32x32x16_bf16 v[48:63], v[24:27], a[56:59], v[48:63]
  ds_read_b64_tr_b16 v[20:21], v6 offset:19456
  ds_read_b64_tr_b16 v[22:23], v6 offset:19968
  buffer_load_dwordx4 v3, s[24:27], s44 offen offset:0 lds
  s_waitcnt lgkmcnt(4)
  v_mfma_f32_32x32x16_bf16 v[48:63], v[28:31], a[60:63], v[48:63]
  ds_read_b64_tr_b16 v[24:25], v6 offset:20480
  ds_read_b64_tr_b16 v[26:27], v6 offset:20992
  v_mfma_f32_32x32x16_bf16 v[48:63], v[32:35], a[64:67], v[48:63]
  ds_read_b64_tr_b16 v[28:29], v6 offset:21504
  ds_read_b64_tr_b16 v[30:31], v6 offset:22016
  v_cvt_pk_bf16_f32 v108, v88, v89
  v_mfma_f32_32x32x16_bf16 v[48:63], v[36:39], a[68:71], v[48:63]
  ds_read_b64_tr_b16 v[32:33], v6 offset:22528
  ds_read_b64_tr_b16 v[34:35], v6 offset:23040
  buffer_load_dwordx4 v3, s[24:27], s45 offen offset:1024 lds
  s_waitcnt lgkmcnt(4)
  v_mfma_f32_32x32x16_bf16 v[48:63], v[16:19], a[72:75], v[48:63]
  ds_read_b64_tr_b16 v[36:37], v6 offset:23552
  ds_read_b64_tr_b16 v[38:39], v6 offset:24064
  v_mfma_f32_32x32x16_bf16 v[48:63], v[20:23], a[76:79], v[48:63]
  ds_read_b64_tr_b16 v[16:17], v6 offset:24576
  ds_read_b64_tr_b16 v[18:19], v6 offset:25088
  v_cvt_pk_bf16_f32 v109, v90, v91
  v_cvt_pk_bf16_f32 v110, v92, v93
  v_mfma_f32_32x32x16_bf16 v[48:63], v[24:27], a[80:83], v[48:63]
  ds_read_b64_tr_b16 v[20:21], v6 offset:25600
  ds_read_b64_tr_b16 v[22:23], v6 offset:26112
  buffer_load_dwordx4 v3, s[24:27], s46 offen offset:2048 lds
  s_waitcnt lgkmcnt(4)
  v_mfma_f32_32x32x16_bf16 v[48:63], v[28:31], a[84:87], v[48:63]
  ds_read_b64_tr_b16 v[24:25], v6 offset:26624
  ds_read_b64_tr_b16 v[26:27], v6 offset:27136
  v_mfma_f32_32x32x16_bf16 v[48:63], v[32:35], a[88:91], v[48:63]
  ds_read_b64_tr_b16 v[28:29], v6 offset:27648
  ds_read_b64_tr_b16 v[30:31], v6 offset:28160
  v_cvt_pk_bf16_f32 v111, v94, v95
  v_mfma_f32_32x32x16_bf16 v[48:63], v[36:39], a[92:95], v[48:63]
  ds_read_b64_tr_b16 v[32:33], v6 offset:28672
  ds_read_b64_tr_b16 v[34:35], v6 offset:29184
  buffer_load_dwordx4 v3, s[24:27], s47 offen offset:3072 lds
  s_waitcnt lgkmcnt(4)
  v_mfma_f32_32x32x16_bf16 v[48:63], v[16:19], a[96:99], v[48:63]
  ds_read_b64_tr_b16 v[36:37], v6 offset:29696
  ds_read_b64_tr_b16 v[38:39], v6 offset:30208
  v_mfma_f32_32x32x16_bf16 v[48:63], v[20:23], a[100:103], v[48:63]
  ds_read_b64_tr_b16 v[16:17], v6 offset:30720
  ds_read_b64_tr_b16 v[18:19], v6 offset:31232
  s_add_u32 m0, s30, 8192
  v_mfma_f32_32x32x16_bf16 v[48:63], v[24:27], a[104:107], v[48:63]
  ds_read_b64_tr_b16 v[20:21], v6 offset:31744
  ds_read_b64_tr_b16 v[22:23], v6 offset:32256
  buffer_load_dwordx4 v3, s[24:27], s48 offen offset:0 lds
  s_waitcnt lgkmcnt(4)
  v_mfma_f32_32x32x16_bf16 v[48:63], v[28:31], a[108:111], v[48:63]
  ds_read_b64_tr_b16 v[24:25], v6 offset:32768
  ds_read_b64_tr_b16 v[26:27], v6 offset:33280
  s_add_u32 s38, s49, 20480
  buffer_store_dwordx4 v[104:107], v1, s[52:55], s38 offen sc1
  buffer_store_dwordx4 v[108:111], v1, s[52:55], s38 offen offset:1024 sc1
  v_add_u32 v3, -960, v3
  v_mfma_f32_32x32x16_bf16 v[48:63], v[32:35], a[112:115], v[48:63]
  ds_read_b64_tr_b16 v[28:29], v6 offset:33792
  ds_read_b64_tr_b16 v[30:31], v6 offset:34304
  v_mfma_f32_32x32x16_bf16 v[48:63], v[36:39], a[116:119], v[48:63]
  ds_read_b64_tr_b16 v[32:33], v6 offset:34816
  ds_read_b64_tr_b16 v[34:35], v6 offset:35328
  s_waitcnt lgkmcnt(4)
  v_mfma_f32_32x32x16_bf16 v[48:63], v[16:19], a[120:123], v[48:63]
  ds_read_b64_tr_b16 v[36:37], v6 offset:35840
  ds_read_b64_tr_b16 v[38:39], v6 offset:36352
  v_mfma_f32_32x32x16_bf16 v[48:63], v[20:23], a[124:127], v[48:63]
  s_waitcnt vmcnt(13)
  s_barrier
  v_add_u32 v6, 110592, v5
  ds_read_b64_tr_b16 v[16:17], v6 offset:0
  ds_read_b64_tr_b16 v[18:19], v6 offset:512
  v_mfma_f32_32x32x16_bf16 v[48:63], v[24:27], a[128:131], v[48:63]
  ds_read_b64_tr_b16 v[20:21], v6 offset:1024
  ds_read_b64_tr_b16 v[22:23], v6 offset:1536
  s_waitcnt lgkmcnt(4)
  v_mfma_f32_32x32x16_bf16 v[48:63], v[28:31], a[132:135], v[48:63]
  ds_read_b64_tr_b16 v[24:25], v6 offset:2048
  ds_read_b64_tr_b16 v[26:27], v6 offset:2560
  v_mfma_f32_32x32x16_bf16 v[48:63], v[32:35], a[136:139], v[48:63]
  ds_read_b64_tr_b16 v[28:29], v6 offset:3072
  ds_read_b64_tr_b16 v[30:31], v6 offset:3584
  v_mfma_f32_32x32x16_bf16 v[48:63], v[36:39], a[140:143], v[48:63]
  ds_read_b64_tr_b16 v[32:33], v6 offset:4096
  ds_read_b64_tr_b16 v[34:35], v6 offset:4608
  s_waitcnt lgkmcnt(4)
  v_mfma_f32_32x32x16_bf16 v[80:95], v[16:19], a[0:3], 0
  ds_read_b64_tr_b16 v[36:37], v6 offset:5120
  ds_read_b64_tr_b16 v[38:39], v6 offset:5632
  v_mfma_f32_32x32x16_bf16 v[80:95], v[20:23], a[4:7], v[80:95]
  ds_read_b64_tr_b16 v[16:17], v6 offset:6144
  ds_read_b64_tr_b16 v[18:19], v6 offset:6656
  s_add_u32 m0, s30, 36864
  v_mfma_f32_32x32x16_bf16 v[80:95], v[24:27], a[8:11], v[80:95]
  ds_read_b64_tr_b16 v[20:21], v6 offset:7168
  ds_read_b64_tr_b16 v[22:23], v6 offset:7680
  buffer_load_dwordx4 v3, s[24:27], 0 offen offset:0 lds
  s_waitcnt lgkmcnt(4)
  v_mfma_f32_32x32x16_bf16 v[80:95], v[28:31], a[12:15], v[80:95]
  ds_read_b64_tr_b16 v[24:25], v6 offset:8192
  ds_read_b64_tr_b16 v[26:27], v6 offset:8704
  v_mfma_f32_32x32x16_bf16 v[80:95], v[32:35], a[16:19], v[80:95]
  ds_read_b64_tr_b16 v[28:29], v6 offset:9216
  ds_read_b64_tr_b16 v[30:31], v6 offset:9728
  v_cvt_pk_bf16_f32 v96, v48, v49
  v_mfma_f32_32x32x16_bf16 v[80:95], v[36:39], a[20:23], v[80:95]
  ds_read_b64_tr_b16 v[32:33], v6 offset:10240
  ds_read_b64_tr_b16 v[34:35], v6 offset:10752
  buffer_load_dwordx4 v3, s[24:27], s41 offen offset:1024 lds
  s_waitcnt lgkmcnt(4)
  v_mfma_f32_32x32x16_bf16 v[80:95], v[16:19], a[24:27], v[80:95]
  ds_read_b64_tr_b16 v[36:37], v6 offset:11264
  ds_read_b64_tr_b16 v[38:39], v6 offset:11776
  v_mfma_f32_32x32x16_bf16 v[80:95], v[20:23], a[28:31], v[80:95]
  ds_read_b64_tr_b16 v[16:17], v6 offset:12288
  ds_read_b64_tr_b16 v[18:19], v6 offset:12800
  v_cvt_pk_bf16_f32 v97, v50, v51
  v_cvt_pk_bf16_f32 v98, v52, v53
  v_mfma_f32_32x32x16_bf16 v[80:95], v[24:27], a[32:35], v[80:95]
  ds_read_b64_tr_b16 v[20:21], v6 offset:13312
  ds_read_b64_tr_b16 v[22:23], v6 offset:13824
  buffer_load_dwordx4 v3, s[24:27], s42 offen offset:2048 lds
  s_waitcnt lgkmcnt(4)
  v_mfma_f32_32x32x16_bf16 v[80:95], v[28:31], a[36:39], v[80:95]
  ds_read_b64_tr_b16 v[24:25], v6 offset:14336
  ds_read_b64_tr_b16 v[26:27], v6 offset:14848
  v_mfma_f32_32x32x16_bf16 v[80:95], v[32:35], a[40:43], v[80:95]
  ds_read_b64_tr_b16 v[28:29], v6 offset:15360
  ds_read_b64_tr_b16 v[30:31], v6 offset:15872
  v_cvt_pk_bf16_f32 v99, v54, v55
  v_mfma_f32_32x32x16_bf16 v[80:95], v[36:39], a[44:47], v[80:95]
  ds_read_b64_tr_b16 v[32:33], v6 offset:16384
  ds_read_b64_tr_b16 v[34:35], v6 offset:16896
  buffer_load_dwordx4 v3, s[24:27], s43 offen offset:3072 lds
  s_waitcnt lgkmcnt(4)
  v_mfma_f32_32x32x16_bf16 v[80:95], v[16:19], a[48:51], v[80:95]
  ds_read_b64_tr_b16 v[36:37], v6 offset:17408
  ds_read_b64_tr_b16 v[38:39], v6 offset:17920
  v_mfma_f32_32x32x16_bf16 v[80:95], v[20:23], a[52:55], v[80:95]
  ds_read_b64_tr_b16 v[16:17], v6 offset:18432
  ds_read_b64_tr_b16 v[18:19], v6 offset:18944
  s_add_u32 m0, s30, 40960
  v_mfma_f32_32x32x16_bf16 v[80:95], v[24:27], a[56:59], v[80:95]
  ds_read_b64_tr_b16 v[20:21], v6 offset:19456
  ds_read_b64_tr_b16 v[22:23], v6 offset:19968
  buffer_load_dwordx4 v3, s[24:27], s44 offen offset:0 lds
  s_waitcnt lgkmcnt(4)
  v_mfma_f32_32x32x16_bf16 v[80:95], v[28:31], a[60:63], v[80:95]
  ds_read_b64_tr_b16 v[24:25], v6 offset:20480
  ds_read_b64_tr_b16 v[26:27], v6 offset:20992
  v_mfma_f32_32x32x16_bf16 v[80:95], v[32:35], a[64:67], v[80:95]
  ds_read_b64_tr_b16 v[28:29], v6 offset:21504
  ds_read_b64_tr_b16 v[30:31], v6 offset:22016
  v_cvt_pk_bf16_f32 v100, v56, v57
  v_mfma_f32_32x32x16_bf16 v[80:95], v[36:39], a[68:71], v[80:95]
  ds_read_b64_tr_b16 v[32:33], v6 offset:22528
  ds_read_b64_tr_b16 v[34:35], v6 offset:23040
  buffer_load_dwordx4 v3, s[24:27], s45 offen offset:1024 lds
  s_waitcnt lgkmcnt(4)
  v_mfma_f32_32x32x16_bf16 v[80:95], v[16:19], a[72:75], v[80:95]
  ds_read_b64_tr_b16 v[36:37], v6 offset:23552
  ds_read_b64_tr_b16 v[38:39], v6 offset:24064
  v_mfma_f32_32x32x16_bf16 v[80:95], v[20:23], a[76:79], v[80:95]
  ds_read_b64_tr_b16 v[16:17], v6 offset:24576
  ds_read_b64_tr_b16 v[18:19], v6 offset:25088
  v_cvt_pk_bf16_f32 v101, v58, v59
  v_cvt_pk_bf16_f32 v102, v60, v61
  v_mfma_f32_32x32x16_bf16 v[80:95], v[24:27], a[80:83], v[80:95]
  ds_read_b64_tr_b16 v[20:21], v6 offset:25600
  ds_read_b64_tr_b16 v[22:23], v6 offset:26112
  buffer_load_dwordx4 v3, s[24:27], s46 offen offset:2048 lds
  s_waitcnt lgkmcnt(4)
  v_mfma_f32_32x32x16_bf16 v[80:95], v[28:31], a[84:87], v[80:95]
  ds_read_b64_tr_b16 v[24:25], v6 offset:26624
  ds_read_b64_tr_b16 v[26:27], v6 offset:27136
  v_mfma_f32_32x32x16_bf16 v[80:95], v[32:35], a[88:91], v[80:95]
  ds_read_b64_tr_b16 v[28:29], v6 offset:27648
  ds_read_b64_tr_b16 v[30:31], v6 offset:28160
  v_cvt_pk_bf16_f32 v103, v62, v63
  v_mfma_f32_32x32x16_bf16 v[80:95], v[36:39], a[92:95], v[80:95]
  ds_read_b64_tr_b16 v[32:33], v6 offset:28672
  ds_read_b64_tr_b16 v[34:35], v6 offset:29184
  buffer_load_dwordx4 v3, s[24:27], s47 offen offset:3072 lds
  s_waitcnt lgkmcnt(4)
  v_mfma_f32_32x32x16_bf16 v[80:95], v[16:19], a[96:99], v[80:95]
  ds_read_b64_tr_b16 v[36:37], v6 offset:29696
  ds_read_b64_tr_b16 v[38:39], v6 offset:30208
  v_mfma_f32_32x32x16_bf16 v[80:95], v[20:23], a[100:103], v[80:95]
  ds_read_b64_tr_b16 v[16:17], v6 offset:30720
  ds_read_b64_tr_b16 v[18:19], v6 offset:31232
  s_add_u32 m0, s30, 45056
  v_mfma_f32_32x32x16_bf16 v[80:95], v[24:27], a[104:107], v[80:95]
  ds_read_b64_tr_b16 v[20:21], v6 offset:31744
  ds_read_b64_tr_b16 v[22:23], v6 offset:32256
  buffer_load_dwordx4 v3, s[24:27], s48 offen offset:0 lds
  s_waitcnt lgkmcnt(4)
  v_mfma_f32_32x32x16_bf16 v[80:95], v[28:31], a[108:111], v[80:95]
  ds_read_b64_tr_b16 v[24:25], v6 offset:32768
  ds_read_b64_tr_b16 v[26:27], v6 offset:33280
  s_add_u32 s38, s49, 24576
  buffer_store_dwordx4 v[96:99], v1, s[52:55], s38 offen sc1
  buffer_store_dwordx4 v[100:103], v1, s[52:55], s38 offen offset:1024 sc1
  v_add_u32 v3, 128, v3
  v_mfma_f32_32x32x16_bf16 v[80:95], v[32:35], a[112:115], v[80:95]
  ds_read_b64_tr_b16 v[28:29], v6 offset:33792
  ds_read_b64_tr_b16 v[30:31], v6 offset:34304
  v_mfma_f32_32x32x16_bf16 v[80:95], v[36:39], a[116:119], v[80:95]
  ds_read_b64_tr_b16 v[32:33], v6 offset:34816
  ds_read_b64_tr_b16 v[34:35], v6 offset:35328
  s_waitcnt lgkmcnt(4)
  v_mfma_f32_32x32x16_bf16 v[80:95], v[16:19], a[120:123], v[80:95]
  ds_read_b64_tr_b16 v[36:37], v6 offset:35840
  ds_read_b64_tr_b16 v[38:39], v6 offset:36352
  v_mfma_f32_32x32x16_bf16 v[80:95], v[20:23], a[124:127], v[80:95]
  s_waitcnt vmcnt(13)
  s_barrier
  v_add_u32 v6, 0, v5
  ds_read_b64_tr_b16 v[16:17], v6 offset:0
  ds_read_b64_tr_b16 v[18:19], v6 offset:512
  v_mfma_f32_32x32x16_bf16 v[80:95], v[24:27], a[128:131], v[80:95]
  ds_read_b64_tr_b16 v[20:21], v6 offset:1024
  ds_read_b64_tr_b16 v[22:23], v6 offset:1536
  s_waitcnt lgkmcnt(4)
  v_mfma_f32_32x32x16_bf16 v[80:95], v[28:31], a[132:135], v[80:95]
  ds_read_b64_tr_b16 v[24:25], v6 offset:2048
  ds_read_b64_tr_b16 v[26:27], v6 offset:2560
  v_mfma_f32_32x32x16_bf16 v[80:95], v[32:35], a[136:139], v[80:95]
  ds_read_b64_tr_b16 v[28:29], v6 offset:3072
  ds_read_b64_tr_b16 v[30:31], v6 offset:3584
  v_mfma_f32_32x32x16_bf16 v[80:95], v[36:39], a[140:143], v[80:95]
  ds_read_b64_tr_b16 v[32:33], v6 offset:4096
  ds_read_b64_tr_b16 v[34:35], v6 offset:4608
  s_waitcnt lgkmcnt(4)
  v_mfma_f32_32x32x16_bf16 v[48:63], v[16:19], a[0:3], 0
  ds_read_b64_tr_b16 v[36:37], v6 offset:5120
  ds_read_b64_tr_b16 v[38:39], v6 offset:5632
  v_mfma_f32_32x32x16_bf16 v[48:63], v[20:23], a[4:7], v[48:63]
  ds_read_b64_tr_b16 v[16:17], v6 offset:6144
  ds_read_b64_tr_b16 v[18:19], v6 offset:6656
  s_add_u32 m0, s30, 73728
  v_mfma_f32_32x32x16_bf16 v[48:63], v[24:27], a[8:11], v[48:63]
  ds_read_b64_tr_b16 v[20:21], v6 offset:7168
  ds_read_b64_tr_b16 v[22:23], v6 offset:7680
  buffer_load_dwordx4 v3, s[24:27], 0 offen offset:0 lds
  s_waitcnt lgkmcnt(4)
  v_mfma_f32_32x32x16_bf16 v[48:63], v[28:31], a[12:15], v[48:63]
  ds_read_b64_tr_b16 v[24:25], v6 offset:8192
  ds_read_b64_tr_b16 v[26:27], v6 offset:8704
  v_mfma_f32_32x32x16_bf16 v[48:63], v[32:35], a[16:19], v[48:63]
  ds_read_b64_tr_b16 v[28:29], v6 offset:9216
  ds_read_b64_tr_b16 v[30:31], v6 offset:9728
  v_cvt_pk_bf16_f32 v104, v80, v81
  v_mfma_f32_32x32x16_bf16 v[48:63], v[36:39], a[20:23], v[48:63]
  ds_read_b64_tr_b16 v[32:33], v6 offset:10240
  ds_read_b64_tr_b16 v[34:35], v6 offset:10752
  buffer_load_dwordx4 v3, s[24:27], s41 offen offset:1024 lds
  s_waitcnt lgkmcnt(4)
  v_mfma_f32_32x32x16_bf16 v[48:63], v[16:19], a[24:27], v[48:63]
  ds_read_b64_tr_b16 v[36:37], v6 offset:11264
  ds_read_b64_tr_b16 v[38:39], v6 offset:11776
  v_mfma_f32_32x32x16_bf16 v[48:63], v[20:23], a[28:31], v[48:63]
  ds_read_b64_tr_b16 v[16:17], v6 offset:12288
  ds_read_b64_tr_b16 v[18:19], v6 offset:12800
  v_cvt_pk_bf16_f32 v105, v82, v83
  v_cvt_pk_bf16_f32 v106, v84, v85
  v_mfma_f32_32x32x16_bf16 v[48:63], v[24:27], a[32:35], v[48:63]
  ds_read_b64_tr_b16 v[20:21], v6 offset:13312
  ds_read_b64_tr_b16 v[22:23], v6 offset:13824
  buffer_load_dwordx4 v3, s[24:27], s42 offen offset:2048 lds
  s_waitcnt lgkmcnt(4)
  v_mfma_f32_32x32x16_bf16 v[48:63], v[28:31], a[36:39], v[48:63]
  ds_read_b64_tr_b16 v[24:25], v6 offset:14336
  ds_read_b64_tr_b16 v[26:27], v6 offset:14848
  v_mfma_f32_32x32x16_bf16 v[48:63], v[32:35], a[40:43], v[48:63]
  ds_read_b64_tr_b16 v[28:29], v6 offset:15360
  ds_read_b64_tr_b16 v[30:31], v6 offset:15872
  v_cvt_pk_bf16_f32 v107, v86, v87
  v_mfma_f32_32x32x16_bf16 v[48:63], v[36:39], a[44:47], v[48:63]
  ds_read_b64_tr_b16 v[32:33], v6 offset:16384
  ds_read_b64_tr_b16 v[34:35], v6 offset:16896
  buffer_load_dwordx4 v3, s[24:27], s43 offen offset:3072 lds
  s_waitcnt lgkmcnt(4)
  v_mfma_f32_32x32x16_bf16 v[48:63], v[16:19], a[48:51], v[48:63]
  ds_read_b64_tr_b16 v[36:37], v6 offset:17408
  ds_read_b64_tr_b16 v[38:39], v6 offset:17920
  v_mfma_f32_32x32x16_bf16 v[48:63], v[20:23], a[52:55], v[48:63]
  ds_read_b64_tr_b16 v[16:17], v6 offset:18432
  ds_read_b64_tr_b16 v[18:19], v6 offset:18944
  s_add_u32 m0, s30, 77824
  v_mfma_f32_32x32x16_bf16 v[48:63], v[24:27], a[56:59], v[48:63]
  ds_read_b64_tr_b16 v[20:21], v6 offset:19456
  ds_read_b64_tr_b16 v[22:23], v6 offset:19968
  buffer_load_dwordx4 v3, s[24:27], s44 offen offset:0 lds
  s_waitcnt lgkmcnt(4)
  v_mfma_f32_32x32x16_bf16 v[48:63], v[28:31], a[60:63], v[48:63]
  ds_read_b64_tr_b16 v[24:25], v6 offset:20480
  ds_read_b64_tr_b16 v[26:27], v6 offset:20992
  v_mfma_f32_32x32x16_bf16 v[48:63], v[32:35], a[64:67], v[48:63]
  ds_read_b64_tr_b16 v[28:29], v6 offset:21504
  ds_read_b64_tr_b16 v[30:31], v6 offset:22016
  v_cvt_pk_bf16_f32 v108, v88, v89
  v_mfma_f32_32x32x16_bf16 v[48:63], v[36:39], a[68:71], v[48:63]
  ds_read_b64_tr_b16 v[32:33], v6 offset:22528
  ds_read_b64_tr_b16 v[34:35], v6 offset:23040
  buffer_load_dwordx4 v3, s[24:27], s45 offen offset:1024 lds
  s_waitcnt lgkmcnt(4)
  v_mfma_f32_32x32x16_bf16 v[48:63], v[16:19], a[72:75], v[48:63]
  ds_read_b64_tr_b16 v[36:37], v6 offset:23552
  ds_read_b64_tr_b16 v[38:39], v6 offset:24064
  v_mfma_f32_32x32x16_bf16 v[48:63], v[20:23], a[76:79], v[48:63]
  ds_read_b64_tr_b16 v[16:17], v6 offset:24576
  ds_read_b64_tr_b16 v[18:19], v6 offset:25088
  v_cvt_pk_bf16_f32 v109, v90, v91
  v_cvt_pk_bf16_f32 v110, v92, v93
  v_mfma_f32_32x32x16_bf16 v[48:63], v[24:27], a[80:83], v[48:63]
  ds_read_b64_tr_b16 v[20:21], v6 offset:25600
  ds_read_b64_tr_b16 v[22:23], v6 offset:26112
  buffer_load_dwordx4 v3, s[24:27], s46 offen offset:2048 lds
  s_waitcnt lgkmcnt(4)
  v_mfma_f32_32x32x16_bf16 v[48:63], v[28:31], a[84:87], v[48:63]
  ds_read_b64_tr_b16 v[24:25], v6 offset:26624
  ds_read_b64_tr_b16 v[26:27], v6 offset:27136
  v_mfma_f32_32x32x16_bf16 v[48:63], v[32:35], a[88:91], v[48:63]
  ds_read_b64_tr_b16 v[28:29], v6 offset:27648
  ds_read_b64_tr_b16 v[30:31], v6 offset:28160
  v_cvt_pk_bf16_f32 v111, v94, v95
  v_mfma_f32_32x32x16_bf16 v[48:63], v[36:39], a[92:95], v[48:63]
  ds_read_b64_tr_b16 v[32:33], v6 offset:28672
  ds_read_b64_tr_b16 v[34:35], v6 offset:29184
  buffer_load_dwordx4 v3, s[24:27], s47 offen offset:3072 lds
  s_waitcnt lgkmcnt(4)
  v_mfma_f32_32x32x16_bf16 v[48:63], v[16:19], a[96:99], v[48:63]
  ds_read_b64_tr_b16 v[36:37], v6 offset:29696
  ds_read_b64_tr_b16 v[38:39], v6 offset:30208
  v_mfma_f32_32x32x16_bf16 v[48:63], v[20:23], a[100:103], v[48:63]
  ds_read_b64_tr_b16 v[16:17], v6 offset:30720
  ds_read_b64_tr_b16 v[18:19], v6 offset:31232
  s_add_u32 m0, s30, 81920
  v_mfma_f32_32x32x16_bf16 v[48:63], v[24:27], a[104:107], v[48:63]
  ds_read_b64_tr_b16 v[20:21], v6 offset:31744
  ds_read_b64_tr_b16 v[22:23], v6 offset:32256
  buffer_load_dwordx4 v3, s[24:27], s48 offen offset:0 lds
  s_waitcnt lgkmcnt(4)
  v_mfma_f32_32x32x16_bf16 v[48:63], v[28:31], a[108:111], v[48:63]
  ds_read_b64_tr_b16 v[24:25], v6 offset:32768
  ds_read_b64_tr_b16 v[26:27], v6 offset:33280
  s_add_u32 s38, s49, 28672
  buffer_store_dwordx4 v[104:107], v1, s[52:55], s38 offen sc1
  buffer_store_dwordx4 v[108:111], v1, s[52:55], s38 offen offset:1024 sc1
  v_add_u32 v3, 128, v3
  v_mfma_f32_32x32x16_bf16 v[48:63], v[32:35], a[112:115], v[48:63]
  ds_read_b64_tr_b16 v[28:29], v6 offset:33792
  ds_read_b64_tr_b16 v[30:31], v6 offset:34304
  buffer_load_dword v14, off, s[96:99], 0
  v_mfma_f32_32x32x16_bf16 v[48:63], v[36:39], a[116:119], v[48:63]
  ds_read_b64_tr_b16 v[32:33], v6 offset:34816
  ds_read_b64_tr_b16 v[34:35], v6 offset:35328
  s_waitcnt lgkmcnt(4)
  v_mfma_f32_32x32x16_bf16 v[48:63], v[16:19], a[120:123], v[48:63]
  ds_read_b64_tr_b16 v[36:37], v6 offset:35840
  ds_read_b64_tr_b16 v[38:39], v6 offset:36352
  v_mfma_f32_32x32x16_bf16 v[48:63], v[20:23], a[124:127], v[48:63]
  s_waitcnt vmcnt(14)
  s_barrier
  v_add_u32 v6, 36864, v5
  ds_read_b64_tr_b16 v[16:17], v6 offset:0
  ds_read_b64_tr_b16 v[18:19], v6 offset:512
  v_mfma_f32_32x32x16_bf16 v[48:63], v[24:27], a[128:131], v[48:63]
  ds_read_b64_tr_b16 v[20:21], v6 offset:1024
  ds_read_b64_tr_b16 v[22:23], v6 offset:1536
  s_waitcnt lgkmcnt(4)
  v_mfma_f32_32x32x16_bf16 v[48:63], v[28:31], a[132:135], v[48:63]
  ds_read_b64_tr_b16 v[24:25], v6 offset:2048
  ds_read_b64_tr_b16 v[26:27], v6 offset:2560
  v_mfma_f32_32x32x16_bf16 v[48:63], v[32:35], a[136:139], v[48:63]
  ds_read_b64_tr_b16 v[28:29], v6 offset:3072
  ds_read_b64_tr_b16 v[30:31], v6 offset:3584
  v_mfma_f32_32x32x16_bf16 v[48:63], v[36:39], a[140:143], v[48:63]
  ds_read_b64_tr_b16 v[32:33], v6 offset:4096
  ds_read_b64_tr_b16 v[34:35], v6 offset:4608
  s_waitcnt lgkmcnt(4)
  v_mfma_f32_32x32x16_bf16 v[80:95], v[16:19], a[0:3], 0
  ds_read_b64_tr_b16 v[36:37], v6 offset:5120
  ds_read_b64_tr_b16 v[38:39], v6 offset:5632
  v_mfma_f32_32x32x16_bf16 v[80:95], v[20:23], a[4:7], v[80:95]
  ds_read_b64_tr_b16 v[16:17], v6 offset:6144
  ds_read_b64_tr_b16 v[18:19], v6 offset:6656
  s_add_u32 m0, s30, 110592
  v_mfma_f32_32x32x16_bf16 v[80:95], v[24:27], a[8:11], v[80:95]
  ds_read_b64_tr_b16 v[20:21], v6 offset:7168
  ds_read_b64_tr_b16 v[22:23], v6 offset:7680
  buffer_load_dwordx4 v3, s[24:27], 0 offen offset:0 lds
  s_waitcnt lgkmcnt(4)
  v_mfma_f32_32x32x16_bf16 v[80:95], v[28:31], a[12:15], v[80:95]
  ds_read_b64_tr_b16 v[24:25], v6 offset:8192
  ds_read_b64_tr_b16 v[26:27], v6 offset:8704
  v_mfma_f32_32x32x16_bf16 v[80:95], v[32:35], a[16:19], v[80:95]
  ds_read_b64_tr_b16 v[28:29], v6 offset:9216
  ds_read_b64_tr_b16 v[30:31], v6 offset:9728
  v_cvt_pk_bf16_f32 v96, v48, v49
  v_mfma_f32_32x32x16_bf16 v[80:95], v[36:39], a[20:23], v[80:95]
  ds_read_b64_tr_b16 v[32:33], v6 offset:10240
  ds_read_b64_tr_b16 v[34:35], v6 offset:10752
  buffer_load_dwordx4 v3, s[24:27], s41 offen offset:1024 lds
  s_waitcnt lgkmcnt(4)
  v_mfma_f32_32x32x16_bf16 v[80:95], v[16:19], a[24:27], v[80:95]
  ds_read_b64_tr_b16 v[36:37], v6 offset:11264
  ds_read_b64_tr_b16 v[38:39], v6 offset:11776
  v_mfma_f32_32x32x16_bf16 v[80:95], v[20:23], a[28:31], v[80:95]
  ds_read_b64_tr_b16 v[16:17], v6 offset:12288
  ds_read_b64_tr_b16 v[18:19], v6 offset:12800
  v_cvt_pk_bf16_f32 v97, v50, v51
  v_cvt_pk_bf16_f32 v98, v52, v53
  v_mfma_f32_32x32x16_bf16 v[80:95], v[24:27], a[32:35], v[80:95]
  ds_read_b64_tr_b16 v[20:21], v6 offset:13312
  ds_read_b64_tr_b16 v[22:23], v6 offset:13824
  buffer_load_dwordx4 v3, s[24:27], s42 offen offset:2048 lds
  s_waitcnt lgkmcnt(4)
  v_mfma_f32_32x32x16_bf16 v[80:95], v[28:31], a[36:39], v[80:95]
  ds_read_b64_tr_b16 v[24:25], v6 offset:14336
  ds_read_b64_tr_b16 v[26:27], v6 offset:14848
  v_mfma_f32_32x32x16_bf16 v[80:95], v[32:35], a[40:43], v[80:95]
  ds_read_b64_tr_b16 v[28:29], v6 offset:15360
  ds_read_b64_tr_b16 v[30:31], v6 offset:15872
  v_cvt_pk_bf16_f32 v99, v54, v55
  v_mfma_f32_32x32x16_bf16 v[80:95], v[36:39], a[44:47], v[80:95]
  ds_read_b64_tr_b16 v[32:33], v6 offset:16384
  ds_read_b64_tr_b16 v[34:35], v6 offset:16896
  buffer_load_dwordx4 v3, s[24:27], s43 offen offset:3072 lds
  s_waitcnt lgkmcnt(4)
  v_mfma_f32_32x32x16_bf16 v[80:95], v[16:19], a[48:51], v[80:95]
  ds_read_b64_tr_b16 v[36:37], v6 offset:17408
  ds_read_b64_tr_b16 v[38:39], v6 offset:17920
  v_mfma_f32_32x32x16_bf16 v[80:95], v[20:23], a[52:55], v[80:95]
  ds_read_b64_tr_b16 v[16:17], v6 offset:18432
  ds_read_b64_tr_b16 v[18:19], v6 offset:18944
  s_add_u32 m0, s30, 114688
  v_mfma_f32_32x32x16_bf16 v[80:95], v[24:27], a[56:59], v[80:95]
  ds_read_b64_tr_b16 v[20:21], v6 offset:19456
  ds_read_b64_tr_b16 v[22:23], v6 offset:19968
  buffer_load_dwordx4 v3, s[24:27], s44 offen offset:0 lds
  s_waitcnt lgkmcnt(4)
  v_mfma_f32_32x32x16_bf16 v[80:95], v[28:31], a[60:63], v[80:95]
  ds_read_b64_tr_b16 v[24:25], v6 offset:20480
  ds_read_b64_tr_b16 v[26:27], v6 offset:20992
  v_mfma_f32_32x32x16_bf16 v[80:95], v[32:35], a[64:67], v[80:95]
  ds_read_b64_tr_b16 v[28:29], v6 offset:21504
  ds_read_b64_tr_b16 v[30:31], v6 offset:22016
  v_cvt_pk_bf16_f32 v100, v56, v57
  v_mfma_f32_32x32x16_bf16 v[80:95], v[36:39], a[68:71], v[80:95]
  ds_read_b64_tr_b16 v[32:33], v6 offset:22528
  ds_read_b64_tr_b16 v[34:35], v6 offset:23040
  buffer_load_dwordx4 v3, s[24:27], s45 offen offset:1024 lds
  s_waitcnt lgkmcnt(4)
  v_mfma_f32_32x32x16_bf16 v[80:95], v[16:19], a[72:75], v[80:95]
  ds_read_b64_tr_b16 v[36:37], v6 offset:23552
  ds_read_b64_tr_b16 v[38:39], v6 offset:24064
  v_mfma_f32_32x32x16_bf16 v[80:95], v[20:23], a[76:79], v[80:95]
  ds_read_b64_tr_b16 v[16:17], v6 offset:24576
  ds_read_b64_tr_b16 v[18:19], v6 offset:25088
  v_cvt_pk_bf16_f32 v101, v58, v59
  v_cvt_pk_bf16_f32 v102, v60, v61
  v_mfma_f32_32x32x16_bf16 v[80:95], v[24:27], a[80:83], v[80:95]
  ds_read_b64_tr_b16 v[20:21], v6 offset:25600
  ds_read_b64_tr_b16 v[22:23], v6 offset:26112
  buffer_load_dwordx4 v3, s[24:27], s46 offen offset:2048 lds
  s_waitcnt lgkmcnt(4)
  v_mfma_f32_32x32x16_bf16 v[80:95], v[28:31], a[84:87], v[80:95]
  ds_read_b64_tr_b16 v[24:25], v6 offset:26624
  ds_read_b64_tr_b16 v[26:27], v6 offset:27136
  v_mfma_f32_32x32x16_bf16 v[80:95], v[32:35], a[88:91], v[80:95]
  ds_read_b64_tr_b16 v[28:29], v6 offset:27648
  ds_read_b64_tr_b16 v[30:31], v6 offset:28160
  v_cvt_pk_bf16_f32 v103, v62, v63
  v_mfma_f32_32x32x16_bf16 v[80:95], v[36:39], a[92:95], v[80:95]
  ds_read_b64_tr_b16 v[32:33], v6 offset:28672
  ds_read_b64_tr_b16 v[34:35], v6 offset:29184
  buffer_load_dwordx4 v3, s[24:27], s47 offen offset:3072 lds
  s_waitcnt lgkmcnt(4)
  v_mfma_f32_32x32x16_bf16 v[80:95], v[16:19], a[96:99], v[80:95]
  ds_read_b64_tr_b16 v[36:37], v6 offset:29696
  ds_read_b64_tr_b16 v[38:39], v6 offset:30208
  v_mfma_f32_32x32x16_bf16 v[80:95], v[20:23], a[100:103], v[80:95]
  ds_read_b64_tr_b16 v[16:17], v6 offset:30720
  ds_read_b64_tr_b16 v[18:19], v6 offset:31232
  s_add_u32 m0, s30, 118784
  v_mfma_f32_32x32x16_bf16 v[80:95], v[24:27], a[104:107], v[80:95]
  ds_read_b64_tr_b16 v[20:21], v6 offset:31744
  ds_read_b64_tr_b16 v[22:23], v6 offset:32256
  buffer_load_dwordx4 v3, s[24:27], s48 offen offset:0 lds
  s_waitcnt lgkmcnt(4)
  v_mfma_f32_32x32x16_bf16 v[80:95], v[28:31], a[108:111], v[80:95]
  ds_read_b64_tr_b16 v[24:25], v6 offset:32768
  ds_read_b64_tr_b16 v[26:27], v6 offset:33280
  s_add_u32 s38, s49, 32768
  buffer_store_dwordx4 v[96:99], v1, s[52:55], s38 offen sc1
  buffer_store_dwordx4 v[100:103], v1, s[52:55], s38 offen offset:1024 sc1
  v_add_u32 v3, 128, v3
  v_mfma_f32_32x32x16_bf16 v[80:95], v[32:35], a[112:115], v[80:95]
  ds_read_b64_tr_b16 v[28:29], v6 offset:33792
  ds_read_b64_tr_b16 v[30:31], v6 offset:34304
  v_mfma_f32_32x32x16_bf16 v[80:95], v[36:39], a[116:119], v[80:95]
  ds_read_b64_tr_b16 v[32:33], v6 offset:34816
  ds_read_b64_tr_b16 v[34:35], v6 offset:35328
  s_waitcnt lgkmcnt(4)
  v_mfma_f32_32x32x16_bf16 v[80:95], v[16:19], a[120:123], v[80:95]
  ds_read_b64_tr_b16 v[36:37], v6 offset:35840
  ds_read_b64_tr_b16 v[38:39], v6 offset:36352
  v_mfma_f32_32x32x16_bf16 v[80:95], v[20:23], a[124:127], v[80:95]
  s_waitcnt vmcnt(14)
  s_barrier
  v_add_u32 v6, 73728, v5
  ds_read_b64_tr_b16 v[16:17], v6 offset:0
  ds_read_b64_tr_b16 v[18:19], v6 offset:512
  v_mfma_f32_32x32x16_bf16 v[80:95], v[24:27], a[128:131], v[80:95]
  ds_read_b64_tr_b16 v[20:21], v6 offset:1024
  ds_read_b64_tr_b16 v[22:23], v6 offset:1536
  s_waitcnt lgkmcnt(4)
  v_mfma_f32_32x32x16_bf16 v[80:95], v[28:31], a[132:135], v[80:95]
  ds_read_b64_tr_b16 v[24:25], v6 offset:2048
  ds_read_b64_tr_b16 v[26:27], v6 offset:2560
  v_mfma_f32_32x32x16_bf16 v[80:95], v[32:35], a[136:139], v[80:95]
  ds_read_b64_tr_b16 v[28:29], v6 offset:3072
  ds_read_b64_tr_b16 v[30:31], v6 offset:3584
  v_mfma_f32_32x32x16_bf16 v[80:95], v[36:39], a[140:143], v[80:95]
  ds_read_b64_tr_b16 v[32:33], v6 offset:4096
  ds_read_b64_tr_b16 v[34:35], v6 offset:4608
  s_waitcnt lgkmcnt(4)
  v_mfma_f32_32x32x16_bf16 v[48:63], v[16:19], a[0:3], 0
  ds_read_b64_tr_b16 v[36:37], v6 offset:5120
  ds_read_b64_tr_b16 v[38:39], v6 offset:5632
  v_mfma_f32_32x32x16_bf16 v[48:63], v[20:23], a[4:7], v[48:63]
  ds_read_b64_tr_b16 v[16:17], v6 offset:6144
  ds_read_b64_tr_b16 v[18:19], v6 offset:6656
  s_add_u32 m0, s30, 0
  v_mfma_f32_32x32x16_bf16 v[48:63], v[24:27], a[8:11], v[48:63]
  ds_read_b64_tr_b16 v[20:21], v6 offset:7168
  ds_read_b64_tr_b16 v[22:23], v6 offset:7680
  buffer_load_dwordx4 v3, s[24:27], 0 offen offset:0 lds
  s_waitcnt lgkmcnt(4)
  v_mfma_f32_32x32x16_bf16 v[48:63], v[28:31], a[12:15], v[48:63]
  ds_read_b64_tr_b16 v[24:25], v6 offset:8192
  ds_read_b64_tr_b16 v[26:27], v6 offset:8704
  v_mfma_f32_32x32x16_bf16 v[48:63], v[32:35], a[16:19], v[48:63]
  ds_read_b64_tr_b16 v[28:29], v6 offset:9216
  ds_read_b64_tr_b16 v[30:31], v6 offset:9728
  v_cvt_pk_bf16_f32 v104, v80, v81
  v_mfma_f32_32x32x16_bf16 v[48:63], v[36:39], a[20:23], v[48:63]
  ds_read_b64_tr_b16 v[32:33], v6 offset:10240
  ds_read_b64_tr_b16 v[34:35], v6 offset:10752
  buffer_load_dwordx4 v3, s[24:27], s41 offen offset:1024 lds
  s_waitcnt lgkmcnt(4)
  v_mfma_f32_32x32x16_bf16 v[48:63], v[16:19], a[24:27], v[48:63]
  ds_read_b64_tr_b16 v[36:37], v6 offset:11264
  ds_read_b64_tr_b16 v[38:39], v6 offset:11776
  v_mfma_f32_32x32x16_bf16 v[48:63], v[20:23], a[28:31], v[48:63]
  ds_read_b64_tr_b16 v[16:17], v6 offset:12288
  ds_read_b64_tr_b16 v[18:19], v6 offset:12800
  v_cvt_pk_bf16_f32 v105, v82, v83
  v_cvt_pk_bf16_f32 v106, v84, v85
  v_mfma_f32_32x32x16_bf16 v[48:63], v[24:27], a[32:35], v[48:63]
  ds_read_b64_tr_b16 v[20:21], v6 offset:13312
  ds_read_b64_tr_b16 v[22:23], v6 offset:13824
  buffer_load_dwordx4 v3, s[24:27], s42 offen offset:2048 lds
  s_waitcnt lgkmcnt(4)
  v_mfma_f32_32x32x16_bf16 v[48:63], v[28:31], a[36:39], v[48:63]
  ds_read_b64_tr_b16 v[24:25], v6 offset:14336
  ds_read_b64_tr_b16 v[26:27], v6 offset:14848
  v_mfma_f32_32x32x16_bf16 v[48:63], v[32:35], a[40:43], v[48:63]
  ds_read_b64_tr_b16 v[28:29], v6 offset:15360
  ds_read_b64_tr_b16 v[30:31], v6 offset:15872
  v_cvt_pk_bf16_f32 v107, v86, v87
  v_mfma_f32_32x32x16_bf16 v[48:63], v[36:39], a[44:47], v[48:63]
  ds_read_b64_tr_b16 v[32:33], v6 offset:16384
  ds_read_b64_tr_b16 v[34:35], v6 offset:16896
  buffer_load_dwordx4 v3, s[24:27], s43 offen offset:3072 lds
  s_waitcnt lgkmcnt(4)
  v_mfma_f32_32x32x16_bf16 v[48:63], v[16:19], a[48:51], v[48:63]
  ds_read_b64_tr_b16 v[36:37], v6 offset:17408
  ds_read_b64_tr_b16 v[38:39], v6 offset:17920
  v_mfma_f32_32x32x16_bf16 v[48:63], v[20:23], a[52:55], v[48:63]
  ds_read_b64_tr_b16 v[16:17], v6 offset:18432
  ds_read_b64_tr_b16 v[18:19], v6 offset:18944
  s_add_u32 m0, s30, 4096
  v_mfma_f32_32x32x16_bf16 v[48:63], v[24:27], a[56:59], v[48:63]
  ds_read_b64_tr_b16 v[20:21], v6 offset:19456
  ds_read_b64_tr_b16 v[22:23], v6 offset:19968
  buffer_load_dwordx4 v3, s[24:27], s44 offen offset:0 lds
  s_waitcnt lgkmcnt(4)
  v_mfma_f32_32x32x16_bf16 v[48:63], v[28:31], a[60:63], v[48:63]
  ds_read_b64_tr_b16 v[24:25], v6 offset:20480
  ds_read_b64_tr_b16 v[26:27], v6 offset:20992
  v_mfma_f32_32x32x16_bf16 v[48:63], v[32:35], a[64:67], v[48:63]
  ds_read_b64_tr_b16 v[28:29], v6 offset:21504
  ds_read_b64_tr_b16 v[30:31], v6 offset:22016
  v_cvt_pk_bf16_f32 v108, v88, v89
  v_mfma_f32_32x32x16_bf16 v[48:63], v[36:39], a[68:71], v[48:63]
  ds_read_b64_tr_b16 v[32:33], v6 offset:22528
  ds_read_b64_tr_b16 v[34:35], v6 offset:23040
  buffer_load_dwordx4 v3, s[24:27], s45 offen offset:1024 lds
  s_waitcnt lgkmcnt(4)
  v_mfma_f32_32x32x16_bf16 v[48:63], v[16:19], a[72:75], v[48:63]
  ds_read_b64_tr_b16 v[36:37], v6 offset:23552
  ds_read_b64_tr_b16 v[38:39], v6 offset:24064
  v_mfma_f32_32x32x16_bf16 v[48:63], v[20:23], a[76:79], v[48:63]
  ds_read_b64_tr_b16 v[16:17], v6 offset:24576
  ds_read_b64_tr_b16 v[18:19], v6 offset:25088
  v_cvt_pk_bf16_f32 v109, v90, v91
  v_cvt_pk_bf16_f32 v110, v92, v93
  v_mfma_f32_32x32x16_bf16 v[48:63], v[24:27], a[80:83], v[48:63]
  ds_read_b64_tr_b16 v[20:21], v6 offset:25600
  ds_read_b64_tr_b16 v[22:23], v6 offset:26112
  buffer_load_dwordx4 v3, s[24:27], s46 offen offset:2048 lds
  s_waitcnt lgkmcnt(4)
  v_mfma_f32_32x32x16_bf16 v[48:63], v[28:31], a[84:87], v[48:63]
  ds_read_b64_tr_b16 v[24:25], v6 offset:26624
  ds_read_b64_tr_b16 v[26:27], v6 offset:27136
  v_mfma_f32_32x32x16_bf16 v[48:63], v[32:35], a[88:91], v[48:63]
  ds_read_b64_tr_b16 v[28:29], v6 offset:27648
  ds_read_b64_tr_b16 v[30:31], v6 offset:28160
  v_cvt_pk_bf16_f32 v111, v94, v95
  v_mfma_f32_32x32x16_bf16 v[48:63], v[36:39], a[92:95], v[48:63]
  ds_read_b64_tr_b16 v[32:33], v6 offset:28672
  ds_read_b64_tr_b16 v[34:35], v6 offset:29184
  buffer_load_dwordx4 v3, s[24:27], s47 offen offset:3072 lds
  s_waitcnt lgkmcnt(4)
  v_mfma_f32_32x32x16_bf16 v[48:63], v[16:19], a[96:99], v[48:63]
  ds_read_b64_tr_b16 v[36:37], v6 offset:29696
  ds_read_b64_tr_b16 v[38:39], v6 offset:30208
  v_mfma_f32_32x32x16_bf16 v[48:63], v[20:23], a[100:103], v[48:63]
  ds_read_b64_tr_b16 v[16:17], v6 offset:30720
  ds_read_b64_tr_b16 v[18:19], v6 offset:31232
  s_add_u32 m0, s30, 8192
  v_mfma_f32_32x32x16_bf16 v[48:63], v[24:27], a[104:107], v[48:63]
  ds_read_b64_tr_b16 v[20:21], v6 offset:31744
  ds_read_b64_tr_b16 v[22:23], v6 offset:32256
  buffer_load_dwordx4 v3, s[24:27], s48 offen offset:0 lds
  s_waitcnt lgkmcnt(4)
  v_mfma_f32_32x32x16_bf16 v[48:63], v[28:31], a[108:111], v[48:63]
  ds_read_b64_tr_b16 v[24:25], v6 offset:32768
  ds_read_b64_tr_b16 v[26:27], v6 offset:33280
  s_add_u32 s38, s49, 2048
  buffer_store_dwordx4 v[104:107], v1, s[52:55], s38 offen sc1
  buffer_store_dwordx4 v[108:111], v1, s[52:55], s38 offen offset:1024 sc1
  v_add_u32 v3, 128, v3
  v_mfma_f32_32x32x16_bf16 v[48:63], v[32:35], a[112:115], v[48:63]
  ds_read_b64_tr_b16 v[28:29], v6 offset:33792
  ds_read_b64_tr_b16 v[30:31], v6 offset:34304
  v_mfma_f32_32x32x16_bf16 v[48:63], v[36:39], a[116:119], v[48:63]
  ds_read_b64_tr_b16 v[32:33], v6 offset:34816
  ds_read_b64_tr_b16 v[34:35], v6 offset:35328
  s_waitcnt lgkmcnt(4)
  v_mfma_f32_32x32x16_bf16 v[48:63], v[16:19], a[120:123], v[48:63]
  ds_read_b64_tr_b16 v[36:37], v6 offset:35840
  ds_read_b64_tr_b16 v[38:39], v6 offset:36352
  v_mfma_f32_32x32x16_bf16 v[48:63], v[20:23], a[124:127], v[48:63]
  s_waitcnt vmcnt(13)
  s_barrier
  v_add_u32 v6, 110592, v5
  ds_read_b64_tr_b16 v[16:17], v6 offset:0
  ds_read_b64_tr_b16 v[18:19], v6 offset:512
  v_mfma_f32_32x32x16_bf16 v[48:63], v[24:27], a[128:131], v[48:63]
  ds_read_b64_tr_b16 v[20:21], v6 offset:1024
  ds_read_b64_tr_b16 v[22:23], v6 offset:1536
  s_waitcnt lgkmcnt(4)
  v_mfma_f32_32x32x16_bf16 v[48:63], v[28:31], a[132:135], v[48:63]
  ds_read_b64_tr_b16 v[24:25], v6 offset:2048
  ds_read_b64_tr_b16 v[26:27], v6 offset:2560
  v_mfma_f32_32x32x16_bf16 v[48:63], v[32:35], a[136:139], v[48:63]
  ds_read_b64_tr_b16 v[28:29], v6 offset:3072
  ds_read_b64_tr_b16 v[30:31], v6 offset:3584
  v_mfma_f32_32x32x16_bf16 v[48:63], v[36:39], a[140:143], v[48:63]
  ds_read_b64_tr_b16 v[32:33], v6 offset:4096
  ds_read_b64_tr_b16 v[34:35], v6 offset:4608
  s_waitcnt lgkmcnt(4)
  v_mfma_f32_32x32x16_bf16 v[80:95], v[16:19], a[0:3], 0
  ds_read_b64_tr_b16 v[36:37], v6 offset:5120
  ds_read_b64_tr_b16 v[38:39], v6 offset:5632
  v_mfma_f32_32x32x16_bf16 v[80:95], v[20:23], a[4:7], v[80:95]
  ds_read_b64_tr_b16 v[16:17], v6 offset:6144
  ds_read_b64_tr_b16 v[18:19], v6 offset:6656
  s_add_u32 m0, s30, 36864
  v_mfma_f32_32x32x16_bf16 v[80:95], v[24:27], a[8:11], v[80:95]
  ds_read_b64_tr_b16 v[20:21], v6 offset:7168
  ds_read_b64_tr_b16 v[22:23], v6 offset:7680
  buffer_load_dwordx4 v3, s[24:27], 0 offen offset:0 lds
  s_waitcnt lgkmcnt(4)
  v_mfma_f32_32x32x16_bf16 v[80:95], v[28:31], a[12:15], v[80:95]
  ds_read_b64_tr_b16 v[24:25], v6 offset:8192
  ds_read_b64_tr_b16 v[26:27], v6 offset:8704
  v_mfma_f32_32x32x16_bf16 v[80:95], v[32:35], a[16:19], v[80:95]
  ds_read_b64_tr_b16 v[28:29], v6 offset:9216
  ds_read_b64_tr_b16 v[30:31], v6 offset:9728
  v_cvt_pk_bf16_f32 v96, v48, v49
  v_mfma_f32_32x32x16_bf16 v[80:95], v[36:39], a[20:23], v[80:95]
  ds_read_b64_tr_b16 v[32:33], v6 offset:10240
  ds_read_b64_tr_b16 v[34:35], v6 offset:10752
  buffer_load_dwordx4 v3, s[24:27], s41 offen offset:1024 lds
  s_waitcnt lgkmcnt(4)
  v_mfma_f32_32x32x16_bf16 v[80:95], v[16:19], a[24:27], v[80:95]
  ds_read_b64_tr_b16 v[36:37], v6 offset:11264
  ds_read_b64_tr_b16 v[38:39], v6 offset:11776
  v_mfma_f32_32x32x16_bf16 v[80:95], v[20:23], a[28:31], v[80:95]
  ds_read_b64_tr_b16 v[16:17], v6 offset:12288
  ds_read_b64_tr_b16 v[18:19], v6 offset:12800
  v_cvt_pk_bf16_f32 v97, v50, v51
  v_cvt_pk_bf16_f32 v98, v52, v53
  v_mfma_f32_32x32x16_bf16 v[80:95], v[24:27], a[32:35], v[80:95]
  ds_read_b64_tr_b16 v[20:21], v6 offset:13312
  ds_read_b64_tr_b16 v[22:23], v6 offset:13824
  buffer_load_dwordx4 v3, s[24:27], s42 offen offset:2048 lds
  s_waitcnt lgkmcnt(4)
  v_mfma_f32_32x32x16_bf16 v[80:95], v[28:31], a[36:39], v[80:95]
  ds_read_b64_tr_b16 v[24:25], v6 offset:14336
  ds_read_b64_tr_b16 v[26:27], v6 offset:14848
  v_mfma_f32_32x32x16_bf16 v[80:95], v[32:35], a[40:43], v[80:95]
  ds_read_b64_tr_b16 v[28:29], v6 offset:15360
  ds_read_b64_tr_b16 v[30:31], v6 offset:15872
  v_cvt_pk_bf16_f32 v99, v54, v55
  v_mfma_f32_32x32x16_bf16 v[80:95], v[36:39], a[44:47], v[80:95]
  ds_read_b64_tr_b16 v[32:33], v6 offset:16384
  ds_read_b64_tr_b16 v[34:35], v6 offset:16896
  buffer_load_dwordx4 v3, s[24:27], s43 offen offset:3072 lds
  s_waitcnt lgkmcnt(4)
  v_mfma_f32_32x32x16_bf16 v[80:95], v[16:19], a[48:51], v[80:95]
  ds_read_b64_tr_b16 v[36:37], v6 offset:17408
  ds_read_b64_tr_b16 v[38:39], v6 offset:17920
  v_mfma_f32_32x32x16_bf16 v[80:95], v[20:23], a[52:55], v[80:95]
  ds_read_b64_tr_b16 v[16:17], v6 offset:18432
  ds_read_b64_tr_b16 v[18:19], v6 offset:18944
  s_add_u32 m0, s30, 40960
  v_mfma_f32_32x32x16_bf16 v[80:95], v[24:27], a[56:59], v[80:95]
  ds_read_b64_tr_b16 v[20:21], v6 offset:19456
  ds_read_b64_tr_b16 v[22:23], v6 offset:19968
  buffer_load_dwordx4 v3, s[24:27], s44 offen offset:0 lds
  s_waitcnt lgkmcnt(4)
  v_mfma_f32_32x32x16_bf16 v[80:95], v[28:31], a[60:63], v[80:95]
  ds_read_b64_tr_b16 v[24:25], v6 offset:20480
  ds_read_b64_tr_b16 v[26:27], v6 offset:20992
  v_mfma_f32_32x32x16_bf16 v[80:95], v[32:35], a[64:67], v[80:95]
  ds_read_b64_tr_b16 v[28:29], v6 offset:21504
  ds_read_b64_tr_b16 v[30:31], v6 offset:22016
  v_cvt_pk_bf16_f32 v100, v56, v57
  v_mfma_f32_32x32x16_bf16 v[80:95], v[36:39], a[68:71], v[80:95]
  ds_read_b64_tr_b16 v[32:33], v6 offset:22528
  ds_read_b64_tr_b16 v[34:35], v6 offset:23040
  buffer_load_dwordx4 v3, s[24:27], s45 offen offset:1024 lds
  s_waitcnt lgkmcnt(4)
  v_mfma_f32_32x32x16_bf16 v[80:95], v[16:19], a[72:75], v[80:95]
  ds_read_b64_tr_b16 v[36:37], v6 offset:23552
  ds_read_b64_tr_b16 v[38:39], v6 offset:24064
  v_mfma_f32_32x32x16_bf16 v[80:95], v[20:23], a[76:79], v[80:95]
  ds_read_b64_tr_b16 v[16:17], v6 offset:24576
  ds_read_b64_tr_b16 v[18:19], v6 offset:25088
  v_cvt_pk_bf16_f32 v101, v58, v59
  v_cvt_pk_bf16_f32 v102, v60, v61
  v_mfma_f32_32x32x16_bf16 v[80:95], v[24:27], a[80:83], v[80:95]
  ds_read_b64_tr_b16 v[20:21], v6 offset:25600
  ds_read_b64_tr_b16 v[22:23], v6 offset:26112
  buffer_load_dwordx4 v3, s[24:27], s46 offen offset:2048 lds
  s_waitcnt lgkmcnt(4)
  v_mfma_f32_32x32x16_bf16 v[80:95], v[28:31], a[84:87], v[80:95]
  ds_read_b64_tr_b16 v[24:25], v6 offset:26624
  ds_read_b64_tr_b16 v[26:27], v6 offset:27136
  v_mfma_f32_32x32x16_bf16 v[80:95], v[32:35], a[88:91], v[80:95]
  ds_read_b64_tr_b16 v[28:29], v6 offset:27648
  ds_read_b64_tr_b16 v[30:31], v6 offset:28160
  v_cvt_pk_bf16_f32 v103, v62, v63
  v_mfma_f32_32x32x16_bf16 v[80:95], v[36:39], a[92:95], v[80:95]
  ds_read_b64_tr_b16 v[32:33], v6 offset:28672
  ds_read_b64_tr_b16 v[34:35], v6 offset:29184
  buffer_load_dwordx4 v3, s[24:27], s47 offen offset:3072 lds
  s_waitcnt lgkmcnt(4)
  v_mfma_f32_32x32x16_bf16 v[80:95], v[16:19], a[96:99], v[80:95]
  ds_read_b64_tr_b16 v[36:37], v6 offset:29696
  ds_read_b64_tr_b16 v[38:39], v6 offset:30208
  v_mfma_f32_32x32x16_bf16 v[80:95], v[20:23], a[100:103], v[80:95]
  ds_read_b64_tr_b16 v[16:17], v6 offset:30720
  ds_read_b64_tr_b16 v[18:19], v6 offset:31232
  s_add_u32 m0, s30, 45056
  v_mfma_f32_32x32x16_bf16 v[80:95], v[24:27], a[104:107], v[80:95]
  ds_read_b64_tr_b16 v[20:21], v6 offset:31744
  ds_read_b64_tr_b16 v[22:23], v6 offset:32256
  buffer_load_dwordx4 v3, s[24:27], s48 offen offset:0 lds
  s_waitcnt lgkmcnt(4)
  v_mfma_f32_32x32x16_bf16 v[80:95], v[28:31], a[108:111], v[80:95]
  ds_read_b64_tr_b16 v[24:25], v6 offset:32768
  ds_read_b64_tr_b16 v[26:27], v6 offset:33280
  s_add_u32 s38, s49, 6144
  buffer_store_dwordx4 v[96:99], v1, s[52:55], s38 offen sc1
  buffer_store_dwordx4 v[100:103], v1, s[52:55], s38 offen offset:1024 sc1
  v_add_u32 v3, 128, v3
  v_mfma_f32_32x32x16_bf16 v[80:95], v[32:35], a[112:115], v[80:95]
  ds_read_b64_tr_b16 v[28:29], v6 offset:33792
  ds_read_b64_tr_b16 v[30:31], v6 offset:34304
  v_mfma_f32_32x32x16_bf16 v[80:95], v[36:39], a[116:119], v[80:95]
  ds_read_b64_tr_b16 v[32:33], v6 offset:34816
  ds_read_b64_tr_b16 v[34:35], v6 offset:35328
  s_waitcnt lgkmcnt(4)
  v_mfma_f32_32x32x16_bf16 v[80:95], v[16:19], a[120:123], v[80:95]
  ds_read_b64_tr_b16 v[36:37], v6 offset:35840
  ds_read_b64_tr_b16 v[38:39], v6 offset:36352
  v_mfma_f32_32x32x16_bf16 v[80:95], v[20:23], a[124:127], v[80:95]
  s_waitcnt vmcnt(13)
  s_barrier
  v_add_u32 v6, 0, v5
  ds_read_b64_tr_b16 v[16:17], v6 offset:0
  ds_read_b64_tr_b16 v[18:19], v6 offset:512
  v_mfma_f32_32x32x16_bf16 v[80:95], v[24:27], a[128:131], v[80:95]
  ds_read_b64_tr_b16 v[20:21], v6 offset:1024
  ds_read_b64_tr_b16 v[22:23], v6 offset:1536
  s_nop 0
  s_lshl_b32 s39, s37, 8
  s_add_u32 s39, s39, 11540480
  s_cmp_lg_u32 s28, 0
  s_cbranch_scc1 1f
  s_mov_b32 s31, 0x40000
3:
  v_readfirstlane_b32 s38, v14
  s_cmp_lg_u32 s38, 0
  s_cbranch_scc1 4f
  buffer_load_dword v14, off, s[96:99], 0 sc1

  s_waitcnt vmcnt(0)
  s_sub_u32 s31, s31, 1
  s_cbranch_scc0 3b
4:
  s_mov_b64 exec, 1
  v_mov_b32 v15, 1
  buffer_atomic_add v15, off, s[52:55], s39 sc1
  s_mov_b64 exec, -1
1:
  s_waitcnt lgkmcnt(4)
  v_mfma_f32_32x32x16_bf16 v[80:95], v[28:31], a[132:135], v[80:95]
  ds_read_b64_tr_b16 v[24:25], v6 offset:2048
  ds_read_b64_tr_b16 v[26:27], v6 offset:2560
  v_mfma_f32_32x32x16_bf16 v[80:95], v[32:35], a[136:139], v[80:95]
  ds_read_b64_tr_b16 v[28:29], v6 offset:3072
  ds_read_b64_tr_b16 v[30:31], v6 offset:3584
  v_mfma_f32_32x32x16_bf16 v[80:95], v[36:39], a[140:143], v[80:95]
  ds_read_b64_tr_b16 v[32:33], v6 offset:4096
  ds_read_b64_tr_b16 v[34:35], v6 offset:4608
  s_waitcnt lgkmcnt(4)
  v_mfma_f32_32x32x16_bf16 v[48:63], v[16:19], a[0:3], 0
  ds_read_b64_tr_b16 v[36:37], v6 offset:5120
  ds_read_b64_tr_b16 v[38:39], v6 offset:5632
  v_mfma_f32_32x32x16_bf16 v[48:63], v[20:23], a[4:7], v[48:63]
  ds_read_b64_tr_b16 v[16:17], v6 offset:6144
  ds_read_b64_tr_b16 v[18:19], v6 offset:6656
  s_add_u32 m0, s30, 73728
  v_mfma_f32_32x32x16_bf16 v[48:63], v[24:27], a[8:11], v[48:63]
  ds_read_b64_tr_b16 v[20:21], v6 offset:7168
  ds_read_b64_tr_b16 v[22:23], v6 offset:7680
  buffer_load_dwordx4 v3, s[24:27], 0 offen offset:0 lds
  s_waitcnt lgkmcnt(4)
  v_mfma_f32_32x32x16_bf16 v[48:63], v[28:31], a[12:15], v[48:63]
  ds_read_b64_tr_b16 v[24:25], v6 offset:8192
  ds_read_b64_tr_b16 v[26:27], v6 offset:8704
  v_mfma_f32_32x32x16_bf16 v[48:63], v[32:35], a[16:19], v[48:63]
  ds_read_b64_tr_b16 v[28:29], v6 offset:9216
  ds_read_b64_tr_b16 v[30:31], v6 offset:9728
  v_cvt_pk_bf16_f32 v104, v80, v81
  v_mfma_f32_32x32x16_bf16 v[48:63], v[36:39], a[20:23], v[48:63]
  ds_read_b64_tr_b16 v[32:33], v6 offset:10240
  ds_read_b64_tr_b16 v[34:35], v6 offset:10752
  buffer_load_dwordx4 v3, s[24:27], s41 offen offset:1024 lds
  s_waitcnt lgkmcnt(4)
  v_mfma_f32_32x32x16_bf16 v[48:63], v[16:19], a[24:27], v[48:63]
  ds_read_b64_tr_b16 v[36:37], v6 offset:11264
  ds_read_b64_tr_b16 v[38:39], v6 offset:11776
  v_mfma_f32_32x32x16_bf16 v[48:63], v[20:23], a[28:31], v[48:63]
  ds_read_b64_tr_b16 v[16:17], v6 offset:12288
  ds_read_b64_tr_b16 v[18:19], v6 offset:12800
  v_cvt_pk_bf16_f32 v105, v82, v83
  v_cvt_pk_bf16_f32 v106, v84, v85
  v_mfma_f32_32x32x16_bf16 v[48:63], v[24:27], a[32:35], v[48:63]
  ds_read_b64_tr_b16 v[20:21], v6 offset:13312
  ds_read_b64_tr_b16 v[22:23], v6 offset:13824
  buffer_load_dwordx4 v3, s[24:27], s42 offen offset:2048 lds
  s_waitcnt lgkmcnt(4)
  v_mfma_f32_32x32x16_bf16 v[48:63], v[28:31], a[36:39], v[48:63]
  ds_read_b64_tr_b16 v[24:25], v6 offset:14336
  ds_read_b64_tr_b16 v[26:27], v6 offset:14848
  v_mfma_f32_32x32x16_bf16 v[48:63], v[32:35], a[40:43], v[48:63]
  ds_read_b64_tr_b16 v[28:29], v6 offset:15360
  ds_read_b64_tr_b16 v[30:31], v6 offset:15872
  v_cvt_pk_bf16_f32 v107, v86, v87
  v_mfma_f32_32x32x16_bf16 v[48:63], v[36:39], a[44:47], v[48:63]
  ds_read_b64_tr_b16 v[32:33], v6 offset:16384
  ds_read_b64_tr_b16 v[34:35], v6 offset:16896
  buffer_load_dwordx4 v3, s[24:27], s43 offen offset:3072 lds
  s_waitcnt lgkmcnt(4)
  v_mfma_f32_32x32x16_bf16 v[48:63], v[16:19], a[48:51], v[48:63]
  ds_read_b64_tr_b16 v[36:37], v6 offset:17408
  ds_read_b64_tr_b16 v[38:39], v6 offset:17920
  v_mfma_f32_32x32x16_bf16 v[48:63], v[20:23], a[52:55], v[48:63]
  ds_read_b64_tr_b16 v[16:17], v6 offset:18432
  ds_read_b64_tr_b16 v[18:19], v6 offset:18944
  s_add_u32 m0, s30, 77824
  v_mfma_f32_32x32x16_bf16 v[48:63], v[24:27], a[56:59], v[48:63]
  ds_read_b64_tr_b16 v[20:21], v6 offset:19456
  ds_read_b64_tr_b16 v[22:23], v6 offset:19968
  buffer_load_dwordx4 v3, s[24:27], s44 offen offset:0 lds
  s_waitcnt lgkmcnt(4)
  v_mfma_f32_32x32x16_bf16 v[48:63], v[28:31], a[60:63], v[48:63]
  ds_read_b64_tr_b16 v[24:25], v6 offset:20480
  ds_read_b64_tr_b16 v[26:27], v6 offset:20992
  v_mfma_f32_32x32x16_bf16 v[48:63], v[32:35], a[64:67], v[48:63]
  ds_read_b64_tr_b16 v[28:29], v6 offset:21504
  ds_read_b64_tr_b16 v[30:31], v6 offset:22016
  v_cvt_pk_bf16_f32 v108, v88, v89
  v_mfma_f32_32x32x16_bf16 v[48:63], v[36:39], a[68:71], v[48:63]
  ds_read_b64_tr_b16 v[32:33], v6 offset:22528
  ds_read_b64_tr_b16 v[34:35], v6 offset:23040
  buffer_load_dwordx4 v3, s[24:27], s45 offen offset:1024 lds
  s_waitcnt lgkmcnt(4)
  v_mfma_f32_32x32x16_bf16 v[48:63], v[16:19], a[72:75], v[48:63]
  ds_read_b64_tr_b16 v[36:37], v6 offset:23552
  ds_read_b64_tr_b16 v[38:39], v6 offset:24064
  v_mfma_f32_32x32x16_bf16 v[48:63], v[20:23], a[76:79], v[48:63]
  ds_read_b64_tr_b16 v[16:17], v6 offset:24576
  ds_read_b64_tr_b16 v[18:19], v6 offset:25088
  v_cvt_pk_bf16_f32 v109, v90, v91
  v_cvt_pk_bf16_f32 v110, v92, v93
  v_mfma_f32_32x32x16_bf16 v[48:63], v[24:27], a[80:83], v[48:63]
  ds_read_b64_tr_b16 v[20:21], v6 offset:25600
  ds_read_b64_tr_b16 v[22:23], v6 offset:26112
  buffer_load_dwordx4 v3, s[24:27], s46 offen offset:2048 lds
  s_waitcnt lgkmcnt(4)
  v_mfma_f32_32x32x16_bf16 v[48:63], v[28:31], a[84:87], v[48:63]
  ds_read_b64_tr_b16 v[24:25], v6 offset:26624
  ds_read_b64_tr_b16 v[26:27], v6 offset:27136
  v_mfma_f32_32x32x16_bf16 v[48:63], v[32:35], a[88:91], v[48:63]
  ds_read_b64_tr_b16 v[28:29], v6 offset:27648
  ds_read_b64_tr_b16 v[30:31], v6 offset:28160
  v_cvt_pk_bf16_f32 v111, v94, v95
  v_mfma_f32_32x32x16_bf16 v[48:63], v[36:39], a[92:95], v[48:63]
  ds_read_b64_tr_b16 v[32:33], v6 offset:28672
  ds_read_b64_tr_b16 v[34:35], v6 offset:29184
  buffer_load_dwordx4 v3, s[24:27], s47 offen offset:3072 lds
  s_waitcnt lgkmcnt(4)
  v_mfma_f32_32x32x16_bf16 v[48:63], v[16:19], a[96:99], v[48:63]
  ds_read_b64_tr_b16 v[36:37], v6 offset:29696
  ds_read_b64_tr_b16 v[38:39], v6 offset:30208
  v_mfma_f32_32x32x16_bf16 v[48:63], v[20:23], a[100:103], v[48:63]
  ds_read_b64_tr_b16 v[16:17], v6 offset:30720
  ds_read_b64_tr_b16 v[18:19], v6 offset:31232
  s_add_u32 m0, s30, 81920
  v_mfma_f32_32x32x16_bf16 v[48:63], v[24:27], a[104:107], v[48:63]
  ds_read_b64_tr_b16 v[20:21], v6 offset:31744
  ds_read_b64_tr_b16 v[22:23], v6 offset:32256
  buffer_load_dwordx4 v3, s[24:27], s48 offen offset:0 lds
  s_waitcnt lgkmcnt(4)
  v_mfma_f32_32x32x16_bf16 v[48:63], v[28:31], a[108:111], v[48:63]
  ds_read_b64_tr_b16 v[24:25], v6 offset:32768
  ds_read_b64_tr_b16 v[26:27], v6 offset:33280
  s_add_u32 s38, s49, 10240
  buffer_store_dwordx4 v[104:107], v1, s[52:55], s38 offen sc1
  buffer_store_dwordx4 v[108:111], v1, s[52:55], s38 offen offset:1024 sc1
  v_add_u32 v3, 128, v3
  v_mfma_f32_32x32x16_bf16 v[48:63], v[32:35], a[112:115], v[48:63]
  ds_read_b64_tr_b16 v[28:29], v6 offset:33792
  ds_read_b64_tr_b16 v[30:31], v6 offset:34304
  v_mfma_f32_32x32x16_bf16 v[48:63], v[36:39], a[116:119], v[48:63]
  ds_read_b64_tr_b16 v[32:33], v6 offset:34816
  ds_read_b64_tr_b16 v[34:35], v6 offset:35328
  s_waitcnt lgkmcnt(4)
  v_mfma_f32_32x32x16_bf16 v[48:63], v[16:19], a[120:123], v[48:63]
  ds_read_b64_tr_b16 v[36:37], v6 offset:35840
  ds_read_b64_tr_b16 v[38:39], v6 offset:36352
  v_mfma_f32_32x32x16_bf16 v[48:63], v[20:23], a[124:127], v[48:63]
  s_waitcnt vmcnt(13)
  s_barrier
  v_add_u32 v6, 36864, v5
  ds_read_b64_tr_b16 v[16:17], v6 offset:0
  ds_read_b64_tr_b16 v[18:19], v6 offset:512
  v_mfma_f32_32x32x16_bf16 v[48:63], v[24:27], a[128:131], v[48:63]
  ds_read_b64_tr_b16 v[20:21], v6 offset:1024
  ds_read_b64_tr_b16 v[22:23], v6 offset:1536
  s_waitcnt lgkmcnt(4)
  v_mfma_f32_32x32x16_bf16 v[48:63], v[28:31], a[132:135], v[48:63]
  ds_read_b64_tr_b16 v[24:25], v6 offset:2048
  ds_read_b64_tr_b16 v[26:27], v6 offset:2560
  v_mfma_f32_32x32x16_bf16 v[48:63], v[32:35], a[136:139], v[48:63]
  ds_read_b64_tr_b16 v[28:29], v6 offset:3072
  ds_read_b64_tr_b16 v[30:31], v6 offset:3584
  v_mfma_f32_32x32x16_bf16 v[48:63], v[36:39], a[140:143], v[48:63]
  ds_read_b64_tr_b16 v[32:33], v6 offset:4096
  ds_read_b64_tr_b16 v[34:35], v6 offset:4608
  s_waitcnt lgkmcnt(4)
  v_mfma_f32_32x32x16_bf16 v[80:95], v[16:19], a[0:3], 0
  ds_read_b64_tr_b16 v[36:37], v6 offset:5120
  ds_read_b64_tr_b16 v[38:39], v6 offset:5632
  v_mfma_f32_32x32x16_bf16 v[80:95], v[20:23], a[4:7], v[80:95]
  ds_read_b64_tr_b16 v[16:17], v6 offset:6144
  ds_read_b64_tr_b16 v[18:19], v6 offset:6656
  s_add_u32 m0, s30, 110592
  v_mfma_f32_32x32x16_bf16 v[80:95], v[24:27], a[8:11], v[80:95]
  ds_read_b64_tr_b16 v[20:21], v6 offset:7168
  ds_read_b64_tr_b16 v[22:23], v6 offset:7680
  buffer_load_dwordx4 v3, s[24:27], 0 offen offset:0 lds
  s_waitcnt lgkmcnt(4)
  v_mfma_f32_32x32x16_bf16 v[80:95], v[28:31], a[12:15], v[80:95]
  ds_read_b64_tr_b16 v[24:25], v6 offset:8192
  ds_read_b64_tr_b16 v[26:27], v6 offset:8704
  v_mfma_f32_32x32x16_bf16 v[80:95], v[32:35], a[16:19], v[80:95]
  ds_read_b64_tr_b16 v[28:29], v6 offset:9216
  ds_read_b64_tr_b16 v[30:31], v6 offset:9728
  v_cvt_pk_bf16_f32 v96, v48, v49
  v_mfma_f32_32x32x16_bf16 v[80:95], v[36:39], a[20:23], v[80:95]
  ds_read_b64_tr_b16 v[32:33], v6 offset:10240
  ds_read_b64_tr_b16 v[34:35], v6 offset:10752
  buffer_load_dwordx4 v3, s[24:27], s41 offen offset:1024 lds
  s_waitcnt lgkmcnt(4)
  v_mfma_f32_32x32x16_bf16 v[80:95], v[16:19], a[24:27], v[80:95]
  ds_read_b64_tr_b16 v[36:37], v6 offset:11264
  ds_read_b64_tr_b16 v[38:39], v6 offset:11776
  v_mfma_f32_32x32x16_bf16 v[80:95], v[20:23], a[28:31], v[80:95]
  ds_read_b64_tr_b16 v[16:17], v6 offset:12288
  ds_read_b64_tr_b16 v[18:19], v6 offset:12800
  v_cvt_pk_bf16_f32 v97, v50, v51
  v_cvt_pk_bf16_f32 v98, v52, v53
  v_mfma_f32_32x32x16_bf16 v[80:95], v[24:27], a[32:35], v[80:95]
  ds_read_b64_tr_b16 v[20:21], v6 offset:13312
  ds_read_b64_tr_b16 v[22:23], v6 offset:13824
  buffer_load_dwordx4 v3, s[24:27], s42 offen offset:2048 lds
  s_waitcnt lgkmcnt(4)
  v_mfma_f32_32x32x16_bf16 v[80:95], v[28:31], a[36:39], v[80:95]
  ds_read_b64_tr_b16 v[24:25], v6 offset:14336
  ds_read_b64_tr_b16 v[26:27], v6 offset:14848
  v_mfma_f32_32x32x16_bf16 v[80:95], v[32:35], a[40:43], v[80:95]
  ds_read_b64_tr_b16 v[28:29], v6 offset:15360
  ds_read_b64_tr_b16 v[30:31], v6 offset:15872
  v_cvt_pk_bf16_f32 v99, v54, v55
  v_mfma_f32_32x32x16_bf16 v[80:95], v[36:39], a[44:47], v[80:95]
  ds_read_b64_tr_b16 v[32:33], v6 offset:16384
  ds_read_b64_tr_b16 v[34:35], v6 offset:16896
  buffer_load_dwordx4 v3, s[24:27], s43 offen offset:3072 lds
  s_waitcnt lgkmcnt(4)
  v_mfma_f32_32x32x16_bf16 v[80:95], v[16:19], a[48:51], v[80:95]
  ds_read_b64_tr_b16 v[36:37], v6 offset:17408
  ds_read_b64_tr_b16 v[38:39], v6 offset:17920
  v_mfma_f32_32x32x16_bf16 v[80:95], v[20:23], a[52:55], v[80:95]
  ds_read_b64_tr_b16 v[16:17], v6 offset:18432
  ds_read_b64_tr_b16 v[18:19], v6 offset:18944
  s_add_u32 m0, s30, 114688
  v_mfma_f32_32x32x16_bf16 v[80:95], v[24:27], a[56:59], v[80:95]
  ds_read_b64_tr_b16 v[20:21], v6 offset:19456
  ds_read_b64_tr_b16 v[22:23], v6 offset:19968
  buffer_load_dwordx4 v3, s[24:27], s44 offen offset:0 lds
  s_waitcnt lgkmcnt(4)
  v_mfma_f32_32x32x16_bf16 v[80:95], v[28:31], a[60:63], v[80:95]
  ds_read_b64_tr_b16 v[24:25], v6 offset:20480
  ds_read_b64_tr_b16 v[26:27], v6 offset:20992
  v_mfma_f32_32x32x16_bf16 v[80:95], v[32:35], a[64:67], v[80:95]
  ds_read_b64_tr_b16 v[28:29], v6 offset:21504
  ds_read_b64_tr_b16 v[30:31], v6 offset:22016
  v_cvt_pk_bf16_f32 v100, v56, v57
  v_mfma_f32_32x32x16_bf16 v[80:95], v[36:39], a[68:71], v[80:95]
  ds_read_b64_tr_b16 v[32:33], v6 offset:22528
  ds_read_b64_tr_b16 v[34:35], v6 offset:23040
  buffer_load_dwordx4 v3, s[24:27], s45 offen offset:1024 lds
  s_waitcnt lgkmcnt(4)
  v_mfma_f32_32x32x16_bf16 v[80:95], v[16:19], a[72:75], v[80:95]
  ds_read_b64_tr_b16 v[36:37], v6 offset:23552
  ds_read_b64_tr_b16 v[38:39], v6 offset:24064
  v_mfma_f32_32x32x16_bf16 v[80:95], v[20:23], a[76:79], v[80:95]
  ds_read_b64_tr_b16 v[16:17], v6 offset:24576
  ds_read_b64_tr_b16 v[18:19], v6 offset:25088
  v_cvt_pk_bf16_f32 v101, v58, v59
  v_cvt_pk_bf16_f32 v102, v60, v61
  v_mfma_f32_32x32x16_bf16 v[80:95], v[24:27], a[80:83], v[80:95]
  ds_read_b64_tr_b16 v[20:21], v6 offset:25600
  ds_read_b64_tr_b16 v[22:23], v6 offset:26112
  buffer_load_dwordx4 v3, s[24:27], s46 offen offset:2048 lds
  s_waitcnt lgkmcnt(4)
  v_mfma_f32_32x32x16_bf16 v[80:95], v[28:31], a[84:87], v[80:95]
  ds_read_b64_tr_b16 v[24:25], v6 offset:26624
  ds_read_b64_tr_b16 v[26:27], v6 offset:27136
  v_mfma_f32_32x32x16_bf16 v[80:95], v[32:35], a[88:91], v[80:95]
  ds_read_b64_tr_b16 v[28:29], v6 offset:27648
  ds_read_b64_tr_b16 v[30:31], v6 offset:28160
  v_cvt_pk_bf16_f32 v103, v62, v63
  v_mfma_f32_32x32x16_bf16 v[80:95], v[36:39], a[92:95], v[80:95]
  ds_read_b64_tr_b16 v[32:33], v6 offset:28672
  ds_read_b64_tr_b16 v[34:35], v6 offset:29184
  buffer_load_dwordx4 v3, s[24:27], s47 offen offset:3072 lds
  s_waitcnt lgkmcnt(4)
  v_mfma_f32_32x32x16_bf16 v[80:95], v[16:19], a[96:99], v[80:95]
  ds_read_b64_tr_b16 v[36:37], v6 offset:29696
  ds_read_b64_tr_b16 v[38:39], v6 offset:30208
  v_mfma_f32_32x32x16_bf16 v[80:95], v[20:23], a[100:103], v[80:95]
  ds_read_b64_tr_b16 v[16:17], v6 offset:30720
  ds_read_b64_tr_b16 v[18:19], v6 offset:31232
  s_add_u32 m0, s30, 118784
  v_mfma_f32_32x32x16_bf16 v[80:95], v[24:27], a[104:107], v[80:95]
  ds_read_b64_tr_b16 v[20:21], v6 offset:31744
  ds_read_b64_tr_b16 v[22:23], v6 offset:32256
  buffer_load_dwordx4 v3, s[24:27], s48 offen offset:0 lds
  s_waitcnt lgkmcnt(4)
  v_mfma_f32_32x32x16_bf16 v[80:95], v[28:31], a[108:111], v[80:95]
  ds_read_b64_tr_b16 v[24:25], v6 offset:32768
  ds_read_b64_tr_b16 v[26:27], v6 offset:33280
  s_add_u32 s38, s49, 14336
  buffer_store_dwordx4 v[96:99], v1, s[52:55], s38 offen sc1
  buffer_store_dwordx4 v[100:103], v1, s[52:55], s38 offen offset:1024 sc1
  v_add_u32 v3, 128, v3
  v_mfma_f32_32x32x16_bf16 v[80:95], v[32:35], a[112:115], v[80:95]
  ds_read_b64_tr_b16 v[28:29], v6 offset:33792
  ds_read_b64_tr_b16 v[30:31], v6 offset:34304
  v_mfma_f32_32x32x16_bf16 v[80:95], v[36:39], a[116:119], v[80:95]
  ds_read_b64_tr_b16 v[32:33], v6 offset:34816
  ds_read_b64_tr_b16 v[34:35], v6 offset:35328
  s_waitcnt lgkmcnt(4)
  v_mfma_f32_32x32x16_bf16 v[80:95], v[16:19], a[120:123], v[80:95]
  ds_read_b64_tr_b16 v[36:37], v6 offset:35840
  ds_read_b64_tr_b16 v[38:39], v6 offset:36352
  v_mfma_f32_32x32x16_bf16 v[80:95], v[20:23], a[124:127], v[80:95]
  s_waitcnt vmcnt(13)
  s_barrier
  v_add_u32 v6, 73728, v5
  ds_read_b64_tr_b16 v[16:17], v6 offset:0
  ds_read_b64_tr_b16 v[18:19], v6 offset:512
  v_mfma_f32_32x32x16_bf16 v[80:95], v[24:27], a[128:131], v[80:95]
  ds_read_b64_tr_b16 v[20:21], v6 offset:1024
  ds_read_b64_tr_b16 v[22:23], v6 offset:1536
  s_waitcnt lgkmcnt(4)
  v_mfma_f32_32x32x16_bf16 v[80:95], v[28:31], a[132:135], v[80:95]
  ds_read_b64_tr_b16 v[24:25], v6 offset:2048
  ds_read_b64_tr_b16 v[26:27], v6 offset:2560
  v_mfma_f32_32x32x16_bf16 v[80:95], v[32:35], a[136:139], v[80:95]
  ds_read_b64_tr_b16 v[28:29], v6 offset:3072
  ds_read_b64_tr_b16 v[30:31], v6 offset:3584
  v_mfma_f32_32x32x16_bf16 v[80:95], v[36:39], a[140:143], v[80:95]
  ds_read_b64_tr_b16 v[32:33], v6 offset:4096
  ds_read_b64_tr_b16 v[34:35], v6 offset:4608
  s_waitcnt lgkmcnt(4)
  v_mfma_f32_32x32x16_bf16 v[48:63], v[16:19], a[0:3], 0
  ds_read_b64_tr_b16 v[36:37], v6 offset:5120
  ds_read_b64_tr_b16 v[38:39], v6 offset:5632
  v_mfma_f32_32x32x16_bf16 v[48:63], v[20:23], a[4:7], v[48:63]
  ds_read_b64_tr_b16 v[16:17], v6 offset:6144
  ds_read_b64_tr_b16 v[18:19], v6 offset:6656
  s_add_u32 m0, s30, 0
  v_mfma_f32_32x32x16_bf16 v[48:63], v[24:27], a[8:11], v[48:63]
  ds_read_b64_tr_b16 v[20:21], v6 offset:7168
  ds_read_b64_tr_b16 v[22:23], v6 offset:7680
  buffer_load_dwordx4 v3, s[24:27], 0 offen offset:0 lds
  s_waitcnt lgkmcnt(4)
  v_mfma_f32_32x32x16_bf16 v[48:63], v[28:31], a[12:15], v[48:63]
  ds_read_b64_tr_b16 v[24:25], v6 offset:8192
  ds_read_b64_tr_b16 v[26:27], v6 offset:8704
  v_mfma_f32_32x32x16_bf16 v[48:63], v[32:35], a[16:19], v[48:63]
  ds_read_b64_tr_b16 v[28:29], v6 offset:9216
  ds_read_b64_tr_b16 v[30:31], v6 offset:9728
  v_cvt_pk_bf16_f32 v104, v80, v81
  v_mfma_f32_32x32x16_bf16 v[48:63], v[36:39], a[20:23], v[48:63]
  ds_read_b64_tr_b16 v[32:33], v6 offset:10240
  ds_read_b64_tr_b16 v[34:35], v6 offset:10752
  buffer_load_dwordx4 v3, s[24:27], s41 offen offset:1024 lds
  s_waitcnt lgkmcnt(4)
  v_mfma_f32_32x32x16_bf16 v[48:63], v[16:19], a[24:27], v[48:63]
  ds_read_b64_tr_b16 v[36:37], v6 offset:11264
  ds_read_b64_tr_b16 v[38:39], v6 offset:11776
  v_mfma_f32_32x32x16_bf16 v[48:63], v[20:23], a[28:31], v[48:63]
  ds_read_b64_tr_b16 v[16:17], v6 offset:12288
  ds_read_b64_tr_b16 v[18:19], v6 offset:12800
  v_cvt_pk_bf16_f32 v105, v82, v83
  v_cvt_pk_bf16_f32 v106, v84, v85
  v_mfma_f32_32x32x16_bf16 v[48:63], v[24:27], a[32:35], v[48:63]
  ds_read_b64_tr_b16 v[20:21], v6 offset:13312
  ds_read_b64_tr_b16 v[22:23], v6 offset:13824
  buffer_load_dwordx4 v3, s[24:27], s42 offen offset:2048 lds
  s_waitcnt lgkmcnt(4)
  v_mfma_f32_32x32x16_bf16 v[48:63], v[28:31], a[36:39], v[48:63]
  ds_read_b64_tr_b16 v[24:25], v6 offset:14336
  ds_read_b64_tr_b16 v[26:27], v6 offset:14848
  v_mfma_f32_32x32x16_bf16 v[48:63], v[32:35], a[40:43], v[48:63]
  ds_read_b64_tr_b16 v[28:29], v6 offset:15360
  ds_read_b64_tr_b16 v[30:31], v6 offset:15872
  v_cvt_pk_bf16_f32 v107, v86, v87
  v_mfma_f32_32x32x16_bf16 v[48:63], v[36:39], a[44:47], v[48:63]
  ds_read_b64_tr_b16 v[32:33], v6 offset:16384
  ds_read_b64_tr_b16 v[34:35], v6 offset:16896
  buffer_load_dwordx4 v3, s[24:27], s43 offen offset:3072 lds
  s_waitcnt lgkmcnt(4)
  v_mfma_f32_32x32x16_bf16 v[48:63], v[16:19], a[48:51], v[48:63]
  ds_read_b64_tr_b16 v[36:37], v6 offset:17408
  ds_read_b64_tr_b16 v[38:39], v6 offset:17920
  v_mfma_f32_32x32x16_bf16 v[48:63], v[20:23], a[52:55], v[48:63]
  ds_read_b64_tr_b16 v[16:17], v6 offset:18432
  ds_read_b64_tr_b16 v[18:19], v6 offset:18944
  s_add_u32 m0, s30, 4096
  v_mfma_f32_32x32x16_bf16 v[48:63], v[24:27], a[56:59], v[48:63]
  ds_read_b64_tr_b16 v[20:21], v6 offset:19456
  ds_read_b64_tr_b16 v[22:23], v6 offset:19968
  buffer_load_dwordx4 v3, s[24:27], s44 offen offset:0 lds
  s_waitcnt lgkmcnt(4)
  v_mfma_f32_32x32x16_bf16 v[48:63], v[28:31], a[60:63], v[48:63]
  ds_read_b64_tr_b16 v[24:25], v6 offset:20480
  ds_read_b64_tr_b16 v[26:27], v6 offset:20992
  v_mfma_f32_32x32x16_bf16 v[48:63], v[32:35], a[64:67], v[48:63]
  ds_read_b64_tr_b16 v[28:29], v6 offset:21504
  ds_read_b64_tr_b16 v[30:31], v6 offset:22016
  v_cvt_pk_bf16_f32 v108, v88, v89
  v_mfma_f32_32x32x16_bf16 v[48:63], v[36:39], a[68:71], v[48:63]
  ds_read_b64_tr_b16 v[32:33], v6 offset:22528
  ds_read_b64_tr_b16 v[34:35], v6 offset:23040
  buffer_load_dwordx4 v3, s[24:27], s45 offen offset:1024 lds
  s_waitcnt lgkmcnt(4)
  v_mfma_f32_32x32x16_bf16 v[48:63], v[16:19], a[72:75], v[48:63]
  ds_read_b64_tr_b16 v[36:37], v6 offset:23552
  ds_read_b64_tr_b16 v[38:39], v6 offset:24064
  v_mfma_f32_32x32x16_bf16 v[48:63], v[20:23], a[76:79], v[48:63]
  ds_read_b64_tr_b16 v[16:17], v6 offset:24576
  ds_read_b64_tr_b16 v[18:19], v6 offset:25088
  v_cvt_pk_bf16_f32 v109, v90, v91
  v_cvt_pk_bf16_f32 v110, v92, v93
  v_mfma_f32_32x32x16_bf16 v[48:63], v[24:27], a[80:83], v[48:63]
  ds_read_b64_tr_b16 v[20:21], v6 offset:25600
  ds_read_b64_tr_b16 v[22:23], v6 offset:26112
  buffer_load_dwordx4 v3, s[24:27], s46 offen offset:2048 lds
  s_waitcnt lgkmcnt(4)
  v_mfma_f32_32x32x16_bf16 v[48:63], v[28:31], a[84:87], v[48:63]
  ds_read_b64_tr_b16 v[24:25], v6 offset:26624
  ds_read_b64_tr_b16 v[26:27], v6 offset:27136
  v_mfma_f32_32x32x16_bf16 v[48:63], v[32:35], a[88:91], v[48:63]
  ds_read_b64_tr_b16 v[28:29], v6 offset:27648
  ds_read_b64_tr_b16 v[30:31], v6 offset:28160
  v_cvt_pk_bf16_f32 v111, v94, v95
  v_mfma_f32_32x32x16_bf16 v[48:63], v[36:39], a[92:95], v[48:63]
  ds_read_b64_tr_b16 v[32:33], v6 offset:28672
  ds_read_b64_tr_b16 v[34:35], v6 offset:29184
  buffer_load_dwordx4 v3, s[24:27], s47 offen offset:3072 lds
  s_waitcnt lgkmcnt(4)
  v_mfma_f32_32x32x16_bf16 v[48:63], v[16:19], a[96:99], v[48:63]
  ds_read_b64_tr_b16 v[36:37], v6 offset:29696
  ds_read_b64_tr_b16 v[38:39], v6 offset:30208
  v_mfma_f32_32x32x16_bf16 v[48:63], v[20:23], a[100:103], v[48:63]
  ds_read_b64_tr_b16 v[16:17], v6 offset:30720
  ds_read_b64_tr_b16 v[18:19], v6 offset:31232
  s_add_u32 m0, s30, 8192
  v_mfma_f32_32x32x16_bf16 v[48:63], v[24:27], a[104:107], v[48:63]
  ds_read_b64_tr_b16 v[20:21], v6 offset:31744
  ds_read_b64_tr_b16 v[22:23], v6 offset:32256
  buffer_load_dwordx4 v3, s[24:27], s48 offen offset:0 lds
  s_waitcnt lgkmcnt(4)
  v_mfma_f32_32x32x16_bf16 v[48:63], v[28:31], a[108:111], v[48:63]
  ds_read_b64_tr_b16 v[24:25], v6 offset:32768
  ds_read_b64_tr_b16 v[26:27], v6 offset:33280
  s_add_u32 s38, s49, 18432
  buffer_store_dwordx4 v[104:107], v1, s[52:55], s38 offen sc1
  buffer_store_dwordx4 v[108:111], v1, s[52:55], s38 offen offset:1024 sc1
  v_add_u32 v3, 128, v3
  v_mfma_f32_32x32x16_bf16 v[48:63], v[32:35], a[112:115], v[48:63]
  ds_read_b64_tr_b16 v[28:29], v6 offset:33792
  ds_read_b64_tr_b16 v[30:31], v6 offset:34304
  v_mfma_f32_32x32x16_bf16 v[48:63], v[36:39], a[116:119], v[48:63]
  ds_read_b64_tr_b16 v[32:33], v6 offset:34816
  ds_read_b64_tr_b16 v[34:35], v6 offset:35328
  s_waitcnt lgkmcnt(4)
  v_mfma_f32_32x32x16_bf16 v[48:63], v[16:19], a[120:123], v[48:63]
  ds_read_b64_tr_b16 v[36:37], v6 offset:35840
  ds_read_b64_tr_b16 v[38:39], v6 offset:36352
  v_mfma_f32_32x32x16_bf16 v[48:63], v[20:23], a[124:127], v[48:63]
  s_waitcnt vmcnt(13)
  s_barrier
  v_add_u32 v6, 110592, v5
  ds_read_b64_tr_b16 v[16:17], v6 offset:0
  ds_read_b64_tr_b16 v[18:19], v6 offset:512
  v_mfma_f32_32x32x16_bf16 v[48:63], v[24:27], a[128:131], v[48:63]
  ds_read_b64_tr_b16 v[20:21], v6 offset:1024
  ds_read_b64_tr_b16 v[22:23], v6 offset:1536
  s_waitcnt lgkmcnt(4)
  v_mfma_f32_32x32x16_bf16 v[48:63], v[28:31], a[132:135], v[48:63]
  ds_read_b64_tr_b16 v[24:25], v6 offset:2048
  ds_read_b64_tr_b16 v[26:27], v6 offset:2560
  v_mfma_f32_32x32x16_bf16 v[48:63], v[32:35], a[136:139], v[48:63]
  ds_read_b64_tr_b16 v[28:29], v6 offset:3072
  ds_read_b64_tr_b16 v[30:31], v6 offset:3584
  v_mfma_f32_32x32x16_bf16 v[48:63], v[36:39], a[140:143], v[48:63]
  ds_read_b64_tr_b16 v[32:33], v6 offset:4096
  ds_read_b64_tr_b16 v[34:35], v6 offset:4608
  s_waitcnt lgkmcnt(4)
  v_mfma_f32_32x32x16_bf16 v[80:95], v[16:19], a[0:3], 0
  ds_read_b64_tr_b16 v[36:37], v6 offset:5120
  ds_read_b64_tr_b16 v[38:39], v6 offset:5632
  v_mfma_f32_32x32x16_bf16 v[80:95], v[20:23], a[4:7], v[80:95]
  ds_read_b64_tr_b16 v[16:17], v6 offset:6144
  ds_read_b64_tr_b16 v[18:19], v6 offset:6656
  s_add_u32 m0, s30, 36864
  v_mfma_f32_32x32x16_bf16 v[80:95], v[24:27], a[8:11], v[80:95]
  ds_read_b64_tr_b16 v[20:21], v6 offset:7168
  ds_read_b64_tr_b16 v[22:23], v6 offset:7680
  buffer_load_dwordx4 v3, s[24:27], 0 offen offset:0 lds
  s_waitcnt lgkmcnt(4)
  v_mfma_f32_32x32x16_bf16 v[80:95], v[28:31], a[12:15], v[80:95]
  ds_read_b64_tr_b16 v[24:25], v6 offset:8192
  ds_read_b64_tr_b16 v[26:27], v6 offset:8704
  v_mfma_f32_32x32x16_bf16 v[80:95], v[32:35], a[16:19], v[80:95]
  ds_read_b64_tr_b16 v[28:29], v6 offset:9216
  ds_read_b64_tr_b16 v[30:31], v6 offset:9728
  v_cvt_pk_bf16_f32 v96, v48, v49
  v_mfma_f32_32x32x16_bf16 v[80:95], v[36:39], a[20:23], v[80:95]
  ds_read_b64_tr_b16 v[32:33], v6 offset:10240
  ds_read_b64_tr_b16 v[34:35], v6 offset:10752
  buffer_load_dwordx4 v3, s[24:27], s41 offen offset:1024 lds
  s_waitcnt lgkmcnt(4)
  v_mfma_f32_32x32x16_bf16 v[80:95], v[16:19], a[24:27], v[80:95]
  ds_read_b64_tr_b16 v[36:37], v6 offset:11264
  ds_read_b64_tr_b16 v[38:39], v6 offset:11776
  s_lshl_b32 s39, s37, 8
  v_mfma_f32_32x32x16_bf16 v[80:95], v[20:23], a[28:31], v[80:95]
  ds_read_b64_tr_b16 v[16:17], v6 offset:12288
  ds_read_b64_tr_b16 v[18:19], v6 offset:12800
  v_cvt_pk_bf16_f32 v97, v50, v51
  v_cvt_pk_bf16_f32 v98, v52, v53
  v_mfma_f32_32x32x16_bf16 v[80:95], v[24:27], a[32:35], v[80:95]
  ds_read_b64_tr_b16 v[20:21], v6 offset:13312
  ds_read_b64_tr_b16 v[22:23], v6 offset:13824
  buffer_load_dwordx4 v3, s[24:27], s42 offen offset:2048 lds
  s_waitcnt lgkmcnt(4)
  v_mfma_f32_32x32x16_bf16 v[80:95], v[28:31], a[36:39], v[80:95]
  ds_read_b64_tr_b16 v[24:25], v6 offset:14336
  ds_read_b64_tr_b16 v[26:27], v6 offset:14848
  v_mfma_f32_32x32x16_bf16 v[80:95], v[32:35], a[40:43], v[80:95]
  ds_read_b64_tr_b16 v[28:29], v6 offset:15360
  ds_read_b64_tr_b16 v[30:31], v6 offset:15872
  v_cvt_pk_bf16_f32 v99, v54, v55
  v_mfma_f32_32x32x16_bf16 v[80:95], v[36:39], a[44:47], v[80:95]
  ds_read_b64_tr_b16 v[32:33], v6 offset:16384
  ds_read_b64_tr_b16 v[34:35], v6 offset:16896
  buffer_load_dwordx4 v3, s[24:27], s43 offen offset:3072 lds
  s_waitcnt lgkmcnt(4)
  v_mfma_f32_32x32x16_bf16 v[80:95], v[16:19], a[48:51], v[80:95]
  ds_read_b64_tr_b16 v[36:37], v6 offset:17408
  ds_read_b64_tr_b16 v[38:39], v6 offset:17920
  v_mfma_f32_32x32x16_bf16 v[80:95], v[20:23], a[52:55], v[80:95]
  ds_read_b64_tr_b16 v[16:17], v6 offset:18432
  ds_read_b64_tr_b16 v[18:19], v6 offset:18944
  s_add_u32 s39, s39, 11536384
  s_add_u32 m0, s30, 40960
  v_mfma_f32_32x32x16_bf16 v[80:95], v[24:27], a[56:59], v[80:95]
  ds_read_b64_tr_b16 v[20:21], v6 offset:19456
  ds_read_b64_tr_b16 v[22:23], v6 offset:19968
  buffer_load_dwordx4 v3, s[24:27], s44 offen offset:0 lds
  s_waitcnt lgkmcnt(4)
  v_mfma_f32_32x32x16_bf16 v[80:95], v[28:31], a[60:63], v[80:95]
  ds_read_b64_tr_b16 v[24:25], v6 offset:20480
  ds_read_b64_tr_b16 v[26:27], v6 offset:20992
  v_mfma_f32_32x32x16_bf16 v[80:95], v[32:35], a[64:67], v[80:95]
  ds_read_b64_tr_b16 v[28:29], v6 offset:21504
  ds_read_b64_tr_b16 v[30:31], v6 offset:22016
  v_cvt_pk_bf16_f32 v100, v56, v57
  v_mfma_f32_32x32x16_bf16 v[80:95], v[36:39], a[68:71], v[80:95]
  ds_read_b64_tr_b16 v[32:33], v6 offset:22528
  ds_read_b64_tr_b16 v[34:35], v6 offset:23040
  buffer_load_dwordx4 v3, s[24:27], s45 offen offset:1024 lds
  s_waitcnt lgkmcnt(4)
  v_mfma_f32_32x32x16_bf16 v[80:95], v[16:19], a[72:75], v[80:95]
  ds_read_b64_tr_b16 v[36:37], v6 offset:23552
  ds_read_b64_tr_b16 v[38:39], v6 offset:24064
  v_mfma_f32_32x32x16_bf16 v[80:95], v[20:23], a[76:79], v[80:95]
  ds_read_b64_tr_b16 v[16:17], v6 offset:24576
  ds_read_b64_tr_b16 v[18:19], v6 offset:25088
  v_cvt_pk_bf16_f32 v101, v58, v59
  v_cvt_pk_bf16_f32 v102, v60, v61
  v_mfma_f32_32x32x16_bf16 v[80:95], v[24:27], a[80:83], v[80:95]
  ds_read_b64_tr_b16 v[20:21], v6 offset:25600
  ds_read_b64_tr_b16 v[22:23], v6 offset:26112
  buffer_load_dwordx4 v3, s[24:27], s46 offen offset:2048 lds
  s_waitcnt lgkmcnt(4)
  v_mfma_f32_32x32x16_bf16 v[80:95], v[28:31], a[84:87], v[80:95]
  ds_read_b64_tr_b16 v[24:25], v6 offset:26624
  ds_read_b64_tr_b16 v[26:27], v6 offset:27136
  v_mfma_f32_32x32x16_bf16 v[80:95], v[32:35], a[88:91], v[80:95]
  ds_read_b64_tr_b16 v[28:29], v6 offset:27648
  ds_read_b64_tr_b16 v[30:31], v6 offset:28160
  v_cvt_pk_bf16_f32 v103, v62, v63
  s_add_u32 s3, s39, 4096
  v_mfma_f32_32x32x16_bf16 v[80:95], v[36:39], a[92:95], v[80:95]
  ds_read_b64_tr_b16 v[32:33], v6 offset:28672
  ds_read_b64_tr_b16 v[34:35], v6 offset:29184
  buffer_load_dwordx4 v3, s[24:27], s47 offen offset:3072 lds
  s_waitcnt lgkmcnt(4)
  v_mfma_f32_32x32x16_bf16 v[80:95], v[16:19], a[96:99], v[80:95]
  ds_read_b64_tr_b16 v[36:37], v6 offset:29696
  ds_read_b64_tr_b16 v[38:39], v6 offset:30208
  v_mfma_f32_32x32x16_bf16 v[80:95], v[20:23], a[100:103], v[80:95]
  ds_read_b64_tr_b16 v[16:17], v6 offset:30720
  ds_read_b64_tr_b16 v[18:19], v6 offset:31232
  s_add_u32 m0, s30, 45056
  v_mfma_f32_32x32x16_bf16 v[80:95], v[24:27], a[104:107], v[80:95]
  ds_read_b64_tr_b16 v[20:21], v6 offset:31744
  ds_read_b64_tr_b16 v[22:23], v6 offset:32256
  buffer_load_dwordx4 v3, s[24:27], s48 offen offset:0 lds
  s_waitcnt lgkmcnt(4)
  v_mfma_f32_32x32x16_bf16 v[80:95], v[28:31], a[108:111], v[80:95]
  ds_read_b64_tr_b16 v[24:25], v6 offset:32768
  ds_read_b64_tr_b16 v[26:27], v6 offset:33280
  s_add_u32 s38, s49, 22528
  buffer_store_dwordx4 v[96:99], v1, s[52:55], s38 offen sc1
  buffer_store_dwordx4 v[100:103], v1, s[52:55], s38 offen offset:1024 sc1
  v_mfma_f32_32x32x16_bf16 v[80:95], v[32:35], a[112:115], v[80:95]
  ds_read_b64_tr_b16 v[28:29], v6 offset:33792
  ds_read_b64_tr_b16 v[30:31], v6 offset:34304
  buffer_load_dword v12, off, s[52:55], s39 sc1
  buffer_load_dword v13, off, s[52:55], s3 sc1
  v_mfma_f32_32x32x16_bf16 v[80:95], v[36:39], a[116:119], v[80:95]
  ds_read_b64_tr_b16 v[32:33], v6 offset:34816
  ds_read_b64_tr_b16 v[34:35], v6 offset:35328
  s_waitcnt lgkmcnt(4)
  v_mfma_f32_32x32x16_bf16 v[80:95], v[16:19], a[120:123], v[80:95]
  ds_read_b64_tr_b16 v[36:37], v6 offset:35840
  ds_read_b64_tr_b16 v[38:39], v6 offset:36352
  v_mfma_f32_32x32x16_bf16 v[80:95], v[20:23], a[124:127], v[80:95]
  s_waitcnt vmcnt(15)
  s_barrier
  v_add_u32 v6, 0, v5
  ds_read_b64_tr_b16 v[16:17], v6 offset:0
  ds_read_b64_tr_b16 v[18:19], v6 offset:512
  v_mfma_f32_32x32x16_bf16 v[80:95], v[24:27], a[128:131], v[80:95]
  ds_read_b64_tr_b16 v[20:21], v6 offset:1024
  ds_read_b64_tr_b16 v[22:23], v6 offset:1536
  s_waitcnt lgkmcnt(4)
  v_mfma_f32_32x32x16_bf16 v[80:95], v[28:31], a[132:135], v[80:95]
  ds_read_b64_tr_b16 v[24:25], v6 offset:2048
  ds_read_b64_tr_b16 v[26:27], v6 offset:2560
  v_mfma_f32_32x32x16_bf16 v[80:95], v[32:35], a[136:139], v[80:95]
  ds_read_b64_tr_b16 v[28:29], v6 offset:3072
  ds_read_b64_tr_b16 v[30:31], v6 offset:3584
  v_mfma_f32_32x32x16_bf16 v[80:95], v[36:39], a[140:143], v[80:95]
  ds_read_b64_tr_b16 v[32:33], v6 offset:4096
  ds_read_b64_tr_b16 v[34:35], v6 offset:4608
  s_waitcnt lgkmcnt(4)
  v_mfma_f32_32x32x16_bf16 v[48:63], v[16:19], a[0:3], 0
  ds_read_b64_tr_b16 v[36:37], v6 offset:5120
  ds_read_b64_tr_b16 v[38:39], v6 offset:5632
  v_mfma_f32_32x32x16_bf16 v[48:63], v[20:23], a[4:7], v[48:63]
  ds_read_b64_tr_b16 v[16:17], v6 offset:6144
  ds_read_b64_tr_b16 v[18:19], v6 offset:6656
  s_add_u32 m0, s30, 73728
  v_mfma_f32_32x32x16_bf16 v[48:63], v[24:27], a[8:11], v[48:63]
  ds_read_b64_tr_b16 v[20:21], v6 offset:7168
  ds_read_b64_tr_b16 v[22:23], v6 offset:7680
  buffer_load_dwordx4 v200, s[16:19], 0 offen offset:0 lds
  s_waitcnt lgkmcnt(4)
  v_mfma_f32_32x32x16_bf16 v[48:63], v[28:31], a[12:15], v[48:63]
  ds_read_b64_tr_b16 v[24:25], v6 offset:8192
  ds_read_b64_tr_b16 v[26:27], v6 offset:8704
  v_mfma_f32_32x32x16_bf16 v[48:63], v[32:35], a[16:19], v[48:63]
  ds_read_b64_tr_b16 v[28:29], v6 offset:9216
  ds_read_b64_tr_b16 v[30:31], v6 offset:9728
  v_cvt_pk_bf16_f32 v104, v80, v81
  v_mfma_f32_32x32x16_bf16 v[48:63], v[36:39], a[20:23], v[48:63]
  ds_read_b64_tr_b16 v[32:33], v6 offset:10240
  ds_read_b64_tr_b16 v[34:35], v6 offset:10752
  buffer_load_dwordx4 v200, s[16:19], s67 offen offset:1024 lds
  s_waitcnt lgkmcnt(4)
  v_mfma_f32_32x32x16_bf16 v[48:63], v[16:19], a[24:27], v[48:63]
  ds_read_b64_tr_b16 v[36:37], v6 offset:11264
  ds_read_b64_tr_b16 v[38:39], v6 offset:11776
  v_mfma_f32_32x32x16_bf16 v[48:63], v[20:23], a[28:31], v[48:63]
  ds_read_b64_tr_b16 v[16:17], v6 offset:12288
  ds_read_b64_tr_b16 v[18:19], v6 offset:12800
  v_cvt_pk_bf16_f32 v105, v82, v83
  v_cvt_pk_bf16_f32 v106, v84, v85
  v_mfma_f32_32x32x16_bf16 v[48:63], v[24:27], a[32:35], v[48:63]
  ds_read_b64_tr_b16 v[20:21], v6 offset:13312
  ds_read_b64_tr_b16 v[22:23], v6 offset:13824
  buffer_load_dwordx4 v200, s[16:19], s68 offen offset:2048 lds
  s_waitcnt lgkmcnt(4)
  v_mfma_f32_32x32x16_bf16 v[48:63], v[28:31], a[36:39], v[48:63]
  ds_read_b64_tr_b16 v[24:25], v6 offset:14336
  ds_read_b64_tr_b16 v[26:27], v6 offset:14848
  v_mfma_f32_32x32x16_bf16 v[48:63], v[32:35], a[40:43], v[48:63]
  ds_read_b64_tr_b16 v[28:29], v6 offset:15360
  ds_read_b64_tr_b16 v[30:31], v6 offset:15872
  v_cvt_pk_bf16_f32 v107, v86, v87
  v_mfma_f32_32x32x16_bf16 v[48:63], v[36:39], a[44:47], v[48:63]
  ds_read_b64_tr_b16 v[32:33], v6 offset:16384
  ds_read_b64_tr_b16 v[34:35], v6 offset:16896
  buffer_load_dwordx4 v200, s[16:19], s69 offen offset:3072 lds
  s_waitcnt lgkmcnt(4)
  v_mfma_f32_32x32x16_bf16 v[48:63], v[16:19], a[48:51], v[48:63]
  ds_read_b64_tr_b16 v[36:37], v6 offset:17408
  ds_read_b64_tr_b16 v[38:39], v6 offset:17920
  v_mfma_f32_32x32x16_bf16 v[48:63], v[20:23], a[52:55], v[48:63]
  ds_read_b64_tr_b16 v[16:17], v6 offset:18432
  ds_read_b64_tr_b16 v[18:19], v6 offset:18944
  s_add_u32 m0, s30, 77824
  v_mfma_f32_32x32x16_bf16 v[48:63], v[24:27], a[56:59], v[48:63]
  ds_read_b64_tr_b16 v[20:21], v6 offset:19456
  ds_read_b64_tr_b16 v[22:23], v6 offset:19968
  buffer_load_dwordx4 v200, s[16:19], s70 offen offset:0 lds
  s_waitcnt lgkmcnt(4)
  v_mfma_f32_32x32x16_bf16 v[48:63], v[28:31], a[60:63], v[48:63]
  ds_read_b64_tr_b16 v[24:25], v6 offset:20480
  ds_read_b64_tr_b16 v[26:27], v6 offset:20992
  v_mfma_f32_32x32x16_bf16 v[48:63], v[32:35], a[64:67], v[48:63]
  ds_read_b64_tr_b16 v[28:29], v6 offset:21504
  ds_read_b64_tr_b16 v[30:31], v6 offset:22016
  v_cvt_pk_bf16_f32 v108, v88, v89
  v_mfma_f32_32x32x16_bf16 v[48:63], v[36:39], a[68:71], v[48:63]
  ds_read_b64_tr_b16 v[32:33], v6 offset:22528
  ds_read_b64_tr_b16 v[34:35], v6 offset:23040
  buffer_load_dwordx4 v201, s[16:19], s71 offen offset:1024 lds
  s_waitcnt lgkmcnt(4)
  v_mfma_f32_32x32x16_bf16 v[48:63], v[16:19], a[72:75], v[48:63]
  ds_read_b64_tr_b16 v[36:37], v6 offset:23552
  ds_read_b64_tr_b16 v[38:39], v6 offset:24064
  v_mfma_f32_32x32x16_bf16 v[48:63], v[20:23], a[76:79], v[48:63]
  ds_read_b64_tr_b16 v[16:17], v6 offset:24576
  ds_read_b64_tr_b16 v[18:19], v6 offset:25088
  v_cvt_pk_bf16_f32 v109, v90, v91
  v_cvt_pk_bf16_f32 v110, v92, v93
  v_mfma_f32_32x32x16_bf16 v[48:63], v[24:27], a[80:83], v[48:63]
  ds_read_b64_tr_b16 v[20:21], v6 offset:25600
  ds_read_b64_tr_b16 v[22:23], v6 offset:26112
  buffer_load_dwordx4 v201, s[16:19], s72 offen offset:2048 lds
  s_waitcnt lgkmcnt(4)
  v_mfma_f32_32x32x16_bf16 v[48:63], v[28:31], a[84:87], v[48:63]
  ds_read_b64_tr_b16 v[24:25], v6 offset:26624
  ds_read_b64_tr_b16 v[26:27], v6 offset:27136
  v_mfma_f32_32x32x16_bf16 v[48:63], v[32:35], a[88:91], v[48:63]
  ds_read_b64_tr_b16 v[28:29], v6 offset:27648
  ds_read_b64_tr_b16 v[30:31], v6 offset:28160
  v_cvt_pk_bf16_f32 v111, v94, v95
  v_mfma_f32_32x32x16_bf16 v[48:63], v[36:39], a[92:95], v[48:63]
  ds_read_b64_tr_b16 v[32:33], v6 offset:28672
  ds_read_b64_tr_b16 v[34:35], v6 offset:29184
  buffer_load_dwordx4 v201, s[16:19], s73 offen offset:3072 lds
  s_waitcnt lgkmcnt(4)
  v_mfma_f32_32x32x16_bf16 v[48:63], v[16:19], a[96:99], v[48:63]
  ds_read_b64_tr_b16 v[36:37], v6 offset:29696
  ds_read_b64_tr_b16 v[38:39], v6 offset:30208
  v_mfma_f32_32x32x16_bf16 v[48:63], v[20:23], a[100:103], v[48:63]
  ds_read_b64_tr_b16 v[16:17], v6 offset:30720
  ds_read_b64_tr_b16 v[18:19], v6 offset:31232
  s_add_u32 m0, s30, 81920
  v_mfma_f32_32x32x16_bf16 v[48:63], v[24:27], a[104:107], v[48:63]
  ds_read_b64_tr_b16 v[20:21], v6 offset:31744
  ds_read_b64_tr_b16 v[22:23], v6 offset:32256
  buffer_load_dwordx4 v201, s[16:19], s74 offen offset:0 lds
  s_waitcnt lgkmcnt(4)
  v_mfma_f32_32x32x16_bf16 v[48:63], v[28:31], a[108:111], v[48:63]
  ds_read_b64_tr_b16 v[24:25], v6 offset:32768
  ds_read_b64_tr_b16 v[26:27], v6 offset:33280
  s_add_u32 s38, s49, 26624
  buffer_store_dwordx4 v[104:107], v1, s[52:55], s38 offen sc1
  buffer_store_dwordx4 v[108:111], v1, s[52:55], s38 offen offset:1024 sc1
  v_add_u32 v200, 64, v200
  v_add_u32 v201, 64, v201
  v_mfma_f32_32x32x16_bf16 v[48:63], v[32:35], a[112:115], v[48:63]
  ds_read_b64_tr_b16 v[28:29], v6 offset:33792
  ds_read_b64_tr_b16 v[30:31], v6 offset:34304
  v_mfma_f32_32x32x16_bf16 v[48:63], v[36:39], a[116:119], v[48:63]
  ds_read_b64_tr_b16 v[32:33], v6 offset:34816
  ds_read_b64_tr_b16 v[34:35], v6 offset:35328
  s_waitcnt lgkmcnt(4)
  v_mfma_f32_32x32x16_bf16 v[48:63], v[16:19], a[120:123], v[48:63]
  ds_read_b64_tr_b16 v[36:37], v6 offset:35840
  ds_read_b64_tr_b16 v[38:39], v6 offset:36352
  v_mfma_f32_32x32x16_bf16 v[48:63], v[20:23], a[124:127], v[48:63]
  s_waitcnt vmcnt(15)
  s_barrier
  v_add_u32 v6, 36864, v5
  ds_read_b64_tr_b16 v[16:17], v6 offset:0
  ds_read_b64_tr_b16 v[18:19], v6 offset:512
  v_mfma_f32_32x32x16_bf16 v[48:63], v[24:27], a[128:131], v[48:63]
  ds_read_b64_tr_b16 v[20:21], v6 offset:1024
  ds_read_b64_tr_b16 v[22:23], v6 offset:1536
  s_waitcnt vmcnt(11)
  v_min_u32 v15, v12, v13
  s_waitcnt lgkmcnt(4)
  v_mfma_f32_32x32x16_bf16 v[48:63], v[28:31], a[132:135], v[48:63]
  ds_read_b64_tr_b16 v[24:25], v6 offset:2048
  ds_read_b64_tr_b16 v[26:27], v6 offset:2560
  v_readfirstlane_b32 s60, v15
  v_mfma_f32_32x32x16_bf16 v[48:63], v[32:35], a[136:139], v[48:63]
  ds_read_b64_tr_b16 v[28:29], v6 offset:3072
  ds_read_b64_tr_b16 v[30:31], v6 offset:3584
  s_cmp_ge_u32 s60, 8
  s_cselect_b32 s60, 0, 2146435072
  v_or_b32 v14, s60, v1
  v_mfma_f32_32x32x16_bf16 v[48:63], v[36:39], a[140:143], v[48:63]
  ds_read_b64_tr_b16 v[32:33], v6 offset:4096
  ds_read_b64_tr_b16 v[34:35], v6 offset:4608
  s_waitcnt lgkmcnt(4)
  v_mfma_f32_32x32x16_bf16 v[80:95], v[16:19], a[0:3], 0
  ds_read_b64_tr_b16 v[36:37], v6 offset:5120
  ds_read_b64_tr_b16 v[38:39], v6 offset:5632
  buffer_load_dwordx4 v[112:115], v14, s[52:55], s61 offen offset:0 sc1
  v_mfma_f32_32x32x16_bf16 v[80:95], v[20:23], a[4:7], v[80:95]
  ds_read_b64_tr_b16 v[16:17], v6 offset:6144
  ds_read_b64_tr_b16 v[18:19], v6 offset:6656
  buffer_load_dwordx4 v[116:119], v14, s[52:55], s61 offen offset:1024 sc1
  s_add_u32 m0, s30, 110592
  v_mfma_f32_32x32x16_bf16 v[80:95], v[24:27], a[8:11], v[80:95]
  ds_read_b64_tr_b16 v[20:21], v6 offset:7168
  ds_read_b64_tr_b16 v[22:23], v6 offset:7680
  buffer_load_dwordx4 v200, s[16:19], 0 offen offset:0 lds
  s_waitcnt lgkmcnt(4)
  v_mfma_f32_32x32x16_bf16 v[80:95], v[28:31], a[12:15], v[80:95]
  ds_read_b64_tr_b16 v[24:25], v6 offset:8192
  ds_read_b64_tr_b16 v[26:27], v6 offset:8704
  buffer_load_dwordx4 v[120:123], v14, s[52:55], s61 offen offset:2048 sc1
  v_mfma_f32_32x32x16_bf16 v[80:95], v[32:35], a[16:19], v[80:95]
  ds_read_b64_tr_b16 v[28:29], v6 offset:9216
  ds_read_b64_tr_b16 v[30:31], v6 offset:9728
  buffer_load_dwordx4 v[124:127], v14, s[52:55], s61 offen offset:3072 sc1
  v_cvt_pk_bf16_f32 v96, v48, v49
  v_mfma_f32_32x32x16_bf16 v[80:95], v[36:39], a[20:23], v[80:95]
  ds_read_b64_tr_b16 v[32:33], v6 offset:10240
  ds_read_b64_tr_b16 v[34:35], v6 offset:10752
  buffer_load_dwordx4 v200, s[16:19], s67 offen offset:1024 lds
  s_waitcnt lgkmcnt(4)
  v_mfma_f32_32x32x16_bf16 v[80:95], v[16:19], a[24:27], v[80:95]
  ds_read_b64_tr_b16 v[36:37], v6 offset:11264
  ds_read_b64_tr_b16 v[38:39], v6 offset:11776
  s_add_u32 s61, s61, 4096
  buffer_load_dwordx4 v[128:131], v14, s[52:55], s61 offen offset:0 sc1
  v_mfma_f32_32x32x16_bf16 v[80:95], v[20:23], a[28:31], v[80:95]
  ds_read_b64_tr_b16 v[16:17], v6 offset:12288
  ds_read_b64_tr_b16 v[18:19], v6 offset:12800
  buffer_load_dwordx4 v[132:135], v14, s[52:55], s61 offen offset:1024 sc1
  v_cvt_pk_bf16_f32 v97, v50, v51
  v_cvt_pk_bf16_f32 v98, v52, v53
  v_mfma_f32_32x32x16_bf16 v[80:95], v[24:27], a[32:35], v[80:95]
  ds_read_b64_tr_b16 v[20:21], v6 offset:13312
  ds_read_b64_tr_b16 v[22:23], v6 offset:13824
  buffer_load_dwordx4 v200, s[16:19], s68 offen offset:2048 lds
  s_waitcnt lgkmcnt(4)
  v_mfma_f32_32x32x16_bf16 v[80:95], v[28:31], a[36:39], v[80:95]
  ds_read_b64_tr_b16 v[24:25], v6 offset:14336
  ds_read_b64_tr_b16 v[26:27], v6 offset:14848
  buffer_load_dwordx4 v[136:139], v14, s[52:55], s61 offen offset:2048 sc1
  v_mfma_f32_32x32x16_bf16 v[80:95], v[32:35], a[40:43], v[80:95]
  ds_read_b64_tr_b16 v[28:29], v6 offset:15360
  ds_read_b64_tr_b16 v[30:31], v6 offset:15872
  buffer_load_dwordx4 v[140:143], v14, s[52:55], s61 offen offset:3072 sc1
  v_cvt_pk_bf16_f32 v99, v54, v55
  v_mfma_f32_32x32x16_bf16 v[80:95], v[36:39], a[44:47], v[80:95]
  ds_read_b64_tr_b16 v[32:33], v6 offset:16384
  ds_read_b64_tr_b16 v[34:35], v6 offset:16896
  buffer_load_dwordx4 v200, s[16:19], s69 offen offset:3072 lds
  s_waitcnt lgkmcnt(4)
  v_mfma_f32_32x32x16_bf16 v[80:95], v[16:19], a[48:51], v[80:95]
  ds_read_b64_tr_b16 v[36:37], v6 offset:17408
  ds_read_b64_tr_b16 v[38:39], v6 offset:17920
  s_add_u32 s61, s61, 4096
  buffer_load_dwordx4 v[144:147], v14, s[52:55], s61 offen offset:0 sc1
  v_mfma_f32_32x32x16_bf16 v[80:95], v[20:23], a[52:55], v[80:95]
  ds_read_b64_tr_b16 v[16:17], v6 offset:18432
  ds_read_b64_tr_b16 v[18:19], v6 offset:18944
  buffer_load_dwordx4 v[148:151], v14, s[52:55], s61 offen offset:1024 sc1
  s_add_u32 m0, s30, 114688
  v_mfma_f32_32x32x16_bf16 v[80:95], v[24:27], a[56:59], v[80:95]
  ds_read_b64_tr_b16 v[20:21], v6 offset:19456
  ds_read_b64_tr_b16 v[22:23], v6 offset:19968
  buffer_load_dwordx4 v200, s[16:19], s70 offen offset:0 lds
  s_waitcnt lgkmcnt(4)
  v_mfma_f32_32x32x16_bf16 v[80:95], v[28:31], a[60:63], v[80:95]
  ds_read_b64_tr_b16 v[24:25], v6 offset:20480
  ds_read_b64_tr_b16 v[26:27], v6 offset:20992
  buffer_load_dwordx4 v[152:155], v14, s[52:55], s61 offen offset:2048 sc1
  v_mfma_f32_32x32x16_bf16 v[80:95], v[32:35], a[64:67], v[80:95]
  ds_read_b64_tr_b16 v[28:29], v6 offset:21504
  ds_read_b64_tr_b16 v[30:31], v6 offset:22016
  buffer_load_dwordx4 v[156:159], v14, s[52:55], s61 offen offset:3072 sc1
  v_cvt_pk_bf16_f32 v100, v56, v57
  v_mfma_f32_32x32x16_bf16 v[80:95], v[36:39], a[68:71], v[80:95]
  ds_read_b64_tr_b16 v[32:33], v6 offset:22528
  ds_read_b64_tr_b16 v[34:35], v6 offset:23040
  buffer_load_dwordx4 v201, s[16:19], s71 offen offset:1024 lds
  s_waitcnt lgkmcnt(4)
  v_mfma_f32_32x32x16_bf16 v[80:95], v[16:19], a[72:75], v[80:95]
  ds_read_b64_tr_b16 v[36:37], v6 offset:23552
  ds_read_b64_tr_b16 v[38:39], v6 offset:24064
  s_add_u32 s61, s61, 4096
  buffer_load_dwordx4 v[160:163], v14, s[52:55], s61 offen offset:0 sc1
  v_mfma_f32_32x32x16_bf16 v[80:95], v[20:23], a[76:79], v[80:95]
  ds_read_b64_tr_b16 v[16:17], v6 offset:24576
  ds_read_b64_tr_b16 v[18:19], v6 offset:25088
  buffer_load_dwordx4 v[164:167], v14, s[52:55], s61 offen offset:1024 sc1
  v_cvt_pk_bf16_f32 v101, v58, v59
  v_cvt_pk_bf16_f32 v102, v60, v61
  v_mfma_f32_32x32x16_bf16 v[80:95], v[24:27], a[80:83], v[80:95]
  ds_read_b64_tr_b16 v[20:21], v6 offset:25600
  ds_read_b64_tr_b16 v[22:23], v6 offset:26112
  buffer_load_dwordx4 v201, s[16:19], s72 offen offset:2048 lds
  s_waitcnt lgkmcnt(4)
  v_mfma_f32_32x32x16_bf16 v[80:95], v[28:31], a[84:87], v[80:95]
  ds_read_b64_tr_b16 v[24:25], v6 offset:26624
  ds_read_b64_tr_b16 v[26:27], v6 offset:27136
  buffer_load_dwordx4 v[168:171], v14, s[52:55], s61 offen offset:2048 sc1
  v_mfma_f32_32x32x16_bf16 v[80:95], v[32:35], a[88:91], v[80:95]
  ds_read_b64_tr_b16 v[28:29], v6 offset:27648
  ds_read_b64_tr_b16 v[30:31], v6 offset:28160
  buffer_load_dwordx4 v[172:175], v14, s[52:55], s61 offen offset:3072 sc1
  v_cvt_pk_bf16_f32 v103, v62, v63
  v_mfma_f32_32x32x16_bf16 v[80:95], v[36:39], a[92:95], v[80:95]
  ds_read_b64_tr_b16 v[32:33], v6 offset:28672
  ds_read_b64_tr_b16 v[34:35], v6 offset:29184
  buffer_load_dwordx4 v201, s[16:19], s73 offen offset:3072 lds
  s_waitcnt lgkmcnt(4)
  v_mfma_f32_32x32x16_bf16 v[80:95], v[16:19], a[96:99], v[80:95]
  ds_read_b64_tr_b16 v[36:37], v6 offset:29696
  ds_read_b64_tr_b16 v[38:39], v6 offset:30208
  s_add_u32 s61, s61, 4096
  buffer_load_dwordx4 v[184:187], v14, s[52:55], s61 offen offset:0 sc1
  v_mfma_f32_32x32x16_bf16 v[80:95], v[20:23], a[100:103], v[80:95]
  ds_read_b64_tr_b16 v[16:17], v6 offset:30720
  ds_read_b64_tr_b16 v[18:19], v6 offset:31232
  buffer_load_dwordx4 v[188:191], v14, s[52:55], s61 offen offset:1024 sc1
  s_add_u32 m0, s30, 118784
  v_mfma_f32_32x32x16_bf16 v[80:95], v[24:27], a[104:107], v[80:95]
  ds_read_b64_tr_b16 v[20:21], v6 offset:31744
  ds_read_b64_tr_b16 v[22:23], v6 offset:32256
  buffer_load_dwordx4 v201, s[16:19], s74 offen offset:0 lds
  s_waitcnt lgkmcnt(4)
  v_mfma_f32_32x32x16_bf16 v[80:95], v[28:31], a[108:111], v[80:95]
  ds_read_b64_tr_b16 v[24:25], v6 offset:32768
  ds_read_b64_tr_b16 v[26:27], v6 offset:33280
  s_add_u32 s38, s49, 30720
  buffer_store_dwordx4 v[96:99], v1, s[52:55], s38 offen sc1
  buffer_store_dwordx4 v[100:103], v1, s[52:55], s38 offen offset:1024 sc1
  v_mfma_f32_32x32x16_bf16 v[80:95], v[32:35], a[112:115], v[80:95]
  ds_read_b64_tr_b16 v[28:29], v6 offset:33792
  ds_read_b64_tr_b16 v[30:31], v6 offset:34304
  v_mfma_f32_32x32x16_bf16 v[80:95], v[36:39], a[116:119], v[80:95]
  ds_read_b64_tr_b16 v[32:33], v6 offset:34816
  ds_read_b64_tr_b16 v[34:35], v6 offset:35328
  s_waitcnt lgkmcnt(4)
  v_mfma_f32_32x32x16_bf16 v[80:95], v[16:19], a[120:123], v[80:95]
  ds_read_b64_tr_b16 v[36:37], v6 offset:35840
  ds_read_b64_tr_b16 v[38:39], v6 offset:36352
  v_mfma_f32_32x32x16_bf16 v[80:95], v[20:23], a[124:127], v[80:95]
  v_mfma_f32_32x32x16_bf16 v[80:95], v[24:27], a[128:131], v[80:95]
  s_waitcnt lgkmcnt(0)
  v_mfma_f32_32x32x16_bf16 v[80:95], v[28:31], a[132:135], v[80:95]
  v_mfma_f32_32x32x16_bf16 v[80:95], v[32:35], a[136:139], v[80:95]
  v_mfma_f32_32x32x16_bf16 v[80:95], v[36:39], a[140:143], v[80:95]
  s_nop 7
  s_nop 3
  v_cvt_pk_bf16_f32 v104, v80, v81
  v_cvt_pk_bf16_f32 v105, v82, v83
  v_cvt_pk_bf16_f32 v106, v84, v85
  v_cvt_pk_bf16_f32 v107, v86, v87
  v_cvt_pk_bf16_f32 v108, v88, v89
  v_cvt_pk_bf16_f32 v109, v90, v91
  v_cvt_pk_bf16_f32 v110, v92, v93
  v_cvt_pk_bf16_f32 v111, v94, v95
  s_nop 1
  s_add_u32 s38, s49, 34816
  buffer_store_dwordx4 v[104:107], v1, s[52:55], s38 offen sc1
  buffer_store_dwordx4 v[108:111], v1, s[52:55], s38 offen offset:1024 sc1
  v_mov_b32 v4, v1
  s_add_u32 s39, s39, 4224
  s_and_b32 s45, s28, 1
  s_mul_i32 s38, s45, 55296
  s_add_u32 s38, s38, 73728
  v_add_u32 v250, s38, v5
  s_mul_i32 s38, s45, 18432
  s_sub_u32 s38, 110592, s38
  v_add_u32 v251, s38, v5
  s_mul_i32 s38, s45, 18432
  s_add_u32 s46, s38, 73728
  v_add_u32 v252, s46, v5
  s_mul_i32 s43, s63, 36864
  s_add_u32 s43, s43, s38
  s_add_u32 s43, s43, 8388608
  s_lshl_b32 s38, s28, 13
  s_add_u32 s38, s38, 0
  v_add_u32 v253, s38, v4
  s_lshl_b32 s38, s28, 13
  s_xor_b32 s38, s38, 8192
  s_add_u32 s38, s38, 0
  v_add_u32 v254, s38, v4
  s_mul_i32 s47, s63, 36864
  s_lshl_b32 s38, s36, 12
  s_add_u32 s47, s47, s38
  s_lshl_b32 s38, s45, 11
  s_add_u32 s47, s47, s38
  s_add_u32 s47, s47, 12582912
  s_mov_b32 s42, s47
  s_mul_i32 s38, s45, 2146435072
  v_or_b32 v255, s38, v4
  s_mov_b32 s40, 0xbfb8aa3b
  s_waitcnt vmcnt(0)
  s_barrier
  s_cmp_lg_u32 s28, 0
  s_cbranch_scc1 1f
  s_mov_b64 exec, 1
  v_mov_b32 v15, 1
  buffer_atomic_add v15, off, s[52:55], s39 sc1
  s_mov_b64 exec, -1
1:
  s_sub_u32 s39, s39, 4224
  s_cmp_eq_u32 s60, 0
  s_cbranch_scc1 .Lffn_have_o
  s_mov_b32 s31, 0x40000
1:
  buffer_load_dword v12, off, s[52:55], s39 sc1
  buffer_load_dword v13, off, s[52:55], s3 sc1
  s_waitcnt vmcnt(0)
  v_min_u32 v15, v12, v13
  s_nop 0
  v_readfirstlane_b32 s38, v15
  s_cmp_ge_u32 s38, 8
  s_cbranch_scc1 2f
  s_sleep 4
  s_sub_u32 s31, s31, 1
  s_cbranch_scc0 1b
2:
  s_sub_u32 s61, s61, 16384
  v_mov_b32 v14, v1
  buffer_load_dwordx4 v[112:115], v14, s[52:55], s61 offen offset:0 sc1
  buffer_load_dwordx4 v[116:119], v14, s[52:55], s61 offen offset:1024 sc1
  buffer_load_dwordx4 v[120:123], v14, s[52:55], s61 offen offset:2048 sc1
  buffer_load_dwordx4 v[124:127], v14, s[52:55], s61 offen offset:3072 sc1
  s_add_u32 s61, s61, 4096
  buffer_load_dwordx4 v[128:131], v14, s[52:55], s61 offen offset:0 sc1
  buffer_load_dwordx4 v[132:135], v14, s[52:55], s61 offen offset:1024 sc1
  buffer_load_dwordx4 v[136:139], v14, s[52:55], s61 offen offset:2048 sc1
  buffer_load_dwordx4 v[140:143], v14, s[52:55], s61 offen offset:3072 sc1
  s_add_u32 s61, s61, 4096
  buffer_load_dwordx4 v[144:147], v14, s[52:55], s61 offen offset:0 sc1
  buffer_load_dwordx4 v[148:151], v14, s[52:55], s61 offen offset:1024 sc1
  buffer_load_dwordx4 v[152:155], v14, s[52:55], s61 offen offset:2048 sc1
  buffer_load_dwordx4 v[156:159], v14, s[52:55], s61 offen offset:3072 sc1
  s_add_u32 s61, s61, 4096
  buffer_load_dwordx4 v[160:163], v14, s[52:55], s61 offen offset:0 sc1
  buffer_load_dwordx4 v[164:167], v14, s[52:55], s61 offen offset:1024 sc1
  buffer_load_dwordx4 v[168:171], v14, s[52:55], s61 offen offset:2048 sc1
  buffer_load_dwordx4 v[172:175], v14, s[52:55], s61 offen offset:3072 sc1
  s_add_u32 s61, s61, 4096
  buffer_load_dwordx4 v[184:187], v14, s[52:55], s61 offen offset:0 sc1
  buffer_load_dwordx4 v[188:191], v14, s[52:55], s61 offen offset:1024 sc1
  s_waitcnt vmcnt(0)
.Lffn_have_o:
  buffer_load_dwordx2 v[232:233], v9, s[56:59], s62 offen offset:0
  buffer_load_dwordx2 v[234:235], v9, s[56:59], s62 offen offset:16
  buffer_load_dwordx2 v[236:237], v9, s[56:59], s62 offen offset:32
  buffer_load_dwordx2 v[238:239], v9, s[56:59], s62 offen offset:48
  buffer_load_dwordx4 a[72:75], v255, s[52:55], s42 offen offset:0 sc1
  buffer_load_dwordx4 a[76:79], v255, s[52:55], s42 offen offset:1024 sc1
  s_add_u32 s42, s42, 2359296
  buffer_load_dwordx4 a[80:83], v255, s[52:55], s42 offen offset:0 sc1
  buffer_load_dwordx4 a[84:87], v255, s[52:55], s42 offen offset:1024 sc1
  s_add_u32 s42, s42, 2359296
  buffer_load_dwordx4 a[88:91], v255, s[52:55], s42 offen offset:0 sc1
  buffer_load_dwordx4 a[92:95], v255, s[52:55], s42 offen offset:1024 sc1
  s_add_u32 s42, s42, 2359296
  buffer_load_dwordx4 a[96:99], v255, s[52:55], s42 offen offset:0 sc1
  buffer_load_dwordx4 a[100:103], v255, s[52:55], s42 offen offset:1024 sc1
  s_add_u32 s42, s42, 2359296
  buffer_load_dwordx4 a[104:107], v255, s[52:55], s42 offen offset:0 sc1
  buffer_load_dwordx4 a[108:111], v255, s[52:55], s42 offen offset:1024 sc1
  s_add_u32 s42, s42, 2359296
  buffer_load_dwordx4 a[112:115], v255, s[52:55], s42 offen offset:0 sc1
  buffer_load_dwordx4 a[116:119], v255, s[52:55], s42 offen offset:1024 sc1
  s_add_u32 s42, s42, 2359296
  buffer_load_dwordx4 a[120:123], v255, s[52:55], s42 offen offset:0 sc1
  buffer_load_dwordx4 a[124:127], v255, s[52:55], s42 offen offset:1024 sc1
  s_add_u32 s42, s42, 2359296
  buffer_load_dwordx4 a[128:131], v255, s[52:55], s42 offen offset:0 sc1
  buffer_load_dwordx4 a[132:135], v255, s[52:55], s42 offen offset:1024 sc1
  ds_read_b64_tr_b16 v[16:17], v251 offset:0
  ds_read_b64_tr_b16 v[18:19], v251 offset:512
  ds_read_b64_tr_b16 v[20:21], v250 offset:0
  ds_read_b64_tr_b16 v[22:23], v250 offset:512
  ds_read_b64_tr_b16 v[24:25], v251 offset:1024
  ds_read_b64_tr_b16 v[26:27], v251 offset:1536
  ds_read_b64_tr_b16 v[28:29], v250 offset:1024
  ds_read_b64_tr_b16 v[30:31], v250 offset:1536
  ds_read_b64_tr_b16 v[64:65], v251 offset:2048
  ds_read_b64_tr_b16 v[66:67], v251 offset:2560
  ds_read_b64_tr_b16 v[68:69], v250 offset:2048
  ds_read_b64_tr_b16 v[70:71], v250 offset:2560
  s_waitcnt lgkmcnt(10)
  v_mfma_f32_32x32x16_bf16 v[48:63], v[16:19], v[112:115], 0
  ds_read_b64_tr_b16 v[72:73], v251 offset:3072
  ds_read_b64_tr_b16 v[74:75], v251 offset:3584
  v_and_b32 v13, 31, v0
  v_lshrrev_b32 v12, 5, v0
  v_mul_u32_u24 v248, 1152, v13
  s_waitcnt lgkmcnt(10)
  v_mfma_f32_32x32x16_bf16 v[32:47], v[20:23], v[112:115], 0
  ds_read_b64_tr_b16 v[76:77], v250 offset:3072
  ds_read_b64_tr_b16 v[78:79], v250 offset:3584
  v_lshl_add_u32 v248, v12, 4, v248
  v_lshlrev_b32 v12, 2, v12
  v_sub_u32 v13, v13, v12
  s_waitcnt lgkmcnt(10)
  v_mfma_f32_32x32x16_bf16 v[48:63], v[24:27], v[116:119], v[48:63]
  ds_read_b64_tr_b16 v[16:17], v251 offset:4096
  ds_read_b64_tr_b16 v[18:19], v251 offset:4608
  v_mov_b32 v10, 0x3f80
  v_mov_b32 v11, 0x3f800000
  v_cmp_eq_u32 vcc, 0, v13
  s_waitcnt lgkmcnt(10)
  v_mfma_f32_32x32x16_bf16 v[32:47], v[28:31], v[116:119], v[32:47]
  ds_read_b64_tr_b16 v[20:21], v250 offset:4096
  ds_read_b64_tr_b16 v[22:23], v250 offset:4608
  v_cmp_eq_u32 s[32:33], 1, v13
  s_nop 1
  v_cndmask_b32 v12, 0, v10, vcc
  s_waitcnt lgkmcnt(10)
  v_mfma_f32_32x32x16_bf16 v[48:63], v[64:67], v[120:123], v[48:63]
  ds_read_b64_tr_b16 v[24:25], v251 offset:5120
  ds_read_b64_tr_b16 v[26:27], v251 offset:5632
  v_cndmask_b32 v176, v12, v11, s[32:33]
  v_cmp_eq_u32 vcc, 2, v13
  v_cmp_eq_u32 s[32:33], 3, v13
  s_waitcnt lgkmcnt(10)
  v_mfma_f32_32x32x16_bf16 v[32:47], v[68:71], v[120:123], v[32:47]
  ds_read_b64_tr_b16 v[28:29], v250 offset:5120
  ds_read_b64_tr_b16 v[30:31], v250 offset:5632
  s_nop 1
  v_cndmask_b32 v12, 0, v10, vcc
  v_cndmask_b32 v177, v12, v11, s[32:33]
  s_waitcnt lgkmcnt(10)
  v_mfma_f32_32x32x16_bf16 v[48:63], v[72:75], v[124:127], v[48:63]
  ds_read_b64_tr_b16 v[64:65], v251 offset:6144
  ds_read_b64_tr_b16 v[66:67], v251 offset:6656
  v_cmp_eq_u32 vcc, 8, v13
  v_cmp_eq_u32 s[32:33], 9, v13
  s_nop 1
  s_waitcnt lgkmcnt(10)
  v_mfma_f32_32x32x16_bf16 v[32:47], v[76:79], v[124:127], v[32:47]
  ds_read_b64_tr_b16 v[68:69], v250 offset:6144
  ds_read_b64_tr_b16 v[70:71], v250 offset:6656
  v_cndmask_b32 v12, 0, v10, vcc
  v_cndmask_b32 v178, v12, v11, s[32:33]
  v_cmp_eq_u32 vcc, 10, v13
  s_waitcnt lgkmcnt(10)
  v_mfma_f32_32x32x16_bf16 v[48:63], v[16:19], v[128:131], v[48:63]
  ds_read_b64_tr_b16 v[72:73], v251 offset:7168
  ds_read_b64_tr_b16 v[74:75], v251 offset:7680
  v_cmp_eq_u32 s[32:33], 11, v13
  s_nop 1
  v_cndmask_b32 v12, 0, v10, vcc
  s_waitcnt lgkmcnt(10)
  v_mfma_f32_32x32x16_bf16 v[32:47], v[20:23], v[128:131], v[32:47]
  ds_read_b64_tr_b16 v[76:77], v250 offset:7168
  ds_read_b64_tr_b16 v[78:79], v250 offset:7680
  v_cndmask_b32 v179, v12, v11, s[32:33]
  v_cmp_eq_u32 vcc, 16, v13
  v_cmp_eq_u32 s[32:33], 17, v13
  s_waitcnt lgkmcnt(10)
  v_mfma_f32_32x32x16_bf16 v[48:63], v[24:27], v[132:135], v[48:63]
  ds_read_b64_tr_b16 v[16:17], v251 offset:8192
  ds_read_b64_tr_b16 v[18:19], v251 offset:8704
  s_nop 1
  v_cndmask_b32 v12, 0, v10, vcc
  v_cndmask_b32 v180, v12, v11, s[32:33]
  s_waitcnt lgkmcnt(10)
  v_mfma_f32_32x32x16_bf16 v[32:47], v[28:31], v[132:135], v[32:47]
  ds_read_b64_tr_b16 v[20:21], v250 offset:8192
  ds_read_b64_tr_b16 v[22:23], v250 offset:8704
  v_cmp_eq_u32 vcc, 18, v13
  v_cmp_eq_u32 s[32:33], 19, v13
  s_nop 1
  s_waitcnt lgkmcnt(10)
  v_mfma_f32_32x32x16_bf16 v[48:63], v[64:67], v[136:139], v[48:63]
  ds_read_b64_tr_b16 v[24:25], v251 offset:9216
  ds_read_b64_tr_b16 v[26:27], v251 offset:9728
  v_cndmask_b32 v12, 0, v10, vcc
  v_cndmask_b32 v181, v12, v11, s[32:33]
  v_cmp_eq_u32 vcc, 24, v13
  s_waitcnt lgkmcnt(10)
  v_mfma_f32_32x32x16_bf16 v[32:47], v[68:71], v[136:139], v[32:47]
  ds_read_b64_tr_b16 v[28:29], v250 offset:9216
  ds_read_b64_tr_b16 v[30:31], v250 offset:9728
  v_cmp_eq_u32 s[32:33], 25, v13
  s_nop 1
  v_cndmask_b32 v12, 0, v10, vcc
  s_waitcnt lgkmcnt(10)
  v_mfma_f32_32x32x16_bf16 v[48:63], v[72:75], v[140:143], v[48:63]
  ds_read_b64_tr_b16 v[64:65], v251 offset:10240
  ds_read_b64_tr_b16 v[66:67], v251 offset:10752
  v_cndmask_b32 v182, v12, v11, s[32:33]
  v_cmp_eq_u32 vcc, 26, v13
  v_cmp_eq_u32 s[32:33], 27, v13
  s_waitcnt lgkmcnt(10)
  v_mfma_f32_32x32x16_bf16 v[32:47], v[76:79], v[140:143], v[32:47]
  ds_read_b64_tr_b16 v[68:69], v250 offset:10240
  ds_read_b64_tr_b16 v[70:71], v250 offset:10752
  s_nop 1
  v_cndmask_b32 v12, 0, v10, vcc
  v_cndmask_b32 v183, v12, v11, s[32:33]
  s_waitcnt vmcnt(16)
  s_waitcnt lgkmcnt(10)
  v_mfma_f32_32x32x16_bf16 v[48:63], v[16:19], v[144:147], v[48:63]
  ds_read_b64_tr_b16 v[72:73], v251 offset:11264
  ds_read_b64_tr_b16 v[74:75], v251 offset:11776
  v_lshlrev_b32 v80, 16, v232
  v_and_b32 v81, 0xffff0000, v232
  v_lshlrev_b32 v82, 16, v233
  s_waitcnt lgkmcnt(10)
  v_mfma_f32_32x32x16_bf16 v[32:47], v[20:23], v[144:147], v[32:47]
  ds_read_b64_tr_b16 v[76:77], v250 offset:11264
  ds_read_b64_tr_b16 v[78:79], v250 offset:11776
  v_and_b32 v83, 0xffff0000, v233
  v_lshlrev_b32 v84, 16, v234
  v_and_b32 v85, 0xffff0000, v234
  s_waitcnt lgkmcnt(10)
  v_mfma_f32_32x32x16_bf16 v[48:63], v[24:27], v[148:151], v[48:63]
  ds_read_b64_tr_b16 v[16:17], v251 offset:12288
  ds_read_b64_tr_b16 v[18:19], v251 offset:12800
  v_lshlrev_b32 v86, 16, v235
  v_and_b32 v87, 0xffff0000, v235
  v_lshlrev_b32 v88, 16, v236
  s_waitcnt lgkmcnt(10)
  v_mfma_f32_32x32x16_bf16 v[32:47], v[28:31], v[148:151], v[32:47]
  ds_read_b64_tr_b16 v[20:21], v250 offset:12288
  ds_read_b64_tr_b16 v[22:23], v250 offset:12800
  v_and_b32 v89, 0xffff0000, v236
  v_lshlrev_b32 v90, 16, v237
  v_and_b32 v91, 0xffff0000, v237
  s_waitcnt lgkmcnt(10)
  v_mfma_f32_32x32x16_bf16 v[48:63], v[64:67], v[152:155], v[48:63]
  ds_read_b64_tr_b16 v[24:25], v251 offset:13312
  ds_read_b64_tr_b16 v[26:27], v251 offset:13824
  v_lshlrev_b32 v92, 16, v238
  v_and_b32 v93, 0xffff0000, v238
  v_lshlrev_b32 v94, 16, v239
  s_waitcnt lgkmcnt(10)
  v_mfma_f32_32x32x16_bf16 v[32:47], v[68:71], v[152:155], v[32:47]
  ds_read_b64_tr_b16 v[28:29], v250 offset:13312
  ds_read_b64_tr_b16 v[30:31], v250 offset:13824
  v_and_b32 v95, 0xffff0000, v239
  s_waitcnt lgkmcnt(10)
  v_mfma_f32_32x32x16_bf16 v[48:63], v[72:75], v[156:159], v[48:63]
  ds_read_b64_tr_b16 v[64:65], v251 offset:14336
  ds_read_b64_tr_b16 v[66:67], v251 offset:14848
  s_waitcnt lgkmcnt(10)
  v_mfma_f32_32x32x16_bf16 v[32:47], v[76:79], v[156:159], v[32:47]
  ds_read_b64_tr_b16 v[68:69], v250 offset:14336
  ds_read_b64_tr_b16 v[70:71], v250 offset:14848
  s_waitcnt lgkmcnt(10)
  v_mfma_f32_32x32x16_bf16 v[48:63], v[16:19], v[160:163], v[48:63]
  ds_read_b64_tr_b16 v[72:73], v251 offset:15360
  ds_read_b64_tr_b16 v[74:75], v251 offset:15872
  s_waitcnt lgkmcnt(10)
  v_mfma_f32_32x32x16_bf16 v[32:47], v[20:23], v[160:163], v[32:47]
  ds_read_b64_tr_b16 v[76:77], v250 offset:15360
  ds_read_b64_tr_b16 v[78:79], v250 offset:15872
  s_waitcnt lgkmcnt(10)
  v_mfma_f32_32x32x16_bf16 v[48:63], v[24:27], v[164:167], v[48:63]
  ds_read_b64_tr_b16 v[16:17], v251 offset:16384
  ds_read_b64_tr_b16 v[18:19], v251 offset:16896
  s_waitcnt lgkmcnt(10)
  v_mfma_f32_32x32x16_bf16 v[32:47], v[28:31], v[164:167], v[32:47]
  ds_read_b64_tr_b16 v[20:21], v250 offset:16384
  ds_read_b64_tr_b16 v[22:23], v250 offset:16896
  s_waitcnt lgkmcnt(10)
  v_mfma_f32_32x32x16_bf16 v[48:63], v[64:67], v[168:171], v[48:63]
  ds_read_b64_tr_b16 v[24:25], v251 offset:17408
  ds_read_b64_tr_b16 v[26:27], v251 offset:17920
  s_waitcnt lgkmcnt(10)
  v_mfma_f32_32x32x16_bf16 v[32:47], v[68:71], v[168:171], v[32:47]
  ds_read_b64_tr_b16 v[28:29], v250 offset:17408
  ds_read_b64_tr_b16 v[30:31], v250 offset:17920
  s_waitcnt lgkmcnt(10)
  v_mfma_f32_32x32x16_bf16 v[48:63], v[72:75], v[172:175], v[48:63]
  s_waitcnt lgkmcnt(8)
  v_mfma_f32_32x32x16_bf16 v[32:47], v[76:79], v[172:175], v[32:47]
  s_waitcnt lgkmcnt(6)
  v_mfma_f32_32x32x16_bf16 v[48:63], v[16:19], v[184:187], v[48:63]
  s_waitcnt lgkmcnt(4)
  v_mfma_f32_32x32x16_bf16 v[32:47], v[20:23], v[184:187], v[32:47]
  s_waitcnt lgkmcnt(2)
  v_mfma_f32_32x32x16_bf16 v[48:63], v[24:27], v[188:191], v[48:63]
  s_waitcnt lgkmcnt(0)
  v_mfma_f32_32x32x16_bf16 v[32:47], v[28:31], v[188:191], v[32:47]
  s_add_u32 s39, s39, 4224
  s_nop 7
  s_nop 1
  ds_write_b128 v253, v[48:51] offset:0
  ds_write_b128 v253, v[52:55] offset:1024
  ds_write_b128 v253, v[56:59] offset:2048
  ds_write_b128 v253, v[60:63] offset:3072
  s_cmp_lg_u32 s28, 0
  s_cbranch_scc1 2f
  s_mov_b32 s31, 0x40000
1:
  buffer_load_dword v15, off, s[52:55], s39 sc1
  s_waitcnt vmcnt(0)
  v_readfirstlane_b32 s38, v15
  s_cmp_ge_u32 s38, 8
  s_cbranch_scc1 2f
  s_sleep 2
  s_sub_u32 s31, s31, 1
  s_cbranch_scc0 1b
2:
  s_waitcnt lgkmcnt(0)
  s_barrier
  s_bitcmp1_b32 s28, 0
  s_cbranch_scc0 .Lffn_even
  buffer_load_dwordx4 a[72:75], v4, s[52:55], s47 offen offset:0 sc1
  buffer_load_dwordx4 a[76:79], v4, s[52:55], s47 offen offset:1024 sc1
  s_add_u32 s47, s47, 2359296
  buffer_load_dwordx4 a[80:83], v4, s[52:55], s47 offen offset:0 sc1
  buffer_load_dwordx4 a[84:87], v4, s[52:55], s47 offen offset:1024 sc1
  s_add_u32 s47, s47, 2359296
  buffer_load_dwordx4 a[88:91], v4, s[52:55], s47 offen offset:0 sc1
  buffer_load_dwordx4 a[92:95], v4, s[52:55], s47 offen offset:1024 sc1
  s_add_u32 s47, s47, 2359296
  buffer_load_dwordx4 a[96:99], v4, s[52:55], s47 offen offset:0 sc1
  buffer_load_dwordx4 a[100:103], v4, s[52:55], s47 offen offset:1024 sc1
  s_add_u32 s47, s47, 2359296
  buffer_load_dwordx4 a[104:107], v4, s[52:55], s47 offen offset:0 sc1
  buffer_load_dwordx4 a[108:111], v4, s[52:55], s47 offen offset:1024 sc1
  s_add_u32 s47, s47, 2359296
  buffer_load_dwordx4 a[112:115], v4, s[52:55], s47 offen offset:0 sc1
  buffer_load_dwordx4 a[116:119], v4, s[52:55], s47 offen offset:1024 sc1
  s_add_u32 s47, s47, 2359296
  buffer_load_dwordx4 a[120:123], v4, s[52:55], s47 offen offset:0 sc1
  buffer_load_dwordx4 a[124:127], v4, s[52:55], s47 offen offset:1024 sc1
  s_add_u32 s47, s47, 2359296
  buffer_load_dwordx4 a[128:131], v4, s[52:55], s47 offen offset:0 sc1
  buffer_load_dwordx4 a[132:135], v4, s[52:55], s47 offen offset:1024 sc1
  ds_read_b128 v[160:163], v254 offset:0
  ds_read_b128 v[164:167], v254 offset:1024
  ds_read_b128 v[168:171], v254 offset:2048
  ds_read_b128 v[172:175], v254 offset:3072
  s_waitcnt vmcnt(12)
  v_mfma_f32_32x32x16_bf16 v[128:143], v[176:179], a[72:75], 0
  v_mfma_f32_32x32x16_bf16 v[128:143], v[180:183], a[76:79], v[128:143]
  v_mfma_f32_32x32x16_bf16 v[128:143], v[176:179], a[80:83], v[128:143]
  v_mfma_f32_32x32x16_bf16 v[128:143], v[180:183], a[84:87], v[128:143]
  s_waitcnt vmcnt(8)
  v_mfma_f32_32x32x16_bf16 v[128:143], v[176:179], a[88:91], v[128:143]
  v_mfma_f32_32x32x16_bf16 v[128:143], v[180:183], a[92:95], v[128:143]
  v_mfma_f32_32x32x16_bf16 v[128:143], v[176:179], a[96:99], v[128:143]
  v_mfma_f32_32x32x16_bf16 v[128:143], v[180:183], a[100:103], v[128:143]
  s_waitcnt vmcnt(4)
  v_mfma_f32_32x32x16_bf16 v[128:143], v[176:179], a[104:107], v[128:143]
  v_mfma_f32_32x32x16_bf16 v[128:143], v[180:183], a[108:111], v[128:143]
  v_mfma_f32_32x32x16_bf16 v[128:143], v[176:179], a[112:115], v[128:143]
  v_mfma_f32_32x32x16_bf16 v[128:143], v[180:183], a[116:119], v[128:143]
  s_waitcnt vmcnt(0)
  v_mfma_f32_32x32x16_bf16 v[128:143], v[176:179], a[120:123], v[128:143]
  v_mfma_f32_32x32x16_bf16 v[128:143], v[180:183], a[124:127], v[128:143]
  v_mfma_f32_32x32x16_bf16 v[128:143], v[176:179], a[128:131], v[128:143]
  v_mfma_f32_32x32x16_bf16 v[128:143], v[180:183], a[132:135], v[128:143]
  s_waitcnt lgkmcnt(0)
  v_pk_add_f32 v[32:33], v[32:33], v[160:161]
  v_pk_add_f32 v[34:35], v[34:35], v[162:163]
  v_pk_add_f32 v[36:37], v[36:37], v[164:165]
  v_pk_add_f32 v[38:39], v[38:39], v[166:167]
  v_pk_add_f32 v[40:41], v[40:41], v[168:169]
  v_pk_add_f32 v[42:43], v[42:43], v[170:171]
  v_pk_add_f32 v[44:45], v[44:45], v[172:173]
  v_pk_add_f32 v[46:47], v[46:47], v[174:175]
  s_nop 3
  v_pk_mul_f32 v[184:185], v[128:129], s[40:41] op_sel_hi:[1,0]
  v_pk_mul_f32 v[186:187], v[130:131], s[40:41] op_sel_hi:[1,0]
  v_pk_mul_f32 v[188:189], v[132:133], s[40:41] op_sel_hi:[1,0]
  v_pk_mul_f32 v[190:191], v[134:135], s[40:41] op_sel_hi:[1,0]
  v_pk_mul_f32 v[192:193], v[136:137], s[40:41] op_sel_hi:[1,0]
  v_pk_mul_f32 v[194:195], v[138:139], s[40:41] op_sel_hi:[1,0]
  v_pk_mul_f32 v[196:197], v[140:141], s[40:41] op_sel_hi:[1,0]
  v_pk_mul_f32 v[198:199], v[142:143], s[40:41] op_sel_hi:[1,0]
  v_exp_f32 v184, v184
  v_exp_f32 v185, v185
  v_exp_f32 v186, v186
  v_exp_f32 v187, v187
  v_exp_f32 v188, v188
  v_exp_f32 v189, v189
  v_exp_f32 v190, v190
  v_exp_f32 v191, v191
  v_exp_f32 v192, v192
  v_exp_f32 v193, v193
  v_exp_f32 v194, v194
  v_exp_f32 v195, v195
  v_exp_f32 v196, v196
  v_exp_f32 v197, v197
  v_exp_f32 v198, v198
  v_exp_f32 v199, v199
  v_pk_mul_f32 v[128:129], v[128:129], v[32:33]
  v_pk_mul_f32 v[130:131], v[130:131], v[34:35]
  v_pk_mul_f32 v[132:133], v[132:133], v[36:37]
  v_pk_mul_f32 v[134:135], v[134:135], v[38:39]
  v_pk_mul_f32 v[136:137], v[136:137], v[40:41]
  v_pk_mul_f32 v[138:139], v[138:139], v[42:43]
  v_pk_mul_f32 v[140:141], v[140:141], v[44:45]
  v_pk_mul_f32 v[142:143], v[142:143], v[46:47]
  v_pk_add_f32 v[184:185], v[184:185], 1.0 op_sel_hi:[1,0]
  v_pk_add_f32 v[186:187], v[186:187], 1.0 op_sel_hi:[1,0]
  v_pk_add_f32 v[188:189], v[188:189], 1.0 op_sel_hi:[1,0]
  v_pk_add_f32 v[190:191], v[190:191], 1.0 op_sel_hi:[1,0]
  v_pk_add_f32 v[192:193], v[192:193], 1.0 op_sel_hi:[1,0]
  v_pk_add_f32 v[194:195], v[194:195], 1.0 op_sel_hi:[1,0]
  v_pk_add_f32 v[196:197], v[196:197], 1.0 op_sel_hi:[1,0]
  v_pk_add_f32 v[198:199], v[198:199], 1.0 op_sel_hi:[1,0]
  v_rcp_f32 v184, v184
  v_rcp_f32 v185, v185
  v_rcp_f32 v186, v186
  v_rcp_f32 v187, v187
  v_rcp_f32 v188, v188
  v_rcp_f32 v189, v189
  v_rcp_f32 v190, v190
  v_rcp_f32 v191, v191
  v_rcp_f32 v192, v192
  v_rcp_f32 v193, v193
  v_rcp_f32 v194, v194
  v_rcp_f32 v195, v195
  v_rcp_f32 v196, v196
  v_rcp_f32 v197, v197
  v_rcp_f32 v198, v198
  v_rcp_f32 v199, v199
  s_nop 0
  v_pk_fma_f32 v[128:129], v[128:129], v[184:185], v[80:81]
  v_pk_fma_f32 v[130:131], v[130:131], v[186:187], v[82:83]
  v_pk_fma_f32 v[132:133], v[132:133], v[188:189], v[84:85]
  v_pk_fma_f32 v[134:135], v[134:135], v[190:191], v[86:87]
  v_pk_fma_f32 v[136:137], v[136:137], v[192:193], v[88:89]
  v_pk_fma_f32 v[138:139], v[138:139], v[194:195], v[90:91]
  v_pk_fma_f32 v[140:141], v[140:141], v[196:197], v[92:93]
  v_pk_fma_f32 v[142:143], v[142:143], v[198:199], v[94:95]
  v_cvt_pk_bf16_f32 v216, v128, v129
  v_cvt_pk_bf16_f32 v217, v130, v131
  v_cvt_pk_bf16_f32 v218, v132, v133
  v_cvt_pk_bf16_f32 v219, v134, v135
  v_cvt_pk_bf16_f32 v220, v136, v137
  v_cvt_pk_bf16_f32 v221, v138, v139
  v_cvt_pk_bf16_f32 v222, v140, v141
  v_cvt_pk_bf16_f32 v223, v142, v143
  s_nop 1
  v_permlane32_swap_b32 v216, v218
  v_permlane32_swap_b32 v217, v219
  v_permlane32_swap_b32 v220, v222
  v_permlane32_swap_b32 v221, v223
  buffer_store_dwordx4 v[216:219], v248, s[20:23], s62 offen nt
  buffer_store_dwordx4 v[220:223], v248, s[20:23], s62 offen offset:32 nt
  s_branch .Lffn_done
.Lffn_even:
  ds_read_b128 v[160:163], v254 offset:0
  ds_read_b128 v[164:167], v254 offset:1024
  ds_read_b128 v[168:171], v254 offset:2048
  ds_read_b128 v[172:175], v254 offset:3072
  s_waitcnt vmcnt(0)
  v_mfma_f32_32x32x16_bf16 v[128:143], v[176:179], a[72:75], 0
  v_mfma_f32_32x32x16_bf16 v[128:143], v[180:183], a[76:79], v[128:143]
  v_mfma_f32_32x32x16_bf16 v[128:143], v[176:179], a[80:83], v[128:143]
  v_mfma_f32_32x32x16_bf16 v[128:143], v[180:183], a[84:87], v[128:143]
  v_mfma_f32_32x32x16_bf16 v[128:143], v[176:179], a[88:91], v[128:143]
  v_mfma_f32_32x32x16_bf16 v[128:143], v[180:183], a[92:95], v[128:143]
  v_mfma_f32_32x32x16_bf16 v[128:143], v[176:179], a[96:99], v[128:143]
  v_mfma_f32_32x32x16_bf16 v[128:143], v[180:183], a[100:103], v[128:143]
  v_mfma_f32_32x32x16_bf16 v[128:143], v[176:179], a[104:107], v[128:143]
  v_mfma_f32_32x32x16_bf16 v[128:143], v[180:183], a[108:111], v[128:143]
  v_mfma_f32_32x32x16_bf16 v[128:143], v[176:179], a[112:115], v[128:143]
  v_mfma_f32_32x32x16_bf16 v[128:143], v[180:183], a[116:119], v[128:143]
  v_mfma_f32_32x32x16_bf16 v[128:143], v[176:179], a[120:123], v[128:143]
  v_mfma_f32_32x32x16_bf16 v[128:143], v[180:183], a[124:127], v[128:143]
  v_mfma_f32_32x32x16_bf16 v[128:143], v[176:179], a[128:131], v[128:143]
  v_mfma_f32_32x32x16_bf16 v[128:143], v[180:183], a[132:135], v[128:143]
  s_waitcnt lgkmcnt(0)
  v_pk_add_f32 v[32:33], v[32:33], v[160:161]
  v_pk_add_f32 v[34:35], v[34:35], v[162:163]
  v_pk_add_f32 v[36:37], v[36:37], v[164:165]
  v_pk_add_f32 v[38:39], v[38:39], v[166:167]
  v_pk_add_f32 v[40:41], v[40:41], v[168:169]
  v_pk_add_f32 v[42:43], v[42:43], v[170:171]
  v_pk_add_f32 v[44:45], v[44:45], v[172:173]
  v_pk_add_f32 v[46:47], v[46:47], v[174:175]
  s_nop 3
  v_pk_mul_f32 v[184:185], v[128:129], s[40:41] op_sel_hi:[1,0]
  v_pk_mul_f32 v[186:187], v[130:131], s[40:41] op_sel_hi:[1,0]
  v_pk_mul_f32 v[188:189], v[132:133], s[40:41] op_sel_hi:[1,0]
  v_pk_mul_f32 v[190:191], v[134:135], s[40:41] op_sel_hi:[1,0]
  v_pk_mul_f32 v[192:193], v[136:137], s[40:41] op_sel_hi:[1,0]
  v_pk_mul_f32 v[194:195], v[138:139], s[40:41] op_sel_hi:[1,0]
  v_pk_mul_f32 v[196:197], v[140:141], s[40:41] op_sel_hi:[1,0]
  v_pk_mul_f32 v[198:199], v[142:143], s[40:41] op_sel_hi:[1,0]
  v_exp_f32 v184, v184
  v_exp_f32 v185, v185
  v_exp_f32 v186, v186
  v_exp_f32 v187, v187
  v_exp_f32 v188, v188
  v_exp_f32 v189, v189
  v_exp_f32 v190, v190
  v_exp_f32 v191, v191
  v_exp_f32 v192, v192
  v_exp_f32 v193, v193
  v_exp_f32 v194, v194
  v_exp_f32 v195, v195
  v_exp_f32 v196, v196
  v_exp_f32 v197, v197
  v_exp_f32 v198, v198
  v_exp_f32 v199, v199
  v_pk_mul_f32 v[128:129], v[128:129], v[32:33]
  v_pk_mul_f32 v[130:131], v[130:131], v[34:35]
  v_pk_mul_f32 v[132:133], v[132:133], v[36:37]
  v_pk_mul_f32 v[134:135], v[134:135], v[38:39]
  v_pk_mul_f32 v[136:137], v[136:137], v[40:41]
  v_pk_mul_f32 v[138:139], v[138:139], v[42:43]
  v_pk_mul_f32 v[140:141], v[140:141], v[44:45]
  v_pk_mul_f32 v[142:143], v[142:143], v[46:47]
  v_pk_add_f32 v[184:185], v[184:185], 1.0 op_sel_hi:[1,0]
  v_pk_add_f32 v[186:187], v[186:187], 1.0 op_sel_hi:[1,0]
  v_pk_add_f32 v[188:189], v[188:189], 1.0 op_sel_hi:[1,0]
  v_pk_add_f32 v[190:191], v[190:191], 1.0 op_sel_hi:[1,0]
  v_pk_add_f32 v[192:193], v[192:193], 1.0 op_sel_hi:[1,0]
  v_pk_add_f32 v[194:195], v[194:195], 1.0 op_sel_hi:[1,0]
  v_pk_add_f32 v[196:197], v[196:197], 1.0 op_sel_hi:[1,0]
  v_pk_add_f32 v[198:199], v[198:199], 1.0 op_sel_hi:[1,0]
  v_rcp_f32 v184, v184
  v_rcp_f32 v185, v185
  v_rcp_f32 v186, v186
  v_rcp_f32 v187, v187
  v_rcp_f32 v188, v188
  v_rcp_f32 v189, v189
  v_rcp_f32 v190, v190
  v_rcp_f32 v191, v191
  v_rcp_f32 v192, v192
  v_rcp_f32 v193, v193
  v_rcp_f32 v194, v194
  v_rcp_f32 v195, v195
  v_rcp_f32 v196, v196
  v_rcp_f32 v197, v197
  v_rcp_f32 v198, v198
  v_rcp_f32 v199, v199
  s_nop 0
  v_pk_fma_f32 v[128:129], v[128:129], v[184:185], v[80:81]
  v_pk_fma_f32 v[130:131], v[130:131], v[186:187], v[82:83]
  v_pk_fma_f32 v[132:133], v[132:133], v[188:189], v[84:85]
  v_pk_fma_f32 v[134:135], v[134:135], v[190:191], v[86:87]
  v_pk_fma_f32 v[136:137], v[136:137], v[192:193], v[88:89]
  v_pk_fma_f32 v[138:139], v[138:139], v[194:195], v[90:91]
  v_pk_fma_f32 v[140:141], v[140:141], v[196:197], v[92:93]
  v_pk_fma_f32 v[142:143], v[142:143], v[198:199], v[94:95]
  v_cvt_pk_bf16_f32 v216, v128, v129
  v_cvt_pk_bf16_f32 v217, v130, v131
  v_cvt_pk_bf16_f32 v218, v132, v133
  v_cvt_pk_bf16_f32 v219, v134, v135
  v_cvt_pk_bf16_f32 v220, v136, v137
  v_cvt_pk_bf16_f32 v221, v138, v139
  v_cvt_pk_bf16_f32 v222, v140, v141
  v_cvt_pk_bf16_f32 v223, v142, v143
  s_nop 1
  v_permlane32_swap_b32 v216, v218
  v_permlane32_swap_b32 v217, v219
  v_permlane32_swap_b32 v220, v222
  v_permlane32_swap_b32 v221, v223
  buffer_store_dwordx4 v[216:219], v248, s[20:23], s62 offen nt
  buffer_store_dwordx4 v[220:223], v248, s[20:23], s62 offen offset:32 nt
.Lffn_done:
  s_endpgm
.Lk2_att:
  s_lshr_b32 s65, s2, 4
  s_and_b32 s38, s2, 7
  s_and_b32 s39, s65, 1
  s_lshr_b32 s65, s65, 1
  s_and_b32 s36, s38, 1
  s_lshl_b32 s36, s36, 3
  s_add_u32 s65, s65, s36
  s_lshl_b32 s65, s65, 3
  s_andn2_b32 s38, s38, 1
  s_add_u32 s65, s65, s38
  s_add_u32 s65, s65, s39
  s_load_dwordx4 s[4:7], s[0:1], 8
  s_load_dwordx2 s[8:9], s[0:1], 56
  s_load_dwordx2 s[10:11], s[0:1], 0
  s_load_dwordx4 s[12:15], s[0:1], 64
  v_lshrrev_b32 v1, 6, v0
  v_and_b32 v0, 63, v0
  v_readfirstlane_b32 s28, v1
  s_and_b32 s36, s65, 7
  s_lshr_b32 s37, s65, 3
  s_lshl_b32 s38, s37, 2
  s_add_u32 s51, s38, s28
  s_waitcnt lgkmcnt(0)

  s_mov_b32 s56, s10
  s_mov_b32 s57, s11
  s_mov_b32 s58, 2359296
  s_mov_b32 s59, 0x20000
  s_mov_b32 s52, s14
  s_mov_b32 s53, s15
  s_mov_b32 s54, 268435456
  s_mov_b32 s55, 0x20000
  s_mov_b32 s96, s12
  s_mov_b32 s97, s13
  s_mov_b32 s98, 256
  s_mov_b32 s99, 0x20000
  s_mov_b32 s16, s4
  s_mov_b32 s17, s5
  s_mov_b32 s18, 1990656
  s_mov_b32 s19, 0x20000
  s_mov_b32 s20, s6
  s_mov_b32 s21, s7
  s_mov_b32 s22, 663552
  s_mov_b32 s23, 0x20000
  s_mov_b32 s24, s8
  s_mov_b32 s25, s9
  s_mov_b32 s26, 2359296
  s_mov_b32 s27, 0x20000
  s_lshl_b32 s38, s2, 2
  s_add_u32 s38, s38, s28
  s_cmp_eq_u32 s38, 32
  s_cselect_b32 s49, 0, 2146435072
  v_cmp_gt_u32 vcc, 40, v0
  v_lshlrev_b32 v12, 8, v0
  v_mov_b32 v13, 2146435072
  v_cndmask_b32 v12, v13, v12, vcc
  v_or_b32 v12, s49, v12
  v_mov_b32 v14, 0
  s_mov_b32 s38, 11534336
  buffer_store_dword v14, v12, s[52:55], s38 offen sc1
  buffer_store_dword v14, v12, s[52:55], s38 offen offset:128 sc1
  s_lshr_b32 s75, s2, 5
  s_lshl_b32 s75, s75, 2
  s_add_u32 s75, s75, s28
  s_mul_i32 s64, s36, 144
  s_andn2_b32 s64, s64, 127
  s_add_u32 s38, s75, 0
  s_mul_i32 s39, s38, 57
  s_lshr_b32 s39, s39, 9
  s_cmp_lt_u32 s38, 18
  s_cselect_b32 s50, 0, 2146435072
  s_cselect_b32 s39, s39, 0
  s_cselect_b32 s38, s38, 0
  v_mov_b32 v12, s50
  s_movk_i32 s50, 3456
  v_mad_u32_u24 v12, v0, s50, v12
  s_mul_i32 s50, s39, 9
  s_sub_u32 s38, s38, s50
  s_mul_i32 s38, s38, 221184
  s_mul_i32 s39, s39, 128
  s_add_u32 s39, s39, s38
  s_add_u32 s39, s39, 2304
  s_add_u32 s39, s39, s64
  buffer_load_dword a255, v12, s[16:19], s39 offen
  v_lshrrev_b32 v1, 3, v0
  s_movk_i32 s62, 1152
  v_mul_lo_u32 v7, v1, s62
  v_lshrrev_b32 v1, 4, v0
  v_and_b32 v9, 7, v0
  v_xor_b32 v1, v1, v9
  v_lshlrev_b32 v1, 4, v1
  v_add_u32 v7, v7, v1
  v_xor_b32 v9, 64, v7
  s_mul_i32 s62, s51, 36864
  s_mul_i32 s60, s28, 36864
  s_lshl_b32 s61, s28, 13

  s_add_u32 m0, s60, 32768
  s_add_u32 s63, s62, 1024
  buffer_load_dwordx4 v7, s[56:59], s63 offen offset:0 lds
  v_lshrrev_b32 v1, 2, v0
  v_and_b32 v10, 3, v0
  v_lshlrev_b32 v10, 4, v10
  s_movk_i32 s38, 3456
  v_mul_lo_u32 v2, v1, s38
  s_add_u32 s63, s62, 9216
  buffer_load_dwordx4 v9, s[56:59], s63 offen offset:1024 lds
  v_add_u32 v2, v2, v10
  s_movk_i32 s38, 1152
  v_mul_lo_u32 v3, v1, s38
  v_add_u32 v3, v3, v10
  v_bfe_u32 v1, v0, 2, 2
  v_lshlrev_b32 v1, 6, v1
  s_add_u32 s63, s62, 17408
  buffer_load_dwordx4 v7, s[56:59], s63 offen offset:2048 lds
  v_bfe_u32 v10, v0, 4, 1
  v_lshlrev_b32 v10, 5, v10
  v_add_u32 v1, v1, v10
  v_and_b32 v10, 3, v0
  v_lshlrev_b32 v10, 3, v10
  s_add_u32 s63, s62, 25600
  buffer_load_dwordx4 v9, s[56:59], s63 offen offset:3072 lds
  v_add_u32 v1, v1, v10
  v_lshrrev_b32 v10, 5, v0
  v_lshlrev_b32 v11, 9, v10
  v_add_u32 v4, v1, v11
  v_lshlrev_b32 v11, 8, v10
  v_add_u32 v5, v1, v11
  s_add_u32 m0, s61, 0
  s_add_u32 s63, s62, 0
  buffer_load_dwordx4 v7, s[56:59], s63 offen offset:0 lds
  s_mul_i32 s30, s28, 9216
  s_mul_i32 s38, s28, 497664
  v_add_u32 v2, s38, v2
  s_mov_b32 s29, 0
  s_mul_i32 s38, s36, 144
  s_add_u32 s63, s62, 8192
  buffer_load_dwordx4 v9, s[56:59], s63 offen offset:1024 lds
  s_and_b32 s38, s38, 63
  v_bfe_u32 v1, v0, 4, 1
  v_lshlrev_b32 v1, 5, v1
  v_and_b32 v10, 3, v0
  v_lshl_add_u32 v1, v10, 3, v1
  v_sub_u32 v4, v4, v1
  s_add_u32 s63, s62, 16384
  buffer_load_dwordx4 v7, s[56:59], s63 offen offset:2048 lds
  v_add_u32 v13, s38, v1
  v_bfe_u32 v1, v0, 3, 1
  v_bfe_u32 v10, v0, 4, 1
  v_lshl_add_u32 v1, v10, 2, v1
  v_lshrrev_b32 v10, 5, v0
  s_add_u32 s63, s62, 24576
  buffer_load_dwordx4 v9, s[56:59], s63 offen offset:3072 lds
  v_lshl_add_u32 v1, v10, 1, v1
  v_mul_u32_u24 v10, 18, v1
  v_bfe_u32 v1, v0, 2, 1
  v_add3_u32 v10, v10, v1, 16
  s_movk_i32 s38, 1152
  v_mul_lo_u32 v10, v10, s38
  s_add_u32 m0, s61, 4096
  s_add_u32 s63, s62, 128
  buffer_load_dwordx4 v7, s[56:59], s63 offen offset:0 lds
  v_and_b32 v1, 3, v0
  v_lshlrev_b32 v1, 4, v1
  v_add_u32 v10, v10, v1
  v_mov_b32 v8, v10
  s_mov_b32 s67, 54272
  s_add_u32 s63, s62, 8320
  buffer_load_dwordx4 v9, s[56:59], s63 offen offset:1024 lds
  s_mov_b32 s68, 108544
  s_mov_b32 s69, 162816
  s_mov_b32 s70, 221184
  s_mov_b32 s71, 275456
  s_mov_b32 s72, 329728
  s_mov_b32 s73, 384000
  s_add_u32 s63, s62, 16512
  buffer_load_dwordx4 v7, s[56:59], s63 offen offset:2048 lds
  s_mov_b32 s74, 442368
  v_and_b32 v1, 31, v0
  v_lshrrev_b32 v10, 3, v1
  v_lshlrev_b32 v10, 10, v10
  v_and_b32 v11, 7, v1
  s_add_u32 s63, s62, 24704
  buffer_load_dwordx4 v9, s[56:59], s63 offen offset:3072 lds
  v_lshlrev_b32 v11, 7, v11
  v_add_u32 v10, v10, v11
  v_bfe_u32 v11, v1, 1, 3
  v_lshrrev_b32 v1, 5, v0
  v_xor_b32 v11, v11, v1
  v_lshlrev_b32 v11, 4, v11
  s_add_u32 m0, s61, 36864
  s_add_u32 s63, s62, 256
  buffer_load_dwordx4 v7, s[56:59], s63 offen offset:0 lds
  v_add_u32 v10, v10, v11
  v_add_u32 v16, s61, v10
  v_add_u32 v24, s60, v10
  v_add_u32 v20, 73728, v16
  v_xor_b32 v17, 32, v16
  s_add_u32 s63, s62, 8448
  buffer_load_dwordx4 v9, s[56:59], s63 offen offset:1024 lds
  v_xor_b32 v21, 32, v20
  v_xor_b32 v25, 32, v24
  v_xor_b32 v18, 64, v16
  v_xor_b32 v22, 64, v20
  v_xor_b32 v26, 64, v24
  v_xor_b32 v19, 96, v16
  s_add_u32 s63, s62, 16640
  buffer_load_dwordx4 v7, s[56:59], s63 offen offset:2048 lds
  v_xor_b32 v23, 96, v20
  v_xor_b32 v27, 96, v24
  v_mov_b32 v40, 0
  v_mov_b32 v41, 0
  v_mov_b32 v42, 0
  s_add_u32 s63, s62, 24832
  buffer_load_dwordx4 v9, s[56:59], s63 offen offset:3072 lds
  v_mov_b32 v43, 0
  v_mov_b32 v44, 0
  v_mov_b32 v45, 0
  v_mov_b32 v46, 0
  v_mov_b32 v47, 0
  v_mov_b32 v11, 0x3f803f80
  s_waitcnt vmcnt(12)
  ds_read_b128 v[240:243], v24 offset:32768
  ds_read_b128 v[244:247], v25 offset:32768
  ds_read_b128 v[248:251], v26 offset:32768
  ds_read_b128 v[252:255], v27 offset:32768
  v_lshlrev_b32 v12, 8, v0
  v_or_b32 v12, s49, v12
  v_mov_b32 v14, 1
  buffer_store_dword v14, v12, s[96:99], 0 offen sc1
  s_add_u32 m0, s61, 40960
  s_add_u32 s63, s62, 384
  buffer_load_dwordx4 v7, s[56:59], s63 offen offset:0 lds
  s_add_u32 s63, s62, 8576
  buffer_load_dwordx4 v9, s[56:59], s63 offen offset:1024 lds
  s_add_u32 s63, s62, 16768
  buffer_load_dwordx4 v7, s[56:59], s63 offen offset:2048 lds
  s_add_u32 s63, s62, 24960
  buffer_load_dwordx4 v9, s[56:59], s63 offen offset:3072 lds
  s_waitcnt lgkmcnt(0)
  s_waitcnt vmcnt(13)
  ds_read_b128 v[112:115], v16 offset:0
  ds_read_b128 v[116:119], v17 offset:0
  ds_read_b128 v[120:123], v18 offset:0
  ds_read_b128 v[124:127], v19 offset:0
  s_add_u32 m0, s61, 73728
  s_add_u32 s63, s62, 512
  buffer_load_dwordx4 v7, s[56:59], s63 offen offset:0 lds
  v_dot2c_f32_bf16 v40, v240, v11
  v_dot2c_f32_bf16 v41, v241, v11
  v_dot2c_f32_bf16 v42, v242, v11
  v_dot2c_f32_bf16 v43, v243, v11
  v_dot2c_f32_bf16 v44, v240, v240
  v_dot2c_f32_bf16 v45, v241, v241
  v_dot2c_f32_bf16 v46, v242, v242
  v_dot2c_f32_bf16 v47, v243, v243
  s_add_u32 s63, s62, 8704
  buffer_load_dwordx4 v9, s[56:59], s63 offen offset:1024 lds
  v_dot2c_f32_bf16 v40, v244, v11
  v_dot2c_f32_bf16 v41, v245, v11
  v_dot2c_f32_bf16 v42, v246, v11
  v_dot2c_f32_bf16 v43, v247, v11
  v_dot2c_f32_bf16 v44, v244, v244
  v_dot2c_f32_bf16 v45, v245, v245
  v_dot2c_f32_bf16 v46, v246, v246
  v_dot2c_f32_bf16 v47, v247, v247
  s_add_u32 s63, s62, 16896
  buffer_load_dwordx4 v7, s[56:59], s63 offen offset:2048 lds
  v_dot2c_f32_bf16 v40, v248, v11
  v_dot2c_f32_bf16 v41, v249, v11
  v_dot2c_f32_bf16 v42, v250, v11
  v_dot2c_f32_bf16 v43, v251, v11
  v_dot2c_f32_bf16 v44, v248, v248
  v_dot2c_f32_bf16 v45, v249, v249
  v_dot2c_f32_bf16 v46, v250, v250
  v_dot2c_f32_bf16 v47, v251, v251
  s_add_u32 s63, s62, 25088
  buffer_load_dwordx4 v9, s[56:59], s63 offen offset:3072 lds
  v_dot2c_f32_bf16 v40, v252, v11
  v_dot2c_f32_bf16 v41, v253, v11
  v_dot2c_f32_bf16 v42, v254, v11
  v_dot2c_f32_bf16 v43, v255, v11
  v_dot2c_f32_bf16 v44, v252, v252
  v_dot2c_f32_bf16 v45, v253, v253
  v_dot2c_f32_bf16 v46, v254, v254
  v_dot2c_f32_bf16 v47, v255, v255
  s_waitcnt lgkmcnt(0)
  s_waitcnt vmcnt(13)
  ds_read_b128 v[128:131], v16 offset:4096
  ds_read_b128 v[132:135], v17 offset:4096
  ds_read_b128 v[136:139], v18 offset:4096
  ds_read_b128 v[140:143], v19 offset:4096
  s_add_u32 m0, s61, 77824
  s_add_u32 s63, s62, 640
  buffer_load_dwordx4 v7, s[56:59], s63 offen offset:0 lds
  v_dot2c_f32_bf16 v40, v112, v11
  v_dot2c_f32_bf16 v41, v113, v11
  v_dot2c_f32_bf16 v42, v114, v11
  v_dot2c_f32_bf16 v43, v115, v11
  v_dot2c_f32_bf16 v44, v112, v112
  v_dot2c_f32_bf16 v45, v113, v113
  v_dot2c_f32_bf16 v46, v114, v114
  v_dot2c_f32_bf16 v47, v115, v115
  s_add_u32 s63, s62, 8832
  buffer_load_dwordx4 v9, s[56:59], s63 offen offset:1024 lds
  v_dot2c_f32_bf16 v40, v116, v11
  v_dot2c_f32_bf16 v41, v117, v11
  v_dot2c_f32_bf16 v42, v118, v11
  v_dot2c_f32_bf16 v43, v119, v11
  v_dot2c_f32_bf16 v44, v116, v116
  v_dot2c_f32_bf16 v45, v117, v117
  v_dot2c_f32_bf16 v46, v118, v118
  v_dot2c_f32_bf16 v47, v119, v119
  s_add_u32 s63, s62, 17024
  buffer_load_dwordx4 v7, s[56:59], s63 offen offset:2048 lds
  v_dot2c_f32_bf16 v40, v120, v11
  v_dot2c_f32_bf16 v41, v121, v11
  v_dot2c_f32_bf16 v42, v122, v11
  v_dot2c_f32_bf16 v43, v123, v11
  v_dot2c_f32_bf16 v44, v120, v120
  v_dot2c_f32_bf16 v45, v121, v121
  v_dot2c_f32_bf16 v46, v122, v122
  v_dot2c_f32_bf16 v47, v123, v123
  s_add_u32 s63, s62, 25216
  buffer_load_dwordx4 v9, s[56:59], s63 offen offset:3072 lds
  v_dot2c_f32_bf16 v40, v124, v11
  v_dot2c_f32_bf16 v41, v125, v11
  v_dot2c_f32_bf16 v42, v126, v11
  v_dot2c_f32_bf16 v43, v127, v11
  v_dot2c_f32_bf16 v44, v124, v124
  v_dot2c_f32_bf16 v45, v125, v125
  v_dot2c_f32_bf16 v46, v126, v126
  v_dot2c_f32_bf16 v47, v127, v127
  s_waitcnt lgkmcnt(0)
  s_waitcnt vmcnt(13)
  ds_read_b128 v[144:147], v16 offset:36864
  ds_read_b128 v[148:151], v17 offset:36864
  ds_read_b128 v[152:155], v18 offset:36864
  ds_read_b128 v[156:159], v19 offset:36864
  s_add_u32 m0, s61, 110592
  s_add_u32 s63, s62, 768
  buffer_load_dwordx4 v7, s[56:59], s63 offen offset:0 lds
  v_dot2c_f32_bf16 v40, v128, v11
  v_dot2c_f32_bf16 v41, v129, v11
  v_dot2c_f32_bf16 v42, v130, v11
  v_dot2c_f32_bf16 v43, v131, v11
  v_dot2c_f32_bf16 v44, v128, v128
  v_dot2c_f32_bf16 v45, v129, v129
  v_dot2c_f32_bf16 v46, v130, v130
  v_dot2c_f32_bf16 v47, v131, v131
  s_add_u32 s63, s62, 8960
  buffer_load_dwordx4 v9, s[56:59], s63 offen offset:1024 lds
  v_dot2c_f32_bf16 v40, v132, v11
  v_dot2c_f32_bf16 v41, v133, v11
  v_dot2c_f32_bf16 v42, v134, v11
  v_dot2c_f32_bf16 v43, v135, v11
  v_dot2c_f32_bf16 v44, v132, v132
  v_dot2c_f32_bf16 v45, v133, v133
  v_dot2c_f32_bf16 v46, v134, v134
  v_dot2c_f32_bf16 v47, v135, v135
  s_add_u32 s63, s62, 17152
  buffer_load_dwordx4 v7, s[56:59], s63 offen offset:2048 lds
  v_dot2c_f32_bf16 v40, v136, v11
  v_dot2c_f32_bf16 v41, v137, v11
  v_dot2c_f32_bf16 v42, v138, v11
  v_dot2c_f32_bf16 v43, v139, v11
  v_dot2c_f32_bf16 v44, v136, v136
  v_dot2c_f32_bf16 v45, v137, v137
  v_dot2c_f32_bf16 v46, v138, v138
  v_dot2c_f32_bf16 v47, v139, v139
  s_add_u32 s63, s62, 25344
  buffer_load_dwordx4 v9, s[56:59], s63 offen offset:3072 lds
  v_dot2c_f32_bf16 v40, v140, v11
  v_dot2c_f32_bf16 v41, v141, v11
  v_dot2c_f32_bf16 v42, v142, v11
  v_dot2c_f32_bf16 v43, v143, v11
  v_dot2c_f32_bf16 v44, v140, v140
  v_dot2c_f32_bf16 v45, v141, v141
  v_dot2c_f32_bf16 v46, v142, v142
  v_dot2c_f32_bf16 v47, v143, v143
  s_waitcnt lgkmcnt(0)
  s_waitcnt vmcnt(12)
  ds_read_b128 v[160:163], v16 offset:40960
  ds_read_b128 v[164:167], v17 offset:40960
  ds_read_b128 v[168:171], v18 offset:40960
  ds_read_b128 v[172:175], v19 offset:40960
  s_add_u32 m0, s61, 114688
  s_add_u32 s63, s62, 896
  buffer_load_dwordx4 v7, s[56:59], s63 offen offset:0 lds
  v_dot2c_f32_bf16 v40, v144, v11
  v_dot2c_f32_bf16 v41, v145, v11
  v_dot2c_f32_bf16 v42, v146, v11
  v_dot2c_f32_bf16 v43, v147, v11
  v_dot2c_f32_bf16 v44, v144, v144
  v_dot2c_f32_bf16 v45, v145, v145
  v_dot2c_f32_bf16 v46, v146, v146
  v_dot2c_f32_bf16 v47, v147, v147
  s_add_u32 s63, s62, 9088
  buffer_load_dwordx4 v9, s[56:59], s63 offen offset:1024 lds
  v_dot2c_f32_bf16 v40, v148, v11
  v_dot2c_f32_bf16 v41, v149, v11
  v_dot2c_f32_bf16 v42, v150, v11
  v_dot2c_f32_bf16 v43, v151, v11
  v_dot2c_f32_bf16 v44, v148, v148
  v_dot2c_f32_bf16 v45, v149, v149
  v_dot2c_f32_bf16 v46, v150, v150
  v_dot2c_f32_bf16 v47, v151, v151
  s_add_u32 s63, s62, 17280
  buffer_load_dwordx4 v7, s[56:59], s63 offen offset:2048 lds
  v_dot2c_f32_bf16 v40, v152, v11
  v_dot2c_f32_bf16 v41, v153, v11
  v_dot2c_f32_bf16 v42, v154, v11
  v_dot2c_f32_bf16 v43, v155, v11
  v_dot2c_f32_bf16 v44, v152, v152
  v_dot2c_f32_bf16 v45, v153, v153
  v_dot2c_f32_bf16 v46, v154, v154
  v_dot2c_f32_bf16 v47, v155, v155
  s_add_u32 s63, s62, 25472
  buffer_load_dwordx4 v9, s[56:59], s63 offen offset:3072 lds
  v_dot2c_f32_bf16 v40, v156, v11
  v_dot2c_f32_bf16 v41, v157, v11
  v_dot2c_f32_bf16 v42, v158, v11
  v_dot2c_f32_bf16 v43, v159, v11
  v_dot2c_f32_bf16 v44, v156, v156
  v_dot2c_f32_bf16 v45, v157, v157
  v_dot2c_f32_bf16 v46, v158, v158
  v_dot2c_f32_bf16 v47, v159, v159
  s_add_u32 s38, s75, 0
  s_mul_i32 s39, s38, 57
  s_lshr_b32 s39, s39, 9
  s_cmp_lt_u32 s38, 18
  s_cselect_b32 s50, 0, 2146435072
  s_cselect_b32 s39, s39, 0
  s_cselect_b32 s38, s38, 0
  v_mov_b32 v12, s50
  s_movk_i32 s50, 3456
  v_mad_u32_u24 v12, v0, s50, v12
  s_mul_i32 s50, s39, 9
  s_sub_u32 s38, s38, s50
  s_mul_i32 s38, s38, 221184
  s_mul_i32 s39, s39, 128
  s_add_u32 s39, s39, s38
  s_add_u32 s39, s39, 1152
  s_add_u32 s39, s39, s64
  buffer_load_dword a255, v12, s[16:19], s39 offen
  s_mov_b32 s4, s4
  s_mov_b32 s5, s5
  s_mov_b32 s6, 1990656
  s_mov_b32 s7, 0x20000
  s_mul_i32 s38, s36, 144
  s_andn2_b32 s38, s38, 63
  s_add_u32 s38, s38, 2304
  s_add_u32 s16, s16, s38
  s_addc_u32 s17, s17, 0
  s_sub_u32 s18, s18, s38

  s_waitcnt lgkmcnt(0)
  s_barrier
  s_waitcnt vmcnt(13)
  ds_read_b128 v[176:179], v20 offset:0
  ds_read_b128 v[180:183], v21 offset:0
  ds_read_b128 v[184:187], v22 offset:0
  ds_read_b128 v[188:191], v23 offset:0
  s_mov_b32 m0, s30
  v_dot2c_f32_bf16 v40, v160, v11
  v_dot2c_f32_bf16 v41, v161, v11
  v_dot2c_f32_bf16 v42, v162, v11
  buffer_load_dwordx4 v2, s[16:19], 0 offen offset:0 lds
  v_dot2c_f32_bf16 v43, v163, v11
  v_dot2c_f32_bf16 v44, v160, v160
  v_dot2c_f32_bf16 v45, v161, v161
  v_dot2c_f32_bf16 v46, v162, v162
  buffer_load_dwordx4 v2, s[16:19], s67 offen offset:1024 lds
  v_dot2c_f32_bf16 v47, v163, v163
  v_dot2c_f32_bf16 v40, v164, v11
  v_dot2c_f32_bf16 v41, v165, v11
  buffer_load_dwordx4 v2, s[16:19], s68 offen offset:2048 lds
  v_dot2c_f32_bf16 v42, v166, v11
  v_dot2c_f32_bf16 v43, v167, v11
  v_dot2c_f32_bf16 v44, v164, v164
  v_dot2c_f32_bf16 v45, v165, v165
  buffer_load_dwordx4 v2, s[16:19], s69 offen offset:3072 lds
  s_add_u32 m0, m0, 4096
  v_dot2c_f32_bf16 v46, v166, v166
  v_dot2c_f32_bf16 v47, v167, v167
  v_dot2c_f32_bf16 v40, v168, v11
  buffer_load_dwordx4 v2, s[16:19], s70 offen offset:0 lds
  v_dot2c_f32_bf16 v41, v169, v11
  v_dot2c_f32_bf16 v42, v170, v11
  v_dot2c_f32_bf16 v43, v171, v11
  v_dot2c_f32_bf16 v44, v168, v168
  buffer_load_dwordx4 v2, s[16:19], s71 offen offset:1024 lds
  v_dot2c_f32_bf16 v45, v169, v169
  v_dot2c_f32_bf16 v46, v170, v170
  v_dot2c_f32_bf16 v47, v171, v171
  buffer_load_dwordx4 v2, s[16:19], s72 offen offset:2048 lds
  v_dot2c_f32_bf16 v40, v172, v11
  v_dot2c_f32_bf16 v41, v173, v11
  v_dot2c_f32_bf16 v42, v174, v11
  v_dot2c_f32_bf16 v43, v175, v11
  buffer_load_dwordx4 v2, s[16:19], s73 offen offset:3072 lds
  s_add_u32 m0, m0, 4096
  v_dot2c_f32_bf16 v44, v172, v172
  v_dot2c_f32_bf16 v45, v173, v173
  v_dot2c_f32_bf16 v46, v174, v174
  v_dot2c_f32_bf16 v47, v175, v175
  buffer_load_dwordx4 v2, s[16:19], s74 offen offset:0 lds
  s_add_u32 s30, s30, 36864
  s_cmp_ge_u32 s30, 147456
  s_cselect_b32 s35, 147456, 0
  s_sub_u32 s30, s30, s35
  s_add_u32 s16, s16, 64
  s_addc_u32 s17, s17, 0
  s_sub_u32 s18, s18, 64
  s_waitcnt lgkmcnt(0)
  s_waitcnt vmcnt(18)
  ds_read_b128 v[192:195], v20 offset:4096
  ds_read_b128 v[196:199], v21 offset:4096
  ds_read_b128 v[200:203], v22 offset:4096
  ds_read_b128 v[204:207], v23 offset:4096
  s_mov_b32 m0, s30
  v_dot2c_f32_bf16 v40, v176, v11
  v_dot2c_f32_bf16 v41, v177, v11
  v_dot2c_f32_bf16 v42, v178, v11
  buffer_load_dwordx4 v2, s[16:19], 0 offen offset:0 lds
  v_dot2c_f32_bf16 v43, v179, v11
  v_dot2c_f32_bf16 v44, v176, v176
  v_dot2c_f32_bf16 v45, v177, v177
  v_dot2c_f32_bf16 v46, v178, v178
  buffer_load_dwordx4 v2, s[16:19], s67 offen offset:1024 lds
  v_dot2c_f32_bf16 v47, v179, v179
  v_dot2c_f32_bf16 v40, v180, v11
  v_dot2c_f32_bf16 v41, v181, v11
  buffer_load_dwordx4 v2, s[16:19], s68 offen offset:2048 lds
  v_dot2c_f32_bf16 v42, v182, v11
  v_dot2c_f32_bf16 v43, v183, v11
  v_dot2c_f32_bf16 v44, v180, v180
  v_dot2c_f32_bf16 v45, v181, v181
  buffer_load_dwordx4 v2, s[16:19], s69 offen offset:3072 lds
  s_add_u32 m0, m0, 4096
  v_dot2c_f32_bf16 v46, v182, v182
  v_dot2c_f32_bf16 v47, v183, v183
  v_dot2c_f32_bf16 v40, v184, v11
  buffer_load_dwordx4 v2, s[16:19], s70 offen offset:0 lds
  v_dot2c_f32_bf16 v41, v185, v11
  v_dot2c_f32_bf16 v42, v186, v11
  v_dot2c_f32_bf16 v43, v187, v11
  v_dot2c_f32_bf16 v44, v184, v184
  buffer_load_dwordx4 v2, s[16:19], s71 offen offset:1024 lds
  v_dot2c_f32_bf16 v45, v185, v185
  v_dot2c_f32_bf16 v46, v186, v186
  v_dot2c_f32_bf16 v47, v187, v187
  buffer_load_dwordx4 v2, s[16:19], s72 offen offset:2048 lds
  v_dot2c_f32_bf16 v40, v188, v11
  v_dot2c_f32_bf16 v41, v189, v11
  v_dot2c_f32_bf16 v42, v190, v11
  v_dot2c_f32_bf16 v43, v191, v11
  buffer_load_dwordx4 v2, s[16:19], s73 offen offset:3072 lds
  s_add_u32 m0, m0, 4096
  v_dot2c_f32_bf16 v44, v188, v188
  v_dot2c_f32_bf16 v45, v189, v189
  v_dot2c_f32_bf16 v46, v190, v190
  v_dot2c_f32_bf16 v47, v191, v191
  buffer_load_dwordx4 v2, s[16:19], s74 offen offset:0 lds
  s_add_u32 s30, s30, 36864
  s_cmp_ge_u32 s30, 147456
  s_cselect_b32 s35, 147456, 0
  s_sub_u32 s30, s30, s35
  s_add_u32 s16, s16, 64
  s_addc_u32 s17, s17, 0
  s_sub_u32 s18, s18, 64
  s_waitcnt lgkmcnt(0)
  s_waitcnt vmcnt(23)
  ds_read_b128 v[208:211], v20 offset:36864
  ds_read_b128 v[212:215], v21 offset:36864
  ds_read_b128 v[216:219], v22 offset:36864
  ds_read_b128 v[220:223], v23 offset:36864
  v_dot2c_f32_bf16 v40, v192, v11
  v_dot2c_f32_bf16 v41, v193, v11
  v_dot2c_f32_bf16 v42, v194, v11
  v_dot2c_f32_bf16 v43, v195, v11
  v_dot2c_f32_bf16 v44, v192, v192
  v_dot2c_f32_bf16 v45, v193, v193
  v_dot2c_f32_bf16 v46, v194, v194
  v_dot2c_f32_bf16 v47, v195, v195
  v_dot2c_f32_bf16 v40, v196, v11
  v_dot2c_f32_bf16 v41, v197, v11
  v_dot2c_f32_bf16 v42, v198, v11
  v_dot2c_f32_bf16 v43, v199, v11
  v_dot2c_f32_bf16 v44, v196, v196
  v_dot2c_f32_bf16 v45, v197, v197
  v_dot2c_f32_bf16 v46, v198, v198
  v_dot2c_f32_bf16 v47, v199, v199
  v_dot2c_f32_bf16 v40, v200, v11
  v_dot2c_f32_bf16 v41, v201, v11
  v_dot2c_f32_bf16 v42, v202, v11
  v_dot2c_f32_bf16 v43, v203, v11
  v_dot2c_f32_bf16 v44, v200, v200
  v_dot2c_f32_bf16 v45, v201, v201
  v_dot2c_f32_bf16 v46, v202, v202
  v_dot2c_f32_bf16 v47, v203, v203
  v_dot2c_f32_bf16 v40, v204, v11
  v_dot2c_f32_bf16 v41, v205, v11
  v_dot2c_f32_bf16 v42, v206, v11
  v_dot2c_f32_bf16 v43, v207, v11
  v_dot2c_f32_bf16 v44, v204, v204
  v_dot2c_f32_bf16 v45, v205, v205
  v_dot2c_f32_bf16 v46, v206, v206
  v_dot2c_f32_bf16 v47, v207, v207
  s_waitcnt lgkmcnt(0)
  s_waitcnt vmcnt(19)
  ds_read_b128 v[224:227], v20 offset:40960
  ds_read_b128 v[228:231], v21 offset:40960
  ds_read_b128 v[232:235], v22 offset:40960
  ds_read_b128 v[236:239], v23 offset:40960
  v_dot2c_f32_bf16 v40, v208, v11
  v_dot2c_f32_bf16 v41, v209, v11
  v_dot2c_f32_bf16 v42, v210, v11
  v_dot2c_f32_bf16 v43, v211, v11
  v_dot2c_f32_bf16 v44, v208, v208
  v_dot2c_f32_bf16 v45, v209, v209
  v_dot2c_f32_bf16 v46, v210, v210
  v_dot2c_f32_bf16 v47, v211, v211
  v_dot2c_f32_bf16 v40, v212, v11
  v_dot2c_f32_bf16 v41, v213, v11
  v_dot2c_f32_bf16 v42, v214, v11
  v_dot2c_f32_bf16 v43, v215, v11
  v_dot2c_f32_bf16 v44, v212, v212
  v_dot2c_f32_bf16 v45, v213, v213
  v_dot2c_f32_bf16 v46, v214, v214
  v_dot2c_f32_bf16 v47, v215, v215
  v_dot2c_f32_bf16 v40, v216, v11
  v_dot2c_f32_bf16 v41, v217, v11
  v_dot2c_f32_bf16 v42, v218, v11
  v_dot2c_f32_bf16 v43, v219, v11
  v_dot2c_f32_bf16 v44, v216, v216
  v_dot2c_f32_bf16 v45, v217, v217
  v_dot2c_f32_bf16 v46, v218, v218
  v_dot2c_f32_bf16 v47, v219, v219
  v_dot2c_f32_bf16 v40, v220, v11
  v_dot2c_f32_bf16 v41, v221, v11
  v_dot2c_f32_bf16 v42, v222, v11
  v_dot2c_f32_bf16 v43, v223, v11
  v_dot2c_f32_bf16 v44, v220, v220
  v_dot2c_f32_bf16 v45, v221, v221
  v_dot2c_f32_bf16 v46, v222, v222
  v_dot2c_f32_bf16 v47, v223, v223
  s_waitcnt lgkmcnt(0)
  v_dot2c_f32_bf16 v40, v224, v11
  v_dot2c_f32_bf16 v41, v225, v11
  v_dot2c_f32_bf16 v42, v226, v11
  v_dot2c_f32_bf16 v43, v227, v11
  v_dot2c_f32_bf16 v44, v224, v224
  v_dot2c_f32_bf16 v45, v225, v225
  v_dot2c_f32_bf16 v46, v226, v226
  v_dot2c_f32_bf16 v47, v227, v227
  v_dot2c_f32_bf16 v40, v228, v11
  v_dot2c_f32_bf16 v41, v229, v11
  v_dot2c_f32_bf16 v42, v230, v11
  v_dot2c_f32_bf16 v43, v231, v11
  v_dot2c_f32_bf16 v44, v228, v228
  v_dot2c_f32_bf16 v45, v229, v229
  v_dot2c_f32_bf16 v46, v230, v230
  v_dot2c_f32_bf16 v47, v231, v231
  v_dot2c_f32_bf16 v40, v232, v11
  v_dot2c_f32_bf16 v41, v233, v11
  v_dot2c_f32_bf16 v42, v234, v11
  v_dot2c_f32_bf16 v43, v235, v11
  v_dot2c_f32_bf16 v44, v232, v232
  v_dot2c_f32_bf16 v45, v233, v233
  v_dot2c_f32_bf16 v46, v234, v234
  v_dot2c_f32_bf16 v47, v235, v235
  v_dot2c_f32_bf16 v40, v236, v11
  v_dot2c_f32_bf16 v41, v237, v11
  v_dot2c_f32_bf16 v42, v238, v11
  v_dot2c_f32_bf16 v43, v239, v11
  v_dot2c_f32_bf16 v44, v236, v236
  v_dot2c_f32_bf16 v45, v237, v237
  v_dot2c_f32_bf16 v46, v238, v238
  v_dot2c_f32_bf16 v47, v239, v239
  s_nop 2
  v_add_f32 v40, v40, v41
  v_add_f32 v42, v42, v43
  v_add_f32 v44, v44, v45
  v_add_f32 v46, v46, v47
  v_add_f32 v40, v40, v42
  v_add_f32 v44, v44, v46
  v_mov_b32 v41, v40
  v_mov_b32 v45, v44
  s_nop 1
  v_permlane32_swap_b32 v40, v41
  v_permlane32_swap_b32 v44, v45
  s_nop 1
  v_add_f32 v40, v40, v41
  v_add_f32 v44, v44, v45
  v_mul_f32 v40, 0x3ae38e39, v40
  v_mul_f32 v44, 0x3ae38e39, v44
  v_fma_f32 v44, -v40, v40, v44
  v_max_f32 v44, 0, v44
  v_cvt_pk_bf16_f32 v41, v40, v44
  v_lshlrev_b32 v40, 16, v41
  v_and_b32 v44, 0xffff0000, v41
  v_add_f32 v44, 0x3727c5ac, v44
  v_cvt_pk_bf16_f32 v44, v44, v44
  v_and_b32 v44, 0xffff0000, v44
  v_sqrt_f32 v44, v44
  s_nop 0
  v_cvt_pk_bf16_f32 v44, v44, v44
  v_and_b32 v44, 0xffff0000, v44
  v_rcp_f32 v12, v44
  s_nop 0
  v_mul_f32 v14, v40, v12
  v_sub_f32 v14, 0, v14

  s_mul_i32 s62, s36, 622592
  s_mul_i32 s38, s51, 2432
  s_add_u32 s62, s62, s38
  s_add_u32 s62, s62, 0

  v_add_u32 v10, 0, v13
  v_lshrrev_b32 v15, 6, v10
  v_and_b32 v15, 3, v15
  v_mul_u32_u24 v15, 36864, v15
  v_and_b32 v10, 63, v10
  v_add3_u32 v15, v15, v10, v4
  v_lshlrev_b32 v40, 16, v112
  v_and_b32 v41, 0xffff0000, v112
  v_lshlrev_b32 v42, 16, v113
  v_and_b32 v43, 0xffff0000, v113
  v_lshlrev_b32 v44, 16, v114
  v_and_b32 v45, 0xffff0000, v114
  v_lshlrev_b32 v46, 16, v115
  v_and_b32 v47, 0xffff0000, v115
  v_pk_fma_f32 v[40:41], v[40:41], v[12:13], v[14:15] op_sel_hi:[1,0,0]
  v_pk_fma_f32 v[42:43], v[42:43], v[12:13], v[14:15] op_sel_hi:[1,0,0]
  v_pk_fma_f32 v[44:45], v[44:45], v[12:13], v[14:15] op_sel_hi:[1,0,0]
  v_pk_fma_f32 v[46:47], v[46:47], v[12:13], v[14:15] op_sel_hi:[1,0,0]
  v_cvt_pk_bf16_f32 v112, v40, v41
  v_cvt_pk_bf16_f32 v113, v42, v43
  v_cvt_pk_bf16_f32 v114, v44, v45
  v_cvt_pk_bf16_f32 v115, v46, v47
  v_lshlrev_b32 v40, 16, v116
  v_and_b32 v41, 0xffff0000, v116
  v_lshlrev_b32 v42, 16, v117
  v_and_b32 v43, 0xffff0000, v117
  v_lshlrev_b32 v44, 16, v118
  v_and_b32 v45, 0xffff0000, v118
  v_lshlrev_b32 v46, 16, v119
  v_and_b32 v47, 0xffff0000, v119
  v_pk_fma_f32 v[40:41], v[40:41], v[12:13], v[14:15] op_sel_hi:[1,0,0]
  v_pk_fma_f32 v[42:43], v[42:43], v[12:13], v[14:15] op_sel_hi:[1,0,0]
  v_pk_fma_f32 v[44:45], v[44:45], v[12:13], v[14:15] op_sel_hi:[1,0,0]
  v_pk_fma_f32 v[46:47], v[46:47], v[12:13], v[14:15] op_sel_hi:[1,0,0]
  v_cvt_pk_bf16_f32 v116, v40, v41
  v_cvt_pk_bf16_f32 v117, v42, v43
  v_cvt_pk_bf16_f32 v118, v44, v45
  v_cvt_pk_bf16_f32 v119, v46, v47
  s_waitcnt vmcnt(0)
  s_barrier
  v_mov_b32 v6, v15
  ds_read_b64_tr_b16 v[16:17], v6 offset:0
  ds_read_b64_tr_b16 v[18:19], v6 offset:256
  ds_read_b64_tr_b16 v[20:21], v6 offset:1024
  ds_read_b64_tr_b16 v[22:23], v6 offset:1280
  ds_read_b64_tr_b16 v[24:25], v6 offset:2048
  ds_read_b64_tr_b16 v[26:27], v6 offset:2304
  ds_read_b64_tr_b16 v[28:29], v6 offset:3072
  ds_read_b64_tr_b16 v[30:31], v6 offset:3328
  ds_read_b64_tr_b16 v[32:33], v6 offset:4096
  ds_read_b64_tr_b16 v[34:35], v6 offset:4352
  s_waitcnt lgkmcnt(4)
  v_mfma_f32_32x32x16_bf16 v[48:63], v[112:115], v[16:19], 0
  ds_read_b64_tr_b16 v[36:37], v6 offset:5120
  ds_read_b64_tr_b16 v[38:39], v6 offset:5376
  v_lshlrev_b32 v40, 16, v120
  v_and_b32 v41, 0xffff0000, v120
  v_lshlrev_b32 v42, 16, v121
  v_and_b32 v43, 0xffff0000, v121
  v_lshlrev_b32 v44, 16, v122
  v_and_b32 v45, 0xffff0000, v122
  v_lshlrev_b32 v46, 16, v123
  v_and_b32 v47, 0xffff0000, v123
  v_pk_fma_f32 v[40:41], v[40:41], v[12:13], v[14:15] op_sel_hi:[1,0,0]
  v_pk_fma_f32 v[42:43], v[42:43], v[12:13], v[14:15] op_sel_hi:[1,0,0]
  v_pk_fma_f32 v[44:45], v[44:45], v[12:13], v[14:15] op_sel_hi:[1,0,0]
  v_pk_fma_f32 v[46:47], v[46:47], v[12:13], v[14:15] op_sel_hi:[1,0,0]
  v_cvt_pk_bf16_f32 v120, v40, v41
  v_cvt_pk_bf16_f32 v121, v42, v43
  v_cvt_pk_bf16_f32 v122, v44, v45
  v_cvt_pk_bf16_f32 v123, v46, v47
  s_mov_b32 m0, s30
  v_mfma_f32_32x32x16_bf16 v[48:63], v[116:119], v[20:23], v[48:63]
  ds_read_b64_tr_b16 v[16:17], v6 offset:6144
  ds_read_b64_tr_b16 v[18:19], v6 offset:6400
  buffer_load_dwordx4 v2, s[16:19], 0 offen offset:0 lds
  v_lshlrev_b32 v40, 16, v124
  v_and_b32 v41, 0xffff0000, v124
  v_lshlrev_b32 v42, 16, v125
  v_and_b32 v43, 0xffff0000, v125
  v_lshlrev_b32 v44, 16, v126
  v_and_b32 v45, 0xffff0000, v126
  v_lshlrev_b32 v46, 16, v127
  v_and_b32 v47, 0xffff0000, v127
  v_pk_fma_f32 v[40:41], v[40:41], v[12:13], v[14:15] op_sel_hi:[1,0,0]
  v_pk_fma_f32 v[42:43], v[42:43], v[12:13], v[14:15] op_sel_hi:[1,0,0]
  v_pk_fma_f32 v[44:45], v[44:45], v[12:13], v[14:15] op_sel_hi:[1,0,0]
  v_pk_fma_f32 v[46:47], v[46:47], v[12:13], v[14:15] op_sel_hi:[1,0,0]
  v_cvt_pk_bf16_f32 v124, v40, v41
  v_cvt_pk_bf16_f32 v125, v42, v43
  v_cvt_pk_bf16_f32 v126, v44, v45
  v_cvt_pk_bf16_f32 v127, v46, v47
  v_mfma_f32_32x32x16_bf16 v[48:63], v[120:123], v[24:27], v[48:63]
  ds_read_b64_tr_b16 v[20:21], v6 offset:7168
  ds_read_b64_tr_b16 v[22:23], v6 offset:7424
  v_lshlrev_b32 v40, 16, v128
  v_and_b32 v41, 0xffff0000, v128
  v_lshlrev_b32 v42, 16, v129
  v_and_b32 v43, 0xffff0000, v129
  v_lshlrev_b32 v44, 16, v130
  v_and_b32 v45, 0xffff0000, v130
  v_lshlrev_b32 v46, 16, v131
  v_and_b32 v47, 0xffff0000, v131
  v_pk_fma_f32 v[40:41], v[40:41], v[12:13], v[14:15] op_sel_hi:[1,0,0]
  v_pk_fma_f32 v[42:43], v[42:43], v[12:13], v[14:15] op_sel_hi:[1,0,0]
  v_pk_fma_f32 v[44:45], v[44:45], v[12:13], v[14:15] op_sel_hi:[1,0,0]
  v_pk_fma_f32 v[46:47], v[46:47], v[12:13], v[14:15] op_sel_hi:[1,0,0]
  v_cvt_pk_bf16_f32 v128, v40, v41
  v_cvt_pk_bf16_f32 v129, v42, v43
  v_cvt_pk_bf16_f32 v130, v44, v45
  v_cvt_pk_bf16_f32 v131, v46, v47
  s_waitcnt lgkmcnt(4)
  v_mfma_f32_32x32x16_bf16 v[48:63], v[124:127], v[28:31], v[48:63]
  ds_read_b64_tr_b16 v[24:25], v6 offset:8192
  ds_read_b64_tr_b16 v[26:27], v6 offset:8448
  buffer_load_dwordx4 v2, s[16:19], s67 offen offset:1024 lds
  v_lshlrev_b32 v40, 16, v132
  v_and_b32 v41, 0xffff0000, v132
  v_lshlrev_b32 v42, 16, v133
  v_and_b32 v43, 0xffff0000, v133
  v_lshlrev_b32 v44, 16, v134
  v_and_b32 v45, 0xffff0000, v134
  v_lshlrev_b32 v46, 16, v135
  v_and_b32 v47, 0xffff0000, v135
  v_pk_fma_f32 v[40:41], v[40:41], v[12:13], v[14:15] op_sel_hi:[1,0,0]
  v_pk_fma_f32 v[42:43], v[42:43], v[12:13], v[14:15] op_sel_hi:[1,0,0]
  v_pk_fma_f32 v[44:45], v[44:45], v[12:13], v[14:15] op_sel_hi:[1,0,0]
  v_pk_fma_f32 v[46:47], v[46:47], v[12:13], v[14:15] op_sel_hi:[1,0,0]
  v_cvt_pk_bf16_f32 v132, v40, v41
  v_cvt_pk_bf16_f32 v133, v42, v43
  v_cvt_pk_bf16_f32 v134, v44, v45
  v_cvt_pk_bf16_f32 v135, v46, v47
  v_mfma_f32_32x32x16_bf16 v[48:63], v[128:131], v[32:35], v[48:63]
  ds_read_b64_tr_b16 v[28:29], v6 offset:9216
  ds_read_b64_tr_b16 v[30:31], v6 offset:9472
  v_lshlrev_b32 v40, 16, v136
  v_and_b32 v41, 0xffff0000, v136
  v_lshlrev_b32 v42, 16, v137
  v_and_b32 v43, 0xffff0000, v137
  v_lshlrev_b32 v44, 16, v138
  v_and_b32 v45, 0xffff0000, v138
  v_lshlrev_b32 v46, 16, v139
  v_and_b32 v47, 0xffff0000, v139
  v_pk_fma_f32 v[40:41], v[40:41], v[12:13], v[14:15] op_sel_hi:[1,0,0]
  v_pk_fma_f32 v[42:43], v[42:43], v[12:13], v[14:15] op_sel_hi:[1,0,0]
  v_pk_fma_f32 v[44:45], v[44:45], v[12:13], v[14:15] op_sel_hi:[1,0,0]
  v_pk_fma_f32 v[46:47], v[46:47], v[12:13], v[14:15] op_sel_hi:[1,0,0]
  v_cvt_pk_bf16_f32 v136, v40, v41
  v_cvt_pk_bf16_f32 v137, v42, v43
  v_cvt_pk_bf16_f32 v138, v44, v45
  v_cvt_pk_bf16_f32 v139, v46, v47
  v_mfma_f32_32x32x16_bf16 v[48:63], v[132:135], v[36:39], v[48:63]
  ds_read_b64_tr_b16 v[32:33], v6 offset:10240
  ds_read_b64_tr_b16 v[34:35], v6 offset:10496
  buffer_load_dwordx4 v2, s[16:19], s68 offen offset:2048 lds
  v_lshlrev_b32 v40, 16, v140
  v_and_b32 v41, 0xffff0000, v140
  v_lshlrev_b32 v42, 16, v141
  v_and_b32 v43, 0xffff0000, v141
  v_lshlrev_b32 v44, 16, v142
  v_and_b32 v45, 0xffff0000, v142
  v_lshlrev_b32 v46, 16, v143
  v_and_b32 v47, 0xffff0000, v143
  v_pk_fma_f32 v[40:41], v[40:41], v[12:13], v[14:15] op_sel_hi:[1,0,0]
  v_pk_fma_f32 v[42:43], v[42:43], v[12:13], v[14:15] op_sel_hi:[1,0,0]
  v_pk_fma_f32 v[44:45], v[44:45], v[12:13], v[14:15] op_sel_hi:[1,0,0]
  v_pk_fma_f32 v[46:47], v[46:47], v[12:13], v[14:15] op_sel_hi:[1,0,0]
  v_cvt_pk_bf16_f32 v140, v40, v41
  v_cvt_pk_bf16_f32 v141, v42, v43
  v_cvt_pk_bf16_f32 v142, v44, v45
  v_cvt_pk_bf16_f32 v143, v46, v47
  s_waitcnt lgkmcnt(4)
  v_mfma_f32_32x32x16_bf16 v[48:63], v[136:139], v[16:19], v[48:63]
  ds_read_b64_tr_b16 v[36:37], v6 offset:11264
  ds_read_b64_tr_b16 v[38:39], v6 offset:11520
  v_lshlrev_b32 v40, 16, v144
  v_and_b32 v41, 0xffff0000, v144
  v_lshlrev_b32 v42, 16, v145
  v_and_b32 v43, 0xffff0000, v145
  v_lshlrev_b32 v44, 16, v146
  v_and_b32 v45, 0xffff0000, v146
  v_lshlrev_b32 v46, 16, v147
  v_and_b32 v47, 0xffff0000, v147
  v_pk_fma_f32 v[40:41], v[40:41], v[12:13], v[14:15] op_sel_hi:[1,0,0]
  v_pk_fma_f32 v[42:43], v[42:43], v[12:13], v[14:15] op_sel_hi:[1,0,0]
  v_pk_fma_f32 v[44:45], v[44:45], v[12:13], v[14:15] op_sel_hi:[1,0,0]
  v_pk_fma_f32 v[46:47], v[46:47], v[12:13], v[14:15] op_sel_hi:[1,0,0]
  v_cvt_pk_bf16_f32 v144, v40, v41
  v_cvt_pk_bf16_f32 v145, v42, v43
  v_cvt_pk_bf16_f32 v146, v44, v45
  v_cvt_pk_bf16_f32 v147, v46, v47
  v_mfma_f32_32x32x16_bf16 v[48:63], v[140:143], v[20:23], v[48:63]
  ds_read_b64_tr_b16 v[16:17], v6 offset:12288
  ds_read_b64_tr_b16 v[18:19], v6 offset:12544
  buffer_load_dwordx4 v2, s[16:19], s69 offen offset:3072 lds
  v_lshlrev_b32 v40, 16, v148
  v_and_b32 v41, 0xffff0000, v148
  v_lshlrev_b32 v42, 16, v149
  v_and_b32 v43, 0xffff0000, v149
  v_lshlrev_b32 v44, 16, v150
  v_and_b32 v45, 0xffff0000, v150
  v_lshlrev_b32 v46, 16, v151
  v_and_b32 v47, 0xffff0000, v151
  v_pk_fma_f32 v[40:41], v[40:41], v[12:13], v[14:15] op_sel_hi:[1,0,0]
  v_pk_fma_f32 v[42:43], v[42:43], v[12:13], v[14:15] op_sel_hi:[1,0,0]
  v_pk_fma_f32 v[44:45], v[44:45], v[12:13], v[14:15] op_sel_hi:[1,0,0]
  v_pk_fma_f32 v[46:47], v[46:47], v[12:13], v[14:15] op_sel_hi:[1,0,0]
  v_cvt_pk_bf16_f32 v148, v40, v41
  v_cvt_pk_bf16_f32 v149, v42, v43
  v_cvt_pk_bf16_f32 v150, v44, v45
  v_cvt_pk_bf16_f32 v151, v46, v47
  v_mfma_f32_32x32x16_bf16 v[48:63], v[144:147], v[24:27], v[48:63]
  ds_read_b64_tr_b16 v[20:21], v6 offset:13312
  ds_read_b64_tr_b16 v[22:23], v6 offset:13568
  v_lshlrev_b32 v40, 16, v152
  v_and_b32 v41, 0xffff0000, v152
  v_lshlrev_b32 v42, 16, v153
  v_and_b32 v43, 0xffff0000, v153
  v_lshlrev_b32 v44, 16, v154
  v_and_b32 v45, 0xffff0000, v154
  v_lshlrev_b32 v46, 16, v155
  v_and_b32 v47, 0xffff0000, v155
  v_pk_fma_f32 v[40:41], v[40:41], v[12:13], v[14:15] op_sel_hi:[1,0,0]
  v_pk_fma_f32 v[42:43], v[42:43], v[12:13], v[14:15] op_sel_hi:[1,0,0]
  v_pk_fma_f32 v[44:45], v[44:45], v[12:13], v[14:15] op_sel_hi:[1,0,0]
  v_pk_fma_f32 v[46:47], v[46:47], v[12:13], v[14:15] op_sel_hi:[1,0,0]
  v_cvt_pk_bf16_f32 v152, v40, v41
  v_cvt_pk_bf16_f32 v153, v42, v43
  v_cvt_pk_bf16_f32 v154, v44, v45
  v_cvt_pk_bf16_f32 v155, v46, v47
  s_add_u32 m0, m0, 4096
  s_waitcnt lgkmcnt(4)
  v_mfma_f32_32x32x16_bf16 v[48:63], v[148:151], v[28:31], v[48:63]
  ds_read_b64_tr_b16 v[24:25], v6 offset:14336
  ds_read_b64_tr_b16 v[26:27], v6 offset:14592
  buffer_load_dwordx4 v2, s[16:19], s70 offen offset:0 lds
  v_lshlrev_b32 v40, 16, v156
  v_and_b32 v41, 0xffff0000, v156
  v_lshlrev_b32 v42, 16, v157
  v_and_b32 v43, 0xffff0000, v157
  v_lshlrev_b32 v44, 16, v158
  v_and_b32 v45, 0xffff0000, v158
  v_lshlrev_b32 v46, 16, v159
  v_and_b32 v47, 0xffff0000, v159
  v_pk_fma_f32 v[40:41], v[40:41], v[12:13], v[14:15] op_sel_hi:[1,0,0]
  v_pk_fma_f32 v[42:43], v[42:43], v[12:13], v[14:15] op_sel_hi:[1,0,0]
  v_pk_fma_f32 v[44:45], v[44:45], v[12:13], v[14:15] op_sel_hi:[1,0,0]
  v_pk_fma_f32 v[46:47], v[46:47], v[12:13], v[14:15] op_sel_hi:[1,0,0]
  v_cvt_pk_bf16_f32 v156, v40, v41
  v_cvt_pk_bf16_f32 v157, v42, v43
  v_cvt_pk_bf16_f32 v158, v44, v45
  v_cvt_pk_bf16_f32 v159, v46, v47
  v_mfma_f32_32x32x16_bf16 v[48:63], v[152:155], v[32:35], v[48:63]
  ds_read_b64_tr_b16 v[28:29], v6 offset:15360
  ds_read_b64_tr_b16 v[30:31], v6 offset:15616
  v_lshlrev_b32 v40, 16, v160
  v_and_b32 v41, 0xffff0000, v160
  v_lshlrev_b32 v42, 16, v161
  v_and_b32 v43, 0xffff0000, v161
  v_lshlrev_b32 v44, 16, v162
  v_and_b32 v45, 0xffff0000, v162
  v_lshlrev_b32 v46, 16, v163
  v_and_b32 v47, 0xffff0000, v163
  v_pk_fma_f32 v[40:41], v[40:41], v[12:13], v[14:15] op_sel_hi:[1,0,0]
  v_pk_fma_f32 v[42:43], v[42:43], v[12:13], v[14:15] op_sel_hi:[1,0,0]
  v_pk_fma_f32 v[44:45], v[44:45], v[12:13], v[14:15] op_sel_hi:[1,0,0]
  v_pk_fma_f32 v[46:47], v[46:47], v[12:13], v[14:15] op_sel_hi:[1,0,0]
  v_cvt_pk_bf16_f32 v160, v40, v41
  v_cvt_pk_bf16_f32 v161, v42, v43
  v_cvt_pk_bf16_f32 v162, v44, v45
  v_cvt_pk_bf16_f32 v163, v46, v47
  v_mfma_f32_32x32x16_bf16 v[48:63], v[156:159], v[36:39], v[48:63]
  ds_read_b64_tr_b16 v[32:33], v6 offset:16384
  ds_read_b64_tr_b16 v[34:35], v6 offset:16640
  buffer_load_dwordx4 v2, s[16:19], s71 offen offset:1024 lds
  v_lshlrev_b32 v40, 16, v164
  v_and_b32 v41, 0xffff0000, v164
  v_lshlrev_b32 v42, 16, v165
  v_and_b32 v43, 0xffff0000, v165
  v_lshlrev_b32 v44, 16, v166
  v_and_b32 v45, 0xffff0000, v166
  v_lshlrev_b32 v46, 16, v167
  v_and_b32 v47, 0xffff0000, v167
  v_pk_fma_f32 v[40:41], v[40:41], v[12:13], v[14:15] op_sel_hi:[1,0,0]
  v_pk_fma_f32 v[42:43], v[42:43], v[12:13], v[14:15] op_sel_hi:[1,0,0]
  v_pk_fma_f32 v[44:45], v[44:45], v[12:13], v[14:15] op_sel_hi:[1,0,0]
  v_pk_fma_f32 v[46:47], v[46:47], v[12:13], v[14:15] op_sel_hi:[1,0,0]
  v_cvt_pk_bf16_f32 v164, v40, v41
  v_cvt_pk_bf16_f32 v165, v42, v43
  v_cvt_pk_bf16_f32 v166, v44, v45
  v_cvt_pk_bf16_f32 v167, v46, v47
  s_waitcnt lgkmcnt(4)
  v_mfma_f32_32x32x16_bf16 v[48:63], v[160:163], v[16:19], v[48:63]
  ds_read_b64_tr_b16 v[36:37], v6 offset:17408
  ds_read_b64_tr_b16 v[38:39], v6 offset:17664
  v_lshlrev_b32 v40, 16, v168
  v_and_b32 v41, 0xffff0000, v168
  v_lshlrev_b32 v42, 16, v169
  v_and_b32 v43, 0xffff0000, v169
  v_lshlrev_b32 v44, 16, v170
  v_and_b32 v45, 0xffff0000, v170
  v_lshlrev_b32 v46, 16, v171
  v_and_b32 v47, 0xffff0000, v171
  v_pk_fma_f32 v[40:41], v[40:41], v[12:13], v[14:15] op_sel_hi:[1,0,0]
  v_pk_fma_f32 v[42:43], v[42:43], v[12:13], v[14:15] op_sel_hi:[1,0,0]
  v_pk_fma_f32 v[44:45], v[44:45], v[12:13], v[14:15] op_sel_hi:[1,0,0]
  v_pk_fma_f32 v[46:47], v[46:47], v[12:13], v[14:15] op_sel_hi:[1,0,0]
  v_cvt_pk_bf16_f32 v168, v40, v41
  v_cvt_pk_bf16_f32 v169, v42, v43
  v_cvt_pk_bf16_f32 v170, v44, v45
  v_cvt_pk_bf16_f32 v171, v46, v47
  v_mfma_f32_32x32x16_bf16 v[48:63], v[164:167], v[20:23], v[48:63]
  ds_read_b64_tr_b16 v[16:17], v6 offset:18432
  ds_read_b64_tr_b16 v[18:19], v6 offset:18688
  buffer_load_dwordx4 v2, s[16:19], s72 offen offset:2048 lds
  v_lshlrev_b32 v40, 16, v172
  v_and_b32 v41, 0xffff0000, v172
  v_lshlrev_b32 v42, 16, v173
  v_and_b32 v43, 0xffff0000, v173
  v_lshlrev_b32 v44, 16, v174
  v_and_b32 v45, 0xffff0000, v174
  v_lshlrev_b32 v46, 16, v175
  v_and_b32 v47, 0xffff0000, v175
  v_pk_fma_f32 v[40:41], v[40:41], v[12:13], v[14:15] op_sel_hi:[1,0,0]
  v_pk_fma_f32 v[42:43], v[42:43], v[12:13], v[14:15] op_sel_hi:[1,0,0]
  v_pk_fma_f32 v[44:45], v[44:45], v[12:13], v[14:15] op_sel_hi:[1,0,0]
  v_pk_fma_f32 v[46:47], v[46:47], v[12:13], v[14:15] op_sel_hi:[1,0,0]
  v_cvt_pk_bf16_f32 v172, v40, v41
  v_cvt_pk_bf16_f32 v173, v42, v43
  v_cvt_pk_bf16_f32 v174, v44, v45
  v_cvt_pk_bf16_f32 v175, v46, v47
  v_mfma_f32_32x32x16_bf16 v[48:63], v[168:171], v[24:27], v[48:63]
  ds_read_b64_tr_b16 v[20:21], v6 offset:19456
  ds_read_b64_tr_b16 v[22:23], v6 offset:19712
  v_lshlrev_b32 v40, 16, v176
  v_and_b32 v41, 0xffff0000, v176
  v_lshlrev_b32 v42, 16, v177
  v_and_b32 v43, 0xffff0000, v177
  v_lshlrev_b32 v44, 16, v178
  v_and_b32 v45, 0xffff0000, v178
  v_lshlrev_b32 v46, 16, v179
  v_and_b32 v47, 0xffff0000, v179
  v_pk_fma_f32 v[40:41], v[40:41], v[12:13], v[14:15] op_sel_hi:[1,0,0]
  v_pk_fma_f32 v[42:43], v[42:43], v[12:13], v[14:15] op_sel_hi:[1,0,0]
  v_pk_fma_f32 v[44:45], v[44:45], v[12:13], v[14:15] op_sel_hi:[1,0,0]
  v_pk_fma_f32 v[46:47], v[46:47], v[12:13], v[14:15] op_sel_hi:[1,0,0]
  v_cvt_pk_bf16_f32 v176, v40, v41
  v_cvt_pk_bf16_f32 v177, v42, v43
  v_cvt_pk_bf16_f32 v178, v44, v45
  v_cvt_pk_bf16_f32 v179, v46, v47
  s_waitcnt lgkmcnt(4)
  v_mfma_f32_32x32x16_bf16 v[48:63], v[172:175], v[28:31], v[48:63]
  ds_read_b64_tr_b16 v[24:25], v6 offset:20480
  ds_read_b64_tr_b16 v[26:27], v6 offset:20736
  buffer_load_dwordx4 v2, s[16:19], s73 offen offset:3072 lds
  v_lshlrev_b32 v40, 16, v180
  v_and_b32 v41, 0xffff0000, v180
  v_lshlrev_b32 v42, 16, v181
  v_and_b32 v43, 0xffff0000, v181
  v_lshlrev_b32 v44, 16, v182
  v_and_b32 v45, 0xffff0000, v182
  v_lshlrev_b32 v46, 16, v183
  v_and_b32 v47, 0xffff0000, v183
  v_pk_fma_f32 v[40:41], v[40:41], v[12:13], v[14:15] op_sel_hi:[1,0,0]
  v_pk_fma_f32 v[42:43], v[42:43], v[12:13], v[14:15] op_sel_hi:[1,0,0]
  v_pk_fma_f32 v[44:45], v[44:45], v[12:13], v[14:15] op_sel_hi:[1,0,0]
  v_pk_fma_f32 v[46:47], v[46:47], v[12:13], v[14:15] op_sel_hi:[1,0,0]
  v_cvt_pk_bf16_f32 v180, v40, v41
  v_cvt_pk_bf16_f32 v181, v42, v43
  v_cvt_pk_bf16_f32 v182, v44, v45
  v_cvt_pk_bf16_f32 v183, v46, v47
  v_mfma_f32_32x32x16_bf16 v[48:63], v[176:179], v[32:35], v[48:63]
  ds_read_b64_tr_b16 v[28:29], v6 offset:21504
  ds_read_b64_tr_b16 v[30:31], v6 offset:21760
  v_lshlrev_b32 v40, 16, v184
  v_and_b32 v41, 0xffff0000, v184
  v_lshlrev_b32 v42, 16, v185
  v_and_b32 v43, 0xffff0000, v185
  v_lshlrev_b32 v44, 16, v186
  v_and_b32 v45, 0xffff0000, v186
  v_lshlrev_b32 v46, 16, v187
  v_and_b32 v47, 0xffff0000, v187
  v_pk_fma_f32 v[40:41], v[40:41], v[12:13], v[14:15] op_sel_hi:[1,0,0]
  v_pk_fma_f32 v[42:43], v[42:43], v[12:13], v[14:15] op_sel_hi:[1,0,0]
  v_pk_fma_f32 v[44:45], v[44:45], v[12:13], v[14:15] op_sel_hi:[1,0,0]
  v_pk_fma_f32 v[46:47], v[46:47], v[12:13], v[14:15] op_sel_hi:[1,0,0]
  v_cvt_pk_bf16_f32 v184, v40, v41
  v_cvt_pk_bf16_f32 v185, v42, v43
  v_cvt_pk_bf16_f32 v186, v44, v45
  v_cvt_pk_bf16_f32 v187, v46, v47
  s_add_u32 m0, m0, 4096
  v_mfma_f32_32x32x16_bf16 v[48:63], v[180:183], v[36:39], v[48:63]
  ds_read_b64_tr_b16 v[32:33], v6 offset:22528
  ds_read_b64_tr_b16 v[34:35], v6 offset:22784
  buffer_load_dwordx4 v2, s[16:19], s74 offen offset:0 lds
  v_lshlrev_b32 v40, 16, v188
  v_and_b32 v41, 0xffff0000, v188
  v_lshlrev_b32 v42, 16, v189
  v_and_b32 v43, 0xffff0000, v189
  v_lshlrev_b32 v44, 16, v190
  v_and_b32 v45, 0xffff0000, v190
  v_lshlrev_b32 v46, 16, v191
  v_and_b32 v47, 0xffff0000, v191
  v_pk_fma_f32 v[40:41], v[40:41], v[12:13], v[14:15] op_sel_hi:[1,0,0]
  v_pk_fma_f32 v[42:43], v[42:43], v[12:13], v[14:15] op_sel_hi:[1,0,0]
  v_pk_fma_f32 v[44:45], v[44:45], v[12:13], v[14:15] op_sel_hi:[1,0,0]
  v_pk_fma_f32 v[46:47], v[46:47], v[12:13], v[14:15] op_sel_hi:[1,0,0]
  v_cvt_pk_bf16_f32 v188, v40, v41
  v_cvt_pk_bf16_f32 v189, v42, v43
  v_cvt_pk_bf16_f32 v190, v44, v45
  v_cvt_pk_bf16_f32 v191, v46, v47
  s_add_u32 s30, s30, 36864
  s_cmp_ge_u32 s30, 147456
  s_cselect_b32 s35, 147456, 0
  s_sub_u32 s30, s30, s35
  s_sub_u32 s16, s16, 1152
  s_subb_u32 s17, s17, 0
  s_add_u32 s18, s18, 1152
  s_waitcnt lgkmcnt(4)
  v_mfma_f32_32x32x16_bf16 v[48:63], v[184:187], v[16:19], v[48:63]
  ds_read_b64_tr_b16 v[36:37], v6 offset:23552
  ds_read_b64_tr_b16 v[38:39], v6 offset:23808
  v_lshlrev_b32 v40, 16, v192
  v_and_b32 v41, 0xffff0000, v192
  v_lshlrev_b32 v42, 16, v193
  v_and_b32 v43, 0xffff0000, v193
  v_lshlrev_b32 v44, 16, v194
  v_and_b32 v45, 0xffff0000, v194
  v_lshlrev_b32 v46, 16, v195
  v_and_b32 v47, 0xffff0000, v195
  v_pk_fma_f32 v[40:41], v[40:41], v[12:13], v[14:15] op_sel_hi:[1,0,0]
  v_pk_fma_f32 v[42:43], v[42:43], v[12:13], v[14:15] op_sel_hi:[1,0,0]
  v_pk_fma_f32 v[44:45], v[44:45], v[12:13], v[14:15] op_sel_hi:[1,0,0]
  v_pk_fma_f32 v[46:47], v[46:47], v[12:13], v[14:15] op_sel_hi:[1,0,0]
  v_cvt_pk_bf16_f32 v192, v40, v41
  v_cvt_pk_bf16_f32 v193, v42, v43
  v_cvt_pk_bf16_f32 v194, v44, v45
  v_cvt_pk_bf16_f32 v195, v46, v47
  s_mov_b32 m0, s30
  v_mfma_f32_32x32x16_bf16 v[48:63], v[188:191], v[20:23], v[48:63]
  ds_read_b64_tr_b16 v[16:17], v6 offset:24576
  ds_read_b64_tr_b16 v[18:19], v6 offset:24832
  buffer_load_dwordx4 v2, s[16:19], 0 offen offset:0 lds
  v_lshlrev_b32 v40, 16, v196
  v_and_b32 v41, 0xffff0000, v196
  v_lshlrev_b32 v42, 16, v197
  v_and_b32 v43, 0xffff0000, v197
  v_lshlrev_b32 v44, 16, v198
  v_and_b32 v45, 0xffff0000, v198
  v_lshlrev_b32 v46, 16, v199
  v_and_b32 v47, 0xffff0000, v199
  v_pk_fma_f32 v[40:41], v[40:41], v[12:13], v[14:15] op_sel_hi:[1,0,0]
  v_pk_fma_f32 v[42:43], v[42:43], v[12:13], v[14:15] op_sel_hi:[1,0,0]
  v_pk_fma_f32 v[44:45], v[44:45], v[12:13], v[14:15] op_sel_hi:[1,0,0]
  v_pk_fma_f32 v[46:47], v[46:47], v[12:13], v[14:15] op_sel_hi:[1,0,0]
  v_cvt_pk_bf16_f32 v196, v40, v41
  v_cvt_pk_bf16_f32 v197, v42, v43
  v_cvt_pk_bf16_f32 v198, v44, v45
  v_cvt_pk_bf16_f32 v199, v46, v47
  v_mfma_f32_32x32x16_bf16 v[48:63], v[192:195], v[24:27], v[48:63]
  ds_read_b64_tr_b16 v[20:21], v6 offset:25600
  ds_read_b64_tr_b16 v[22:23], v6 offset:25856
  v_lshlrev_b32 v40, 16, v200
  v_and_b32 v41, 0xffff0000, v200
  v_lshlrev_b32 v42, 16, v201
  v_and_b32 v43, 0xffff0000, v201
  v_lshlrev_b32 v44, 16, v202
  v_and_b32 v45, 0xffff0000, v202
  v_lshlrev_b32 v46, 16, v203
  v_and_b32 v47, 0xffff0000, v203
  v_pk_fma_f32 v[40:41], v[40:41], v[12:13], v[14:15] op_sel_hi:[1,0,0]
  v_pk_fma_f32 v[42:43], v[42:43], v[12:13], v[14:15] op_sel_hi:[1,0,0]
  v_pk_fma_f32 v[44:45], v[44:45], v[12:13], v[14:15] op_sel_hi:[1,0,0]
  v_pk_fma_f32 v[46:47], v[46:47], v[12:13], v[14:15] op_sel_hi:[1,0,0]
  v_cvt_pk_bf16_f32 v200, v40, v41
  v_cvt_pk_bf16_f32 v201, v42, v43
  v_cvt_pk_bf16_f32 v202, v44, v45
  v_cvt_pk_bf16_f32 v203, v46, v47
  v_add_u32 v10, 64, v13
  v_lshrrev_b32 v15, 6, v10
  s_waitcnt lgkmcnt(4)
  v_mfma_f32_32x32x16_bf16 v[48:63], v[196:199], v[28:31], v[48:63]
  ds_read_b64_tr_b16 v[24:25], v6 offset:26624
  ds_read_b64_tr_b16 v[26:27], v6 offset:26880
  buffer_load_dwordx4 v2, s[16:19], s67 offen offset:1024 lds
  v_lshlrev_b32 v40, 16, v204
  v_and_b32 v41, 0xffff0000, v204
  v_lshlrev_b32 v42, 16, v205
  v_and_b32 v43, 0xffff0000, v205
  v_lshlrev_b32 v44, 16, v206
  v_and_b32 v45, 0xffff0000, v206
  v_lshlrev_b32 v46, 16, v207
  v_and_b32 v47, 0xffff0000, v207
  v_pk_fma_f32 v[40:41], v[40:41], v[12:13], v[14:15] op_sel_hi:[1,0,0]
  v_pk_fma_f32 v[42:43], v[42:43], v[12:13], v[14:15] op_sel_hi:[1,0,0]
  v_pk_fma_f32 v[44:45], v[44:45], v[12:13], v[14:15] op_sel_hi:[1,0,0]
  v_pk_fma_f32 v[46:47], v[46:47], v[12:13], v[14:15] op_sel_hi:[1,0,0]
  v_cvt_pk_bf16_f32 v204, v40, v41
  v_cvt_pk_bf16_f32 v205, v42, v43
  v_cvt_pk_bf16_f32 v206, v44, v45
  v_cvt_pk_bf16_f32 v207, v46, v47
  v_mfma_f32_32x32x16_bf16 v[48:63], v[200:203], v[32:35], v[48:63]
  ds_read_b64_tr_b16 v[28:29], v6 offset:27648
  ds_read_b64_tr_b16 v[30:31], v6 offset:27904
  v_lshlrev_b32 v40, 16, v208
  v_and_b32 v41, 0xffff0000, v208
  v_lshlrev_b32 v42, 16, v209
  v_and_b32 v43, 0xffff0000, v209
  v_lshlrev_b32 v44, 16, v210
  v_and_b32 v45, 0xffff0000, v210
  v_lshlrev_b32 v46, 16, v211
  v_and_b32 v47, 0xffff0000, v211
  v_pk_fma_f32 v[40:41], v[40:41], v[12:13], v[14:15] op_sel_hi:[1,0,0]
  v_pk_fma_f32 v[42:43], v[42:43], v[12:13], v[14:15] op_sel_hi:[1,0,0]
  v_pk_fma_f32 v[44:45], v[44:45], v[12:13], v[14:15] op_sel_hi:[1,0,0]
  v_pk_fma_f32 v[46:47], v[46:47], v[12:13], v[14:15] op_sel_hi:[1,0,0]
  v_cvt_pk_bf16_f32 v208, v40, v41
  v_cvt_pk_bf16_f32 v209, v42, v43
  v_cvt_pk_bf16_f32 v210, v44, v45
  v_cvt_pk_bf16_f32 v211, v46, v47
  v_and_b32 v15, 3, v15
  v_mfma_f32_32x32x16_bf16 v[48:63], v[204:207], v[36:39], v[48:63]
  ds_read_b64_tr_b16 v[32:33], v6 offset:28672
  ds_read_b64_tr_b16 v[34:35], v6 offset:28928
  buffer_load_dwordx4 v2, s[16:19], s68 offen offset:2048 lds
  v_lshlrev_b32 v40, 16, v212
  v_and_b32 v41, 0xffff0000, v212
  v_lshlrev_b32 v42, 16, v213
  v_and_b32 v43, 0xffff0000, v213
  v_lshlrev_b32 v44, 16, v214
  v_and_b32 v45, 0xffff0000, v214
  v_lshlrev_b32 v46, 16, v215
  v_and_b32 v47, 0xffff0000, v215
  v_pk_fma_f32 v[40:41], v[40:41], v[12:13], v[14:15] op_sel_hi:[1,0,0]
  v_pk_fma_f32 v[42:43], v[42:43], v[12:13], v[14:15] op_sel_hi:[1,0,0]
  v_pk_fma_f32 v[44:45], v[44:45], v[12:13], v[14:15] op_sel_hi:[1,0,0]
  v_pk_fma_f32 v[46:47], v[46:47], v[12:13], v[14:15] op_sel_hi:[1,0,0]
  v_cvt_pk_bf16_f32 v212, v40, v41
  v_cvt_pk_bf16_f32 v213, v42, v43
  v_cvt_pk_bf16_f32 v214, v44, v45
  v_cvt_pk_bf16_f32 v215, v46, v47
  s_waitcnt lgkmcnt(4)
  v_mfma_f32_32x32x16_bf16 v[48:63], v[208:211], v[16:19], v[48:63]
  ds_read_b64_tr_b16 v[36:37], v6 offset:29696
  ds_read_b64_tr_b16 v[38:39], v6 offset:29952
  v_lshlrev_b32 v40, 16, v216
  v_and_b32 v41, 0xffff0000, v216
  v_lshlrev_b32 v42, 16, v217
  v_and_b32 v43, 0xffff0000, v217
  v_lshlrev_b32 v44, 16, v218
  v_and_b32 v45, 0xffff0000, v218
  v_lshlrev_b32 v46, 16, v219
  v_and_b32 v47, 0xffff0000, v219
  v_pk_fma_f32 v[40:41], v[40:41], v[12:13], v[14:15] op_sel_hi:[1,0,0]
  v_pk_fma_f32 v[42:43], v[42:43], v[12:13], v[14:15] op_sel_hi:[1,0,0]
  v_pk_fma_f32 v[44:45], v[44:45], v[12:13], v[14:15] op_sel_hi:[1,0,0]
  v_pk_fma_f32 v[46:47], v[46:47], v[12:13], v[14:15] op_sel_hi:[1,0,0]
  v_cvt_pk_bf16_f32 v216, v40, v41
  v_cvt_pk_bf16_f32 v217, v42, v43
  v_cvt_pk_bf16_f32 v218, v44, v45
  v_cvt_pk_bf16_f32 v219, v46, v47
  v_mul_u32_u24 v15, 36864, v15
  v_mfma_f32_32x32x16_bf16 v[48:63], v[212:215], v[20:23], v[48:63]
  ds_read_b64_tr_b16 v[16:17], v6 offset:30720
  ds_read_b64_tr_b16 v[18:19], v6 offset:30976
  buffer_load_dwordx4 v2, s[16:19], s69 offen offset:3072 lds
  v_lshlrev_b32 v40, 16, v220
  v_and_b32 v41, 0xffff0000, v220
  v_lshlrev_b32 v42, 16, v221
  v_and_b32 v43, 0xffff0000, v221
  v_lshlrev_b32 v44, 16, v222
  v_and_b32 v45, 0xffff0000, v222
  v_lshlrev_b32 v46, 16, v223
  v_and_b32 v47, 0xffff0000, v223
  v_pk_fma_f32 v[40:41], v[40:41], v[12:13], v[14:15] op_sel_hi:[1,0,0]
  v_pk_fma_f32 v[42:43], v[42:43], v[12:13], v[14:15] op_sel_hi:[1,0,0]
  v_pk_fma_f32 v[44:45], v[44:45], v[12:13], v[14:15] op_sel_hi:[1,0,0]
  v_pk_fma_f32 v[46:47], v[46:47], v[12:13], v[14:15] op_sel_hi:[1,0,0]
  v_cvt_pk_bf16_f32 v220, v40, v41
  v_cvt_pk_bf16_f32 v221, v42, v43
  v_cvt_pk_bf16_f32 v222, v44, v45
  v_cvt_pk_bf16_f32 v223, v46, v47
  v_mfma_f32_32x32x16_bf16 v[48:63], v[216:219], v[24:27], v[48:63]
  ds_read_b64_tr_b16 v[20:21], v6 offset:31744
  ds_read_b64_tr_b16 v[22:23], v6 offset:32000
  v_lshlrev_b32 v40, 16, v224
  v_and_b32 v41, 0xffff0000, v224
  v_lshlrev_b32 v42, 16, v225
  v_and_b32 v43, 0xffff0000, v225
  v_lshlrev_b32 v44, 16, v226
  v_and_b32 v45, 0xffff0000, v226
  v_lshlrev_b32 v46, 16, v227
  v_and_b32 v47, 0xffff0000, v227
  v_pk_fma_f32 v[40:41], v[40:41], v[12:13], v[14:15] op_sel_hi:[1,0,0]
  v_pk_fma_f32 v[42:43], v[42:43], v[12:13], v[14:15] op_sel_hi:[1,0,0]
  v_pk_fma_f32 v[44:45], v[44:45], v[12:13], v[14:15] op_sel_hi:[1,0,0]
  v_pk_fma_f32 v[46:47], v[46:47], v[12:13], v[14:15] op_sel_hi:[1,0,0]
  v_cvt_pk_bf16_f32 v224, v40, v41
  v_cvt_pk_bf16_f32 v225, v42, v43
  v_cvt_pk_bf16_f32 v226, v44, v45
  v_cvt_pk_bf16_f32 v227, v46, v47
  s_add_u32 m0, m0, 4096
  s_waitcnt lgkmcnt(4)
  v_mfma_f32_32x32x16_bf16 v[48:63], v[220:223], v[28:31], v[48:63]
  ds_read_b64_tr_b16 v[24:25], v6 offset:32768
  ds_read_b64_tr_b16 v[26:27], v6 offset:33024
  buffer_load_dwordx4 v2, s[16:19], s70 offen offset:0 lds
  v_lshlrev_b32 v40, 16, v228
  v_and_b32 v41, 0xffff0000, v228
  v_lshlrev_b32 v42, 16, v229
  v_and_b32 v43, 0xffff0000, v229
  v_lshlrev_b32 v44, 16, v230
  v_and_b32 v45, 0xffff0000, v230
  v_lshlrev_b32 v46, 16, v231
  v_and_b32 v47, 0xffff0000, v231
  v_pk_fma_f32 v[40:41], v[40:41], v[12:13], v[14:15] op_sel_hi:[1,0,0]
  v_pk_fma_f32 v[42:43], v[42:43], v[12:13], v[14:15] op_sel_hi:[1,0,0]
  v_pk_fma_f32 v[44:45], v[44:45], v[12:13], v[14:15] op_sel_hi:[1,0,0]
  v_pk_fma_f32 v[46:47], v[46:47], v[12:13], v[14:15] op_sel_hi:[1,0,0]
  v_cvt_pk_bf16_f32 v228, v40, v41
  v_cvt_pk_bf16_f32 v229, v42, v43
  v_cvt_pk_bf16_f32 v230, v44, v45
  v_cvt_pk_bf16_f32 v231, v46, v47
  v_mfma_f32_32x32x16_bf16 v[48:63], v[224:227], v[32:35], v[48:63]
  ds_read_b64_tr_b16 v[28:29], v6 offset:33792
  ds_read_b64_tr_b16 v[30:31], v6 offset:34048
  v_lshlrev_b32 v40, 16, v232
  v_and_b32 v41, 0xffff0000, v232
  v_lshlrev_b32 v42, 16, v233
  v_and_b32 v43, 0xffff0000, v233
  v_lshlrev_b32 v44, 16, v234
  v_and_b32 v45, 0xffff0000, v234
  v_lshlrev_b32 v46, 16, v235
  v_and_b32 v47, 0xffff0000, v235
  v_pk_fma_f32 v[40:41], v[40:41], v[12:13], v[14:15] op_sel_hi:[1,0,0]
  v_pk_fma_f32 v[42:43], v[42:43], v[12:13], v[14:15] op_sel_hi:[1,0,0]
  v_pk_fma_f32 v[44:45], v[44:45], v[12:13], v[14:15] op_sel_hi:[1,0,0]
  v_pk_fma_f32 v[46:47], v[46:47], v[12:13], v[14:15] op_sel_hi:[1,0,0]
  v_cvt_pk_bf16_f32 v232, v40, v41
  v_cvt_pk_bf16_f32 v233, v42, v43
  v_cvt_pk_bf16_f32 v234, v44, v45
  v_cvt_pk_bf16_f32 v235, v46, v47
  v_and_b32 v10, 63, v10
  v_add3_u32 v15, v15, v10, v4
  v_mfma_f32_32x32x16_bf16 v[48:63], v[228:231], v[36:39], v[48:63]
  ds_read_b64_tr_b16 v[32:33], v6 offset:34816
  ds_read_b64_tr_b16 v[34:35], v6 offset:35072
  buffer_load_dwordx4 v2, s[16:19], s71 offen offset:1024 lds
  v_lshlrev_b32 v40, 16, v236
  v_and_b32 v41, 0xffff0000, v236
  v_lshlrev_b32 v42, 16, v237
  v_and_b32 v43, 0xffff0000, v237
  v_lshlrev_b32 v44, 16, v238
  v_and_b32 v45, 0xffff0000, v238
  v_lshlrev_b32 v46, 16, v239
  v_and_b32 v47, 0xffff0000, v239
  v_pk_fma_f32 v[40:41], v[40:41], v[12:13], v[14:15] op_sel_hi:[1,0,0]
  v_pk_fma_f32 v[42:43], v[42:43], v[12:13], v[14:15] op_sel_hi:[1,0,0]
  v_pk_fma_f32 v[44:45], v[44:45], v[12:13], v[14:15] op_sel_hi:[1,0,0]
  v_pk_fma_f32 v[46:47], v[46:47], v[12:13], v[14:15] op_sel_hi:[1,0,0]
  v_cvt_pk_bf16_f32 v236, v40, v41
  v_cvt_pk_bf16_f32 v237, v42, v43
  v_cvt_pk_bf16_f32 v238, v44, v45
  v_cvt_pk_bf16_f32 v239, v46, v47
  s_waitcnt lgkmcnt(4)
  v_mfma_f32_32x32x16_bf16 v[48:63], v[232:235], v[16:19], v[48:63]
  ds_read_b64_tr_b16 v[36:37], v6 offset:35840
  ds_read_b64_tr_b16 v[38:39], v6 offset:36096
  v_lshlrev_b32 v40, 16, v240
  v_and_b32 v41, 0xffff0000, v240
  v_lshlrev_b32 v42, 16, v241
  v_and_b32 v43, 0xffff0000, v241
  v_lshlrev_b32 v44, 16, v242
  v_and_b32 v45, 0xffff0000, v242
  v_lshlrev_b32 v46, 16, v243
  v_and_b32 v47, 0xffff0000, v243
  v_pk_fma_f32 v[40:41], v[40:41], v[12:13], v[14:15] op_sel_hi:[1,0,0]
  v_pk_fma_f32 v[42:43], v[42:43], v[12:13], v[14:15] op_sel_hi:[1,0,0]
  v_pk_fma_f32 v[44:45], v[44:45], v[12:13], v[14:15] op_sel_hi:[1,0,0]
  v_pk_fma_f32 v[46:47], v[46:47], v[12:13], v[14:15] op_sel_hi:[1,0,0]
  v_cvt_pk_bf16_f32 v240, v40, v41
  v_cvt_pk_bf16_f32 v241, v42, v43
  v_cvt_pk_bf16_f32 v242, v44, v45
  v_cvt_pk_bf16_f32 v243, v46, v47
  v_mfma_f32_32x32x16_bf16 v[48:63], v[236:239], v[20:23], v[48:63]
  s_waitcnt vmcnt(6)
  s_barrier
  v_mov_b32 v6, v15
  ds_read_b64_tr_b16 v[16:17], v6 offset:0
  ds_read_b64_tr_b16 v[18:19], v6 offset:256
  buffer_load_dwordx4 v2, s[16:19], s72 offen offset:2048 lds
  v_lshlrev_b32 v40, 16, v244
  v_and_b32 v41, 0xffff0000, v244
  v_lshlrev_b32 v42, 16, v245
  v_and_b32 v43, 0xffff0000, v245
  v_lshlrev_b32 v44, 16, v246
  v_and_b32 v45, 0xffff0000, v246
  v_lshlrev_b32 v46, 16, v247
  v_and_b32 v47, 0xffff0000, v247
  v_pk_fma_f32 v[40:41], v[40:41], v[12:13], v[14:15] op_sel_hi:[1,0,0]
  v_pk_fma_f32 v[42:43], v[42:43], v[12:13], v[14:15] op_sel_hi:[1,0,0]
  v_pk_fma_f32 v[44:45], v[44:45], v[12:13], v[14:15] op_sel_hi:[1,0,0]
  v_pk_fma_f32 v[46:47], v[46:47], v[12:13], v[14:15] op_sel_hi:[1,0,0]
  v_cvt_pk_bf16_f32 v244, v40, v41
  v_cvt_pk_bf16_f32 v245, v42, v43
  v_cvt_pk_bf16_f32 v246, v44, v45
  v_cvt_pk_bf16_f32 v247, v46, v47
  v_mfma_f32_32x32x16_bf16 v[48:63], v[240:243], v[24:27], v[48:63]
  ds_read_b64_tr_b16 v[20:21], v6 offset:1024
  ds_read_b64_tr_b16 v[22:23], v6 offset:1280
  v_lshlrev_b32 v40, 16, v248
  v_and_b32 v41, 0xffff0000, v248
  v_lshlrev_b32 v42, 16, v249
  v_and_b32 v43, 0xffff0000, v249
  v_lshlrev_b32 v44, 16, v250
  v_and_b32 v45, 0xffff0000, v250
  v_lshlrev_b32 v46, 16, v251
  v_and_b32 v47, 0xffff0000, v251
  v_pk_fma_f32 v[40:41], v[40:41], v[12:13], v[14:15] op_sel_hi:[1,0,0]
  v_pk_fma_f32 v[42:43], v[42:43], v[12:13], v[14:15] op_sel_hi:[1,0,0]
  v_pk_fma_f32 v[44:45], v[44:45], v[12:13], v[14:15] op_sel_hi:[1,0,0]
  v_pk_fma_f32 v[46:47], v[46:47], v[12:13], v[14:15] op_sel_hi:[1,0,0]
  v_cvt_pk_bf16_f32 v248, v40, v41
  v_cvt_pk_bf16_f32 v249, v42, v43
  v_cvt_pk_bf16_f32 v250, v44, v45
  v_cvt_pk_bf16_f32 v251, v46, v47
  s_waitcnt lgkmcnt(4)
  v_mfma_f32_32x32x16_bf16 v[48:63], v[244:247], v[28:31], v[48:63]
  ds_read_b64_tr_b16 v[24:25], v6 offset:2048
  ds_read_b64_tr_b16 v[26:27], v6 offset:2304
  buffer_load_dwordx4 v2, s[16:19], s73 offen offset:3072 lds
  v_lshlrev_b32 v40, 16, v252
  v_and_b32 v41, 0xffff0000, v252
  v_lshlrev_b32 v42, 16, v253
  v_and_b32 v43, 0xffff0000, v253
  v_lshlrev_b32 v44, 16, v254
  v_and_b32 v45, 0xffff0000, v254
  v_lshlrev_b32 v46, 16, v255
  v_and_b32 v47, 0xffff0000, v255
  v_pk_fma_f32 v[40:41], v[40:41], v[12:13], v[14:15] op_sel_hi:[1,0,0]
  v_pk_fma_f32 v[42:43], v[42:43], v[12:13], v[14:15] op_sel_hi:[1,0,0]
  v_pk_fma_f32 v[44:45], v[44:45], v[12:13], v[14:15] op_sel_hi:[1,0,0]
  v_pk_fma_f32 v[46:47], v[46:47], v[12:13], v[14:15] op_sel_hi:[1,0,0]
  v_cvt_pk_bf16_f32 v252, v40, v41
  v_cvt_pk_bf16_f32 v253, v42, v43
  v_cvt_pk_bf16_f32 v254, v44, v45
  v_cvt_pk_bf16_f32 v255, v46, v47
  v_mfma_f32_32x32x16_bf16 v[48:63], v[248:251], v[32:35], v[48:63]
  ds_read_b64_tr_b16 v[28:29], v6 offset:3072
  ds_read_b64_tr_b16 v[30:31], v6 offset:3328
  s_add_u32 m0, m0, 4096
  v_mfma_f32_32x32x16_bf16 v[48:63], v[252:255], v[36:39], v[48:63]
  ds_read_b64_tr_b16 v[32:33], v6 offset:4096
  ds_read_b64_tr_b16 v[34:35], v6 offset:4352
  buffer_load_dwordx4 v2, s[16:19], s74 offen offset:0 lds
  s_add_u32 s30, s30, 36864
  s_cmp_ge_u32 s30, 147456
  s_cselect_b32 s35, 147456, 0
  s_sub_u32 s30, s30, s35
  s_sub_u32 s16, s16, 64
  s_subb_u32 s17, s17, 0
  s_add_u32 s18, s18, 64
  s_add_u32 s38, s75, 0
  s_mul_i32 s39, s38, 57
  s_lshr_b32 s39, s39, 9
  s_cmp_lt_u32 s38, 18
  s_cselect_b32 s50, 0, 2146435072
  s_cselect_b32 s39, s39, 0
  s_cselect_b32 s38, s38, 0
  v_mov_b32 v12, s50
  s_movk_i32 s50, 3456
  v_mad_u32_u24 v12, v0, s50, v12
  s_mul_i32 s50, s39, 9
  s_sub_u32 s38, s38, s50
  s_mul_i32 s38, s38, 221184
  s_mul_i32 s39, s39, 128
  s_add_u32 s39, s39, s38
  s_add_u32 s39, s39, s64
  buffer_load_dword a255, v12, s[4:7], s39 offen
  s_waitcnt lgkmcnt(4)
  v_mfma_f32_32x32x16_bf16 v[64:79], v[112:115], v[16:19], 0
  ds_read_b64_tr_b16 v[36:37], v6 offset:5120
  ds_read_b64_tr_b16 v[38:39], v6 offset:5376
  v_mfma_f32_32x32x16_bf16 v[64:79], v[116:119], v[20:23], v[64:79]
  ds_read_b64_tr_b16 v[16:17], v6 offset:6144
  ds_read_b64_tr_b16 v[18:19], v6 offset:6400
  s_mov_b32 m0, s30
  v_mfma_f32_32x32x16_bf16 v[64:79], v[120:123], v[24:27], v[64:79]
  ds_read_b64_tr_b16 v[20:21], v6 offset:7168
  ds_read_b64_tr_b16 v[22:23], v6 offset:7424
  buffer_load_dwordx4 v2, s[16:19], 0 offen offset:0 lds
  s_waitcnt lgkmcnt(4)
  v_mfma_f32_32x32x16_bf16 v[64:79], v[124:127], v[28:31], v[64:79]
  ds_read_b64_tr_b16 v[24:25], v6 offset:8192
  ds_read_b64_tr_b16 v[26:27], v6 offset:8448
  v_mfma_f32_32x32x16_bf16 v[64:79], v[128:131], v[32:35], v[64:79]
  ds_read_b64_tr_b16 v[28:29], v6 offset:9216
  ds_read_b64_tr_b16 v[30:31], v6 offset:9472
  v_cvt_pk_bf16_f32 v40, v48, v49
  v_cvt_pk_bf16_f32 v41, v50, v51
  v_mfma_f32_32x32x16_bf16 v[64:79], v[132:135], v[36:39], v[64:79]
  ds_read_b64_tr_b16 v[32:33], v6 offset:10240
  ds_read_b64_tr_b16 v[34:35], v6 offset:10496
  buffer_load_dwordx4 v2, s[16:19], s67 offen offset:1024 lds
  s_waitcnt lgkmcnt(4)
  v_mfma_f32_32x32x16_bf16 v[64:79], v[136:139], v[16:19], v[64:79]
  ds_read_b64_tr_b16 v[36:37], v6 offset:11264
  ds_read_b64_tr_b16 v[38:39], v6 offset:11520
  v_cvt_pk_bf16_f32 v42, v52, v53
  v_mfma_f32_32x32x16_bf16 v[64:79], v[140:143], v[20:23], v[64:79]
  ds_read_b64_tr_b16 v[16:17], v6 offset:12288
  ds_read_b64_tr_b16 v[18:19], v6 offset:12544
  v_cvt_pk_bf16_f32 v43, v54, v55
  v_mfma_f32_32x32x16_bf16 v[64:79], v[144:147], v[24:27], v[64:79]
  ds_read_b64_tr_b16 v[20:21], v6 offset:13312
  ds_read_b64_tr_b16 v[22:23], v6 offset:13568
  buffer_load_dwordx4 v2, s[16:19], s68 offen offset:2048 lds
  s_waitcnt lgkmcnt(4)
  v_mfma_f32_32x32x16_bf16 v[64:79], v[148:151], v[28:31], v[64:79]
  ds_read_b64_tr_b16 v[24:25], v6 offset:14336
  ds_read_b64_tr_b16 v[26:27], v6 offset:14592
  v_cvt_pk_bf16_f32 v44, v56, v57
  v_mfma_f32_32x32x16_bf16 v[64:79], v[152:155], v[32:35], v[64:79]
  ds_read_b64_tr_b16 v[28:29], v6 offset:15360
  ds_read_b64_tr_b16 v[30:31], v6 offset:15616
  v_cvt_pk_bf16_f32 v45, v58, v59
  v_cvt_pk_bf16_f32 v46, v60, v61
  v_mfma_f32_32x32x16_bf16 v[64:79], v[156:159], v[36:39], v[64:79]
  ds_read_b64_tr_b16 v[32:33], v6 offset:16384
  ds_read_b64_tr_b16 v[34:35], v6 offset:16640
  buffer_load_dwordx4 v2, s[16:19], s69 offen offset:3072 lds
  s_waitcnt lgkmcnt(4)
  v_mfma_f32_32x32x16_bf16 v[64:79], v[160:163], v[16:19], v[64:79]
  ds_read_b64_tr_b16 v[36:37], v6 offset:17408
  ds_read_b64_tr_b16 v[38:39], v6 offset:17664
  v_cvt_pk_bf16_f32 v47, v62, v63
  v_mfma_f32_32x32x16_bf16 v[64:79], v[164:167], v[20:23], v[64:79]
  ds_read_b64_tr_b16 v[16:17], v6 offset:18432
  ds_read_b64_tr_b16 v[18:19], v6 offset:18688
  s_add_u32 m0, m0, 4096
  v_mfma_f32_32x32x16_bf16 v[64:79], v[168:171], v[24:27], v[64:79]
  ds_read_b64_tr_b16 v[20:21], v6 offset:19456
  ds_read_b64_tr_b16 v[22:23], v6 offset:19712
  buffer_load_dwordx4 v2, s[16:19], s70 offen offset:0 lds
  s_waitcnt lgkmcnt(4)
  v_mfma_f32_32x32x16_bf16 v[64:79], v[172:175], v[28:31], v[64:79]
  ds_read_b64_tr_b16 v[24:25], v6 offset:20480
  ds_read_b64_tr_b16 v[26:27], v6 offset:20736
  v_accvgpr_write_b32 a0, v40
  v_mfma_f32_32x32x16_bf16 v[64:79], v[176:179], v[32:35], v[64:79]
  ds_read_b64_tr_b16 v[28:29], v6 offset:21504
  ds_read_b64_tr_b16 v[30:31], v6 offset:21760
  v_accvgpr_write_b32 a1, v41
  v_accvgpr_write_b32 a2, v42
  v_mfma_f32_32x32x16_bf16 v[64:79], v[180:183], v[36:39], v[64:79]
  ds_read_b64_tr_b16 v[32:33], v6 offset:22528
  ds_read_b64_tr_b16 v[34:35], v6 offset:22784
  buffer_load_dwordx4 v2, s[16:19], s71 offen offset:1024 lds
  s_waitcnt lgkmcnt(4)
  v_mfma_f32_32x32x16_bf16 v[64:79], v[184:187], v[16:19], v[64:79]
  ds_read_b64_tr_b16 v[36:37], v6 offset:23552
  ds_read_b64_tr_b16 v[38:39], v6 offset:23808
  v_accvgpr_write_b32 a3, v43
  v_mfma_f32_32x32x16_bf16 v[64:79], v[188:191], v[20:23], v[64:79]
  ds_read_b64_tr_b16 v[16:17], v6 offset:24576
  ds_read_b64_tr_b16 v[18:19], v6 offset:24832
  v_accvgpr_write_b32 a4, v44
  v_mfma_f32_32x32x16_bf16 v[64:79], v[192:195], v[24:27], v[64:79]
  ds_read_b64_tr_b16 v[20:21], v6 offset:25600
  ds_read_b64_tr_b16 v[22:23], v6 offset:25856
  buffer_load_dwordx4 v2, s[16:19], s72 offen offset:2048 lds
  s_waitcnt lgkmcnt(4)
  v_mfma_f32_32x32x16_bf16 v[64:79], v[196:199], v[28:31], v[64:79]
  ds_read_b64_tr_b16 v[24:25], v6 offset:26624
  ds_read_b64_tr_b16 v[26:27], v6 offset:26880
  v_accvgpr_write_b32 a5, v45
  v_mfma_f32_32x32x16_bf16 v[64:79], v[200:203], v[32:35], v[64:79]
  ds_read_b64_tr_b16 v[28:29], v6 offset:27648
  ds_read_b64_tr_b16 v[30:31], v6 offset:27904
  v_accvgpr_write_b32 a6, v46
  v_accvgpr_write_b32 a7, v47
  v_mfma_f32_32x32x16_bf16 v[64:79], v[204:207], v[36:39], v[64:79]
  ds_read_b64_tr_b16 v[32:33], v6 offset:28672
  ds_read_b64_tr_b16 v[34:35], v6 offset:28928
  buffer_load_dwordx4 v2, s[16:19], s73 offen offset:3072 lds
  s_waitcnt lgkmcnt(4)
  v_mfma_f32_32x32x16_bf16 v[64:79], v[208:211], v[16:19], v[64:79]
  ds_read_b64_tr_b16 v[36:37], v6 offset:29696
  ds_read_b64_tr_b16 v[38:39], v6 offset:29952
  v_add_u32 v10, 128, v13
  v_mfma_f32_32x32x16_bf16 v[64:79], v[212:215], v[20:23], v[64:79]
  ds_read_b64_tr_b16 v[16:17], v6 offset:30720
  ds_read_b64_tr_b16 v[18:19], v6 offset:30976
  v_lshrrev_b32 v15, 6, v10
  v_and_b32 v15, 3, v15
  s_add_u32 m0, m0, 4096
  v_mfma_f32_32x32x16_bf16 v[64:79], v[216:219], v[24:27], v[64:79]
  ds_read_b64_tr_b16 v[20:21], v6 offset:31744
  ds_read_b64_tr_b16 v[22:23], v6 offset:32000
  buffer_load_dwordx4 v2, s[16:19], s74 offen offset:0 lds
  s_waitcnt lgkmcnt(4)
  v_mfma_f32_32x32x16_bf16 v[64:79], v[220:223], v[28:31], v[64:79]
  ds_read_b64_tr_b16 v[24:25], v6 offset:32768
  ds_read_b64_tr_b16 v[26:27], v6 offset:33024
  s_add_u32 s30, s30, 36864
  s_cmp_ge_u32 s30, 147456
  s_cselect_b32 s35, 147456, 0
  s_sub_u32 s30, s30, s35
  v_mfma_f32_32x32x16_bf16 v[64:79], v[224:227], v[32:35], v[64:79]
  ds_read_b64_tr_b16 v[28:29], v6 offset:33792
  ds_read_b64_tr_b16 v[30:31], v6 offset:34048
  s_sub_u32 s16, s16, 64
  s_subb_u32 s17, s17, 0
  s_add_u32 s18, s18, 64
  v_mfma_f32_32x32x16_bf16 v[64:79], v[228:231], v[36:39], v[64:79]
  ds_read_b64_tr_b16 v[32:33], v6 offset:34816
  ds_read_b64_tr_b16 v[34:35], v6 offset:35072
  v_mul_u32_u24 v15, 36864, v15
  v_and_b32 v10, 63, v10
  s_waitcnt lgkmcnt(4)
  v_mfma_f32_32x32x16_bf16 v[64:79], v[232:235], v[16:19], v[64:79]
  ds_read_b64_tr_b16 v[36:37], v6 offset:35840
  ds_read_b64_tr_b16 v[38:39], v6 offset:36096
  v_add3_u32 v15, v15, v10, v4
  v_mfma_f32_32x32x16_bf16 v[64:79], v[236:239], v[20:23], v[64:79]
  s_barrier
  v_mov_b32 v6, v15
  ds_read_b64_tr_b16 v[16:17], v6 offset:0
  ds_read_b64_tr_b16 v[18:19], v6 offset:256
  v_mfma_f32_32x32x16_bf16 v[64:79], v[240:243], v[24:27], v[64:79]
  ds_read_b64_tr_b16 v[20:21], v6 offset:1024
  ds_read_b64_tr_b16 v[22:23], v6 offset:1280
  s_waitcnt lgkmcnt(4)
  v_mfma_f32_32x32x16_bf16 v[64:79], v[244:247], v[28:31], v[64:79]
  ds_read_b64_tr_b16 v[24:25], v6 offset:2048
  ds_read_b64_tr_b16 v[26:27], v6 offset:2304
  v_mfma_f32_32x32x16_bf16 v[64:79], v[248:251], v[32:35], v[64:79]
  ds_read_b64_tr_b16 v[28:29], v6 offset:3072
  ds_read_b64_tr_b16 v[30:31], v6 offset:3328
  v_mfma_f32_32x32x16_bf16 v[64:79], v[252:255], v[36:39], v[64:79]
  ds_read_b64_tr_b16 v[32:33], v6 offset:4096
  ds_read_b64_tr_b16 v[34:35], v6 offset:4352
  s_waitcnt lgkmcnt(4)
  v_mfma_f32_32x32x16_bf16 v[80:95], v[112:115], v[16:19], 0
  ds_read_b64_tr_b16 v[36:37], v6 offset:5120
  ds_read_b64_tr_b16 v[38:39], v6 offset:5376
  v_mfma_f32_32x32x16_bf16 v[80:95], v[116:119], v[20:23], v[80:95]
  ds_read_b64_tr_b16 v[16:17], v6 offset:6144
  ds_read_b64_tr_b16 v[18:19], v6 offset:6400
  s_mov_b32 m0, s30
  v_mfma_f32_32x32x16_bf16 v[80:95], v[120:123], v[24:27], v[80:95]
  ds_read_b64_tr_b16 v[20:21], v6 offset:7168
  ds_read_b64_tr_b16 v[22:23], v6 offset:7424
  buffer_load_dwordx4 v2, s[16:19], 0 offen offset:0 lds
  s_waitcnt lgkmcnt(4)
  v_mfma_f32_32x32x16_bf16 v[80:95], v[124:127], v[28:31], v[80:95]
  ds_read_b64_tr_b16 v[24:25], v6 offset:8192
  ds_read_b64_tr_b16 v[26:27], v6 offset:8448
  v_mfma_f32_32x32x16_bf16 v[80:95], v[128:131], v[32:35], v[80:95]
  ds_read_b64_tr_b16 v[28:29], v6 offset:9216
  ds_read_b64_tr_b16 v[30:31], v6 offset:9472
  v_cvt_pk_bf16_f32 v40, v64, v65
  v_cvt_pk_bf16_f32 v41, v66, v67
  v_mfma_f32_32x32x16_bf16 v[80:95], v[132:135], v[36:39], v[80:95]
  ds_read_b64_tr_b16 v[32:33], v6 offset:10240
  ds_read_b64_tr_b16 v[34:35], v6 offset:10496
  buffer_load_dwordx4 v2, s[16:19], s67 offen offset:1024 lds
  s_waitcnt lgkmcnt(4)
  v_mfma_f32_32x32x16_bf16 v[80:95], v[136:139], v[16:19], v[80:95]
  ds_read_b64_tr_b16 v[36:37], v6 offset:11264
  ds_read_b64_tr_b16 v[38:39], v6 offset:11520
  v_cvt_pk_bf16_f32 v42, v68, v69
  v_mfma_f32_32x32x16_bf16 v[80:95], v[140:143], v[20:23], v[80:95]
  ds_read_b64_tr_b16 v[16:17], v6 offset:12288
  ds_read_b64_tr_b16 v[18:19], v6 offset:12544
  v_cvt_pk_bf16_f32 v43, v70, v71
  v_mfma_f32_32x32x16_bf16 v[80:95], v[144:147], v[24:27], v[80:95]
  ds_read_b64_tr_b16 v[20:21], v6 offset:13312
  ds_read_b64_tr_b16 v[22:23], v6 offset:13568
  buffer_load_dwordx4 v2, s[16:19], s68 offen offset:2048 lds
  s_waitcnt lgkmcnt(4)
  v_mfma_f32_32x32x16_bf16 v[80:95], v[148:151], v[28:31], v[80:95]
  ds_read_b64_tr_b16 v[24:25], v6 offset:14336
  ds_read_b64_tr_b16 v[26:27], v6 offset:14592
  v_cvt_pk_bf16_f32 v44, v72, v73
  v_mfma_f32_32x32x16_bf16 v[80:95], v[152:155], v[32:35], v[80:95]
  ds_read_b64_tr_b16 v[28:29], v6 offset:15360
  ds_read_b64_tr_b16 v[30:31], v6 offset:15616
  v_cvt_pk_bf16_f32 v45, v74, v75
  v_cvt_pk_bf16_f32 v46, v76, v77
  v_mfma_f32_32x32x16_bf16 v[80:95], v[156:159], v[36:39], v[80:95]
  ds_read_b64_tr_b16 v[32:33], v6 offset:16384
  ds_read_b64_tr_b16 v[34:35], v6 offset:16640
  buffer_load_dwordx4 v2, s[16:19], s69 offen offset:3072 lds
  s_waitcnt lgkmcnt(4)
  v_mfma_f32_32x32x16_bf16 v[80:95], v[160:163], v[16:19], v[80:95]
  ds_read_b64_tr_b16 v[36:37], v6 offset:17408
  ds_read_b64_tr_b16 v[38:39], v6 offset:17664
  v_cvt_pk_bf16_f32 v47, v78, v79
  v_mfma_f32_32x32x16_bf16 v[80:95], v[164:167], v[20:23], v[80:95]
  ds_read_b64_tr_b16 v[16:17], v6 offset:18432
  ds_read_b64_tr_b16 v[18:19], v6 offset:18688
  s_add_u32 m0, m0, 4096
  v_mfma_f32_32x32x16_bf16 v[80:95], v[168:171], v[24:27], v[80:95]
  ds_read_b64_tr_b16 v[20:21], v6 offset:19456
  ds_read_b64_tr_b16 v[22:23], v6 offset:19712
  buffer_load_dwordx4 v2, s[16:19], s70 offen offset:0 lds
  s_waitcnt lgkmcnt(4)
  v_mfma_f32_32x32x16_bf16 v[80:95], v[172:175], v[28:31], v[80:95]
  ds_read_b64_tr_b16 v[24:25], v6 offset:20480
  ds_read_b64_tr_b16 v[26:27], v6 offset:20736
  v_accvgpr_write_b32 a8, v40
  v_mfma_f32_32x32x16_bf16 v[80:95], v[176:179], v[32:35], v[80:95]
  ds_read_b64_tr_b16 v[28:29], v6 offset:21504
  ds_read_b64_tr_b16 v[30:31], v6 offset:21760
  v_accvgpr_write_b32 a9, v41
  v_accvgpr_write_b32 a10, v42
  v_mfma_f32_32x32x16_bf16 v[80:95], v[180:183], v[36:39], v[80:95]
  ds_read_b64_tr_b16 v[32:33], v6 offset:22528
  ds_read_b64_tr_b16 v[34:35], v6 offset:22784
  buffer_load_dwordx4 v2, s[16:19], s71 offen offset:1024 lds
  s_waitcnt lgkmcnt(4)
  v_mfma_f32_32x32x16_bf16 v[80:95], v[184:187], v[16:19], v[80:95]
  ds_read_b64_tr_b16 v[36:37], v6 offset:23552
  ds_read_b64_tr_b16 v[38:39], v6 offset:23808
  v_accvgpr_write_b32 a11, v43
  v_mfma_f32_32x32x16_bf16 v[80:95], v[188:191], v[20:23], v[80:95]
  ds_read_b64_tr_b16 v[16:17], v6 offset:24576
  ds_read_b64_tr_b16 v[18:19], v6 offset:24832
  v_accvgpr_write_b32 a12, v44
  v_mfma_f32_32x32x16_bf16 v[80:95], v[192:195], v[24:27], v[80:95]
  ds_read_b64_tr_b16 v[20:21], v6 offset:25600
  ds_read_b64_tr_b16 v[22:23], v6 offset:25856
  buffer_load_dwordx4 v2, s[16:19], s72 offen offset:2048 lds
  s_waitcnt lgkmcnt(4)
  v_mfma_f32_32x32x16_bf16 v[80:95], v[196:199], v[28:31], v[80:95]
  ds_read_b64_tr_b16 v[24:25], v6 offset:26624
  ds_read_b64_tr_b16 v[26:27], v6 offset:26880
  v_accvgpr_write_b32 a13, v45
  v_mfma_f32_32x32x16_bf16 v[80:95], v[200:203], v[32:35], v[80:95]
  ds_read_b64_tr_b16 v[28:29], v6 offset:27648
  ds_read_b64_tr_b16 v[30:31], v6 offset:27904
  v_accvgpr_write_b32 a14, v46
  v_accvgpr_write_b32 a15, v47
  v_mfma_f32_32x32x16_bf16 v[80:95], v[204:207], v[36:39], v[80:95]
  ds_read_b64_tr_b16 v[32:33], v6 offset:28672
  ds_read_b64_tr_b16 v[34:35], v6 offset:28928
  buffer_load_dwordx4 v2, s[16:19], s73 offen offset:3072 lds
  s_waitcnt lgkmcnt(4)
  v_mfma_f32_32x32x16_bf16 v[80:95], v[208:211], v[16:19], v[80:95]
  ds_read_b64_tr_b16 v[36:37], v6 offset:29696
  ds_read_b64_tr_b16 v[38:39], v6 offset:29952
  v_add_u32 v10, 112, v13
  v_lshrrev_b32 v15, 6, v10
  v_mfma_f32_32x32x16_bf16 v[80:95], v[212:215], v[20:23], v[80:95]
  ds_read_b64_tr_b16 v[16:17], v6 offset:30720
  ds_read_b64_tr_b16 v[18:19], v6 offset:30976
  v_sub_u32 v15, 1, v15
  s_add_u32 m0, m0, 4096
  v_mfma_f32_32x32x16_bf16 v[80:95], v[216:219], v[24:27], v[80:95]
  ds_read_b64_tr_b16 v[20:21], v6 offset:31744
  ds_read_b64_tr_b16 v[22:23], v6 offset:32000
  buffer_load_dwordx4 v2, s[16:19], s74 offen offset:0 lds
  s_waitcnt lgkmcnt(4)
  v_mfma_f32_32x32x16_bf16 v[80:95], v[220:223], v[28:31], v[80:95]
  ds_read_b64_tr_b16 v[24:25], v6 offset:32768
  ds_read_b64_tr_b16 v[26:27], v6 offset:33024
  s_add_u32 s30, s30, 36864
  s_cmp_ge_u32 s30, 147456
  s_cselect_b32 s35, 147456, 0
  s_sub_u32 s30, s30, s35
  v_mfma_f32_32x32x16_bf16 v[80:95], v[224:227], v[32:35], v[80:95]
  ds_read_b64_tr_b16 v[28:29], v6 offset:33792
  ds_read_b64_tr_b16 v[30:31], v6 offset:34048
  s_sub_u32 s16, s16, 1024
  s_subb_u32 s17, s17, 0
  s_add_u32 s18, s18, 1024
  v_mfma_f32_32x32x16_bf16 v[80:95], v[228:231], v[36:39], v[80:95]
  ds_read_b64_tr_b16 v[32:33], v6 offset:34816
  ds_read_b64_tr_b16 v[34:35], v6 offset:35072
  v_and_b32 v15, 3, v15
  v_mul_u32_u24 v15, 36864, v15
  v_and_b32 v10, 63, v10
  s_waitcnt lgkmcnt(4)
  v_mfma_f32_32x32x16_bf16 v[80:95], v[232:235], v[16:19], v[80:95]
  ds_read_b64_tr_b16 v[36:37], v6 offset:35840
  ds_read_b64_tr_b16 v[38:39], v6 offset:36096
  v_add3_u32 v15, v15, v10, v4
  v_mfma_f32_32x32x16_bf16 v[80:95], v[236:239], v[20:23], v[80:95]
  s_waitcnt vmcnt(9)
  s_barrier
  v_mov_b32 v6, v15
  ds_read_b64_tr_b16 v[16:17], v6 offset:0
  ds_read_b64_tr_b16 v[18:19], v6 offset:256
  v_mfma_f32_32x32x16_bf16 v[80:95], v[240:243], v[24:27], v[80:95]
  ds_read_b64_tr_b16 v[20:21], v6 offset:1024
  ds_read_b64_tr_b16 v[22:23], v6 offset:1280
  s_waitcnt lgkmcnt(4)
  v_mfma_f32_32x32x16_bf16 v[80:95], v[244:247], v[28:31], v[80:95]
  ds_read_b64_tr_b16 v[24:25], v6 offset:2048
  ds_read_b64_tr_b16 v[26:27], v6 offset:2304
  v_mfma_f32_32x32x16_bf16 v[80:95], v[248:251], v[32:35], v[80:95]
  ds_read_b64_tr_b16 v[28:29], v6 offset:3072
  ds_read_b64_tr_b16 v[30:31], v6 offset:3328
  v_mfma_f32_32x32x16_bf16 v[80:95], v[252:255], v[36:39], v[80:95]
  ds_read_b64_tr_b16 v[32:33], v6 offset:4096
  ds_read_b64_tr_b16 v[34:35], v6 offset:4352
  s_add_u32 s38, s75, 0
  s_lshl_b32 s3, s36, 7
  s_cmp_lt_u32 s38, 9
  s_cselect_b32 s3, s3, 1024
  s_mul_i32 s39, s38, 57
  s_lshr_b32 s39, s39, 9
  s_cmp_lt_u32 s38, 18
  s_cselect_b32 s50, 0, 2146435072
  s_cselect_b32 s39, s39, 0
  s_cselect_b32 s38, s38, 0
  v_mov_b32 v12, s50
  s_movk_i32 s50, 1152
  v_mad_u32_u24 v12, v0, s50, v12
  s_mul_i32 s50, s39, 9
  s_sub_u32 s38, s38, s50
  s_mul_i32 s38, s38, 73728
  s_mul_i32 s39, s39, 0
  s_add_u32 s39, s39, s38
  s_add_u32 s39, s39, s3
  buffer_load_dword a255, v12, s[20:23], s39 offen
  s_waitcnt lgkmcnt(4)
  v_mfma_f32_32x32x16_bf16 v[96:111], v[16:19], v[112:115], 0
  ds_read_b64_tr_b16 v[36:37], v6 offset:5120
  ds_read_b64_tr_b16 v[38:39], v6 offset:5376
  v_mfma_f32_32x32x16_bf16 v[96:111], v[20:23], v[116:119], v[96:111]
  ds_read_b64_tr_b16 v[16:17], v6 offset:6144
  ds_read_b64_tr_b16 v[18:19], v6 offset:6400
  s_mov_b32 m0, s30
  v_mfma_f32_32x32x16_bf16 v[96:111], v[24:27], v[120:123], v[96:111]
  ds_read_b64_tr_b16 v[20:21], v6 offset:7168
  ds_read_b64_tr_b16 v[22:23], v6 offset:7424
  buffer_load_dwordx4 v2, s[16:19], 0 offen offset:0 lds
  s_waitcnt lgkmcnt(4)
  v_mfma_f32_32x32x16_bf16 v[96:111], v[28:31], v[124:127], v[96:111]
  ds_read_b64_tr_b16 v[24:25], v6 offset:8192
  ds_read_b64_tr_b16 v[26:27], v6 offset:8448
  v_mfma_f32_32x32x16_bf16 v[96:111], v[32:35], v[128:131], v[96:111]
  ds_read_b64_tr_b16 v[28:29], v6 offset:9216
  ds_read_b64_tr_b16 v[30:31], v6 offset:9472
  v_and_b32 v1, 31, v0
  v_cmp_le_u32 vcc, 8, v1
  v_mov_b32 v10, 0x3f803f80
  v_mfma_f32_32x32x16_bf16 v[96:111], v[36:39], v[132:135], v[96:111]
  ds_read_b64_tr_b16 v[32:33], v6 offset:10240
  ds_read_b64_tr_b16 v[34:35], v6 offset:10496
  buffer_load_dwordx4 v2, s[16:19], s67 offen offset:1024 lds
  s_waitcnt lgkmcnt(4)
  v_mfma_f32_32x32x16_bf16 v[96:111], v[16:19], v[136:139], v[96:111]
  ds_read_b64_tr_b16 v[36:37], v6 offset:11264
  ds_read_b64_tr_b16 v[38:39], v6 offset:11520
  v_cvt_pk_bf16_f32 v40, v80, v81
  v_mfma_f32_32x32x16_bf16 v[96:111], v[20:23], v[140:143], v[96:111]
  ds_read_b64_tr_b16 v[16:17], v6 offset:12288
  ds_read_b64_tr_b16 v[18:19], v6 offset:12544
  v_cvt_pk_bf16_f32 v41, v82, v83
  v_cvt_pk_bf16_f32 v42, v84, v85
  v_cvt_pk_bf16_f32 v43, v86, v87
  v_mfma_f32_32x32x16_bf16 v[96:111], v[24:27], v[144:147], v[96:111]
  ds_read_b64_tr_b16 v[20:21], v6 offset:13312
  ds_read_b64_tr_b16 v[22:23], v6 offset:13568
  buffer_load_dwordx4 v2, s[16:19], s68 offen offset:2048 lds
  s_waitcnt lgkmcnt(4)
  v_mfma_f32_32x32x16_bf16 v[96:111], v[28:31], v[148:151], v[96:111]
  ds_read_b64_tr_b16 v[24:25], v6 offset:14336
  ds_read_b64_tr_b16 v[26:27], v6 offset:14592
  v_cvt_pk_bf16_f32 v44, v88, v89
  v_mfma_f32_32x32x16_bf16 v[96:111], v[32:35], v[152:155], v[96:111]
  ds_read_b64_tr_b16 v[28:29], v6 offset:15360
  ds_read_b64_tr_b16 v[30:31], v6 offset:15616
  v_cvt_pk_bf16_f32 v45, v90, v91
  v_cvt_pk_bf16_f32 v46, v92, v93
  v_cvt_pk_bf16_f32 v47, v94, v95
  v_mfma_f32_32x32x16_bf16 v[96:111], v[36:39], v[156:159], v[96:111]
  ds_read_b64_tr_b16 v[32:33], v6 offset:16384
  ds_read_b64_tr_b16 v[34:35], v6 offset:16640
  buffer_load_dwordx4 v2, s[16:19], s69 offen offset:3072 lds
  s_waitcnt lgkmcnt(4)
  v_mfma_f32_32x32x16_bf16 v[96:111], v[16:19], v[160:163], v[96:111]
  ds_read_b64_tr_b16 v[36:37], v6 offset:17408
  ds_read_b64_tr_b16 v[38:39], v6 offset:17664
  v_cndmask_b32 v40, v40, v10, vcc
  v_cndmask_b32 v41, v41, v10, vcc
  v_mfma_f32_32x32x16_bf16 v[96:111], v[20:23], v[164:167], v[96:111]
  ds_read_b64_tr_b16 v[16:17], v6 offset:18432
  ds_read_b64_tr_b16 v[18:19], v6 offset:18688
  v_cndmask_b32 v42, v42, v10, vcc
  s_add_u32 m0, m0, 4096
  v_mfma_f32_32x32x16_bf16 v[96:111], v[24:27], v[168:171], v[96:111]
  ds_read_b64_tr_b16 v[20:21], v6 offset:19456
  ds_read_b64_tr_b16 v[22:23], v6 offset:19712
  buffer_load_dwordx4 v2, s[16:19], s70 offen offset:0 lds
  s_waitcnt lgkmcnt(4)
  v_mfma_f32_32x32x16_bf16 v[96:111], v[28:31], v[172:175], v[96:111]
  ds_read_b64_tr_b16 v[24:25], v6 offset:20480
  ds_read_b64_tr_b16 v[26:27], v6 offset:20736
  v_cndmask_b32 v43, v43, v10, vcc
  v_cndmask_b32 v44, v44, v10, vcc
  v_mfma_f32_32x32x16_bf16 v[96:111], v[32:35], v[176:179], v[96:111]
  ds_read_b64_tr_b16 v[28:29], v6 offset:21504
  ds_read_b64_tr_b16 v[30:31], v6 offset:21760
  v_cndmask_b32 v45, v45, v10, vcc
  v_cndmask_b32 v46, v46, v10, vcc
  v_cndmask_b32 v47, v47, v10, vcc
  v_mfma_f32_32x32x16_bf16 v[96:111], v[36:39], v[180:183], v[96:111]
  ds_read_b64_tr_b16 v[32:33], v6 offset:22528
  ds_read_b64_tr_b16 v[34:35], v6 offset:22784
  buffer_load_dwordx4 v2, s[16:19], s71 offen offset:1024 lds
  s_waitcnt lgkmcnt(4)
  v_mfma_f32_32x32x16_bf16 v[96:111], v[16:19], v[184:187], v[96:111]
  ds_read_b64_tr_b16 v[36:37], v6 offset:23552
  ds_read_b64_tr_b16 v[38:39], v6 offset:23808
  v_accvgpr_write_b32 a16, v40
  v_mfma_f32_32x32x16_bf16 v[96:111], v[20:23], v[188:191], v[96:111]
  ds_read_b64_tr_b16 v[16:17], v6 offset:24576
  ds_read_b64_tr_b16 v[18:19], v6 offset:24832
  v_accvgpr_write_b32 a17, v41
  v_accvgpr_write_b32 a18, v42
  v_accvgpr_write_b32 a19, v43
  v_mfma_f32_32x32x16_bf16 v[96:111], v[24:27], v[192:195], v[96:111]
  ds_read_b64_tr_b16 v[20:21], v6 offset:25600
  ds_read_b64_tr_b16 v[22:23], v6 offset:25856
  buffer_load_dwordx4 v2, s[16:19], s72 offen offset:2048 lds
  s_waitcnt lgkmcnt(4)
  v_mfma_f32_32x32x16_bf16 v[96:111], v[28:31], v[196:199], v[96:111]
  ds_read_b64_tr_b16 v[24:25], v6 offset:26624
  ds_read_b64_tr_b16 v[26:27], v6 offset:26880
  v_accvgpr_write_b32 a20, v44
  v_mfma_f32_32x32x16_bf16 v[96:111], v[32:35], v[200:203], v[96:111]
  ds_read_b64_tr_b16 v[28:29], v6 offset:27648
  ds_read_b64_tr_b16 v[30:31], v6 offset:27904
  v_accvgpr_write_b32 a21, v45
  v_accvgpr_write_b32 a22, v46
  v_accvgpr_write_b32 a23, v47
  v_mfma_f32_32x32x16_bf16 v[96:111], v[36:39], v[204:207], v[96:111]
  ds_read_b64_tr_b16 v[32:33], v6 offset:28672
  ds_read_b64_tr_b16 v[34:35], v6 offset:28928
  buffer_load_dwordx4 v2, s[16:19], s73 offen offset:3072 lds
  s_waitcnt lgkmcnt(4)
  v_mfma_f32_32x32x16_bf16 v[96:111], v[16:19], v[208:211], v[96:111]
  ds_read_b64_tr_b16 v[36:37], v6 offset:29696
  ds_read_b64_tr_b16 v[38:39], v6 offset:29952
  v_add_u32 v10, 48, v13
  v_lshrrev_b32 v15, 6, v10
  v_mfma_f32_32x32x16_bf16 v[96:111], v[20:23], v[212:215], v[96:111]
  ds_read_b64_tr_b16 v[16:17], v6 offset:30720
  ds_read_b64_tr_b16 v[18:19], v6 offset:30976
  v_sub_u32 v15, 1, v15
  s_add_u32 m0, m0, 4096
  v_mfma_f32_32x32x16_bf16 v[96:111], v[24:27], v[216:219], v[96:111]
  ds_read_b64_tr_b16 v[20:21], v6 offset:31744
  ds_read_b64_tr_b16 v[22:23], v6 offset:32000
  buffer_load_dwordx4 v2, s[16:19], s74 offen offset:0 lds
  s_waitcnt lgkmcnt(4)
  v_mfma_f32_32x32x16_bf16 v[96:111], v[28:31], v[220:223], v[96:111]
  ds_read_b64_tr_b16 v[24:25], v6 offset:32768
  ds_read_b64_tr_b16 v[26:27], v6 offset:33024
  s_add_u32 s30, s30, 36864
  s_cmp_ge_u32 s30, 147456
  s_cselect_b32 s35, 147456, 0
  s_sub_u32 s30, s30, s35
  v_mfma_f32_32x32x16_bf16 v[96:111], v[32:35], v[224:227], v[96:111]
  ds_read_b64_tr_b16 v[28:29], v6 offset:33792
  ds_read_b64_tr_b16 v[30:31], v6 offset:34048
  s_sub_u32 s16, s16, 64
  s_subb_u32 s17, s17, 0
  s_add_u32 s18, s18, 64
  v_mfma_f32_32x32x16_bf16 v[96:111], v[36:39], v[228:231], v[96:111]
  ds_read_b64_tr_b16 v[32:33], v6 offset:34816
  ds_read_b64_tr_b16 v[34:35], v6 offset:35072
  v_and_b32 v15, 3, v15
  v_mul_u32_u24 v15, 36864, v15
  v_and_b32 v10, 63, v10
  s_waitcnt lgkmcnt(4)
  v_mfma_f32_32x32x16_bf16 v[96:111], v[16:19], v[232:235], v[96:111]
  ds_read_b64_tr_b16 v[36:37], v6 offset:35840
  ds_read_b64_tr_b16 v[38:39], v6 offset:36096
  v_add3_u32 v15, v15, v10, v4
  v_mfma_f32_32x32x16_bf16 v[96:111], v[20:23], v[236:239], v[96:111]
  s_waitcnt vmcnt(10)
  s_barrier
  v_mov_b32 v6, v15
  ds_read_b64_tr_b16 v[16:17], v6 offset:0
  ds_read_b64_tr_b16 v[18:19], v6 offset:256
  v_mfma_f32_32x32x16_bf16 v[96:111], v[24:27], v[240:243], v[96:111]
  ds_read_b64_tr_b16 v[20:21], v6 offset:1024
  ds_read_b64_tr_b16 v[22:23], v6 offset:1280
  s_waitcnt lgkmcnt(4)
  v_mfma_f32_32x32x16_bf16 v[96:111], v[28:31], v[244:247], v[96:111]
  ds_read_b64_tr_b16 v[24:25], v6 offset:2048
  ds_read_b64_tr_b16 v[26:27], v6 offset:2304
  v_mfma_f32_32x32x16_bf16 v[96:111], v[32:35], v[248:251], v[96:111]
  ds_read_b64_tr_b16 v[28:29], v6 offset:3072
  ds_read_b64_tr_b16 v[30:31], v6 offset:3328
  v_mfma_f32_32x32x16_bf16 v[96:111], v[36:39], v[252:255], v[96:111]
  ds_read_b64_tr_b16 v[32:33], v6 offset:4096
  ds_read_b64_tr_b16 v[34:35], v6 offset:4352
  s_waitcnt lgkmcnt(4)
  v_mfma_f32_32x32x16_bf16 v[48:63], v[16:19], v[112:115], 0
  ds_read_b64_tr_b16 v[36:37], v6 offset:5120
  ds_read_b64_tr_b16 v[38:39], v6 offset:5376
  v_and_b32 v1, 31, v0
  v_add_u32 v1, 0, v1
  v_mul_u32_u24 v9, 3641, v1
  v_lshrrev_b32 v9, 16, v9
  v_mfma_f32_32x32x16_bf16 v[48:63], v[20:23], v[116:119], v[48:63]
  ds_read_b64_tr_b16 v[16:17], v6 offset:6144
  ds_read_b64_tr_b16 v[18:19], v6 offset:6400
  v_mul_u32_u24 v7, 18, v9
  v_sub_u32 v7, v1, v7
  v_lshlrev_b32 v7, 4, v7
  v_lshrrev_b32 v10, 5, v0
  v_mfma_f32_32x32x16_bf16 v[48:63], v[24:27], v[120:123], v[48:63]
  ds_read_b64_tr_b16 v[20:21], v6 offset:7168
  ds_read_b64_tr_b16 v[22:23], v6 offset:7424
  v_mul_u32_u24 v10, 320, v10
  v_add_u32 v7, v7, v10
  s_mul_i32 s38, s28, 1280
  v_mul_u32_u24 v11, 5120, v9
  v_add3_u32 v11, v11, v7, s38
  s_waitcnt lgkmcnt(4)
  v_mfma_f32_32x32x16_bf16 v[48:63], v[28:31], v[124:127], v[48:63]
  ds_read_b64_tr_b16 v[24:25], v6 offset:8192
  ds_read_b64_tr_b16 v[26:27], v6 offset:8448
  s_mov_b32 s38, 155648
  v_mul_lo_u32 v9, v9, s38
  v_add_u32 v7, v7, v9
  v_mfma_f32_32x32x16_bf16 v[48:63], v[32:35], v[128:131], v[48:63]
  ds_read_b64_tr_b16 v[28:29], v6 offset:9216
  ds_read_b64_tr_b16 v[30:31], v6 offset:9472
  v_accvgpr_write_b32 a26, v11
  buffer_store_dwordx4 a[0:3], v7, s[52:55], s62 offen offset:1152 sc1
  v_mfma_f32_32x32x16_bf16 v[48:63], v[36:39], v[132:135], v[48:63]
  ds_read_b64_tr_b16 v[32:33], v6 offset:10240
  ds_read_b64_tr_b16 v[34:35], v6 offset:10496
  buffer_store_dwordx4 a[4:7], v7, s[52:55], s62 offen offset:1792 sc1
  v_and_b32 v1, 31, v0
  v_add_u32 v1, 32, v1
  v_mul_u32_u24 v9, 3641, v1
  s_waitcnt lgkmcnt(4)
  v_mfma_f32_32x32x16_bf16 v[48:63], v[16:19], v[136:139], v[48:63]
  ds_read_b64_tr_b16 v[36:37], v6 offset:11264
  ds_read_b64_tr_b16 v[38:39], v6 offset:11520
  v_lshrrev_b32 v9, 16, v9
  v_mul_u32_u24 v7, 18, v9
  v_sub_u32 v7, v1, v7
  v_mfma_f32_32x32x16_bf16 v[48:63], v[20:23], v[140:143], v[48:63]
  ds_read_b64_tr_b16 v[16:17], v6 offset:12288
  ds_read_b64_tr_b16 v[18:19], v6 offset:12544
  v_lshlrev_b32 v7, 4, v7
  v_lshrrev_b32 v10, 5, v0
  v_mul_u32_u24 v10, 320, v10
  v_add_u32 v7, v7, v10
  s_mul_i32 s38, s28, 1280
  v_mfma_f32_32x32x16_bf16 v[48:63], v[24:27], v[144:147], v[48:63]
  ds_read_b64_tr_b16 v[20:21], v6 offset:13312
  ds_read_b64_tr_b16 v[22:23], v6 offset:13568
  v_mul_u32_u24 v11, 5120, v9
  v_add3_u32 v11, v11, v7, s38
  s_mov_b32 s38, 155648
  v_mul_lo_u32 v9, v9, s38
  s_waitcnt lgkmcnt(4)
  v_mfma_f32_32x32x16_bf16 v[48:63], v[28:31], v[148:151], v[48:63]
  ds_read_b64_tr_b16 v[24:25], v6 offset:14336
  ds_read_b64_tr_b16 v[26:27], v6 offset:14592
  v_add_u32 v7, v7, v9
  v_accvgpr_write_b32 a27, v11
  buffer_store_dwordx4 a[8:11], v7, s[52:55], s62 offen offset:1152 sc1
  v_mfma_f32_32x32x16_bf16 v[48:63], v[32:35], v[152:155], v[48:63]
  ds_read_b64_tr_b16 v[28:29], v6 offset:15360
  ds_read_b64_tr_b16 v[30:31], v6 offset:15616
  buffer_store_dwordx4 a[12:15], v7, s[52:55], s62 offen offset:1792 sc1
  v_and_b32 v1, 31, v0
  v_mfma_f32_32x32x16_bf16 v[48:63], v[36:39], v[156:159], v[48:63]
  ds_read_b64_tr_b16 v[32:33], v6 offset:16384
  ds_read_b64_tr_b16 v[34:35], v6 offset:16640
  v_add_u32 v1, 64, v1
  v_mul_u32_u24 v9, 3641, v1
  v_lshrrev_b32 v9, 16, v9
  v_mul_u32_u24 v7, 18, v9
  s_waitcnt lgkmcnt(4)
  v_mfma_f32_32x32x16_bf16 v[48:63], v[16:19], v[160:163], v[48:63]
  ds_read_b64_tr_b16 v[36:37], v6 offset:17408
  ds_read_b64_tr_b16 v[38:39], v6 offset:17664
  v_sub_u32 v7, v1, v7
  v_cmp_le_u32 vcc, 72, v1
  v_subrev_u32 v10, 72, v1
  s_nop 0
  v_mfma_f32_32x32x16_bf16 v[48:63], v[20:23], v[164:167], v[48:63]
  ds_read_b64_tr_b16 v[16:17], v6 offset:18432
  ds_read_b64_tr_b16 v[18:19], v6 offset:18688
  v_cndmask_b32 v9, v9, v10, vcc
  v_mov_b32 v10, 18
  s_nop 0
  v_cndmask_b32 v7, v7, v10, vcc
  v_mfma_f32_32x32x16_bf16 v[48:63], v[24:27], v[168:171], v[48:63]
  ds_read_b64_tr_b16 v[20:21], v6 offset:19456
  ds_read_b64_tr_b16 v[22:23], v6 offset:19712
  v_lshlrev_b32 v7, 4, v7
  v_lshrrev_b32 v10, 5, v0
  v_mul_u32_u24 v10, 320, v10
  v_add_u32 v7, v7, v10
  s_mul_i32 s38, s28, 1280
  s_waitcnt lgkmcnt(4)
  v_mfma_f32_32x32x16_bf16 v[48:63], v[28:31], v[172:175], v[48:63]
  ds_read_b64_tr_b16 v[24:25], v6 offset:20480
  ds_read_b64_tr_b16 v[26:27], v6 offset:20736
  v_mul_u32_u24 v11, 5120, v9
  v_add3_u32 v11, v11, v7, s38
  s_mov_b32 s38, 155648
  v_mul_lo_u32 v9, v9, s38
  v_mfma_f32_32x32x16_bf16 v[48:63], v[32:35], v[176:179], v[48:63]
  ds_read_b64_tr_b16 v[28:29], v6 offset:21504
  ds_read_b64_tr_b16 v[30:31], v6 offset:21760
  v_add_u32 v7, v7, v9
  s_movk_i32 s38, 76
  v_cmp_le_u32 s[32:33], s38, v1
  v_mov_b32 v10, 2146435072
  v_mfma_f32_32x32x16_bf16 v[48:63], v[36:39], v[180:183], v[48:63]
  ds_read_b64_tr_b16 v[32:33], v6 offset:22528
  ds_read_b64_tr_b16 v[34:35], v6 offset:22784
  v_mov_b32 v9, 304
  v_cndmask_b32 v7, v7, v10, s[32:33]
  v_cndmask_b32 v11, v11, v9, s[32:33]
  v_accvgpr_write_b32 a28, v11
  s_waitcnt lgkmcnt(4)
  v_mfma_f32_32x32x16_bf16 v[48:63], v[16:19], v[184:187], v[48:63]
  ds_read_b64_tr_b16 v[36:37], v6 offset:23552
  ds_read_b64_tr_b16 v[38:39], v6 offset:23808
  buffer_store_dwordx4 a[16:19], v7, s[52:55], s62 offen offset:1152 sc1
  v_mfma_f32_32x32x16_bf16 v[48:63], v[20:23], v[188:191], v[48:63]
  ds_read_b64_tr_b16 v[16:17], v6 offset:24576
  ds_read_b64_tr_b16 v[18:19], v6 offset:24832
  buffer_store_dwordx4 a[20:23], v7, s[52:55], s62 offen offset:1792 sc1
  buffer_load_dword v14, off, s[96:99], 0
  v_mfma_f32_32x32x16_bf16 v[48:63], v[24:27], v[192:195], v[48:63]
  ds_read_b64_tr_b16 v[20:21], v6 offset:25600
  ds_read_b64_tr_b16 v[22:23], v6 offset:25856
  v_cvt_pk_bf16_f32 v96, v96, v97
  v_cvt_pk_bf16_f32 v97, v98, v99
  s_waitcnt lgkmcnt(4)
  v_mfma_f32_32x32x16_bf16 v[48:63], v[28:31], v[196:199], v[48:63]
  ds_read_b64_tr_b16 v[24:25], v6 offset:26624
  ds_read_b64_tr_b16 v[26:27], v6 offset:26880
  v_cvt_pk_bf16_f32 v100, v100, v101
  v_mfma_f32_32x32x16_bf16 v[48:63], v[32:35], v[200:203], v[48:63]
  ds_read_b64_tr_b16 v[28:29], v6 offset:27648
  ds_read_b64_tr_b16 v[30:31], v6 offset:27904
  v_cvt_pk_bf16_f32 v101, v102, v103
  v_mfma_f32_32x32x16_bf16 v[48:63], v[36:39], v[204:207], v[48:63]
  ds_read_b64_tr_b16 v[32:33], v6 offset:28672
  ds_read_b64_tr_b16 v[34:35], v6 offset:28928
  v_and_b32 v1, 0x12, v0
  v_cmp_eq_u32 vcc, 0, v1
  s_waitcnt lgkmcnt(4)
  v_mfma_f32_32x32x16_bf16 v[48:63], v[16:19], v[208:211], v[48:63]
  ds_read_b64_tr_b16 v[36:37], v6 offset:29696
  ds_read_b64_tr_b16 v[38:39], v6 offset:29952
  v_add_u32 v10, 128, v13
  v_mfma_f32_32x32x16_bf16 v[48:63], v[20:23], v[212:215], v[48:63]
  ds_read_b64_tr_b16 v[16:17], v6 offset:30720
  ds_read_b64_tr_b16 v[18:19], v6 offset:30976
  v_add_u32 v1, -16, v13
  v_cndmask_b32 v10, v1, v10, vcc
  v_mfma_f32_32x32x16_bf16 v[48:63], v[24:27], v[216:219], v[48:63]
  ds_read_b64_tr_b16 v[20:21], v6 offset:31744
  ds_read_b64_tr_b16 v[22:23], v6 offset:32000
  v_cndmask_b32 v1, 1, 0, vcc
  v_lshrrev_b32 v15, 6, v10
  s_waitcnt lgkmcnt(4)
  v_mfma_f32_32x32x16_bf16 v[48:63], v[28:31], v[220:223], v[48:63]
  ds_read_b64_tr_b16 v[24:25], v6 offset:32768
  ds_read_b64_tr_b16 v[26:27], v6 offset:33024
  v_sub_u32 v15, v1, v15
  v_mfma_f32_32x32x16_bf16 v[48:63], v[32:35], v[224:227], v[48:63]
  ds_read_b64_tr_b16 v[28:29], v6 offset:33792
  ds_read_b64_tr_b16 v[30:31], v6 offset:34048
  v_and_b32 v15, 3, v15
  v_mfma_f32_32x32x16_bf16 v[48:63], v[36:39], v[228:231], v[48:63]
  ds_read_b64_tr_b16 v[32:33], v6 offset:34816
  ds_read_b64_tr_b16 v[34:35], v6 offset:35072
  v_mul_u32_u24 v15, 36864, v15
  v_and_b32 v10, 63, v10
  s_waitcnt lgkmcnt(4)
  v_mfma_f32_32x32x16_bf16 v[48:63], v[16:19], v[232:235], v[48:63]
  ds_read_b64_tr_b16 v[36:37], v6 offset:35840
  ds_read_b64_tr_b16 v[38:39], v6 offset:36096
  v_add3_u32 v15, v15, v10, v4
  v_mfma_f32_32x32x16_bf16 v[48:63], v[20:23], v[236:239], v[48:63]
  s_waitcnt vmcnt(7)
  s_barrier
  v_mov_b32 v6, v15
  ds_read_b64_tr_b16 v[16:17], v6 offset:0
  ds_read_b64_tr_b16 v[18:19], v6 offset:256
  v_mfma_f32_32x32x16_bf16 v[48:63], v[24:27], v[240:243], v[48:63]
  ds_read_b64_tr_b16 v[20:21], v6 offset:1024
  ds_read_b64_tr_b16 v[22:23], v6 offset:1280
  s_waitcnt lgkmcnt(4)
  v_mfma_f32_32x32x16_bf16 v[48:63], v[28:31], v[244:247], v[48:63]
  ds_read_b64_tr_b16 v[24:25], v6 offset:2048
  ds_read_b64_tr_b16 v[26:27], v6 offset:2304
  v_mfma_f32_32x32x16_bf16 v[48:63], v[32:35], v[248:251], v[48:63]
  ds_read_b64_tr_b16 v[28:29], v6 offset:3072
  ds_read_b64_tr_b16 v[30:31], v6 offset:3328
  v_mfma_f32_32x32x16_bf16 v[48:63], v[36:39], v[252:255], v[48:63]
  ds_read_b64_tr_b16 v[32:33], v6 offset:4096
  ds_read_b64_tr_b16 v[34:35], v6 offset:4352
  s_waitcnt lgkmcnt(4)
  v_mfma_f32_32x32x16_bf16 v[64:79], v[16:19], v[112:115], 0
  ds_read_b64_tr_b16 v[36:37], v6 offset:5120
  ds_read_b64_tr_b16 v[38:39], v6 offset:5376
  s_mov_b32 m0, s30
  v_mfma_f32_32x32x16_bf16 v[64:79], v[20:23], v[116:119], v[64:79]
  ds_read_b64_tr_b16 v[16:17], v6 offset:6144
  ds_read_b64_tr_b16 v[18:19], v6 offset:6400
  buffer_load_dwordx4 v2, s[16:19], 0 offen offset:0 lds
  v_mfma_f32_32x32x16_bf16 v[64:79], v[24:27], v[120:123], v[64:79]
  ds_read_b64_tr_b16 v[20:21], v6 offset:7168
  ds_read_b64_tr_b16 v[22:23], v6 offset:7424
  v_cvt_pk_bf16_f32 v48, v48, v49
  v_cvt_pk_bf16_f32 v49, v50, v51
  s_waitcnt lgkmcnt(4)
  v_mfma_f32_32x32x16_bf16 v[64:79], v[28:31], v[124:127], v[64:79]
  ds_read_b64_tr_b16 v[24:25], v6 offset:8192
  ds_read_b64_tr_b16 v[26:27], v6 offset:8448
  buffer_load_dwordx4 v2, s[16:19], s67 offen offset:1024 lds
  v_mfma_f32_32x32x16_bf16 v[64:79], v[32:35], v[128:131], v[64:79]
  ds_read_b64_tr_b16 v[28:29], v6 offset:9216
  ds_read_b64_tr_b16 v[30:31], v6 offset:9472
  v_cvt_pk_bf16_f32 v52, v52, v53
  v_cvt_pk_bf16_f32 v53, v54, v55
  v_cvt_pk_bf16_f32 v56, v56, v57
  v_mfma_f32_32x32x16_bf16 v[64:79], v[36:39], v[132:135], v[64:79]
  ds_read_b64_tr_b16 v[32:33], v6 offset:10240
  ds_read_b64_tr_b16 v[34:35], v6 offset:10496
  buffer_load_dwordx4 v2, s[16:19], s68 offen offset:2048 lds
  s_waitcnt lgkmcnt(4)
  v_mfma_f32_32x32x16_bf16 v[64:79], v[16:19], v[136:139], v[64:79]
  ds_read_b64_tr_b16 v[36:37], v6 offset:11264
  ds_read_b64_tr_b16 v[38:39], v6 offset:11520
  v_cvt_pk_bf16_f32 v57, v58, v59
  v_mfma_f32_32x32x16_bf16 v[64:79], v[20:23], v[140:143], v[64:79]
  ds_read_b64_tr_b16 v[16:17], v6 offset:12288
  ds_read_b64_tr_b16 v[18:19], v6 offset:12544
  buffer_load_dwordx4 v2, s[16:19], s69 offen offset:3072 lds
  v_mfma_f32_32x32x16_bf16 v[64:79], v[24:27], v[144:147], v[64:79]
  ds_read_b64_tr_b16 v[20:21], v6 offset:13312
  ds_read_b64_tr_b16 v[22:23], v6 offset:13568
  v_cvt_pk_bf16_f32 v60, v60, v61
  v_cvt_pk_bf16_f32 v61, v62, v63
  s_add_u32 m0, m0, 4096
  s_waitcnt lgkmcnt(4)
  v_mfma_f32_32x32x16_bf16 v[64:79], v[28:31], v[148:151], v[64:79]
  ds_read_b64_tr_b16 v[24:25], v6 offset:14336
  ds_read_b64_tr_b16 v[26:27], v6 offset:14592
  buffer_load_dwordx4 v2, s[16:19], s70 offen offset:0 lds
  v_mfma_f32_32x32x16_bf16 v[64:79], v[32:35], v[152:155], v[64:79]
  ds_read_b64_tr_b16 v[28:29], v6 offset:15360
  ds_read_b64_tr_b16 v[30:31], v6 offset:15616
  v_add_u32 v10, 64, v13
  v_lshrrev_b32 v15, 6, v10
  v_mfma_f32_32x32x16_bf16 v[64:79], v[36:39], v[156:159], v[64:79]
  ds_read_b64_tr_b16 v[32:33], v6 offset:16384
  ds_read_b64_tr_b16 v[34:35], v6 offset:16640
  buffer_load_dwordx4 v2, s[16:19], s71 offen offset:1024 lds
  s_waitcnt lgkmcnt(4)
  v_mfma_f32_32x32x16_bf16 v[64:79], v[16:19], v[160:163], v[64:79]
  ds_read_b64_tr_b16 v[36:37], v6 offset:17408
  ds_read_b64_tr_b16 v[38:39], v6 offset:17664
  v_sub_u32 v15, 0, v15
  v_mfma_f32_32x32x16_bf16 v[64:79], v[20:23], v[164:167], v[64:79]
  ds_read_b64_tr_b16 v[16:17], v6 offset:18432
  ds_read_b64_tr_b16 v[18:19], v6 offset:18688
  buffer_load_dwordx4 v2, s[16:19], s72 offen offset:2048 lds
  v_mfma_f32_32x32x16_bf16 v[64:79], v[24:27], v[168:171], v[64:79]
  ds_read_b64_tr_b16 v[20:21], v6 offset:19456
  ds_read_b64_tr_b16 v[22:23], v6 offset:19712
  v_and_b32 v15, 3, v15
  v_mul_u32_u24 v15, 36864, v15
  v_and_b32 v10, 63, v10
  s_waitcnt lgkmcnt(4)
  v_mfma_f32_32x32x16_bf16 v[64:79], v[28:31], v[172:175], v[64:79]
  ds_read_b64_tr_b16 v[24:25], v6 offset:20480
  ds_read_b64_tr_b16 v[26:27], v6 offset:20736
  buffer_load_dwordx4 v2, s[16:19], s73 offen offset:3072 lds
  v_mfma_f32_32x32x16_bf16 v[64:79], v[32:35], v[176:179], v[64:79]
  ds_read_b64_tr_b16 v[28:29], v6 offset:21504
  ds_read_b64_tr_b16 v[30:31], v6 offset:21760
  v_add3_u32 v15, v15, v10, v4
  s_add_u32 m0, m0, 4096
  v_mfma_f32_32x32x16_bf16 v[64:79], v[36:39], v[180:183], v[64:79]
  ds_read_b64_tr_b16 v[32:33], v6 offset:22528
  ds_read_b64_tr_b16 v[34:35], v6 offset:22784
  buffer_load_dwordx4 v2, s[16:19], s74 offen offset:0 lds
  s_waitcnt lgkmcnt(4)
  v_mfma_f32_32x32x16_bf16 v[64:79], v[16:19], v[184:187], v[64:79]
  ds_read_b64_tr_b16 v[36:37], v6 offset:23552
  ds_read_b64_tr_b16 v[38:39], v6 offset:23808
  s_add_u32 s30, s30, 36864
  s_cmp_ge_u32 s30, 147456
  s_cselect_b32 s35, 147456, 0
  s_sub_u32 s30, s30, s35
  v_mfma_f32_32x32x16_bf16 v[64:79], v[20:23], v[188:191], v[64:79]
  ds_read_b64_tr_b16 v[16:17], v6 offset:24576
  ds_read_b64_tr_b16 v[18:19], v6 offset:24832
  s_sub_u32 s16, s16, 64
  s_subb_u32 s17, s17, 0
  s_add_u32 s18, s18, 64
  v_mfma_f32_32x32x16_bf16 v[64:79], v[24:27], v[192:195], v[64:79]
  ds_read_b64_tr_b16 v[20:21], v6 offset:25600
  ds_read_b64_tr_b16 v[22:23], v6 offset:25856
  v_cmp_lt_u32 s[32:33], 31, v0
  v_lshlrev_b32 v7, 4, v0
  s_lshl_b32 s38, s28, 10
  s_waitcnt lgkmcnt(4)
  v_mfma_f32_32x32x16_bf16 v[64:79], v[28:31], v[196:199], v[64:79]
  ds_read_b64_tr_b16 v[24:25], v6 offset:26624
  ds_read_b64_tr_b16 v[26:27], v6 offset:26880
  s_add_u32 s38, s38, 147456
  v_mfma_f32_32x32x16_bf16 v[64:79], v[32:35], v[200:203], v[64:79]
  ds_read_b64_tr_b16 v[28:29], v6 offset:27648
  ds_read_b64_tr_b16 v[30:31], v6 offset:27904
  v_add_u32 v9, s38, v7
  v_mov_b32 v40, v56
  v_mov_b32 v41, v57
  v_mfma_f32_32x32x16_bf16 v[64:79], v[36:39], v[204:207], v[64:79]
  ds_read_b64_tr_b16 v[32:33], v6 offset:28672
  ds_read_b64_tr_b16 v[34:35], v6 offset:28928
  v_cndmask_b32 v42, v60, v52, s[32:33]
  v_cndmask_b32 v43, v61, v53, s[32:33]
  s_add_u32 s38, s62, 311296
  s_waitcnt lgkmcnt(4)
  v_mfma_f32_32x32x16_bf16 v[64:79], v[16:19], v[208:211], v[64:79]
  ds_read_b64_tr_b16 v[36:37], v6 offset:29696
  ds_read_b64_tr_b16 v[38:39], v6 offset:29952
  buffer_store_dwordx4 v[40:43], v7, s[52:55], s38 offen sc1
  v_mfma_f32_32x32x16_bf16 v[64:79], v[20:23], v[212:215], v[64:79]
  ds_read_b64_tr_b16 v[16:17], v6 offset:30720
  ds_read_b64_tr_b16 v[18:19], v6 offset:30976
  ds_write_b128 v9, v[40:43] offset:8192
  v_mfma_f32_32x32x16_bf16 v[64:79], v[24:27], v[216:219], v[64:79]
  ds_read_b64_tr_b16 v[20:21], v6 offset:31744
  ds_read_b64_tr_b16 v[22:23], v6 offset:32000
  v_mov_b32 v44, v96
  v_mov_b32 v45, v97
  v_mov_b32 v46, v100
  s_waitcnt lgkmcnt(5)
  v_mfma_f32_32x32x16_bf16 v[64:79], v[28:31], v[220:223], v[64:79]
  ds_read_b64_tr_b16 v[24:25], v6 offset:32768
  ds_read_b64_tr_b16 v[26:27], v6 offset:33024
  v_mov_b32 v47, v101
  s_add_u32 s38, s62, 466944
  v_mfma_f32_32x32x16_bf16 v[64:79], v[32:35], v[224:227], v[64:79]
  ds_read_b64_tr_b16 v[28:29], v6 offset:33792
  ds_read_b64_tr_b16 v[30:31], v6 offset:34048
  buffer_store_dwordx4 v[44:47], v7, s[52:55], s38 offen sc1
  v_mfma_f32_32x32x16_bf16 v[64:79], v[36:39], v[228:231], v[64:79]
  ds_read_b64_tr_b16 v[32:33], v6 offset:34816
  ds_read_b64_tr_b16 v[34:35], v6 offset:35072
  ds_write_b128 v9, v[44:47] offset:12288
  s_nop 1
  s_waitcnt lgkmcnt(5)
  v_mfma_f32_32x32x16_bf16 v[64:79], v[16:19], v[232:235], v[64:79]
  ds_read_b64_tr_b16 v[36:37], v6 offset:35840
  ds_read_b64_tr_b16 v[38:39], v6 offset:36096
  v_mfma_f32_32x32x16_bf16 v[64:79], v[20:23], v[236:239], v[64:79]
  s_waitcnt vmcnt(2)
  s_barrier
  v_mov_b32 v6, v15
  ds_read_b64_tr_b16 v[16:17], v6 offset:0
  ds_read_b64_tr_b16 v[18:19], v6 offset:256
  v_mfma_f32_32x32x16_bf16 v[64:79], v[24:27], v[240:243], v[64:79]
  ds_read_b64_tr_b16 v[20:21], v6 offset:1024
  ds_read_b64_tr_b16 v[22:23], v6 offset:1280
  s_waitcnt lgkmcnt(4)
  v_mfma_f32_32x32x16_bf16 v[64:79], v[28:31], v[244:247], v[64:79]
  ds_read_b64_tr_b16 v[24:25], v6 offset:2048
  ds_read_b64_tr_b16 v[26:27], v6 offset:2304
  v_mfma_f32_32x32x16_bf16 v[64:79], v[32:35], v[248:251], v[64:79]
  ds_read_b64_tr_b16 v[28:29], v6 offset:3072
  ds_read_b64_tr_b16 v[30:31], v6 offset:3328
  v_mfma_f32_32x32x16_bf16 v[64:79], v[36:39], v[252:255], v[64:79]
  ds_read_b64_tr_b16 v[32:33], v6 offset:4096
  ds_read_b64_tr_b16 v[34:35], v6 offset:4352
  s_waitcnt lgkmcnt(4)
  v_mfma_f32_32x32x16_bf16 v[80:95], v[16:19], v[112:115], 0
  ds_read_b64_tr_b16 v[36:37], v6 offset:5120
  ds_read_b64_tr_b16 v[38:39], v6 offset:5376
  s_mov_b32 m0, s30
  v_mfma_f32_32x32x16_bf16 v[80:95], v[20:23], v[116:119], v[80:95]
  ds_read_b64_tr_b16 v[16:17], v6 offset:6144
  ds_read_b64_tr_b16 v[18:19], v6 offset:6400
  buffer_load_dwordx4 v2, s[16:19], 0 offen offset:0 lds
  v_mfma_f32_32x32x16_bf16 v[80:95], v[24:27], v[120:123], v[80:95]
  ds_read_b64_tr_b16 v[20:21], v6 offset:7168
  ds_read_b64_tr_b16 v[22:23], v6 offset:7424
  buffer_load_dwordx4 v2, s[16:19], s67 offen offset:1024 lds
  v_cvt_pk_bf16_f32 v68, v68, v69
  s_waitcnt lgkmcnt(4)
  v_mfma_f32_32x32x16_bf16 v[80:95], v[28:31], v[124:127], v[80:95]
  ds_read_b64_tr_b16 v[24:25], v6 offset:8192
  ds_read_b64_tr_b16 v[26:27], v6 offset:8448
  buffer_load_dwordx4 v2, s[16:19], s68 offen offset:2048 lds
  v_cvt_pk_bf16_f32 v69, v70, v71
  v_mfma_f32_32x32x16_bf16 v[80:95], v[32:35], v[128:131], v[80:95]
  ds_read_b64_tr_b16 v[28:29], v6 offset:9216
  ds_read_b64_tr_b16 v[30:31], v6 offset:9472
  buffer_load_dwordx4 v2, s[16:19], s69 offen offset:3072 lds
  s_add_u32 m0, m0, 4096
  v_mfma_f32_32x32x16_bf16 v[80:95], v[36:39], v[132:135], v[80:95]
  ds_read_b64_tr_b16 v[32:33], v6 offset:10240
  ds_read_b64_tr_b16 v[34:35], v6 offset:10496
  buffer_load_dwordx4 v2, s[16:19], s70 offen offset:0 lds
  v_cvt_pk_bf16_f32 v72, v72, v73
  v_cvt_pk_bf16_f32 v73, v74, v75
  s_waitcnt lgkmcnt(4)
  v_mfma_f32_32x32x16_bf16 v[80:95], v[16:19], v[136:139], v[80:95]
  ds_read_b64_tr_b16 v[36:37], v6 offset:11264
  ds_read_b64_tr_b16 v[38:39], v6 offset:11520
  buffer_load_dwordx4 v2, s[16:19], s71 offen offset:1024 lds
  v_mfma_f32_32x32x16_bf16 v[80:95], v[20:23], v[140:143], v[80:95]
  ds_read_b64_tr_b16 v[16:17], v6 offset:12288
  ds_read_b64_tr_b16 v[18:19], v6 offset:12544
  buffer_load_dwordx4 v2, s[16:19], s72 offen offset:2048 lds
  v_cvt_pk_bf16_f32 v76, v76, v77
  v_mfma_f32_32x32x16_bf16 v[80:95], v[24:27], v[144:147], v[80:95]
  ds_read_b64_tr_b16 v[20:21], v6 offset:13312
  ds_read_b64_tr_b16 v[22:23], v6 offset:13568
  buffer_load_dwordx4 v2, s[16:19], s73 offen offset:3072 lds
  v_cvt_pk_bf16_f32 v77, v78, v79
  s_add_u32 m0, m0, 4096
  s_waitcnt lgkmcnt(4)
  v_mfma_f32_32x32x16_bf16 v[80:95], v[28:31], v[148:151], v[80:95]
  ds_read_b64_tr_b16 v[24:25], v6 offset:14336
  ds_read_b64_tr_b16 v[26:27], v6 offset:14592
  buffer_load_dwordx4 v2, s[16:19], s74 offen offset:0 lds
  v_mfma_f32_32x32x16_bf16 v[80:95], v[32:35], v[152:155], v[80:95]
  ds_read_b64_tr_b16 v[28:29], v6 offset:15360
  ds_read_b64_tr_b16 v[30:31], v6 offset:15616
  s_add_u32 s30, s30, 36864
  s_cmp_ge_u32 s30, 147456
  s_cselect_b32 s35, 147456, 0
  s_sub_u32 s30, s30, s35
  v_mfma_f32_32x32x16_bf16 v[80:95], v[36:39], v[156:159], v[80:95]
  ds_read_b64_tr_b16 v[32:33], v6 offset:16384
  ds_read_b64_tr_b16 v[34:35], v6 offset:16640
  v_cmp_lt_u32 s[32:33], 31, v0
  v_lshlrev_b32 v7, 4, v0
  s_lshl_b32 s38, s28, 10
  s_add_u32 s38, s38, 147456
  s_waitcnt lgkmcnt(4)
  v_mfma_f32_32x32x16_bf16 v[80:95], v[16:19], v[160:163], v[80:95]
  ds_read_b64_tr_b16 v[36:37], v6 offset:17408
  ds_read_b64_tr_b16 v[38:39], v6 offset:17664
  v_add_u32 v9, s38, v7
  v_mov_b32 v40, v68
  v_mov_b32 v41, v69
  v_mfma_f32_32x32x16_bf16 v[80:95], v[20:23], v[164:167], v[80:95]
  ds_read_b64_tr_b16 v[16:17], v6 offset:18432
  ds_read_b64_tr_b16 v[18:19], v6 offset:18688
  v_mov_b32 v42, v72
  v_mov_b32 v43, v73
  s_add_u32 s38, s62, 0
  v_mfma_f32_32x32x16_bf16 v[80:95], v[24:27], v[168:171], v[80:95]
  ds_read_b64_tr_b16 v[20:21], v6 offset:19456
  ds_read_b64_tr_b16 v[22:23], v6 offset:19712
  buffer_store_dwordx4 v[40:43], v7, s[52:55], s38 offen sc1
  ds_write_b128 v9, v[40:43] offset:0
  v_mov_b32 v44, v48
  s_waitcnt lgkmcnt(5)
  v_mfma_f32_32x32x16_bf16 v[80:95], v[28:31], v[172:175], v[80:95]
  ds_read_b64_tr_b16 v[24:25], v6 offset:20480
  ds_read_b64_tr_b16 v[26:27], v6 offset:20736
  v_mov_b32 v45, v49
  v_cndmask_b32 v46, v52, v76, s[32:33]
  v_cndmask_b32 v47, v53, v77, s[32:33]
  s_add_u32 s38, s62, 155648
  v_mfma_f32_32x32x16_bf16 v[80:95], v[32:35], v[176:179], v[80:95]
  ds_read_b64_tr_b16 v[28:29], v6 offset:21504
  ds_read_b64_tr_b16 v[30:31], v6 offset:21760
  buffer_store_dwordx4 v[44:47], v7, s[52:55], s38 offen sc1
  ds_write_b128 v9, v[44:47] offset:4096
  v_mfma_f32_32x32x16_bf16 v[80:95], v[36:39], v[180:183], v[80:95]
  ds_read_b64_tr_b16 v[32:33], v6 offset:22528
  ds_read_b64_tr_b16 v[34:35], v6 offset:22784
  v_cndmask_b32 v10, v76, v60, s[32:33]
  v_cndmask_b32 v11, v77, v61, s[32:33]
  v_and_b32 v7, 31, v0
  v_lshlrev_b32 v7, 2, v7
  s_waitcnt lgkmcnt(5)
  v_mfma_f32_32x32x16_bf16 v[80:95], v[16:19], v[184:187], v[80:95]
  ds_read_b64_tr_b16 v[36:37], v6 offset:23552
  ds_read_b64_tr_b16 v[38:39], v6 offset:23808
  v_lshrrev_b32 v9, 5, v0
  s_mov_b32 s38, 311296
  v_mul_lo_u32 v9, v9, s38
  v_mfma_f32_32x32x16_bf16 v[80:95], v[20:23], v[188:191], v[80:95]
  ds_read_b64_tr_b16 v[16:17], v6 offset:24576
  ds_read_b64_tr_b16 v[18:19], v6 offset:24832
  v_add_u32 v7, v7, v9
  buffer_store_dword v10, v7, s[52:55], s62 offen offset:1024 sc1
  v_mfma_f32_32x32x16_bf16 v[80:95], v[24:27], v[192:195], v[80:95]
  ds_read_b64_tr_b16 v[20:21], v6 offset:25600
  ds_read_b64_tr_b16 v[22:23], v6 offset:25856
  s_add_u32 s38, s62, 155648
  buffer_store_dword v11, v7, s[52:55], s38 offen offset:1024 sc1
  s_waitcnt lgkmcnt(4)
  v_mfma_f32_32x32x16_bf16 v[80:95], v[28:31], v[196:199], v[80:95]
  ds_read_b64_tr_b16 v[24:25], v6 offset:26624
  ds_read_b64_tr_b16 v[26:27], v6 offset:26880
  v_accvgpr_write_b32 a24, v10
  v_accvgpr_write_b32 a25, v11
  s_nop 1
  v_mfma_f32_32x32x16_bf16 v[80:95], v[32:35], v[200:203], v[80:95]
  ds_read_b64_tr_b16 v[28:29], v6 offset:27648
  ds_read_b64_tr_b16 v[30:31], v6 offset:27904
  v_add_u32 v10, 0, v13
  v_lshrrev_b32 v15, 6, v10
  v_mfma_f32_32x32x16_bf16 v[80:95], v[36:39], v[204:207], v[80:95]
  ds_read_b64_tr_b16 v[32:33], v6 offset:28672
  ds_read_b64_tr_b16 v[34:35], v6 offset:28928
  v_sub_u32 v15, 0, v15
  v_and_b32 v15, 3, v15
  s_waitcnt lgkmcnt(4)
  v_mfma_f32_32x32x16_bf16 v[80:95], v[16:19], v[208:211], v[80:95]
  ds_read_b64_tr_b16 v[36:37], v6 offset:29696
  ds_read_b64_tr_b16 v[38:39], v6 offset:29952
  v_mfma_f32_32x32x16_bf16 v[80:95], v[20:23], v[212:215], v[80:95]
  ds_read_b64_tr_b16 v[16:17], v6 offset:30720
  ds_read_b64_tr_b16 v[18:19], v6 offset:30976
  v_mul_u32_u24 v15, 36864, v15
  v_and_b32 v10, 63, v10
  v_mfma_f32_32x32x16_bf16 v[80:95], v[24:27], v[216:219], v[80:95]
  ds_read_b64_tr_b16 v[20:21], v6 offset:31744
  ds_read_b64_tr_b16 v[22:23], v6 offset:32000
  v_add3_u32 v15, v15, v10, v4
  v_mul_f32 v64, 0x3eae1a93, v64
  s_waitcnt lgkmcnt(4)
  v_mfma_f32_32x32x16_bf16 v[80:95], v[28:31], v[220:223], v[80:95]
  ds_read_b64_tr_b16 v[24:25], v6 offset:32768
  ds_read_b64_tr_b16 v[26:27], v6 offset:33024
  v_mul_f32 v65, 0x3eae1a93, v65
  v_mfma_f32_32x32x16_bf16 v[80:95], v[32:35], v[224:227], v[80:95]
  ds_read_b64_tr_b16 v[28:29], v6 offset:33792
  ds_read_b64_tr_b16 v[30:31], v6 offset:34048
  v_mul_f32 v66, 0x3eae1a93, v66
  v_mfma_f32_32x32x16_bf16 v[80:95], v[36:39], v[228:231], v[80:95]
  ds_read_b64_tr_b16 v[32:33], v6 offset:34816
  ds_read_b64_tr_b16 v[34:35], v6 offset:35072
  v_mul_f32 v67, 0x3eae1a93, v67
  v_cvt_pk_bf16_f32 v64, v64, v65
  s_waitcnt lgkmcnt(4)
  v_mfma_f32_32x32x16_bf16 v[80:95], v[16:19], v[232:235], v[80:95]
  ds_read_b64_tr_b16 v[36:37], v6 offset:35840
  ds_read_b64_tr_b16 v[38:39], v6 offset:36096
  v_cvt_pk_bf16_f32 v65, v66, v67
  v_mfma_f32_32x32x16_bf16 v[80:95], v[20:23], v[236:239], v[80:95]
  s_waitcnt vmcnt(4)
  s_barrier
  v_mov_b32 v6, v15
  ds_read_b64_tr_b16 v[16:17], v6 offset:0
  ds_read_b64_tr_b16 v[18:19], v6 offset:256
  v_mfma_f32_32x32x16_bf16 v[80:95], v[24:27], v[240:243], v[80:95]
  ds_read_b64_tr_b16 v[20:21], v6 offset:1024
  ds_read_b64_tr_b16 v[22:23], v6 offset:1280
  s_waitcnt lgkmcnt(4)
  v_mfma_f32_32x32x16_bf16 v[80:95], v[28:31], v[244:247], v[80:95]
  ds_read_b64_tr_b16 v[24:25], v6 offset:2048
  ds_read_b64_tr_b16 v[26:27], v6 offset:2304
  v_mfma_f32_32x32x16_bf16 v[80:95], v[32:35], v[248:251], v[80:95]
  ds_read_b64_tr_b16 v[28:29], v6 offset:3072
  ds_read_b64_tr_b16 v[30:31], v6 offset:3328
  v_mfma_f32_32x32x16_bf16 v[80:95], v[36:39], v[252:255], v[80:95]
  ds_read_b64_tr_b16 v[32:33], v6 offset:4096
  ds_read_b64_tr_b16 v[34:35], v6 offset:4352
  s_waitcnt lgkmcnt(4)
  v_mfma_f32_32x32x16_bf16 v[96:111], v[16:19], v[112:115], 0
  ds_read_b64_tr_b16 v[36:37], v6 offset:5120
  ds_read_b64_tr_b16 v[38:39], v6 offset:5376
  v_mfma_f32_32x32x16_bf16 v[96:111], v[20:23], v[116:119], v[96:111]
  ds_read_b64_tr_b16 v[16:17], v6 offset:6144
  ds_read_b64_tr_b16 v[18:19], v6 offset:6400
  v_mfma_f32_32x32x16_bf16 v[96:111], v[24:27], v[120:123], v[96:111]
  ds_read_b64_tr_b16 v[20:21], v6 offset:7168
  ds_read_b64_tr_b16 v[22:23], v6 offset:7424
  v_mul_f32 v80, 0x3eae1a93, v80
  s_waitcnt lgkmcnt(4)
  v_mfma_f32_32x32x16_bf16 v[96:111], v[28:31], v[124:127], v[96:111]
  ds_read_b64_tr_b16 v[24:25], v6 offset:8192
  ds_read_b64_tr_b16 v[26:27], v6 offset:8448
  v_mfma_f32_32x32x16_bf16 v[96:111], v[32:35], v[128:131], v[96:111]
  ds_read_b64_tr_b16 v[28:29], v6 offset:9216
  ds_read_b64_tr_b16 v[30:31], v6 offset:9472
  v_mul_f32 v81, 0x3eae1a93, v81
  v_mul_f32 v82, 0x3eae1a93, v82
  v_mfma_f32_32x32x16_bf16 v[96:111], v[36:39], v[132:135], v[96:111]
  ds_read_b64_tr_b16 v[32:33], v6 offset:10240
  ds_read_b64_tr_b16 v[34:35], v6 offset:10496
  v_mul_f32 v83, 0x3eae1a93, v83
  s_waitcnt lgkmcnt(4)
  v_mfma_f32_32x32x16_bf16 v[96:111], v[16:19], v[136:139], v[96:111]
  ds_read_b64_tr_b16 v[36:37], v6 offset:11264
  ds_read_b64_tr_b16 v[38:39], v6 offset:11520
  v_mfma_f32_32x32x16_bf16 v[96:111], v[20:23], v[140:143], v[96:111]
  ds_read_b64_tr_b16 v[16:17], v6 offset:12288
  ds_read_b64_tr_b16 v[18:19], v6 offset:12544
  v_cvt_pk_bf16_f32 v80, v80, v81
  v_mfma_f32_32x32x16_bf16 v[96:111], v[24:27], v[144:147], v[96:111]
  ds_read_b64_tr_b16 v[20:21], v6 offset:13312
  ds_read_b64_tr_b16 v[22:23], v6 offset:13568
  v_cvt_pk_bf16_f32 v81, v82, v83
  s_waitcnt lgkmcnt(4)
  v_mfma_f32_32x32x16_bf16 v[96:111], v[28:31], v[148:151], v[96:111]
  ds_read_b64_tr_b16 v[24:25], v6 offset:14336
  ds_read_b64_tr_b16 v[26:27], v6 offset:14592
  v_mfma_f32_32x32x16_bf16 v[96:111], v[32:35], v[152:155], v[96:111]
  ds_read_b64_tr_b16 v[28:29], v6 offset:15360
  ds_read_b64_tr_b16 v[30:31], v6 offset:15616
  v_mul_f32 v84, 0x3eae1a93, v84
  v_mul_f32 v85, 0x3eae1a93, v85
  v_mfma_f32_32x32x16_bf16 v[96:111], v[36:39], v[156:159], v[96:111]
  ds_read_b64_tr_b16 v[32:33], v6 offset:16384
  ds_read_b64_tr_b16 v[34:35], v6 offset:16640
  v_mul_f32 v86, 0x3eae1a93, v86
  s_waitcnt lgkmcnt(4)
  v_mfma_f32_32x32x16_bf16 v[96:111], v[16:19], v[160:163], v[96:111]
  ds_read_b64_tr_b16 v[36:37], v6 offset:17408
  ds_read_b64_tr_b16 v[38:39], v6 offset:17664
  v_mfma_f32_32x32x16_bf16 v[96:111], v[20:23], v[164:167], v[96:111]
  ds_read_b64_tr_b16 v[16:17], v6 offset:18432
  ds_read_b64_tr_b16 v[18:19], v6 offset:18688
  v_mul_f32 v87, 0x3eae1a93, v87
  v_mfma_f32_32x32x16_bf16 v[96:111], v[24:27], v[168:171], v[96:111]
  ds_read_b64_tr_b16 v[20:21], v6 offset:19456
  ds_read_b64_tr_b16 v[22:23], v6 offset:19712
  v_cvt_pk_bf16_f32 v84, v84, v85
  s_waitcnt lgkmcnt(4)
  v_mfma_f32_32x32x16_bf16 v[96:111], v[28:31], v[172:175], v[96:111]
  ds_read_b64_tr_b16 v[24:25], v6 offset:20480
  ds_read_b64_tr_b16 v[26:27], v6 offset:20736
  v_cvt_pk_bf16_f32 v85, v86, v87
  v_mfma_f32_32x32x16_bf16 v[96:111], v[32:35], v[176:179], v[96:111]
  ds_read_b64_tr_b16 v[28:29], v6 offset:21504
  ds_read_b64_tr_b16 v[30:31], v6 offset:21760
  v_mul_f32 v88, 0x3eae1a93, v88
  v_mfma_f32_32x32x16_bf16 v[96:111], v[36:39], v[180:183], v[96:111]
  ds_read_b64_tr_b16 v[32:33], v6 offset:22528
  ds_read_b64_tr_b16 v[34:35], v6 offset:22784
  v_mul_f32 v89, 0x3eae1a93, v89
  s_waitcnt lgkmcnt(4)
  v_mfma_f32_32x32x16_bf16 v[96:111], v[16:19], v[184:187], v[96:111]
  ds_read_b64_tr_b16 v[36:37], v6 offset:23552
  ds_read_b64_tr_b16 v[38:39], v6 offset:23808
  v_mfma_f32_32x32x16_bf16 v[96:111], v[20:23], v[188:191], v[96:111]
  ds_read_b64_tr_b16 v[16:17], v6 offset:24576
  ds_read_b64_tr_b16 v[18:19], v6 offset:24832
  v_mul_f32 v90, 0x3eae1a93, v90
  v_mfma_f32_32x32x16_bf16 v[96:111], v[24:27], v[192:195], v[96:111]
  ds_read_b64_tr_b16 v[20:21], v6 offset:25600
  ds_read_b64_tr_b16 v[22:23], v6 offset:25856
  v_mul_f32 v91, 0x3eae1a93, v91
  s_waitcnt lgkmcnt(4)
  v_mfma_f32_32x32x16_bf16 v[96:111], v[28:31], v[196:199], v[96:111]
  ds_read_b64_tr_b16 v[24:25], v6 offset:26624
  ds_read_b64_tr_b16 v[26:27], v6 offset:26880
  v_cvt_pk_bf16_f32 v88, v88, v89
  v_mfma_f32_32x32x16_bf16 v[96:111], v[32:35], v[200:203], v[96:111]
  ds_read_b64_tr_b16 v[28:29], v6 offset:27648
  ds_read_b64_tr_b16 v[30:31], v6 offset:27904
  v_cvt_pk_bf16_f32 v89, v90, v91
  v_mfma_f32_32x32x16_bf16 v[96:111], v[36:39], v[204:207], v[96:111]
  ds_read_b64_tr_b16 v[32:33], v6 offset:28672
  ds_read_b64_tr_b16 v[34:35], v6 offset:28928
  v_mul_f32 v92, 0x3eae1a93, v92
  s_waitcnt lgkmcnt(4)
  v_mfma_f32_32x32x16_bf16 v[96:111], v[16:19], v[208:211], v[96:111]
  ds_read_b64_tr_b16 v[36:37], v6 offset:29696
  ds_read_b64_tr_b16 v[38:39], v6 offset:29952
  v_mfma_f32_32x32x16_bf16 v[96:111], v[20:23], v[212:215], v[96:111]
  ds_read_b64_tr_b16 v[16:17], v6 offset:30720
  ds_read_b64_tr_b16 v[18:19], v6 offset:30976
  v_mul_f32 v93, 0x3eae1a93, v93
  v_mfma_f32_32x32x16_bf16 v[96:111], v[24:27], v[216:219], v[96:111]
  ds_read_b64_tr_b16 v[20:21], v6 offset:31744
  ds_read_b64_tr_b16 v[22:23], v6 offset:32000
  v_mul_f32 v94, 0x3eae1a93, v94
  s_waitcnt lgkmcnt(4)
  v_mfma_f32_32x32x16_bf16 v[96:111], v[28:31], v[220:223], v[96:111]
  ds_read_b64_tr_b16 v[24:25], v6 offset:32768
  ds_read_b64_tr_b16 v[26:27], v6 offset:33024
  v_mul_f32 v95, 0x3eae1a93, v95
  v_mfma_f32_32x32x16_bf16 v[96:111], v[32:35], v[224:227], v[96:111]
  ds_read_b64_tr_b16 v[28:29], v6 offset:33792
  ds_read_b64_tr_b16 v[30:31], v6 offset:34048
  v_cvt_pk_bf16_f32 v92, v92, v93
  v_mfma_f32_32x32x16_bf16 v[96:111], v[36:39], v[228:231], v[96:111]
  ds_read_b64_tr_b16 v[32:33], v6 offset:34816
  ds_read_b64_tr_b16 v[34:35], v6 offset:35072
  v_cvt_pk_bf16_f32 v93, v94, v95
  s_waitcnt lgkmcnt(4)
  v_mfma_f32_32x32x16_bf16 v[96:111], v[16:19], v[232:235], v[96:111]
  ds_read_b64_tr_b16 v[36:37], v6 offset:35840
  ds_read_b64_tr_b16 v[38:39], v6 offset:36096
  s_waitcnt lgkmcnt(0)
  s_lshl_b32 s39, s36, 8
  s_add_u32 s39, s39, 11534336
  s_waitcnt vmcnt(0)
  s_barrier
  s_cmp_lg_u32 s28, 0
  s_cbranch_scc1 1f
  s_mov_b32 s31, 0x40000
3:
  v_readfirstlane_b32 s38, v14
  s_cmp_lg_u32 s38, 0
  s_cbranch_scc1 4f
  buffer_load_dword v14, off, s[96:99], 0 sc1

  s_waitcnt vmcnt(0)
  s_sub_u32 s31, s31, 1
  s_cbranch_scc0 3b
4:
  s_mov_b64 exec, 1
  v_mov_b32 v15, 1
  buffer_atomic_add v15, off, s[52:55], s39 sc1
  s_mov_b64 exec, -1
1:
  v_mfma_f32_32x32x16_bf16 v[96:111], v[20:23], v[236:239], v[96:111]
  v_accvgpr_read_b32 v9, a26
  v_accvgpr_read_b32 v10, a27
  v_accvgpr_read_b32 v11, a28
  ds_write_b128 v9, a[0:3]
  v_mfma_f32_32x32x16_bf16 v[96:111], v[24:27], v[240:243], v[96:111]
  ds_write_b128 v9, a[4:7] offset:640
  ds_write_b128 v10, a[8:11]
  ds_write_b128 v10, a[12:15] offset:640
  ds_write_b128 v11, a[16:19]
  s_waitcnt lgkmcnt(5)
  v_mfma_f32_32x32x16_bf16 v[96:111], v[28:31], v[244:247], v[96:111]
  ds_write_b128 v11, a[20:23] offset:640
  v_and_b32 v7, 31, v0
  v_lshlrev_b32 v7, 2, v7
  v_lshrrev_b32 v9, 5, v0
  v_mfma_f32_32x32x16_bf16 v[96:111], v[32:35], v[248:251], v[96:111]
  s_mov_b32 s38, 1024
  v_mul_lo_u32 v9, v9, s38
  v_add_u32 v7, v7, v9
  s_lshl_b32 s38, s28, 7
  v_mfma_f32_32x32x16_bf16 v[96:111], v[36:39], v[252:255], v[96:111]
  s_add_u32 s38, s38, 126976
  v_add_u32 v12, s38, v7
  ds_write_b32 v12, a24 offset:2048
  ds_write_b32 v12, a25 offset:2560
  v_mov_b32 v2, v5
  s_lshl_b32 s50, s36, 2
  s_add_u32 s50, s50, s28
  s_mul_i32 s60, s50, 155648
  s_add_u32 s60, s60, 0
  v_lshlrev_b32 v4, 4, v0
  v_and_b32 v7, 31, v0
  v_lshlrev_b32 v5, 2, v7
  v_add_u32 v5, 1024, v5
  v_cmp_lt_u32 vcc, 15, v7
  v_and_b32 v9, 19, v7
  v_lshrrev_b32 v10, 5, v0
  v_cndmask_b32 v9, v7, v9, vcc
  v_mul_u32_u24 v10, 320, v10
  v_lshlrev_b32 v9, 4, v9
  v_add_u32 v9, v9, v10
  v_add_u32 v6, 1152, v9
  s_lshl_b32 s39, s36, 8
  s_add_u32 s39, s39, 11534336
  s_cmp_eq_u32 s28, 0
  s_cselect_b32 s38, 0, 2146435072
  v_mov_b32 v1, s38

  s_nop 7
  v_mul_f32 v96, 0x3eae1a93, v96
  v_mul_f32 v97, 0x3eae1a93, v97
  v_mul_f32 v98, 0x3eae1a93, v98
  v_mul_f32 v99, 0x3eae1a93, v99
  v_cvt_pk_bf16_f32 v96, v96, v97
  v_cvt_pk_bf16_f32 v97, v98, v99
  v_mul_f32 v100, 0x3eae1a93, v100
  v_mul_f32 v101, 0x3eae1a93, v101
  v_mul_f32 v102, 0x3eae1a93, v102
  v_mul_f32 v103, 0x3eae1a93, v103
  v_cvt_pk_bf16_f32 v100, v100, v101
  v_cvt_pk_bf16_f32 v101, v102, v103
  v_mul_f32 v104, 0x3eae1a93, v104
  v_mul_f32 v105, 0x3eae1a93, v105
  v_mul_f32 v106, 0x3eae1a93, v106
  v_mul_f32 v107, 0x3eae1a93, v107
  v_cvt_pk_bf16_f32 v104, v104, v105
  v_cvt_pk_bf16_f32 v105, v106, v107
  v_mul_f32 v108, 0x3eae1a93, v108
  v_mul_f32 v109, 0x3eae1a93, v109
  v_mul_f32 v110, 0x3eae1a93, v110
  v_mul_f32 v111, 0x3eae1a93, v111
  v_cvt_pk_bf16_f32 v108, v108, v109
  v_cvt_pk_bf16_f32 v109, v110, v111
  v_cmp_lt_u32 s[32:33], 31, v0
  v_lshlrev_b32 v7, 4, v0
  s_lshl_b32 s38, s28, 10
  s_add_u32 s38, s38, 110592
  v_add_u32 v7, s38, v7
  v_cndmask_b32 v10, v104, v88, s[32:33]
  v_cndmask_b32 v11, v105, v89, s[32:33]
  ds_write_b32 v12, v10
  ds_write_b32 v12, v11 offset:512
  v_mov_b32 v44, v92
  v_mov_b32 v45, v93
  v_mov_b32 v46, v64
  v_mov_b32 v47, v65
  ds_write_b128 v7, v[44:47] offset:12288
  v_mov_b32 v40, v84
  v_mov_b32 v41, v85
  v_cndmask_b32 v42, v88, v80, s[32:33]
  v_cndmask_b32 v43, v89, v81, s[32:33]
  ds_write_b128 v7, v[40:43] offset:8192
  v_mov_b32 v44, v108
  v_mov_b32 v45, v109
  v_cndmask_b32 v46, v80, v104, s[32:33]
  v_cndmask_b32 v47, v81, v105, s[32:33]
  ds_write_b128 v7, v[44:47] offset:4096
  v_mov_b32 v40, v96
  v_mov_b32 v41, v97
  v_mov_b32 v42, v100
  v_mov_b32 v43, v101
  ds_write_b128 v7, v[40:43] offset:0
  s_waitcnt lgkmcnt(0)
  s_barrier
  s_lshl_b32 s38, s28, 12
  s_add_u32 s38, s38, 110592
  v_add_u32 v10, s38, v4
  v_add_u32 v9, 36864, v10
  s_lshl_b32 s38, s28, 9
  s_add_u32 s38, s38, 125952
  v_add_u32 v11, s38, v5
  s_mul_i32 s38, s28, 5120
  s_sub_u32 s38, s38, 1152
  v_add_u32 v12, s38, v6
  ds_read_b128 v[96:99], v9
  ds_read_b32 v112, v11 offset:2048
  ds_read_b128 v[16:19], v10 offset:0
  ds_read_b32 v32, v11 offset:0
  ds_read_b128 v[20:23], v10 offset:1024
  ds_read_b32 v36, v11 offset:128
  ds_read_b128 v[24:27], v10 offset:2048
  ds_read_b32 v40, v11 offset:256
  ds_read_b128 v[28:31], v10 offset:3072
  ds_read_b32 v44, v11 offset:384
  v_and_b32 v7, 31, v0
  v_cmp_gt_u32 vcc, 19, v7
  v_mov_b32 v13, 2146435072
  v_cndmask_b32 v6, v13, v6, vcc
  v_cmp_gt_u32 vcc, 32, v0
  v_mov_b32 v7, 0x3f803f80
  v_cndmask_b32 v5, v13, v5, vcc
  v_mov_b32 v13, 0x00003f80
  v_cndmask_b32 v113, 0, v7, vcc
  v_cndmask_b32 v114, 0, v13, vcc
  v_mov_b32 v115, 0
  v_cndmask_b32 v117, 0, v7, vcc
  v_cndmask_b32 v118, 0, v13, vcc
  v_mov_b32 v119, 0
  v_cndmask_b32 v121, 0, v7, vcc
  v_cndmask_b32 v122, 0, v13, vcc
  v_mov_b32 v123, 0
  v_cndmask_b32 v125, 0, v7, vcc
  v_cndmask_b32 v126, 0, v13, vcc
  v_mov_b32 v127, 0
  v_cmp_gt_u32 vcc, 32, v0
  s_mov_b32 s62, 1
  ds_read_b128 v[100:103], v9 offset:1024
  ds_read_b32 v116, v11 offset:2176
  ds_read_b128 v[104:107], v9 offset:2048
  ds_read_b32 v120, v11 offset:2304
  ds_read_b128 v[108:111], v9 offset:3072
  ds_read_b32 v124, v11 offset:2432
  s_waitcnt lgkmcnt(6)
  ds_read_b128 v[128:131], v12 offset:0
  ds_read_b128 v[132:135], v12 offset:640
  ds_read_b128 v[136:139], v12 offset:1280
  ds_read_b128 v[140:143], v12 offset:1920
  ds_read_b128 v[144:147], v12 offset:2560
  ds_read_b128 v[148:151], v12 offset:3200
  ds_read_b128 v[152:155], v12 offset:3840
  ds_read_b128 v[156:159], v12 offset:4480
  v_cndmask_b32 v32, 0, v32, vcc
  v_mov_b32 v35, 0
  v_cndmask_b32 v36, 0, v36, vcc
  v_mov_b32 v39, 0
  v_cndmask_b32 v40, 0, v40, vcc
  v_mov_b32 v43, 0
  v_cndmask_b32 v44, 0, v44, vcc
  v_mov_b32 v47, 0
  s_lshr_b32 s38, s36, 1
  s_and_b32 s38, s38, 2
  s_lshr_b32 s71, s28, 1
  s_add_u32 s71, s71, s38
  s_lshl_b32 s38, s37, 2
  s_add_u32 s71, s71, s38
  s_and_b32 s38, s28, 1
  s_lshl_b32 s38, s38, 6
  s_mul_i32 s66, s71, 36864
  s_add_u32 s66, s66, s38
  s_lshl_b32 s38, s36, 7
  s_add_u32 s66, s66, s38
  s_and_b32 s38, s36, 1
  s_lshl_b32 s38, s38, 6
  s_mul_i32 s67, s71, 36864
  s_add_u32 s67, s67, s38
  s_add_u32 s67, s67, 1024
  s_and_b32 s38, s36, 2
  s_cmp_eq_u32 s38, s28
  s_cselect_b32 s68, 0, 2146435072
  s_mul_i32 s64, s37, 9728
  s_add_u32 s64, s64, s60
  s_add_u32 s49, s60, 155648
  v_and_b32 v7, 31, v0
  v_mul_u32_u24 v14, 1152, v7
  v_lshrrev_b32 v7, 5, v0
  v_lshl_add_u32 v14, v7, 3, v14
.Latt_maxpass:
  v_mov_b32 v33, 0
  v_mov_b32 v34, 0
  v_mov_b32 v224, 0xff800000
  v_mov_b32 v37, 0
  v_mov_b32 v38, 0
  v_mov_b32 v225, 0xff800000
  v_mov_b32 v41, 0
  v_mov_b32 v42, 0
  v_mov_b32 v226, 0xff800000
  v_mov_b32 v45, 0
  v_mov_b32 v46, 0
  v_mov_b32 v227, 0xff800000
  s_mov_b32 s63, s62
.Latt_maxloop:
  v_mfma_f32_32x32x16_bf16 v[160:175], v[96:99], v[16:19], 0
  v_mfma_f32_32x32x16_bf16 v[176:191], v[96:99], v[20:23], 0
  v_mfma_f32_32x32x16_bf16 v[192:207], v[96:99], v[24:27], 0
  v_mfma_f32_32x32x16_bf16 v[208:223], v[96:99], v[28:31], 0
  v_mfma_f32_32x32x16_bf16 v[160:175], v[112:115], v[32:35], v[160:175]
  v_mfma_f32_32x32x16_bf16 v[176:191], v[112:115], v[36:39], v[176:191]
  v_mfma_f32_32x32x16_bf16 v[192:207], v[112:115], v[40:43], v[192:207]
  v_mfma_f32_32x32x16_bf16 v[208:223], v[112:115], v[44:47], v[208:223]
  s_nop 3
  v_max3_f32 v224, v160, v161, v224
  v_max3_f32 v224, v162, v163, v224
  v_max3_f32 v224, v164, v165, v224
  v_max3_f32 v224, v166, v167, v224
  v_max3_f32 v224, v168, v169, v224
  v_max3_f32 v224, v170, v171, v224
  v_max3_f32 v224, v172, v173, v224
  v_max3_f32 v224, v174, v175, v224
  v_max3_f32 v225, v176, v177, v225
  v_max3_f32 v225, v178, v179, v225
  v_max3_f32 v225, v180, v181, v225
  v_max3_f32 v225, v182, v183, v225
  v_max3_f32 v225, v184, v185, v225
  v_max3_f32 v225, v186, v187, v225
  v_max3_f32 v225, v188, v189, v225
  v_max3_f32 v225, v190, v191, v225
  v_max3_f32 v226, v192, v193, v226
  v_max3_f32 v226, v194, v195, v226
  v_max3_f32 v226, v196, v197, v226
  v_max3_f32 v226, v198, v199, v226
  v_max3_f32 v226, v200, v201, v226
  v_max3_f32 v226, v202, v203, v226
  v_max3_f32 v226, v204, v205, v226
  v_max3_f32 v226, v206, v207, v226
  s_nop 3
  v_max3_f32 v227, v208, v209, v227
  v_max3_f32 v227, v210, v211, v227
  v_max3_f32 v227, v212, v213, v227
  v_max3_f32 v227, v214, v215, v227
  v_max3_f32 v227, v216, v217, v227
  v_max3_f32 v227, v218, v219, v227
  v_max3_f32 v227, v220, v221, v227
  v_max3_f32 v227, v222, v223, v227
  s_sub_u32 s63, s63, 1
  s_cmp_lg_u32 s63, 0
  s_cbranch_scc1 .Latt_maxnext
  s_cmp_lg_u32 s62, 1
  s_cbranch_scc1 .Latt_reload
.Latt_fold:
  v_cmp_gt_u32 vcc, 32, v0
  v_mov_b32 v10, v224
  v_mov_b32 v11, v225
  v_mov_b32 v12, v226
  v_mov_b32 v13, v227
  s_nop 0
  v_permlane32_swap_b32 v10, v224
  v_permlane32_swap_b32 v11, v225
  v_permlane32_swap_b32 v12, v226
  v_permlane32_swap_b32 v13, v227
  v_mov_b32 v88, 0
  v_mov_b32 v89, 0
  v_mov_b32 v90, 0
  v_mov_b32 v91, 0
  v_mov_b32 v92, 0
  v_mov_b32 v93, 0
  v_mov_b32 v94, 0
  v_mov_b32 v95, 0
  v_max_f32 v10, v10, v224
  v_sub_f32 v10, 0, v10
  v_and_b32 v7, 0xffff0000, v10
  v_sub_f32 v10, v10, v7
  v_and_b32 v9, 0xffff0000, v10
  v_sub_f32 v10, v10, v9
  v_lshrrev_b32 v7, 16, v7
  v_or_b32 v7, v7, v9
  v_lshrrev_b32 v10, 16, v10
  v_cndmask_b32 v33, 0, v7, vcc
  v_cndmask_b32 v34, 0, v10, vcc
  s_nop 1
  v_mfma_f32_32x32x16_bf16 v[48:63], v[96:99], v[16:19], 0
  v_mfma_f32_32x32x16_bf16 v[48:63], v[112:115], v[32:35], v[48:63]
  v_max_f32 v11, v11, v225
  v_sub_f32 v11, 0, v11
  v_and_b32 v7, 0xffff0000, v11
  v_sub_f32 v11, v11, v7
  v_and_b32 v9, 0xffff0000, v11
  v_sub_f32 v11, v11, v9
  v_lshrrev_b32 v7, 16, v7
  v_or_b32 v7, v7, v9
  v_lshrrev_b32 v11, 16, v11
  v_cndmask_b32 v37, 0, v7, vcc
  v_cndmask_b32 v38, 0, v11, vcc
  v_max_f32 v12, v12, v226
  v_sub_f32 v12, 0, v12
  v_and_b32 v7, 0xffff0000, v12
  v_sub_f32 v12, v12, v7
  v_and_b32 v9, 0xffff0000, v12
  v_sub_f32 v12, v12, v9
  v_lshrrev_b32 v7, 16, v7
  v_or_b32 v7, v7, v9
  v_lshrrev_b32 v12, 16, v12
  v_cndmask_b32 v41, 0, v7, vcc
  v_cndmask_b32 v42, 0, v12, vcc
  v_max_f32 v13, v13, v227
  v_sub_f32 v13, 0, v13
  v_and_b32 v7, 0xffff0000, v13
  v_sub_f32 v13, v13, v7
  v_and_b32 v9, 0xffff0000, v13
  v_sub_f32 v13, v13, v9
  v_lshrrev_b32 v7, 16, v7
  v_or_b32 v7, v7, v9
  v_lshrrev_b32 v13, 16, v13
  v_cndmask_b32 v45, 0, v7, vcc
  v_cndmask_b32 v46, 0, v13, vcc
  v_mov_b32 v160, 0
  v_mov_b32 v161, 0
  v_mov_b32 v162, 0
  v_mov_b32 v163, 0
  v_mov_b32 v164, 0
  v_mov_b32 v165, 0
  v_mov_b32 v166, 0
  v_mov_b32 v167, 0
  v_mov_b32 v168, 0
  v_mov_b32 v169, 0
  v_mov_b32 v170, 0
  v_mov_b32 v171, 0
  v_mov_b32 v172, 0
  v_mov_b32 v173, 0
  v_mov_b32 v174, 0
  v_mov_b32 v175, 0
  v_mov_b32 v176, 0
  v_mov_b32 v177, 0
  v_mov_b32 v178, 0
  v_mov_b32 v179, 0
  v_mov_b32 v180, 0
  v_mov_b32 v181, 0
  v_mov_b32 v182, 0
  v_mov_b32 v183, 0
  v_mov_b32 v184, 0
  v_mov_b32 v185, 0
  v_mov_b32 v186, 0
  v_mov_b32 v187, 0
  v_mov_b32 v188, 0
  v_mov_b32 v189, 0
  v_mov_b32 v190, 0
  v_mov_b32 v191, 0
  v_mov_b32 v192, 0
  v_mov_b32 v193, 0
  v_mov_b32 v194, 0
  v_mov_b32 v195, 0
  v_mov_b32 v196, 0
  v_mov_b32 v197, 0
  v_mov_b32 v198, 0
  v_mov_b32 v199, 0
  v_mov_b32 v200, 0
  v_mov_b32 v201, 0
  v_mov_b32 v202, 0
  v_mov_b32 v203, 0
  v_mov_b32 v204, 0
  v_mov_b32 v205, 0
  v_mov_b32 v206, 0
  v_mov_b32 v207, 0
  v_mov_b32 v208, 0
  v_mov_b32 v209, 0
  v_mov_b32 v210, 0
  v_mov_b32 v211, 0
  v_mov_b32 v212, 0
  v_mov_b32 v213, 0
  v_mov_b32 v214, 0
  v_mov_b32 v215, 0
  v_mov_b32 v216, 0
  v_mov_b32 v217, 0
  v_mov_b32 v218, 0
  v_mov_b32 v219, 0
  v_mov_b32 v220, 0
  v_mov_b32 v221, 0
  v_mov_b32 v222, 0
  v_mov_b32 v223, 0
  s_add_u32 s61, s64, 7296
  s_mov_b32 s63, 0
  s_waitcnt lgkmcnt(0)
  s_cmp_lg_u32 s62, 1
  s_cbranch_scc1 .Latt_loop
  v_mfma_f32_32x32x16_bf16 v[64:79], v[96:99], v[20:23], 0
  buffer_load_dword v15, v1, s[52:55], s39 offen sc1
  v_exp_f32 v48, v48
  v_exp_f32 v49, v49
  v_exp_f32 v50, v50
  v_exp_f32 v51, v51
  v_mfma_f32_32x32x16_bf16 v[64:79], v[112:115], v[36:39], v[64:79]
  v_exp_f32 v52, v52
  v_exp_f32 v53, v53
  v_exp_f32 v54, v54
  v_exp_f32 v55, v55
  v_cvt_pk_bf16_f32 v80, v48, v49
  v_cvt_pk_bf16_f32 v81, v50, v51
  v_exp_f32 v56, v56
  v_exp_f32 v57, v57
  v_exp_f32 v58, v58
  v_exp_f32 v59, v59
  v_cvt_pk_bf16_f32 v82, v52, v53
  v_cvt_pk_bf16_f32 v83, v54, v55
  v_exp_f32 v60, v60
  v_exp_f32 v61, v61
  v_exp_f32 v62, v62
  v_exp_f32 v63, v63
  v_cvt_pk_bf16_f32 v84, v56, v57
  v_cvt_pk_bf16_f32 v85, v58, v59
  v_cvt_pk_bf16_f32 v86, v60, v61
  v_cvt_pk_bf16_f32 v87, v62, v63
  v_mfma_f32_32x32x16_bf16 v[48:63], v[96:99], v[24:27], 0
  v_exp_f32 v64, v64
  v_exp_f32 v65, v65
  v_exp_f32 v66, v66
  v_exp_f32 v67, v67
  v_mfma_f32_32x32x16_bf16 v[48:63], v[112:115], v[40:43], v[48:63]
  v_exp_f32 v68, v68
  v_exp_f32 v69, v69
  v_exp_f32 v70, v70
  v_exp_f32 v71, v71
  v_cvt_pk_bf16_f32 v88, v64, v65
  v_cvt_pk_bf16_f32 v89, v66, v67
  v_mfma_f32_32x32x16_bf16 v[160:175], v[128:131], v[80:83], v[160:175]
  v_exp_f32 v72, v72
  v_exp_f32 v73, v73
  v_exp_f32 v74, v74
  v_exp_f32 v75, v75
  v_cvt_pk_bf16_f32 v90, v68, v69
  v_cvt_pk_bf16_f32 v91, v70, v71
  v_mfma_f32_32x32x16_bf16 v[160:175], v[132:135], v[84:87], v[160:175]
  v_exp_f32 v76, v76
  v_exp_f32 v77, v77
  v_exp_f32 v78, v78
  v_exp_f32 v79, v79
  v_cvt_pk_bf16_f32 v92, v72, v73
  v_cvt_pk_bf16_f32 v93, v74, v75
  v_cvt_pk_bf16_f32 v94, v76, v77
  v_cvt_pk_bf16_f32 v95, v78, v79
  v_mfma_f32_32x32x16_bf16 v[64:79], v[96:99], v[28:31], 0
  s_add_u32 s61, s61, 2432
  v_exp_f32 v48, v48
  v_exp_f32 v49, v49
  v_exp_f32 v50, v50
  v_exp_f32 v51, v51
  v_mfma_f32_32x32x16_bf16 v[64:79], v[112:115], v[44:47], v[64:79]
  s_cmp_eq_u32 s61, s49
  v_exp_f32 v52, v52
  v_exp_f32 v53, v53
  v_exp_f32 v54, v54
  v_exp_f32 v55, v55
  v_cvt_pk_bf16_f32 v80, v48, v49
  v_cvt_pk_bf16_f32 v81, v50, v51
  v_mfma_f32_32x32x16_bf16 v[176:191], v[128:131], v[88:91], v[176:191]
  s_cselect_b32 s61, s60, s61
  v_exp_f32 v56, v56
  v_exp_f32 v57, v57
  v_exp_f32 v58, v58
  v_exp_f32 v59, v59
  v_cvt_pk_bf16_f32 v82, v52, v53
  v_cvt_pk_bf16_f32 v83, v54, v55
  v_mfma_f32_32x32x16_bf16 v[176:191], v[132:135], v[92:95], v[176:191]
  v_exp_f32 v60, v60
  v_exp_f32 v61, v61
  v_exp_f32 v62, v62
  v_exp_f32 v63, v63
  v_cvt_pk_bf16_f32 v84, v56, v57
  v_cvt_pk_bf16_f32 v85, v58, v59
  v_cvt_pk_bf16_f32 v86, v60, v61
  v_cvt_pk_bf16_f32 v87, v62, v63
  v_mfma_f32_32x32x16_bf16 v[48:63], v[100:103], v[16:19], 0
  v_exp_f32 v64, v64
  v_exp_f32 v65, v65
  v_exp_f32 v66, v66
  v_exp_f32 v67, v67
  v_mfma_f32_32x32x16_bf16 v[48:63], v[116:119], v[32:35], v[48:63]
  v_exp_f32 v68, v68
  v_exp_f32 v69, v69
  v_exp_f32 v70, v70
  v_exp_f32 v71, v71
  v_cvt_pk_bf16_f32 v88, v64, v65
  v_cvt_pk_bf16_f32 v89, v66, v67
  v_mfma_f32_32x32x16_bf16 v[192:207], v[128:131], v[80:83], v[192:207]
  v_exp_f32 v72, v72
  v_exp_f32 v73, v73
  v_exp_f32 v74, v74
  v_exp_f32 v75, v75
  v_cvt_pk_bf16_f32 v90, v68, v69
  v_cvt_pk_bf16_f32 v91, v70, v71
  v_mfma_f32_32x32x16_bf16 v[192:207], v[132:135], v[84:87], v[192:207]
  v_exp_f32 v76, v76
  v_exp_f32 v77, v77
  v_exp_f32 v78, v78
  v_exp_f32 v79, v79
  v_cvt_pk_bf16_f32 v92, v72, v73
  v_cvt_pk_bf16_f32 v93, v74, v75
  v_cvt_pk_bf16_f32 v94, v76, v77
  v_cvt_pk_bf16_f32 v95, v78, v79
  s_cmp_lg_u32 s28, 0
  s_cbranch_scc1 2f
  s_mov_b32 s31, 0x40000
1:
  s_waitcnt vmcnt(0)
  v_readfirstlane_b32 s38, v15
  s_cmp_ge_u32 s38, 16
  s_cbranch_scc1 2f
  s_sleep 2
  buffer_load_dword v15, v1, s[52:55], s39 offen sc1
  s_sub_u32 s31, s31, 1
  s_cbranch_scc0 1b
2:
  s_barrier
  v_mfma_f32_32x32x16_bf16 v[64:79], v[100:103], v[20:23], 0
  buffer_load_dwordx4 v[96:99], v4, s[52:55], s61 offen sc1
  v_exp_f32 v48, v48
  v_exp_f32 v49, v49
  v_exp_f32 v50, v50
  v_exp_f32 v51, v51
  v_mfma_f32_32x32x16_bf16 v[64:79], v[116:119], v[36:39], v[64:79]
  buffer_load_dwordx2 v[232:233], v14, s[56:59], s66 offen offset:0
  v_exp_f32 v52, v52
  v_exp_f32 v53, v53
  v_exp_f32 v54, v54
  v_exp_f32 v55, v55
  v_cvt_pk_bf16_f32 v80, v48, v49
  v_cvt_pk_bf16_f32 v81, v50, v51
  v_mfma_f32_32x32x16_bf16 v[208:223], v[128:131], v[88:91], v[208:223]
  buffer_load_dword v112, v5, s[52:55], s61 offen sc1
  v_exp_f32 v56, v56
  v_exp_f32 v57, v57
  v_exp_f32 v58, v58
  v_exp_f32 v59, v59
  v_cvt_pk_bf16_f32 v82, v52, v53
  v_cvt_pk_bf16_f32 v83, v54, v55
  v_mfma_f32_32x32x16_bf16 v[208:223], v[132:135], v[92:95], v[208:223]
  buffer_load_dwordx2 v[234:235], v14, s[56:59], s66 offen offset:16
  v_exp_f32 v60, v60
  v_exp_f32 v61, v61
  v_exp_f32 v62, v62
  v_exp_f32 v63, v63
  v_cvt_pk_bf16_f32 v84, v56, v57
  v_cvt_pk_bf16_f32 v85, v58, v59
  v_cvt_pk_bf16_f32 v86, v60, v61
  v_cvt_pk_bf16_f32 v87, v62, v63
  v_mfma_f32_32x32x16_bf16 v[48:63], v[100:103], v[24:27], 0
  buffer_load_dwordx4 v[128:131], v6, s[52:55], s61 offen sc1
  v_exp_f32 v64, v64
  v_exp_f32 v65, v65
  v_exp_f32 v66, v66
  v_exp_f32 v67, v67
  v_mfma_f32_32x32x16_bf16 v[48:63], v[116:119], v[40:43], v[48:63]
  buffer_load_dwordx2 v[236:237], v14, s[56:59], s66 offen offset:32
  v_exp_f32 v68, v68
  v_exp_f32 v69, v69
  v_exp_f32 v70, v70
  v_exp_f32 v71, v71
  v_cvt_pk_bf16_f32 v88, v64, v65
  v_cvt_pk_bf16_f32 v89, v66, v67
  v_mfma_f32_32x32x16_bf16 v[160:175], v[136:139], v[80:83], v[160:175]
  buffer_load_dwordx4 v[132:135], v6, s[52:55], s61 offen offset:640 sc1
  v_exp_f32 v72, v72
  v_exp_f32 v73, v73
  v_exp_f32 v74, v74
  v_exp_f32 v75, v75
  v_cvt_pk_bf16_f32 v90, v68, v69
  v_cvt_pk_bf16_f32 v91, v70, v71
  v_mfma_f32_32x32x16_bf16 v[160:175], v[140:143], v[84:87], v[160:175]
  buffer_load_dwordx2 v[238:239], v14, s[56:59], s66 offen offset:48
  v_exp_f32 v76, v76
  v_exp_f32 v77, v77
  v_exp_f32 v78, v78
  v_exp_f32 v79, v79
  v_cvt_pk_bf16_f32 v92, v72, v73
  v_cvt_pk_bf16_f32 v93, v74, v75
  v_cvt_pk_bf16_f32 v94, v76, v77
  v_cvt_pk_bf16_f32 v95, v78, v79
  v_mfma_f32_32x32x16_bf16 v[64:79], v[100:103], v[28:31], 0
  s_add_u32 s61, s61, 2432
  v_exp_f32 v48, v48
  v_exp_f32 v49, v49
  v_exp_f32 v50, v50
  v_exp_f32 v51, v51
  v_mfma_f32_32x32x16_bf16 v[64:79], v[116:119], v[44:47], v[64:79]
  buffer_load_dwordx2 v[240:241], v14, s[56:59], s67 offen offset:0
  v_exp_f32 v52, v52
  v_exp_f32 v53, v53
  v_exp_f32 v54, v54
  v_exp_f32 v55, v55
  v_cvt_pk_bf16_f32 v80, v48, v49
  v_cvt_pk_bf16_f32 v81, v50, v51
  v_mfma_f32_32x32x16_bf16 v[176:191], v[136:139], v[88:91], v[176:191]
  buffer_load_dwordx2 v[242:243], v14, s[56:59], s67 offen offset:16
  v_exp_f32 v56, v56
  v_exp_f32 v57, v57
  v_exp_f32 v58, v58
  v_exp_f32 v59, v59
  v_cvt_pk_bf16_f32 v82, v52, v53
  v_cvt_pk_bf16_f32 v83, v54, v55
  v_mfma_f32_32x32x16_bf16 v[176:191], v[140:143], v[92:95], v[176:191]
  buffer_load_dwordx2 v[244:245], v14, s[56:59], s67 offen offset:32
  v_exp_f32 v60, v60
  v_exp_f32 v61, v61
  v_exp_f32 v62, v62
  v_exp_f32 v63, v63
  v_cvt_pk_bf16_f32 v84, v56, v57
  v_cvt_pk_bf16_f32 v85, v58, v59
  v_cvt_pk_bf16_f32 v86, v60, v61
  v_cvt_pk_bf16_f32 v87, v62, v63
  v_mfma_f32_32x32x16_bf16 v[48:63], v[104:107], v[16:19], 0
  buffer_load_dwordx2 v[246:247], v14, s[56:59], s67 offen offset:48
  v_exp_f32 v64, v64
  v_exp_f32 v65, v65
  v_exp_f32 v66, v66
  v_exp_f32 v67, v67
  v_mfma_f32_32x32x16_bf16 v[48:63], v[120:123], v[32:35], v[48:63]
  v_exp_f32 v68, v68
  v_exp_f32 v69, v69
  v_exp_f32 v70, v70
  v_exp_f32 v71, v71
  v_cvt_pk_bf16_f32 v88, v64, v65
  v_cvt_pk_bf16_f32 v89, v66, v67
  v_mfma_f32_32x32x16_bf16 v[192:207], v[136:139], v[80:83], v[192:207]
  v_exp_f32 v72, v72
  v_exp_f32 v73, v73
  v_exp_f32 v74, v74
  v_exp_f32 v75, v75
  v_cvt_pk_bf16_f32 v90, v68, v69
  v_cvt_pk_bf16_f32 v91, v70, v71
  v_mfma_f32_32x32x16_bf16 v[192:207], v[140:143], v[84:87], v[192:207]
  v_exp_f32 v76, v76
  v_exp_f32 v77, v77
  v_exp_f32 v78, v78
  v_exp_f32 v79, v79
  v_cvt_pk_bf16_f32 v92, v72, v73
  v_cvt_pk_bf16_f32 v93, v74, v75
  v_cvt_pk_bf16_f32 v94, v76, v77
  v_cvt_pk_bf16_f32 v95, v78, v79
  v_mfma_f32_32x32x16_bf16 v[64:79], v[104:107], v[20:23], 0
  buffer_load_dwordx4 v[100:103], v4, s[52:55], s61 offen sc1
  v_exp_f32 v48, v48
  v_exp_f32 v49, v49
  v_exp_f32 v50, v50
  v_exp_f32 v51, v51
  v_mfma_f32_32x32x16_bf16 v[64:79], v[120:123], v[36:39], v[64:79]
  v_exp_f32 v52, v52
  v_exp_f32 v53, v53
  v_exp_f32 v54, v54
  v_exp_f32 v55, v55
  v_cvt_pk_bf16_f32 v80, v48, v49
  v_cvt_pk_bf16_f32 v81, v50, v51
  v_mfma_f32_32x32x16_bf16 v[208:223], v[136:139], v[88:91], v[208:223]
  buffer_load_dword v116, v5, s[52:55], s61 offen sc1
  v_exp_f32 v56, v56
  v_exp_f32 v57, v57
  v_exp_f32 v58, v58
  v_exp_f32 v59, v59
  v_cvt_pk_bf16_f32 v82, v52, v53
  v_cvt_pk_bf16_f32 v83, v54, v55
  v_mfma_f32_32x32x16_bf16 v[208:223], v[140:143], v[92:95], v[208:223]
  v_exp_f32 v60, v60
  v_exp_f32 v61, v61
  v_exp_f32 v62, v62
  v_exp_f32 v63, v63
  v_cvt_pk_bf16_f32 v84, v56, v57
  v_cvt_pk_bf16_f32 v85, v58, v59
  v_cvt_pk_bf16_f32 v86, v60, v61
  v_cvt_pk_bf16_f32 v87, v62, v63
  v_mfma_f32_32x32x16_bf16 v[48:63], v[104:107], v[24:27], 0
  buffer_load_dwordx4 v[136:139], v6, s[52:55], s61 offen sc1
  v_exp_f32 v64, v64
  v_exp_f32 v65, v65
  v_exp_f32 v66, v66
  v_exp_f32 v67, v67
  v_mfma_f32_32x32x16_bf16 v[48:63], v[120:123], v[40:43], v[48:63]
  v_exp_f32 v68, v68
  v_exp_f32 v69, v69
  v_exp_f32 v70, v70
  v_exp_f32 v71, v71
  v_cvt_pk_bf16_f32 v88, v64, v65
  v_cvt_pk_bf16_f32 v89, v66, v67
  v_mfma_f32_32x32x16_bf16 v[160:175], v[144:147], v[80:83], v[160:175]
  buffer_load_dwordx4 v[140:143], v6, s[52:55], s61 offen offset:640 sc1
  v_exp_f32 v72, v72
  v_exp_f32 v73, v73
  v_exp_f32 v74, v74
  v_exp_f32 v75, v75
  v_cvt_pk_bf16_f32 v90, v68, v69
  v_cvt_pk_bf16_f32 v91, v70, v71
  v_mfma_f32_32x32x16_bf16 v[160:175], v[148:151], v[84:87], v[160:175]
  v_exp_f32 v76, v76
  v_exp_f32 v77, v77
  v_exp_f32 v78, v78
  v_exp_f32 v79, v79
  v_cvt_pk_bf16_f32 v92, v72, v73
  v_cvt_pk_bf16_f32 v93, v74, v75
  v_cvt_pk_bf16_f32 v94, v76, v77
  v_cvt_pk_bf16_f32 v95, v78, v79
  v_mfma_f32_32x32x16_bf16 v[64:79], v[104:107], v[28:31], 0
  s_add_u32 s61, s61, 2432
  v_exp_f32 v48, v48
  v_exp_f32 v49, v49
  v_exp_f32 v50, v50
  v_exp_f32 v51, v51
  v_mfma_f32_32x32x16_bf16 v[64:79], v[120:123], v[44:47], v[64:79]
  v_exp_f32 v52, v52
  v_exp_f32 v53, v53
  v_exp_f32 v54, v54
  v_exp_f32 v55, v55
  v_cvt_pk_bf16_f32 v80, v48, v49
  v_cvt_pk_bf16_f32 v81, v50, v51
  v_mfma_f32_32x32x16_bf16 v[176:191], v[144:147], v[88:91], v[176:191]
  v_exp_f32 v56, v56
  v_exp_f32 v57, v57
  v_exp_f32 v58, v58
  v_exp_f32 v59, v59
  v_cvt_pk_bf16_f32 v82, v52, v53
  v_cvt_pk_bf16_f32 v83, v54, v55
  v_mfma_f32_32x32x16_bf16 v[176:191], v[148:151], v[92:95], v[176:191]
  v_exp_f32 v60, v60
  v_exp_f32 v61, v61
  v_exp_f32 v62, v62
  v_exp_f32 v63, v63
  v_cvt_pk_bf16_f32 v84, v56, v57
  v_cvt_pk_bf16_f32 v85, v58, v59
  v_cvt_pk_bf16_f32 v86, v60, v61
  v_cvt_pk_bf16_f32 v87, v62, v63
  v_mfma_f32_32x32x16_bf16 v[48:63], v[108:111], v[16:19], 0
  v_exp_f32 v64, v64
  v_exp_f32 v65, v65
  v_exp_f32 v66, v66
  v_exp_f32 v67, v67
  v_mfma_f32_32x32x16_bf16 v[48:63], v[124:127], v[32:35], v[48:63]
  v_exp_f32 v68, v68
  v_exp_f32 v69, v69
  v_exp_f32 v70, v70
  v_exp_f32 v71, v71
  v_cvt_pk_bf16_f32 v88, v64, v65
  v_cvt_pk_bf16_f32 v89, v66, v67
  v_mfma_f32_32x32x16_bf16 v[192:207], v[144:147], v[80:83], v[192:207]
  v_exp_f32 v72, v72
  v_exp_f32 v73, v73
  v_exp_f32 v74, v74
  v_exp_f32 v75, v75
  v_cvt_pk_bf16_f32 v90, v68, v69
  v_cvt_pk_bf16_f32 v91, v70, v71
  v_mfma_f32_32x32x16_bf16 v[192:207], v[148:151], v[84:87], v[192:207]
  v_exp_f32 v76, v76
  v_exp_f32 v77, v77
  v_exp_f32 v78, v78
  v_exp_f32 v79, v79
  v_cvt_pk_bf16_f32 v92, v72, v73
  v_cvt_pk_bf16_f32 v93, v74, v75
  v_cvt_pk_bf16_f32 v94, v76, v77
  v_cvt_pk_bf16_f32 v95, v78, v79
  v_mfma_f32_32x32x16_bf16 v[64:79], v[108:111], v[20:23], 0
  buffer_load_dwordx4 v[104:107], v4, s[52:55], s61 offen sc1
  v_exp_f32 v48, v48
  v_exp_f32 v49, v49
  v_exp_f32 v50, v50
  v_exp_f32 v51, v51
  v_mfma_f32_32x32x16_bf16 v[64:79], v[124:127], v[36:39], v[64:79]
  v_exp_f32 v52, v52
  v_exp_f32 v53, v53
  v_exp_f32 v54, v54
  v_exp_f32 v55, v55
  v_cvt_pk_bf16_f32 v80, v48, v49
  v_cvt_pk_bf16_f32 v81, v50, v51
  v_mfma_f32_32x32x16_bf16 v[208:223], v[144:147], v[88:91], v[208:223]
  buffer_load_dword v120, v5, s[52:55], s61 offen sc1
  v_exp_f32 v56, v56
  v_exp_f32 v57, v57
  v_exp_f32 v58, v58
  v_exp_f32 v59, v59
  v_cvt_pk_bf16_f32 v82, v52, v53
  v_cvt_pk_bf16_f32 v83, v54, v55
  v_mfma_f32_32x32x16_bf16 v[208:223], v[148:151], v[92:95], v[208:223]
  v_exp_f32 v60, v60
  v_exp_f32 v61, v61
  v_exp_f32 v62, v62
  v_exp_f32 v63, v63
  v_cvt_pk_bf16_f32 v84, v56, v57
  v_cvt_pk_bf16_f32 v85, v58, v59
  v_cvt_pk_bf16_f32 v86, v60, v61
  v_cvt_pk_bf16_f32 v87, v62, v63
  v_mfma_f32_32x32x16_bf16 v[48:63], v[108:111], v[24:27], 0
  buffer_load_dwordx4 v[144:147], v6, s[52:55], s61 offen sc1
  v_exp_f32 v64, v64
  v_exp_f32 v65, v65
  v_exp_f32 v66, v66
  v_exp_f32 v67, v67
  v_mfma_f32_32x32x16_bf16 v[48:63], v[124:127], v[40:43], v[48:63]
  v_exp_f32 v68, v68
  v_exp_f32 v69, v69
  v_exp_f32 v70, v70
  v_exp_f32 v71, v71
  v_cvt_pk_bf16_f32 v88, v64, v65
  v_cvt_pk_bf16_f32 v89, v66, v67
  v_mfma_f32_32x32x16_bf16 v[160:175], v[152:155], v[80:83], v[160:175]
  buffer_load_dwordx4 v[148:151], v6, s[52:55], s61 offen offset:640 sc1
  v_exp_f32 v72, v72
  v_exp_f32 v73, v73
  v_exp_f32 v74, v74
  v_exp_f32 v75, v75
  v_cvt_pk_bf16_f32 v90, v68, v69
  v_cvt_pk_bf16_f32 v91, v70, v71
  v_mfma_f32_32x32x16_bf16 v[160:175], v[156:159], v[84:87], v[160:175]
  v_exp_f32 v76, v76
  v_exp_f32 v77, v77
  v_exp_f32 v78, v78
  v_exp_f32 v79, v79
  v_cvt_pk_bf16_f32 v92, v72, v73
  v_cvt_pk_bf16_f32 v93, v74, v75
  v_cvt_pk_bf16_f32 v94, v76, v77
  v_cvt_pk_bf16_f32 v95, v78, v79
  v_mfma_f32_32x32x16_bf16 v[64:79], v[108:111], v[28:31], 0
  s_add_u32 s61, s61, 2432
  v_exp_f32 v48, v48
  v_exp_f32 v49, v49
  v_exp_f32 v50, v50
  v_exp_f32 v51, v51
  v_mfma_f32_32x32x16_bf16 v[64:79], v[124:127], v[44:47], v[64:79]
  v_exp_f32 v52, v52
  v_exp_f32 v53, v53
  v_exp_f32 v54, v54
  v_exp_f32 v55, v55
  v_cvt_pk_bf16_f32 v80, v48, v49
  v_cvt_pk_bf16_f32 v81, v50, v51
  v_mfma_f32_32x32x16_bf16 v[176:191], v[152:155], v[88:91], v[176:191]
  v_exp_f32 v56, v56
  v_exp_f32 v57, v57
  v_exp_f32 v58, v58
  v_exp_f32 v59, v59
  v_cvt_pk_bf16_f32 v82, v52, v53
  v_cvt_pk_bf16_f32 v83, v54, v55
  v_mfma_f32_32x32x16_bf16 v[176:191], v[156:159], v[92:95], v[176:191]
  s_waitcnt vmcnt(13)
  v_exp_f32 v60, v60
  v_exp_f32 v61, v61
  v_exp_f32 v62, v62
  v_exp_f32 v63, v63
  v_cvt_pk_bf16_f32 v84, v56, v57
  v_cvt_pk_bf16_f32 v85, v58, v59
  v_cvt_pk_bf16_f32 v86, v60, v61
  v_cvt_pk_bf16_f32 v87, v62, v63
  v_mfma_f32_32x32x16_bf16 v[48:63], v[96:99], v[16:19], 0
  s_add_u32 s63, s63, 1
  v_exp_f32 v64, v64
  v_exp_f32 v65, v65
  v_exp_f32 v66, v66
  v_exp_f32 v67, v67
  v_mfma_f32_32x32x16_bf16 v[48:63], v[112:115], v[32:35], v[48:63]
  v_exp_f32 v68, v68
  v_exp_f32 v69, v69
  v_exp_f32 v70, v70
  v_exp_f32 v71, v71
  v_cvt_pk_bf16_f32 v88, v64, v65
  v_cvt_pk_bf16_f32 v89, v66, v67
  v_mfma_f32_32x32x16_bf16 v[192:207], v[152:155], v[80:83], v[192:207]
  v_exp_f32 v72, v72
  v_exp_f32 v73, v73
  v_exp_f32 v74, v74
  v_exp_f32 v75, v75
  v_cvt_pk_bf16_f32 v90, v68, v69
  v_cvt_pk_bf16_f32 v91, v70, v71
  v_mfma_f32_32x32x16_bf16 v[192:207], v[156:159], v[84:87], v[192:207]
  v_exp_f32 v76, v76
  v_exp_f32 v77, v77
  v_exp_f32 v78, v78
  v_exp_f32 v79, v79
  v_cvt_pk_bf16_f32 v92, v72, v73
  v_cvt_pk_bf16_f32 v93, v74, v75
  v_cvt_pk_bf16_f32 v94, v76, v77
  v_cvt_pk_bf16_f32 v95, v78, v79
.Latt_loop:
  v_mfma_f32_32x32x16_bf16 v[64:79], v[96:99], v[20:23], 0
  buffer_load_dwordx4 v[108:111], v4, s[52:55], s61 offen sc1
  v_exp_f32 v48, v48
  v_exp_f32 v49, v49
  v_exp_f32 v50, v50
  v_exp_f32 v51, v51
  v_mfma_f32_32x32x16_bf16 v[64:79], v[112:115], v[36:39], v[64:79]
  v_exp_f32 v52, v52
  v_exp_f32 v53, v53
  v_exp_f32 v54, v54
  v_exp_f32 v55, v55
  v_cvt_pk_bf16_f32 v80, v48, v49
  v_cvt_pk_bf16_f32 v81, v50, v51
  v_mfma_f32_32x32x16_bf16 v[208:223], v[152:155], v[88:91], v[208:223]
  buffer_load_dword v124, v5, s[52:55], s61 offen sc1
  v_exp_f32 v56, v56
  v_exp_f32 v57, v57
  v_exp_f32 v58, v58
  v_exp_f32 v59, v59
  v_cvt_pk_bf16_f32 v82, v52, v53
  v_cvt_pk_bf16_f32 v83, v54, v55
  v_mfma_f32_32x32x16_bf16 v[208:223], v[156:159], v[92:95], v[208:223]
  v_exp_f32 v60, v60
  v_exp_f32 v61, v61
  v_exp_f32 v62, v62
  v_exp_f32 v63, v63
  v_cvt_pk_bf16_f32 v84, v56, v57
  v_cvt_pk_bf16_f32 v85, v58, v59
  v_cvt_pk_bf16_f32 v86, v60, v61
  v_cvt_pk_bf16_f32 v87, v62, v63
  v_mfma_f32_32x32x16_bf16 v[48:63], v[96:99], v[24:27], 0
  buffer_load_dwordx4 v[152:155], v6, s[52:55], s61 offen sc1
  v_exp_f32 v64, v64
  v_exp_f32 v65, v65
  v_exp_f32 v66, v66
  v_exp_f32 v67, v67
  v_mfma_f32_32x32x16_bf16 v[48:63], v[112:115], v[40:43], v[48:63]
  v_exp_f32 v68, v68
  v_exp_f32 v69, v69
  v_exp_f32 v70, v70
  v_exp_f32 v71, v71
  v_cvt_pk_bf16_f32 v88, v64, v65
  v_cvt_pk_bf16_f32 v89, v66, v67
  v_mfma_f32_32x32x16_bf16 v[160:175], v[128:131], v[80:83], v[160:175]
  buffer_load_dwordx4 v[156:159], v6, s[52:55], s61 offen offset:640 sc1
  v_exp_f32 v72, v72
  v_exp_f32 v73, v73
  v_exp_f32 v74, v74
  v_exp_f32 v75, v75
  v_cvt_pk_bf16_f32 v90, v68, v69
  v_cvt_pk_bf16_f32 v91, v70, v71
  v_mfma_f32_32x32x16_bf16 v[160:175], v[132:135], v[84:87], v[160:175]
  v_exp_f32 v76, v76
  v_exp_f32 v77, v77
  v_exp_f32 v78, v78
  v_exp_f32 v79, v79
  v_cvt_pk_bf16_f32 v92, v72, v73
  v_cvt_pk_bf16_f32 v93, v74, v75
  v_cvt_pk_bf16_f32 v94, v76, v77
  v_cvt_pk_bf16_f32 v95, v78, v79
  v_mfma_f32_32x32x16_bf16 v[64:79], v[96:99], v[28:31], 0
  s_add_u32 s61, s61, 2432
  v_exp_f32 v48, v48
  v_exp_f32 v49, v49
  v_exp_f32 v50, v50
  v_exp_f32 v51, v51
  v_mfma_f32_32x32x16_bf16 v[64:79], v[112:115], v[44:47], v[64:79]
  s_cmp_eq_u32 s61, s49
  v_exp_f32 v52, v52
  v_exp_f32 v53, v53
  v_exp_f32 v54, v54
  v_exp_f32 v55, v55
  v_cvt_pk_bf16_f32 v80, v48, v49
  v_cvt_pk_bf16_f32 v81, v50, v51
  v_mfma_f32_32x32x16_bf16 v[176:191], v[128:131], v[88:91], v[176:191]
  s_cselect_b32 s61, s60, s61
  v_exp_f32 v56, v56
  v_exp_f32 v57, v57
  v_exp_f32 v58, v58
  v_exp_f32 v59, v59
  v_cvt_pk_bf16_f32 v82, v52, v53
  v_cvt_pk_bf16_f32 v83, v54, v55
  v_mfma_f32_32x32x16_bf16 v[176:191], v[132:135], v[92:95], v[176:191]
  s_waitcnt vmcnt(8)
  v_exp_f32 v60, v60
  v_exp_f32 v61, v61
  v_exp_f32 v62, v62
  v_exp_f32 v63, v63
  v_cvt_pk_bf16_f32 v84, v56, v57
  v_cvt_pk_bf16_f32 v85, v58, v59
  v_cvt_pk_bf16_f32 v86, v60, v61
  v_cvt_pk_bf16_f32 v87, v62, v63
  v_mfma_f32_32x32x16_bf16 v[48:63], v[100:103], v[16:19], 0
  v_exp_f32 v64, v64
  v_exp_f32 v65, v65
  v_exp_f32 v66, v66
  v_exp_f32 v67, v67
  v_mfma_f32_32x32x16_bf16 v[48:63], v[116:119], v[32:35], v[48:63]
  v_exp_f32 v68, v68
  v_exp_f32 v69, v69
  v_exp_f32 v70, v70
  v_exp_f32 v71, v71
  v_cvt_pk_bf16_f32 v88, v64, v65
  v_cvt_pk_bf16_f32 v89, v66, v67
  v_mfma_f32_32x32x16_bf16 v[192:207], v[128:131], v[80:83], v[192:207]
  v_exp_f32 v72, v72
  v_exp_f32 v73, v73
  v_exp_f32 v74, v74
  v_exp_f32 v75, v75
  v_cvt_pk_bf16_f32 v90, v68, v69
  v_cvt_pk_bf16_f32 v91, v70, v71
  v_mfma_f32_32x32x16_bf16 v[192:207], v[132:135], v[84:87], v[192:207]
  v_exp_f32 v76, v76
  v_exp_f32 v77, v77
  v_exp_f32 v78, v78
  v_exp_f32 v79, v79
  v_cvt_pk_bf16_f32 v92, v72, v73
  v_cvt_pk_bf16_f32 v93, v74, v75
  v_cvt_pk_bf16_f32 v94, v76, v77
  v_cvt_pk_bf16_f32 v95, v78, v79
  v_mfma_f32_32x32x16_bf16 v[64:79], v[100:103], v[20:23], 0
  buffer_load_dwordx4 v[96:99], v4, s[52:55], s61 offen sc1
  v_exp_f32 v48, v48
  v_exp_f32 v49, v49
  v_exp_f32 v50, v50
  v_exp_f32 v51, v51
  v_mfma_f32_32x32x16_bf16 v[64:79], v[116:119], v[36:39], v[64:79]
  v_exp_f32 v52, v52
  v_exp_f32 v53, v53
  v_exp_f32 v54, v54
  v_exp_f32 v55, v55
  v_cvt_pk_bf16_f32 v80, v48, v49
  v_cvt_pk_bf16_f32 v81, v50, v51
  v_mfma_f32_32x32x16_bf16 v[208:223], v[128:131], v[88:91], v[208:223]
  buffer_load_dword v112, v5, s[52:55], s61 offen sc1
  v_exp_f32 v56, v56
  v_exp_f32 v57, v57
  v_exp_f32 v58, v58
  v_exp_f32 v59, v59
  v_cvt_pk_bf16_f32 v82, v52, v53
  v_cvt_pk_bf16_f32 v83, v54, v55
  v_mfma_f32_32x32x16_bf16 v[208:223], v[132:135], v[92:95], v[208:223]
  v_exp_f32 v60, v60
  v_exp_f32 v61, v61
  v_exp_f32 v62, v62
  v_exp_f32 v63, v63
  v_cvt_pk_bf16_f32 v84, v56, v57
  v_cvt_pk_bf16_f32 v85, v58, v59
  v_cvt_pk_bf16_f32 v86, v60, v61
  v_cvt_pk_bf16_f32 v87, v62, v63
  v_mfma_f32_32x32x16_bf16 v[48:63], v[100:103], v[24:27], 0
  buffer_load_dwordx4 v[128:131], v6, s[52:55], s61 offen sc1
  v_exp_f32 v64, v64
  v_exp_f32 v65, v65
  v_exp_f32 v66, v66
  v_exp_f32 v67, v67
  v_mfma_f32_32x32x16_bf16 v[48:63], v[116:119], v[40:43], v[48:63]
  v_exp_f32 v68, v68
  v_exp_f32 v69, v69
  v_exp_f32 v70, v70
  v_exp_f32 v71, v71
  v_cvt_pk_bf16_f32 v88, v64, v65
  v_cvt_pk_bf16_f32 v89, v66, v67
  v_mfma_f32_32x32x16_bf16 v[160:175], v[136:139], v[80:83], v[160:175]
  buffer_load_dwordx4 v[132:135], v6, s[52:55], s61 offen offset:640 sc1
  v_exp_f32 v72, v72
  v_exp_f32 v73, v73
  v_exp_f32 v74, v74
  v_exp_f32 v75, v75
  v_cvt_pk_bf16_f32 v90, v68, v69
  v_cvt_pk_bf16_f32 v91, v70, v71
  v_mfma_f32_32x32x16_bf16 v[160:175], v[140:143], v[84:87], v[160:175]
  v_exp_f32 v76, v76
  v_exp_f32 v77, v77
  v_exp_f32 v78, v78
  v_exp_f32 v79, v79
  v_cvt_pk_bf16_f32 v92, v72, v73
  v_cvt_pk_bf16_f32 v93, v74, v75
  v_cvt_pk_bf16_f32 v94, v76, v77
  v_cvt_pk_bf16_f32 v95, v78, v79
  v_mfma_f32_32x32x16_bf16 v[64:79], v[100:103], v[28:31], 0
  s_add_u32 s61, s61, 2432
  v_exp_f32 v48, v48
  v_exp_f32 v49, v49
  v_exp_f32 v50, v50
  v_exp_f32 v51, v51
  v_mfma_f32_32x32x16_bf16 v[64:79], v[116:119], v[44:47], v[64:79]
  v_exp_f32 v52, v52
  v_exp_f32 v53, v53
  v_exp_f32 v54, v54
  v_exp_f32 v55, v55
  v_cvt_pk_bf16_f32 v80, v48, v49
  v_cvt_pk_bf16_f32 v81, v50, v51
  v_mfma_f32_32x32x16_bf16 v[176:191], v[136:139], v[88:91], v[176:191]
  v_exp_f32 v56, v56
  v_exp_f32 v57, v57
  v_exp_f32 v58, v58
  v_exp_f32 v59, v59
  v_cvt_pk_bf16_f32 v82, v52, v53
  v_cvt_pk_bf16_f32 v83, v54, v55
  v_mfma_f32_32x32x16_bf16 v[176:191], v[140:143], v[92:95], v[176:191]
  s_waitcnt vmcnt(8)
  v_exp_f32 v60, v60
  v_exp_f32 v61, v61
  v_exp_f32 v62, v62
  v_exp_f32 v63, v63
  v_cvt_pk_bf16_f32 v84, v56, v57
  v_cvt_pk_bf16_f32 v85, v58, v59
  v_cvt_pk_bf16_f32 v86, v60, v61
  v_cvt_pk_bf16_f32 v87, v62, v63
  v_mfma_f32_32x32x16_bf16 v[48:63], v[104:107], v[16:19], 0
  v_exp_f32 v64, v64
  v_exp_f32 v65, v65
  v_exp_f32 v66, v66
  v_exp_f32 v67, v67
  v_mfma_f32_32x32x16_bf16 v[48:63], v[120:123], v[32:35], v[48:63]
  v_exp_f32 v68, v68
  v_exp_f32 v69, v69
  v_exp_f32 v70, v70
  v_exp_f32 v71, v71
  v_cvt_pk_bf16_f32 v88, v64, v65
  v_cvt_pk_bf16_f32 v89, v66, v67
  v_mfma_f32_32x32x16_bf16 v[192:207], v[136:139], v[80:83], v[192:207]
  v_exp_f32 v72, v72
  v_exp_f32 v73, v73
  v_exp_f32 v74, v74
  v_exp_f32 v75, v75
  v_cvt_pk_bf16_f32 v90, v68, v69
  v_cvt_pk_bf16_f32 v91, v70, v71
  v_mfma_f32_32x32x16_bf16 v[192:207], v[140:143], v[84:87], v[192:207]
  v_exp_f32 v76, v76
  v_exp_f32 v77, v77
  v_exp_f32 v78, v78
  v_exp_f32 v79, v79
  v_cvt_pk_bf16_f32 v92, v72, v73
  v_cvt_pk_bf16_f32 v93, v74, v75
  v_cvt_pk_bf16_f32 v94, v76, v77
  v_cvt_pk_bf16_f32 v95, v78, v79
  v_mfma_f32_32x32x16_bf16 v[64:79], v[104:107], v[20:23], 0
  buffer_load_dwordx4 v[100:103], v4, s[52:55], s61 offen sc1
  v_exp_f32 v48, v48
  v_exp_f32 v49, v49
  v_exp_f32 v50, v50
  v_exp_f32 v51, v51
  v_mfma_f32_32x32x16_bf16 v[64:79], v[120:123], v[36:39], v[64:79]
  v_exp_f32 v52, v52
  v_exp_f32 v53, v53
  v_exp_f32 v54, v54
  v_exp_f32 v55, v55
  v_cvt_pk_bf16_f32 v80, v48, v49
  v_cvt_pk_bf16_f32 v81, v50, v51
  v_mfma_f32_32x32x16_bf16 v[208:223], v[136:139], v[88:91], v[208:223]
  buffer_load_dword v116, v5, s[52:55], s61 offen sc1
  v_exp_f32 v56, v56
  v_exp_f32 v57, v57
  v_exp_f32 v58, v58
  v_exp_f32 v59, v59
  v_cvt_pk_bf16_f32 v82, v52, v53
  v_cvt_pk_bf16_f32 v83, v54, v55
  v_mfma_f32_32x32x16_bf16 v[208:223], v[140:143], v[92:95], v[208:223]
  v_exp_f32 v60, v60
  v_exp_f32 v61, v61
  v_exp_f32 v62, v62
  v_exp_f32 v63, v63
  v_cvt_pk_bf16_f32 v84, v56, v57
  v_cvt_pk_bf16_f32 v85, v58, v59
  v_cvt_pk_bf16_f32 v86, v60, v61
  v_cvt_pk_bf16_f32 v87, v62, v63
  v_mfma_f32_32x32x16_bf16 v[48:63], v[104:107], v[24:27], 0
  buffer_load_dwordx4 v[136:139], v6, s[52:55], s61 offen sc1
  v_exp_f32 v64, v64
  v_exp_f32 v65, v65
  v_exp_f32 v66, v66
  v_exp_f32 v67, v67
  v_mfma_f32_32x32x16_bf16 v[48:63], v[120:123], v[40:43], v[48:63]
  v_exp_f32 v68, v68
  v_exp_f32 v69, v69
  v_exp_f32 v70, v70
  v_exp_f32 v71, v71
  v_cvt_pk_bf16_f32 v88, v64, v65
  v_cvt_pk_bf16_f32 v89, v66, v67
  v_mfma_f32_32x32x16_bf16 v[160:175], v[144:147], v[80:83], v[160:175]
  buffer_load_dwordx4 v[140:143], v6, s[52:55], s61 offen offset:640 sc1
  v_exp_f32 v72, v72
  v_exp_f32 v73, v73
  v_exp_f32 v74, v74
  v_exp_f32 v75, v75
  v_cvt_pk_bf16_f32 v90, v68, v69
  v_cvt_pk_bf16_f32 v91, v70, v71
  v_mfma_f32_32x32x16_bf16 v[160:175], v[148:151], v[84:87], v[160:175]
  v_exp_f32 v76, v76
  v_exp_f32 v77, v77
  v_exp_f32 v78, v78
  v_exp_f32 v79, v79
  v_cvt_pk_bf16_f32 v92, v72, v73
  v_cvt_pk_bf16_f32 v93, v74, v75
  v_cvt_pk_bf16_f32 v94, v76, v77
  v_cvt_pk_bf16_f32 v95, v78, v79
  v_mfma_f32_32x32x16_bf16 v[64:79], v[104:107], v[28:31], 0
  s_add_u32 s61, s61, 2432
  v_exp_f32 v48, v48
  v_exp_f32 v49, v49
  v_exp_f32 v50, v50
  v_exp_f32 v51, v51
  v_mfma_f32_32x32x16_bf16 v[64:79], v[120:123], v[44:47], v[64:79]
  v_exp_f32 v52, v52
  v_exp_f32 v53, v53
  v_exp_f32 v54, v54
  v_exp_f32 v55, v55
  v_cvt_pk_bf16_f32 v80, v48, v49
  v_cvt_pk_bf16_f32 v81, v50, v51
  v_mfma_f32_32x32x16_bf16 v[176:191], v[144:147], v[88:91], v[176:191]
  v_exp_f32 v56, v56
  v_exp_f32 v57, v57
  v_exp_f32 v58, v58
  v_exp_f32 v59, v59
  v_cvt_pk_bf16_f32 v82, v52, v53
  v_cvt_pk_bf16_f32 v83, v54, v55
  v_mfma_f32_32x32x16_bf16 v[176:191], v[148:151], v[92:95], v[176:191]
  s_waitcnt vmcnt(8)
  v_exp_f32 v60, v60
  v_exp_f32 v61, v61
  v_exp_f32 v62, v62
  v_exp_f32 v63, v63
  v_cvt_pk_bf16_f32 v84, v56, v57
  v_cvt_pk_bf16_f32 v85, v58, v59
  v_cvt_pk_bf16_f32 v86, v60, v61
  v_cvt_pk_bf16_f32 v87, v62, v63
  v_mfma_f32_32x32x16_bf16 v[48:63], v[108:111], v[16:19], 0
  v_exp_f32 v64, v64
  v_exp_f32 v65, v65
  v_exp_f32 v66, v66
  v_exp_f32 v67, v67
  v_mfma_f32_32x32x16_bf16 v[48:63], v[124:127], v[32:35], v[48:63]
  v_exp_f32 v68, v68
  v_exp_f32 v69, v69
  v_exp_f32 v70, v70
  v_exp_f32 v71, v71
  v_cvt_pk_bf16_f32 v88, v64, v65
  v_cvt_pk_bf16_f32 v89, v66, v67
  v_mfma_f32_32x32x16_bf16 v[192:207], v[144:147], v[80:83], v[192:207]
  v_exp_f32 v72, v72
  v_exp_f32 v73, v73
  v_exp_f32 v74, v74
  v_exp_f32 v75, v75
  v_cvt_pk_bf16_f32 v90, v68, v69
  v_cvt_pk_bf16_f32 v91, v70, v71
  v_mfma_f32_32x32x16_bf16 v[192:207], v[148:151], v[84:87], v[192:207]
  v_exp_f32 v76, v76
  v_exp_f32 v77, v77
  v_exp_f32 v78, v78
  v_exp_f32 v79, v79
  v_cvt_pk_bf16_f32 v92, v72, v73
  v_cvt_pk_bf16_f32 v93, v74, v75
  v_cvt_pk_bf16_f32 v94, v76, v77
  v_cvt_pk_bf16_f32 v95, v78, v79
  v_mfma_f32_32x32x16_bf16 v[64:79], v[108:111], v[20:23], 0
  buffer_load_dwordx4 v[104:107], v4, s[52:55], s61 offen sc1
  v_exp_f32 v48, v48
  v_exp_f32 v49, v49
  v_exp_f32 v50, v50
  v_exp_f32 v51, v51
  v_mfma_f32_32x32x16_bf16 v[64:79], v[124:127], v[36:39], v[64:79]
  v_exp_f32 v52, v52
  v_exp_f32 v53, v53
  v_exp_f32 v54, v54
  v_exp_f32 v55, v55
  v_cvt_pk_bf16_f32 v80, v48, v49
  v_cvt_pk_bf16_f32 v81, v50, v51
  v_mfma_f32_32x32x16_bf16 v[208:223], v[144:147], v[88:91], v[208:223]
  buffer_load_dword v120, v5, s[52:55], s61 offen sc1
  v_exp_f32 v56, v56
  v_exp_f32 v57, v57
  v_exp_f32 v58, v58
  v_exp_f32 v59, v59
  v_cvt_pk_bf16_f32 v82, v52, v53
  v_cvt_pk_bf16_f32 v83, v54, v55
  v_mfma_f32_32x32x16_bf16 v[208:223], v[148:151], v[92:95], v[208:223]
  v_exp_f32 v60, v60
  v_exp_f32 v61, v61
  v_exp_f32 v62, v62
  v_exp_f32 v63, v63
  v_cvt_pk_bf16_f32 v84, v56, v57
  v_cvt_pk_bf16_f32 v85, v58, v59
  v_cvt_pk_bf16_f32 v86, v60, v61
  v_cvt_pk_bf16_f32 v87, v62, v63
  v_mfma_f32_32x32x16_bf16 v[48:63], v[108:111], v[24:27], 0
  buffer_load_dwordx4 v[144:147], v6, s[52:55], s61 offen sc1
  v_exp_f32 v64, v64
  v_exp_f32 v65, v65
  v_exp_f32 v66, v66
  v_exp_f32 v67, v67
  v_mfma_f32_32x32x16_bf16 v[48:63], v[124:127], v[40:43], v[48:63]
  v_exp_f32 v68, v68
  v_exp_f32 v69, v69
  v_exp_f32 v70, v70
  v_exp_f32 v71, v71
  v_cvt_pk_bf16_f32 v88, v64, v65
  v_cvt_pk_bf16_f32 v89, v66, v67
  v_mfma_f32_32x32x16_bf16 v[160:175], v[152:155], v[80:83], v[160:175]
  buffer_load_dwordx4 v[148:151], v6, s[52:55], s61 offen offset:640 sc1
  v_exp_f32 v72, v72
  v_exp_f32 v73, v73
  v_exp_f32 v74, v74
  v_exp_f32 v75, v75
  v_cvt_pk_bf16_f32 v90, v68, v69
  v_cvt_pk_bf16_f32 v91, v70, v71
  v_mfma_f32_32x32x16_bf16 v[160:175], v[156:159], v[84:87], v[160:175]
  v_exp_f32 v76, v76
  v_exp_f32 v77, v77
  v_exp_f32 v78, v78
  v_exp_f32 v79, v79
  v_cvt_pk_bf16_f32 v92, v72, v73
  v_cvt_pk_bf16_f32 v93, v74, v75
  v_cvt_pk_bf16_f32 v94, v76, v77
  v_cvt_pk_bf16_f32 v95, v78, v79
  v_mfma_f32_32x32x16_bf16 v[64:79], v[108:111], v[28:31], 0
  s_add_u32 s61, s61, 2432
  v_exp_f32 v48, v48
  v_exp_f32 v49, v49
  v_exp_f32 v50, v50
  v_exp_f32 v51, v51
  v_mfma_f32_32x32x16_bf16 v[64:79], v[124:127], v[44:47], v[64:79]
  v_exp_f32 v52, v52
  v_exp_f32 v53, v53
  v_exp_f32 v54, v54
  v_exp_f32 v55, v55
  v_cvt_pk_bf16_f32 v80, v48, v49
  v_cvt_pk_bf16_f32 v81, v50, v51
  v_mfma_f32_32x32x16_bf16 v[176:191], v[152:155], v[88:91], v[176:191]
  v_exp_f32 v56, v56
  v_exp_f32 v57, v57
  v_exp_f32 v58, v58
  v_exp_f32 v59, v59
  v_cvt_pk_bf16_f32 v82, v52, v53
  v_cvt_pk_bf16_f32 v83, v54, v55
  v_mfma_f32_32x32x16_bf16 v[176:191], v[156:159], v[92:95], v[176:191]
  s_waitcnt vmcnt(8)
  v_exp_f32 v60, v60
  v_exp_f32 v61, v61
  v_exp_f32 v62, v62
  v_exp_f32 v63, v63
  v_cvt_pk_bf16_f32 v84, v56, v57
  v_cvt_pk_bf16_f32 v85, v58, v59
  v_cvt_pk_bf16_f32 v86, v60, v61
  v_cvt_pk_bf16_f32 v87, v62, v63
  v_mfma_f32_32x32x16_bf16 v[48:63], v[96:99], v[16:19], 0
  s_add_u32 s63, s63, 1
  v_exp_f32 v64, v64
  v_exp_f32 v65, v65
  v_exp_f32 v66, v66
  v_exp_f32 v67, v67
  v_mfma_f32_32x32x16_bf16 v[48:63], v[112:115], v[32:35], v[48:63]
  v_exp_f32 v68, v68
  v_exp_f32 v69, v69
  v_exp_f32 v70, v70
  v_exp_f32 v71, v71
  v_cvt_pk_bf16_f32 v88, v64, v65
  v_cvt_pk_bf16_f32 v89, v66, v67
  v_mfma_f32_32x32x16_bf16 v[192:207], v[152:155], v[80:83], v[192:207]
  v_exp_f32 v72, v72
  v_exp_f32 v73, v73
  v_exp_f32 v74, v74
  v_exp_f32 v75, v75
  v_cvt_pk_bf16_f32 v90, v68, v69
  v_cvt_pk_bf16_f32 v91, v70, v71
  v_mfma_f32_32x32x16_bf16 v[192:207], v[156:159], v[84:87], v[192:207]
  s_cmp_lg_u32 s63, 16
  v_exp_f32 v76, v76
  v_exp_f32 v77, v77
  v_exp_f32 v78, v78
  v_exp_f32 v79, v79
  v_cvt_pk_bf16_f32 v92, v72, v73
  v_cvt_pk_bf16_f32 v93, v74, v75
  v_cvt_pk_bf16_f32 v94, v76, v77
  v_cvt_pk_bf16_f32 v95, v78, v79
  s_cbranch_scc1 .Latt_loop
  s_nop 1
  v_mfma_f32_32x32x16_bf16 v[208:223], v[152:155], v[88:91], v[208:223]
  v_mfma_f32_32x32x16_bf16 v[208:223], v[156:159], v[92:95], v[208:223]
  s_branch .Latt_chk
.Latt_maxnext:
  s_add_u32 s61, s61, 2432
.Latt_maxld:
  buffer_load_dwordx4 v[96:99], v4, s[52:55], s61 offen sc1
  buffer_load_dword v112, v5, s[52:55], s61 offen sc1
  s_waitcnt vmcnt(0)
  s_cmp_eq_u32 s61, s60
  s_cbranch_scc1 .Latt_maxpass
  s_branch .Latt_maxloop
.Latt_reload:
  s_add_u32 s38, s64, 0
  buffer_load_dwordx4 v[96:99], v4, s[52:55], s38 offen sc1
  buffer_load_dword v112, v5, s[52:55], s38 offen sc1
  buffer_load_dwordx4 v[128:131], v6, s[52:55], s38 offen sc1
  buffer_load_dwordx4 v[132:135], v6, s[52:55], s38 offen offset:640 sc1
  s_add_u32 s38, s64, 2432
  buffer_load_dwordx4 v[100:103], v4, s[52:55], s38 offen sc1
  buffer_load_dword v116, v5, s[52:55], s38 offen sc1
  buffer_load_dwordx4 v[136:139], v6, s[52:55], s38 offen sc1
  buffer_load_dwordx4 v[140:143], v6, s[52:55], s38 offen offset:640 sc1
  s_add_u32 s38, s64, 4864
  buffer_load_dwordx4 v[104:107], v4, s[52:55], s38 offen sc1
  buffer_load_dword v120, v5, s[52:55], s38 offen sc1
  buffer_load_dwordx4 v[144:147], v6, s[52:55], s38 offen sc1
  buffer_load_dwordx4 v[148:151], v6, s[52:55], s38 offen offset:640 sc1
  v_mov_b32 v152, 0
  v_mov_b32 v153, 0
  v_mov_b32 v154, 0
  v_mov_b32 v155, 0
  v_mov_b32 v156, 0
  v_mov_b32 v157, 0
  v_mov_b32 v158, 0
  v_mov_b32 v159, 0
  s_waitcnt vmcnt(0)
  s_branch .Latt_fold
.Latt_chk:
  s_nop 7
  s_nop 3
  v_add_f32 v11, v170, v186
  v_add_f32 v12, v202, v218
  v_add_f32 v11, v11, v12
  v_mov_b32 v12, 0x5d800000
  v_cmp_nlt_f32 vcc, v11, v12
  s_nop 3
  s_and_b32 s38, vcc_lo, vcc_lo
  s_cbranch_scc0 .Latt_ok
  s_cmp_lg_u32 s62, 1
  s_cbranch_scc1 .Latt_ok
  s_mov_b32 s62, 64
  s_mov_b32 s61, s60
  s_waitcnt vmcnt(0)
  s_branch .Latt_maxld
.Latt_ok:

  s_getpc_b64 s[32:33]
  v_lshlrev_b32 v10, 7, v0
  s_lshl_b32 s38, s28, 13
  v_add_u32 v10, s38, v10
  v_min_u32 v10, .Lk2_end-.Latt_ok-64, v10
  v_mov_b32 v11, s33
  v_add_co_u32 v10, vcc, s32, v10
  v_addc_co_u32 v11, vcc, 0, v11, vcc
  global_load_dword a255, v[10:11], off
  s_mul_i32 s38, s37, 147456
  s_lshl_b32 s39, s50, 10
  s_add_u32 s60, s38, s39
  s_add_u32 s60, s60, 8388608
  s_mul_i32 s61, s51, 36864
  s_lshl_b32 s39, s36, 9
  s_add_u32 s61, s61, s39
  s_add_u32 s61, s61, 8421376
  s_lshl_b32 s39, s28, 2
  s_add_u32 s39, s39, 110592
  v_add_u32 v7, s39, v4
  s_lshl_b32 s39, s28, 10
  s_add_u32 s39, s39, 110592
  v_add_u32 v9, s39, v4
  v_cmp_lt_u32 vcc, 31, v0
  v_mov_b32 v6, 2146435072

  v_mov_b32 v10, v170
  v_mov_b32 v11, v186
  v_mov_b32 v12, v202
  v_mov_b32 v13, v218
  v_cndmask_b32 v5, v4, v6, vcc
  v_permlane32_swap_b32 v170, v10
  v_permlane32_swap_b32 v186, v11
  v_permlane32_swap_b32 v202, v12
  v_permlane32_swap_b32 v218, v13
  s_nop 0
  v_rcp_f32 v10, v170
  v_rcp_f32 v11, v186
  v_rcp_f32 v12, v202
  v_rcp_f32 v13, v218
  v_mul_f32 v160, v160, v10
  v_mul_f32 v161, v161, v10
  v_mul_f32 v162, v162, v10
  v_mul_f32 v163, v163, v10
  v_mul_f32 v164, v164, v10
  v_mul_f32 v165, v165, v10
  v_mul_f32 v166, v166, v10
  v_mul_f32 v167, v167, v10
  v_mul_f32 v168, v168, v10
  v_mul_f32 v169, v169, v10
  v_cvt_pk_bf16_f32 v160, v160, v161
  v_cvt_pk_bf16_f32 v161, v162, v163
  v_cvt_pk_bf16_f32 v162, v164, v165
  v_cvt_pk_bf16_f32 v163, v166, v167
  v_cvt_pk_bf16_f32 v164, v168, v169
  buffer_store_dwordx4 v[160:163], v4, s[52:55], s60 offen sc1
  ds_write_b32 v7, v164 offset:0
  s_add_u32 s60, s60, 36864
  v_mul_f32 v176, v176, v11
  v_mul_f32 v177, v177, v11
  v_mul_f32 v178, v178, v11
  v_mul_f32 v179, v179, v11
  v_mul_f32 v180, v180, v11
  v_mul_f32 v181, v181, v11
  v_mul_f32 v182, v182, v11
  v_mul_f32 v183, v183, v11
  v_mul_f32 v184, v184, v11
  v_mul_f32 v185, v185, v11
  v_cvt_pk_bf16_f32 v176, v176, v177
  v_cvt_pk_bf16_f32 v177, v178, v179
  v_cvt_pk_bf16_f32 v178, v180, v181
  v_cvt_pk_bf16_f32 v179, v182, v183
  v_cvt_pk_bf16_f32 v180, v184, v185
  buffer_store_dwordx4 v[176:179], v4, s[52:55], s60 offen sc1
  ds_write_b32 v7, v180 offset:1024
  s_add_u32 s60, s60, 36864
  v_mul_f32 v192, v192, v12
  v_mul_f32 v193, v193, v12
  v_mul_f32 v194, v194, v12
  v_mul_f32 v195, v195, v12
  v_mul_f32 v196, v196, v12
  v_mul_f32 v197, v197, v12
  v_mul_f32 v198, v198, v12
  v_mul_f32 v199, v199, v12
  v_mul_f32 v200, v200, v12
  v_mul_f32 v201, v201, v12
  v_cvt_pk_bf16_f32 v192, v192, v193
  v_cvt_pk_bf16_f32 v193, v194, v195
  v_cvt_pk_bf16_f32 v194, v196, v197
  v_cvt_pk_bf16_f32 v195, v198, v199
  v_cvt_pk_bf16_f32 v196, v200, v201
  buffer_store_dwordx4 v[192:195], v4, s[52:55], s60 offen sc1
  ds_write_b32 v7, v196 offset:2048
  s_add_u32 s60, s60, 36864
  v_mul_f32 v208, v208, v13
  v_mul_f32 v209, v209, v13
  v_mul_f32 v210, v210, v13
  v_mul_f32 v211, v211, v13
  v_mul_f32 v212, v212, v13
  v_mul_f32 v213, v213, v13
  v_mul_f32 v214, v214, v13
  v_mul_f32 v215, v215, v13
  v_mul_f32 v216, v216, v13
  v_mul_f32 v217, v217, v13
  v_cvt_pk_bf16_f32 v208, v208, v209
  v_cvt_pk_bf16_f32 v209, v210, v211
  v_cvt_pk_bf16_f32 v210, v212, v213
  v_cvt_pk_bf16_f32 v211, v214, v215
  v_cvt_pk_bf16_f32 v212, v216, v217
  buffer_store_dwordx4 v[208:211], v4, s[52:55], s60 offen sc1
  ds_write_b32 v7, v212 offset:3072
  s_waitcnt lgkmcnt(0)
  s_barrier
  ds_read_b128 v[10:13], v9
  s_waitcnt lgkmcnt(0)
  buffer_store_dwordx4 v[10:13], v5, s[52:55], s61 offen sc1
  s_lshl_b32 s39, s37, 8
  s_add_u32 s39, s39, 11536384
  s_waitcnt vmcnt(5)
  v_lshlrev_b32 v80, 16, v232
  v_and_b32 v81, 0xffff0000, v232
  v_lshlrev_b32 v82, 16, v233
  v_and_b32 v83, 0xffff0000, v233
  v_lshlrev_b32 v84, 16, v234
  v_and_b32 v85, 0xffff0000, v234
  v_lshlrev_b32 v86, 16, v235
  v_and_b32 v87, 0xffff0000, v235
  v_lshlrev_b32 v88, 16, v236
  v_and_b32 v89, 0xffff0000, v236
  v_lshlrev_b32 v90, 16, v237
  v_and_b32 v91, 0xffff0000, v237
  v_lshlrev_b32 v92, 16, v238
  v_and_b32 v93, 0xffff0000, v238
  v_lshlrev_b32 v94, 16, v239
  v_and_b32 v95, 0xffff0000, v239
  v_lshlrev_b32 v96, 16, v240
  v_and_b32 v97, 0xffff0000, v240
  v_lshlrev_b32 v98, 16, v241
  v_and_b32 v99, 0xffff0000, v241
  v_lshlrev_b32 v100, 16, v242
  v_and_b32 v101, 0xffff0000, v242
  v_lshlrev_b32 v102, 16, v243
  v_and_b32 v103, 0xffff0000, v243
  v_lshlrev_b32 v104, 16, v244
  v_and_b32 v105, 0xffff0000, v244
  v_lshlrev_b32 v106, 16, v245
  v_and_b32 v107, 0xffff0000, v245
  v_lshlrev_b32 v108, 16, v246
  v_and_b32 v109, 0xffff0000, v246
  v_lshlrev_b32 v110, 16, v247
  v_and_b32 v111, 0xffff0000, v247
  v_and_b32 v7, 31, v0
  v_lshrrev_b32 v12, 5, v0
  v_mul_u32_u24 v248, 1152, v7
  v_lshl_add_u32 v248, v12, 4, v248
  v_lshlrev_b32 v12, 2, v12
  v_sub_u32 v7, v7, v12
  v_mov_b32 v10, 0x3f80
  v_mov_b32 v11, 0x3f800000
  v_cmp_eq_u32 vcc, 0, v7
  v_cmp_eq_u32 s[32:33], 1, v7
  s_nop 1
  v_cndmask_b32 v12, 0, v10, vcc
  v_cndmask_b32 v176, v12, v11, s[32:33]
  v_cmp_eq_u32 vcc, 2, v7
  v_cmp_eq_u32 s[32:33], 3, v7
  s_nop 1
  v_cndmask_b32 v12, 0, v10, vcc
  v_cndmask_b32 v177, v12, v11, s[32:33]
  v_cmp_eq_u32 vcc, 8, v7
  v_cmp_eq_u32 s[32:33], 9, v7
  s_nop 1
  v_cndmask_b32 v12, 0, v10, vcc
  v_cndmask_b32 v178, v12, v11, s[32:33]
  v_cmp_eq_u32 vcc, 10, v7
  v_cmp_eq_u32 s[32:33], 11, v7
  s_nop 1
  v_cndmask_b32 v12, 0, v10, vcc
  v_cndmask_b32 v179, v12, v11, s[32:33]
  v_cmp_eq_u32 vcc, 16, v7
  v_cmp_eq_u32 s[32:33], 17, v7
  s_nop 1
  v_cndmask_b32 v12, 0, v10, vcc
  v_cndmask_b32 v180, v12, v11, s[32:33]
  v_cmp_eq_u32 vcc, 18, v7
  v_cmp_eq_u32 s[32:33], 19, v7
  s_nop 1
  v_cndmask_b32 v12, 0, v10, vcc
  v_cndmask_b32 v181, v12, v11, s[32:33]
  v_cmp_eq_u32 vcc, 24, v7
  v_cmp_eq_u32 s[32:33], 25, v7
  s_nop 1
  v_cndmask_b32 v12, 0, v10, vcc
  v_cndmask_b32 v182, v12, v11, s[32:33]
  v_cmp_eq_u32 vcc, 26, v7
  v_cmp_eq_u32 s[32:33], 27, v7
  s_nop 1
  v_cndmask_b32 v12, 0, v10, vcc
  v_cndmask_b32 v183, v12, v11, s[32:33]
  s_and_b32 s45, s28, 1
  s_mul_i32 s38, s45, 55296
  s_add_u32 s38, s38, 0
  v_add_u32 v250, s38, v2
  s_mul_i32 s38, s45, 18432
  s_sub_u32 s38, 36864, s38
  v_add_u32 v251, s38, v2
  s_mul_i32 s38, s45, 18432
  s_add_u32 s46, s38, 73728
  v_add_u32 v252, s46, v2
  s_mul_i32 s43, s71, 36864
  s_add_u32 s43, s43, s38
  s_add_u32 s43, s43, 8388608
  s_lshl_b32 s38, s28, 13
  s_add_u32 s38, s38, 110592
  v_add_u32 v253, s38, v4
  s_lshl_b32 s38, s28, 13
  s_xor_b32 s38, s38, 8192
  s_add_u32 s38, s38, 110592
  v_add_u32 v254, s38, v4
  s_mul_i32 s47, s71, 36864
  s_lshl_b32 s38, s36, 12
  s_add_u32 s47, s47, s38
  s_lshl_b32 s38, s45, 11
  s_add_u32 s47, s47, s38
  s_add_u32 s47, s47, 12582912
  s_mov_b32 s42, s47
  s_mul_i32 s38, s45, 2146435072
  v_or_b32 v255, s38, v4
  s_mov_b32 s40, 0xbfb8aa3b
  s_lshl_b32 s44, s36, 7
  s_lshl_b32 s38, s28, 6
  s_add_u32 s44, s44, s38
  s_sub_u32 s44, s44, 64
  s_and_b32 s38, s36, 1
  s_lshl_b32 s38, s38, 6
  s_add_u32 s38, s38, 1024
  s_cmp_eq_u32 s28, 3
  s_cselect_b32 s44, s38, s44
  s_mul_i32 s45, s28, 36864
  s_sub_u32 s45, s45, 36864
  s_waitcnt vmcnt(0)
  s_barrier
  s_cmp_lg_u32 s28, 0
  s_cbranch_scc1 1f
  s_mov_b64 exec, 1
  v_mov_b32 v15, 1
  buffer_atomic_add v15, off, s[52:55], s39 sc1
  s_mov_b64 exec, -1
1:
  s_cmp_eq_u32 s28, 0
  s_cbranch_scc1 .Lfin_wo
  s_mov_b32 m0, s45
  s_mov_b32 s46, s44
  buffer_load_dwordx4 v3, s[20:23], s46 offen lds
  s_add_u32 m0, m0, 1024
  s_add_u32 s46, s46, 20736
  buffer_load_dwordx4 v3, s[20:23], s46 offen lds
  s_add_u32 m0, m0, 1024
  s_add_u32 s46, s46, 20736
  buffer_load_dwordx4 v3, s[20:23], s46 offen lds
  s_add_u32 m0, m0, 1024
  s_add_u32 s46, s46, 20736
  buffer_load_dwordx4 v3, s[20:23], s46 offen lds
  s_add_u32 m0, m0, 1024
  s_add_u32 s46, s46, 20736
  buffer_load_dwordx4 v3, s[20:23], s46 offen lds
  s_add_u32 m0, m0, 1024
  s_add_u32 s46, s46, 20736
  buffer_load_dwordx4 v3, s[20:23], s46 offen lds
  s_add_u32 m0, m0, 1024
  s_add_u32 s46, s46, 20736
  buffer_load_dwordx4 v3, s[20:23], s46 offen lds
  s_add_u32 m0, m0, 1024
  s_add_u32 s46, s46, 20736
  buffer_load_dwordx4 v3, s[20:23], s46 offen lds
  s_add_u32 m0, m0, 1024
  s_add_u32 s46, s46, 20736
  buffer_load_dwordx4 v3, s[20:23], s46 offen lds
  s_add_u32 m0, m0, 1024
  s_add_u32 s46, s46, 20736
  buffer_load_dwordx4 v3, s[20:23], s46 offen lds
  s_add_u32 m0, m0, 1024
  s_add_u32 s46, s46, 20736
  buffer_load_dwordx4 v3, s[20:23], s46 offen lds
  s_add_u32 m0, m0, 1024
  s_add_u32 s46, s46, 20736
  buffer_load_dwordx4 v3, s[20:23], s46 offen lds
  s_add_u32 m0, m0, 1024
  s_add_u32 s46, s46, 20736
  buffer_load_dwordx4 v3, s[20:23], s46 offen lds
  s_add_u32 m0, m0, 1024
  s_add_u32 s46, s46, 20736
  buffer_load_dwordx4 v3, s[20:23], s46 offen lds
  s_add_u32 m0, m0, 1024
  s_add_u32 s46, s46, 20736
  buffer_load_dwordx4 v3, s[20:23], s46 offen lds
  s_add_u32 m0, m0, 1024
  s_add_u32 s46, s46, 20736
  buffer_load_dwordx4 v3, s[20:23], s46 offen lds
  s_add_u32 m0, m0, 1024
  s_add_u32 s46, s46, 20736
  buffer_load_dwordx4 v3, s[20:23], s46 offen lds
  s_add_u32 m0, m0, 1024
  s_add_u32 s46, s46, 20736
  buffer_load_dwordx4 v3, s[20:23], s46 offen lds
  s_add_u32 m0, m0, 1024
  s_add_u32 s46, s46, 20736
  buffer_load_dwordx4 v3, s[20:23], s46 offen lds
  s_add_u32 m0, m0, 1024
  s_add_u32 s46, s46, 20736
  buffer_load_dwordx4 v3, s[20:23], s46 offen lds
  s_add_u32 m0, m0, 1024
  s_add_u32 s46, s46, 20736
  buffer_load_dwordx4 v3, s[20:23], s46 offen lds
  s_add_u32 m0, m0, 1024
  s_add_u32 s46, s46, 20736
  buffer_load_dwordx4 v3, s[20:23], s46 offen lds
  s_add_u32 m0, m0, 1024
  s_add_u32 s46, s46, 20736
  buffer_load_dwordx4 v3, s[20:23], s46 offen lds
  s_add_u32 m0, m0, 1024
  s_add_u32 s46, s46, 20736
  buffer_load_dwordx4 v3, s[20:23], s46 offen lds
  s_add_u32 m0, m0, 1024
  s_add_u32 s46, s46, 20736
  buffer_load_dwordx4 v3, s[20:23], s46 offen lds
  s_add_u32 m0, m0, 1024
  s_add_u32 s46, s46, 20736
  buffer_load_dwordx4 v3, s[20:23], s46 offen lds
  s_add_u32 m0, m0, 1024
  s_add_u32 s46, s46, 20736
  buffer_load_dwordx4 v3, s[20:23], s46 offen lds
  s_add_u32 m0, m0, 1024
  s_add_u32 s46, s46, 20736
  buffer_load_dwordx4 v3, s[20:23], s46 offen lds
  s_add_u32 m0, m0, 1024
  s_add_u32 s46, s46, 20736
  buffer_load_dwordx4 v3, s[20:23], s46 offen lds
  s_add_u32 m0, m0, 1024
  s_add_u32 s46, s46, 20736
  buffer_load_dwordx4 v3, s[20:23], s46 offen lds
  s_add_u32 m0, m0, 1024
  s_add_u32 s46, s46, 20736
  buffer_load_dwordx4 v3, s[20:23], s46 offen lds
  s_add_u32 m0, m0, 1024
  s_add_u32 s46, s46, 20736
  buffer_load_dwordx4 v3, s[20:23], s46 offen lds
  s_add_u32 m0, m0, 1024
  s_add_u32 s46, s46, 20736
  s_mov_b32 s46, s44
  buffer_load_dwordx4 v8, s[20:23], s46 offen lds
  s_add_u32 m0, m0, 1024
  s_add_u32 s46, s46, 165888
  buffer_load_dwordx4 v8, s[20:23], s46 offen lds
  s_add_u32 m0, m0, 1024
  s_add_u32 s46, s46, 165888
  buffer_load_dwordx4 v8, s[20:23], s46 offen lds
  s_add_u32 m0, m0, 1024
  s_add_u32 s46, s46, 165888
  buffer_load_dwordx4 v8, s[20:23], s46 offen lds
  s_add_u32 m0, m0, 1024
  s_add_u32 s46, s46, 165888
  s_waitcnt vmcnt(0)
.Lfin_wo:
  s_mul_i32 s44, s71, 36864
  s_and_b32 s38, s36, 1
  s_lshl_b32 s38, s38, 11
  s_add_u32 s44, s44, s38
  s_add_u32 s44, s44, 12615680
  s_cmp_lg_u32 s28, 0
  s_cbranch_scc1 2f
  s_mov_b32 s31, 0x40000
  s_add_u32 s3, s39, 4096
1:
  buffer_load_dword v15, off, s[52:55], s39 sc1
  buffer_load_dword v14, off, s[52:55], s3 sc1
  s_waitcnt vmcnt(0)
  v_min_u32 v15, v15, v14
  s_nop 0
  v_readfirstlane_b32 s38, v15
  s_cmp_ge_u32 s38, 8
  s_cbranch_scc1 2f
  s_sleep 2
  s_sub_u32 s31, s31, 1
  s_cbranch_scc0 1b
2:
  s_barrier
  buffer_load_dwordx4 a[0:3], v4, s[52:55], s43 offen offset:0 sc1
  buffer_load_dwordx4 a[4:7], v4, s[52:55], s43 offen offset:1024 sc1
  buffer_load_dwordx4 a[8:11], v4, s[52:55], s43 offen offset:2048 sc1
  buffer_load_dwordx4 a[12:15], v4, s[52:55], s43 offen offset:3072 sc1
  s_add_u32 s43, s43, 4096
  buffer_load_dwordx4 a[16:19], v4, s[52:55], s43 offen offset:0 sc1
  buffer_load_dwordx4 a[20:23], v4, s[52:55], s43 offen offset:1024 sc1
  buffer_load_dwordx4 a[24:27], v4, s[52:55], s43 offen offset:2048 sc1
  buffer_load_dwordx4 a[28:31], v4, s[52:55], s43 offen offset:3072 sc1
  s_add_u32 s43, s43, 4096
  buffer_load_dwordx4 a[32:35], v4, s[52:55], s43 offen offset:0 sc1
  buffer_load_dwordx4 a[36:39], v4, s[52:55], s43 offen offset:1024 sc1
  buffer_load_dwordx4 a[40:43], v4, s[52:55], s43 offen offset:2048 sc1
  buffer_load_dwordx4 a[44:47], v4, s[52:55], s43 offen offset:3072 sc1
  s_add_u32 s43, s43, 4096
  buffer_load_dwordx4 a[48:51], v4, s[52:55], s43 offen offset:0 sc1
  buffer_load_dwordx4 a[52:55], v4, s[52:55], s43 offen offset:1024 sc1
  buffer_load_dwordx4 a[56:59], v4, s[52:55], s43 offen offset:2048 sc1
  buffer_load_dwordx4 a[60:63], v4, s[52:55], s43 offen offset:3072 sc1
  s_add_u32 s43, s43, 4096
  buffer_load_dwordx4 a[64:67], v4, s[52:55], s43 offen offset:0 sc1
  buffer_load_dwordx4 a[68:71], v4, s[52:55], s43 offen offset:1024 sc1
  buffer_load_dwordx4 a[72:75], v255, s[52:55], s42 offen offset:0 sc1
  buffer_load_dwordx4 a[76:79], v255, s[52:55], s42 offen offset:1024 sc1
  s_add_u32 s42, s42, 2359296
  buffer_load_dwordx4 a[80:83], v255, s[52:55], s42 offen offset:0 sc1
  buffer_load_dwordx4 a[84:87], v255, s[52:55], s42 offen offset:1024 sc1
  s_add_u32 s42, s42, 2359296
  buffer_load_dwordx4 a[88:91], v255, s[52:55], s42 offen offset:0 sc1
  buffer_load_dwordx4 a[92:95], v255, s[52:55], s42 offen offset:1024 sc1
  s_add_u32 s42, s42, 2359296
  buffer_load_dwordx4 a[96:99], v255, s[52:55], s42 offen offset:0 sc1
  buffer_load_dwordx4 a[100:103], v255, s[52:55], s42 offen offset:1024 sc1
  s_add_u32 s42, s42, 2359296
  buffer_load_dwordx4 a[104:107], v255, s[52:55], s42 offen offset:0 sc1
  buffer_load_dwordx4 a[108:111], v255, s[52:55], s42 offen offset:1024 sc1
  s_add_u32 s42, s42, 2359296
  buffer_load_dwordx4 a[112:115], v255, s[52:55], s42 offen offset:0 sc1
  buffer_load_dwordx4 a[116:119], v255, s[52:55], s42 offen offset:1024 sc1
  s_add_u32 s42, s42, 2359296
  buffer_load_dwordx4 a[120:123], v255, s[52:55], s42 offen offset:0 sc1
  buffer_load_dwordx4 a[124:127], v255, s[52:55], s42 offen offset:1024 sc1
  s_add_u32 s42, s42, 2359296
  buffer_load_dwordx4 a[128:131], v255, s[52:55], s42 offen offset:0 sc1
  buffer_load_dwordx4 a[132:135], v255, s[52:55], s42 offen offset:1024 sc1
  ds_read_b64_tr_b16 v[16:17], v251 offset:0
  ds_read_b64_tr_b16 v[18:19], v251 offset:512
  ds_read_b64_tr_b16 v[20:21], v252 offset:0
  ds_read_b64_tr_b16 v[22:23], v252 offset:512
  ds_read_b64_tr_b16 v[24:25], v250 offset:0
  ds_read_b64_tr_b16 v[26:27], v250 offset:512
  ds_read_b64_tr_b16 v[28:29], v251 offset:1024
  ds_read_b64_tr_b16 v[30:31], v251 offset:1536
  ds_read_b64_tr_b16 v[232:233], v252 offset:1024
  ds_read_b64_tr_b16 v[234:235], v252 offset:1536
  ds_read_b64_tr_b16 v[236:237], v250 offset:1024
  ds_read_b64_tr_b16 v[238:239], v250 offset:1536
  s_waitcnt vmcnt(32)
  s_waitcnt lgkmcnt(10)
  v_mfma_f32_32x32x16_bf16 v[48:63], v[16:19], a[0:3], 0
  ds_read_b64_tr_b16 v[240:241], v251 offset:2048
  ds_read_b64_tr_b16 v[242:243], v251 offset:2560
  s_waitcnt lgkmcnt(10)
  v_mfma_f32_32x32x16_bf16 v[64:79], v[20:23], a[0:3], 0
  ds_read_b64_tr_b16 v[244:245], v252 offset:2048
  ds_read_b64_tr_b16 v[246:247], v252 offset:2560
  s_waitcnt lgkmcnt(10)
  v_mfma_f32_32x32x16_bf16 v[32:47], v[24:27], a[0:3], 0
  ds_read_b64_tr_b16 v[16:17], v250 offset:2048
  ds_read_b64_tr_b16 v[18:19], v250 offset:2560
  s_waitcnt lgkmcnt(10)
  v_mfma_f32_32x32x16_bf16 v[48:63], v[28:31], a[4:7], v[48:63]
  ds_read_b64_tr_b16 v[20:21], v251 offset:3072
  ds_read_b64_tr_b16 v[22:23], v251 offset:3584
  s_waitcnt lgkmcnt(10)
  v_mfma_f32_32x32x16_bf16 v[64:79], v[232:235], a[4:7], v[64:79]
  ds_read_b64_tr_b16 v[24:25], v252 offset:3072
  ds_read_b64_tr_b16 v[26:27], v252 offset:3584
  s_waitcnt lgkmcnt(10)
  v_mfma_f32_32x32x16_bf16 v[32:47], v[236:239], a[4:7], v[32:47]
  ds_read_b64_tr_b16 v[28:29], v250 offset:3072
  ds_read_b64_tr_b16 v[30:31], v250 offset:3584
  s_waitcnt vmcnt(30)
  s_waitcnt lgkmcnt(10)
  v_mfma_f32_32x32x16_bf16 v[48:63], v[240:243], a[8:11], v[48:63]
  ds_read_b64_tr_b16 v[232:233], v251 offset:4096
  ds_read_b64_tr_b16 v[234:235], v251 offset:4608
  s_waitcnt lgkmcnt(10)
  v_mfma_f32_32x32x16_bf16 v[64:79], v[244:247], a[8:11], v[64:79]
  ds_read_b64_tr_b16 v[236:237], v252 offset:4096
  ds_read_b64_tr_b16 v[238:239], v252 offset:4608
  s_waitcnt lgkmcnt(10)
  v_mfma_f32_32x32x16_bf16 v[32:47], v[16:19], a[8:11], v[32:47]
  ds_read_b64_tr_b16 v[240:241], v250 offset:4096
  ds_read_b64_tr_b16 v[242:243], v250 offset:4608
  s_waitcnt lgkmcnt(10)
  v_mfma_f32_32x32x16_bf16 v[48:63], v[20:23], a[12:15], v[48:63]
  ds_read_b64_tr_b16 v[244:245], v251 offset:5120
  ds_read_b64_tr_b16 v[246:247], v251 offset:5632
  s_waitcnt lgkmcnt(10)
  v_mfma_f32_32x32x16_bf16 v[64:79], v[24:27], a[12:15], v[64:79]
  ds_read_b64_tr_b16 v[16:17], v252 offset:5120
  ds_read_b64_tr_b16 v[18:19], v252 offset:5632
  s_waitcnt lgkmcnt(10)
  v_mfma_f32_32x32x16_bf16 v[32:47], v[28:31], a[12:15], v[32:47]
  ds_read_b64_tr_b16 v[20:21], v250 offset:5120
  ds_read_b64_tr_b16 v[22:23], v250 offset:5632
  s_waitcnt vmcnt(28)
  s_waitcnt lgkmcnt(10)
  v_mfma_f32_32x32x16_bf16 v[48:63], v[232:235], a[16:19], v[48:63]
  ds_read_b64_tr_b16 v[24:25], v251 offset:6144
  ds_read_b64_tr_b16 v[26:27], v251 offset:6656
  s_waitcnt lgkmcnt(10)
  v_mfma_f32_32x32x16_bf16 v[64:79], v[236:239], a[16:19], v[64:79]
  ds_read_b64_tr_b16 v[28:29], v252 offset:6144
  ds_read_b64_tr_b16 v[30:31], v252 offset:6656
  s_waitcnt lgkmcnt(10)
  v_mfma_f32_32x32x16_bf16 v[32:47], v[240:243], a[16:19], v[32:47]
  ds_read_b64_tr_b16 v[232:233], v250 offset:6144
  ds_read_b64_tr_b16 v[234:235], v250 offset:6656
  s_waitcnt lgkmcnt(10)
  v_mfma_f32_32x32x16_bf16 v[48:63], v[244:247], a[20:23], v[48:63]
  ds_read_b64_tr_b16 v[236:237], v251 offset:7168
  ds_read_b64_tr_b16 v[238:239], v251 offset:7680
  s_waitcnt lgkmcnt(10)
  v_mfma_f32_32x32x16_bf16 v[64:79], v[16:19], a[20:23], v[64:79]
  ds_read_b64_tr_b16 v[240:241], v252 offset:7168
  ds_read_b64_tr_b16 v[242:243], v252 offset:7680
  s_waitcnt lgkmcnt(10)
  v_mfma_f32_32x32x16_bf16 v[32:47], v[20:23], a[20:23], v[32:47]
  ds_read_b64_tr_b16 v[244:245], v250 offset:7168
  ds_read_b64_tr_b16 v[246:247], v250 offset:7680
  s_waitcnt vmcnt(26)
  s_waitcnt lgkmcnt(10)
  v_mfma_f32_32x32x16_bf16 v[48:63], v[24:27], a[24:27], v[48:63]
  ds_read_b64_tr_b16 v[16:17], v251 offset:8192
  ds_read_b64_tr_b16 v[18:19], v251 offset:8704
  s_waitcnt lgkmcnt(10)
  v_mfma_f32_32x32x16_bf16 v[64:79], v[28:31], a[24:27], v[64:79]
  ds_read_b64_tr_b16 v[20:21], v252 offset:8192
  ds_read_b64_tr_b16 v[22:23], v252 offset:8704
  s_waitcnt lgkmcnt(10)
  v_mfma_f32_32x32x16_bf16 v[32:47], v[232:235], a[24:27], v[32:47]
  ds_read_b64_tr_b16 v[24:25], v250 offset:8192
  ds_read_b64_tr_b16 v[26:27], v250 offset:8704
  s_waitcnt lgkmcnt(10)
  v_mfma_f32_32x32x16_bf16 v[48:63], v[236:239], a[28:31], v[48:63]
  ds_read_b64_tr_b16 v[28:29], v251 offset:9216
  ds_read_b64_tr_b16 v[30:31], v251 offset:9728
  s_waitcnt lgkmcnt(10)
  v_mfma_f32_32x32x16_bf16 v[64:79], v[240:243], a[28:31], v[64:79]
  ds_read_b64_tr_b16 v[232:233], v252 offset:9216
  ds_read_b64_tr_b16 v[234:235], v252 offset:9728
  s_waitcnt lgkmcnt(10)
  v_mfma_f32_32x32x16_bf16 v[32:47], v[244:247], a[28:31], v[32:47]
  ds_read_b64_tr_b16 v[236:237], v250 offset:9216
  ds_read_b64_tr_b16 v[238:239], v250 offset:9728
  s_waitcnt vmcnt(24)
  s_waitcnt lgkmcnt(10)
  v_mfma_f32_32x32x16_bf16 v[48:63], v[16:19], a[32:35], v[48:63]
  ds_read_b64_tr_b16 v[240:241], v251 offset:10240
  ds_read_b64_tr_b16 v[242:243], v251 offset:10752
  s_waitcnt lgkmcnt(10)
  v_mfma_f32_32x32x16_bf16 v[64:79], v[20:23], a[32:35], v[64:79]
  ds_read_b64_tr_b16 v[244:245], v252 offset:10240
  ds_read_b64_tr_b16 v[246:247], v252 offset:10752
  s_waitcnt lgkmcnt(10)
  v_mfma_f32_32x32x16_bf16 v[32:47], v[24:27], a[32:35], v[32:47]
  ds_read_b64_tr_b16 v[16:17], v250 offset:10240
  ds_read_b64_tr_b16 v[18:19], v250 offset:10752
  s_waitcnt lgkmcnt(10)
  v_mfma_f32_32x32x16_bf16 v[48:63], v[28:31], a[36:39], v[48:63]
  ds_read_b64_tr_b16 v[20:21], v251 offset:11264
  ds_read_b64_tr_b16 v[22:23], v251 offset:11776
  s_waitcnt lgkmcnt(10)
  v_mfma_f32_32x32x16_bf16 v[64:79], v[232:235], a[36:39], v[64:79]
  ds_read_b64_tr_b16 v[24:25], v252 offset:11264
  ds_read_b64_tr_b16 v[26:27], v252 offset:11776
  s_waitcnt lgkmcnt(10)
  v_mfma_f32_32x32x16_bf16 v[32:47], v[236:239], a[36:39], v[32:47]
  ds_read_b64_tr_b16 v[28:29], v250 offset:11264
  ds_read_b64_tr_b16 v[30:31], v250 offset:11776
  s_waitcnt vmcnt(22)
  s_waitcnt lgkmcnt(10)
  v_mfma_f32_32x32x16_bf16 v[48:63], v[240:243], a[40:43], v[48:63]
  ds_read_b64_tr_b16 v[232:233], v251 offset:12288
  ds_read_b64_tr_b16 v[234:235], v251 offset:12800
  s_waitcnt lgkmcnt(10)
  v_mfma_f32_32x32x16_bf16 v[64:79], v[244:247], a[40:43], v[64:79]
  ds_read_b64_tr_b16 v[236:237], v252 offset:12288
  ds_read_b64_tr_b16 v[238:239], v252 offset:12800
  s_waitcnt lgkmcnt(10)
  v_mfma_f32_32x32x16_bf16 v[32:47], v[16:19], a[40:43], v[32:47]
  ds_read_b64_tr_b16 v[240:241], v250 offset:12288
  ds_read_b64_tr_b16 v[242:243], v250 offset:12800
  s_waitcnt lgkmcnt(10)
  v_mfma_f32_32x32x16_bf16 v[48:63], v[20:23], a[44:47], v[48:63]
  ds_read_b64_tr_b16 v[244:245], v251 offset:13312
  ds_read_b64_tr_b16 v[246:247], v251 offset:13824
  s_waitcnt lgkmcnt(10)
  v_mfma_f32_32x32x16_bf16 v[64:79], v[24:27], a[44:47], v[64:79]
  ds_read_b64_tr_b16 v[16:17], v252 offset:13312
  ds_read_b64_tr_b16 v[18:19], v252 offset:13824
  s_waitcnt lgkmcnt(10)
  v_mfma_f32_32x32x16_bf16 v[32:47], v[28:31], a[44:47], v[32:47]
  ds_read_b64_tr_b16 v[20:21], v250 offset:13312
  ds_read_b64_tr_b16 v[22:23], v250 offset:13824
  s_waitcnt vmcnt(20)
  s_waitcnt lgkmcnt(10)
  v_mfma_f32_32x32x16_bf16 v[48:63], v[232:235], a[48:51], v[48:63]
  ds_read_b64_tr_b16 v[24:25], v251 offset:14336
  ds_read_b64_tr_b16 v[26:27], v251 offset:14848
  s_waitcnt lgkmcnt(10)
  v_mfma_f32_32x32x16_bf16 v[64:79], v[236:239], a[48:51], v[64:79]
  ds_read_b64_tr_b16 v[28:29], v252 offset:14336
  ds_read_b64_tr_b16 v[30:31], v252 offset:14848
  s_waitcnt lgkmcnt(10)
  v_mfma_f32_32x32x16_bf16 v[32:47], v[240:243], a[48:51], v[32:47]
  ds_read_b64_tr_b16 v[232:233], v250 offset:14336
  ds_read_b64_tr_b16 v[234:235], v250 offset:14848
  s_waitcnt lgkmcnt(10)
  v_mfma_f32_32x32x16_bf16 v[48:63], v[244:247], a[52:55], v[48:63]
  ds_read_b64_tr_b16 v[236:237], v251 offset:15360
  ds_read_b64_tr_b16 v[238:239], v251 offset:15872
  s_waitcnt lgkmcnt(10)
  v_mfma_f32_32x32x16_bf16 v[64:79], v[16:19], a[52:55], v[64:79]
  ds_read_b64_tr_b16 v[240:241], v252 offset:15360
  ds_read_b64_tr_b16 v[242:243], v252 offset:15872
  s_waitcnt lgkmcnt(10)
  v_mfma_f32_32x32x16_bf16 v[32:47], v[20:23], a[52:55], v[32:47]
  ds_read_b64_tr_b16 v[244:245], v250 offset:15360
  ds_read_b64_tr_b16 v[246:247], v250 offset:15872
  s_waitcnt vmcnt(18)
  s_waitcnt lgkmcnt(10)
  v_mfma_f32_32x32x16_bf16 v[48:63], v[24:27], a[56:59], v[48:63]
  ds_read_b64_tr_b16 v[16:17], v251 offset:16384
  ds_read_b64_tr_b16 v[18:19], v251 offset:16896
  s_waitcnt lgkmcnt(10)
  v_mfma_f32_32x32x16_bf16 v[64:79], v[28:31], a[56:59], v[64:79]
  ds_read_b64_tr_b16 v[20:21], v252 offset:16384
  ds_read_b64_tr_b16 v[22:23], v252 offset:16896
  s_waitcnt lgkmcnt(10)
  v_mfma_f32_32x32x16_bf16 v[32:47], v[232:235], a[56:59], v[32:47]
  ds_read_b64_tr_b16 v[24:25], v250 offset:16384
  ds_read_b64_tr_b16 v[26:27], v250 offset:16896
  s_waitcnt lgkmcnt(10)
  v_mfma_f32_32x32x16_bf16 v[48:63], v[236:239], a[60:63], v[48:63]
  ds_read_b64_tr_b16 v[28:29], v251 offset:17408
  ds_read_b64_tr_b16 v[30:31], v251 offset:17920
  s_waitcnt lgkmcnt(10)
  v_mfma_f32_32x32x16_bf16 v[64:79], v[240:243], a[60:63], v[64:79]
  ds_read_b64_tr_b16 v[232:233], v252 offset:17408
  ds_read_b64_tr_b16 v[234:235], v252 offset:17920
  s_waitcnt lgkmcnt(10)
  v_mfma_f32_32x32x16_bf16 v[32:47], v[244:247], a[60:63], v[32:47]
  ds_read_b64_tr_b16 v[236:237], v250 offset:17408
  ds_read_b64_tr_b16 v[238:239], v250 offset:17920
  s_waitcnt vmcnt(16)
  s_waitcnt lgkmcnt(10)
  v_mfma_f32_32x32x16_bf16 v[48:63], v[16:19], a[64:67], v[48:63]
  s_waitcnt lgkmcnt(8)
  v_mfma_f32_32x32x16_bf16 v[64:79], v[20:23], a[64:67], v[64:79]
  s_waitcnt lgkmcnt(6)
  v_mfma_f32_32x32x16_bf16 v[32:47], v[24:27], a[64:67], v[32:47]
  s_waitcnt lgkmcnt(4)
  v_mfma_f32_32x32x16_bf16 v[48:63], v[28:31], a[68:71], v[48:63]
  s_waitcnt lgkmcnt(2)
  v_mfma_f32_32x32x16_bf16 v[64:79], v[232:235], a[68:71], v[64:79]
  s_waitcnt lgkmcnt(0)
  v_mfma_f32_32x32x16_bf16 v[32:47], v[236:239], a[68:71], v[32:47]
  s_add_u32 s39, s39, 4224
  s_nop 7
  s_nop 1
  ds_write_b128 v253, v[48:51] offset:0
  ds_write_b128 v253, v[52:55] offset:1024
  ds_write_b128 v253, v[56:59] offset:2048
  ds_write_b128 v253, v[60:63] offset:3072
  ds_write_b128 v253, v[64:67] offset:4096
  ds_write_b128 v253, v[68:71] offset:5120
  ds_write_b128 v253, v[72:75] offset:6144
  ds_write_b128 v253, v[76:79] offset:7168
  s_cmp_lg_u32 s28, 0
  s_cbranch_scc1 2f
  s_mov_b32 s31, 0x40000
1:
  buffer_load_dword v15, off, s[52:55], s39 sc1
  s_waitcnt vmcnt(0)
  v_readfirstlane_b32 s38, v15
  s_cmp_ge_u32 s38, 8
  s_cbranch_scc1 2f
  s_sleep 2
  s_sub_u32 s31, s31, 1
  s_cbranch_scc0 1b
2:
  s_waitcnt lgkmcnt(0)
  s_barrier
  s_bitcmp1_b32 s28, 0
  s_cbranch_scc0 .Latt_even
  buffer_load_dwordx4 a[72:75], v4, s[52:55], s47 offen offset:0 sc1
  buffer_load_dwordx4 a[76:79], v4, s[52:55], s47 offen offset:1024 sc1
  s_add_u32 s47, s47, 2359296
  buffer_load_dwordx4 a[80:83], v4, s[52:55], s47 offen offset:0 sc1
  buffer_load_dwordx4 a[84:87], v4, s[52:55], s47 offen offset:1024 sc1
  s_add_u32 s47, s47, 2359296
  buffer_load_dwordx4 a[88:91], v4, s[52:55], s47 offen offset:0 sc1
  buffer_load_dwordx4 a[92:95], v4, s[52:55], s47 offen offset:1024 sc1
  s_add_u32 s47, s47, 2359296
  buffer_load_dwordx4 a[96:99], v4, s[52:55], s47 offen offset:0 sc1
  buffer_load_dwordx4 a[100:103], v4, s[52:55], s47 offen offset:1024 sc1
  s_add_u32 s47, s47, 2359296
  buffer_load_dwordx4 a[104:107], v4, s[52:55], s47 offen offset:0 sc1
  buffer_load_dwordx4 a[108:111], v4, s[52:55], s47 offen offset:1024 sc1
  s_add_u32 s47, s47, 2359296
  buffer_load_dwordx4 a[112:115], v4, s[52:55], s47 offen offset:0 sc1
  buffer_load_dwordx4 a[116:119], v4, s[52:55], s47 offen offset:1024 sc1
  s_add_u32 s47, s47, 2359296
  buffer_load_dwordx4 a[120:123], v4, s[52:55], s47 offen offset:0 sc1
  buffer_load_dwordx4 a[124:127], v4, s[52:55], s47 offen offset:1024 sc1
  s_add_u32 s47, s47, 2359296
  buffer_load_dwordx4 a[128:131], v4, s[52:55], s47 offen offset:0 sc1
  buffer_load_dwordx4 a[132:135], v4, s[52:55], s47 offen offset:1024 sc1
  ds_read_b128 v[160:163], v254 offset:0
  ds_read_b128 v[164:167], v254 offset:1024
  ds_read_b128 v[168:171], v254 offset:2048
  ds_read_b128 v[172:175], v254 offset:3072
  s_waitcnt vmcnt(12)
  v_mfma_f32_32x32x16_bf16 v[128:143], v[176:179], a[72:75], 0
  v_mfma_f32_32x32x16_bf16 v[128:143], v[180:183], a[76:79], v[128:143]
  v_mfma_f32_32x32x16_bf16 v[128:143], v[176:179], a[80:83], v[128:143]
  v_mfma_f32_32x32x16_bf16 v[128:143], v[180:183], a[84:87], v[128:143]
  s_waitcnt vmcnt(8)
  v_mfma_f32_32x32x16_bf16 v[128:143], v[176:179], a[88:91], v[128:143]
  v_mfma_f32_32x32x16_bf16 v[128:143], v[180:183], a[92:95], v[128:143]
  v_mfma_f32_32x32x16_bf16 v[128:143], v[176:179], a[96:99], v[128:143]
  v_mfma_f32_32x32x16_bf16 v[128:143], v[180:183], a[100:103], v[128:143]
  s_waitcnt vmcnt(4)
  v_mfma_f32_32x32x16_bf16 v[128:143], v[176:179], a[104:107], v[128:143]
  v_mfma_f32_32x32x16_bf16 v[128:143], v[180:183], a[108:111], v[128:143]
  v_mfma_f32_32x32x16_bf16 v[128:143], v[176:179], a[112:115], v[128:143]
  v_mfma_f32_32x32x16_bf16 v[128:143], v[180:183], a[116:119], v[128:143]
  s_waitcnt vmcnt(0)
  v_mfma_f32_32x32x16_bf16 v[128:143], v[176:179], a[120:123], v[128:143]
  v_mfma_f32_32x32x16_bf16 v[128:143], v[180:183], a[124:127], v[128:143]
  v_mfma_f32_32x32x16_bf16 v[128:143], v[176:179], a[128:131], v[128:143]
  v_mfma_f32_32x32x16_bf16 v[128:143], v[180:183], a[132:135], v[128:143]
  s_waitcnt lgkmcnt(0)
  v_pk_add_f32 v[32:33], v[32:33], v[160:161]
  v_pk_add_f32 v[34:35], v[34:35], v[162:163]
  v_pk_add_f32 v[36:37], v[36:37], v[164:165]
  v_pk_add_f32 v[38:39], v[38:39], v[166:167]
  v_pk_add_f32 v[40:41], v[40:41], v[168:169]
  v_pk_add_f32 v[42:43], v[42:43], v[170:171]
  v_pk_add_f32 v[44:45], v[44:45], v[172:173]
  v_pk_add_f32 v[46:47], v[46:47], v[174:175]
  s_nop 3
  v_pk_mul_f32 v[184:185], v[128:129], s[40:41] op_sel_hi:[1,0]
  v_pk_mul_f32 v[186:187], v[130:131], s[40:41] op_sel_hi:[1,0]
  v_pk_mul_f32 v[188:189], v[132:133], s[40:41] op_sel_hi:[1,0]
  v_pk_mul_f32 v[190:191], v[134:135], s[40:41] op_sel_hi:[1,0]
  v_pk_mul_f32 v[192:193], v[136:137], s[40:41] op_sel_hi:[1,0]
  v_pk_mul_f32 v[194:195], v[138:139], s[40:41] op_sel_hi:[1,0]
  v_pk_mul_f32 v[196:197], v[140:141], s[40:41] op_sel_hi:[1,0]
  v_pk_mul_f32 v[198:199], v[142:143], s[40:41] op_sel_hi:[1,0]
  v_exp_f32 v184, v184
  v_exp_f32 v185, v185
  v_exp_f32 v186, v186
  v_exp_f32 v187, v187
  v_exp_f32 v188, v188
  v_exp_f32 v189, v189
  v_exp_f32 v190, v190
  v_exp_f32 v191, v191
  v_exp_f32 v192, v192
  v_exp_f32 v193, v193
  v_exp_f32 v194, v194
  v_exp_f32 v195, v195
  v_exp_f32 v196, v196
  v_exp_f32 v197, v197
  v_exp_f32 v198, v198
  v_exp_f32 v199, v199
  v_pk_mul_f32 v[128:129], v[128:129], v[32:33]
  v_pk_mul_f32 v[130:131], v[130:131], v[34:35]
  v_pk_mul_f32 v[132:133], v[132:133], v[36:37]
  v_pk_mul_f32 v[134:135], v[134:135], v[38:39]
  v_pk_mul_f32 v[136:137], v[136:137], v[40:41]
  v_pk_mul_f32 v[138:139], v[138:139], v[42:43]
  v_pk_mul_f32 v[140:141], v[140:141], v[44:45]
  v_pk_mul_f32 v[142:143], v[142:143], v[46:47]
  v_pk_add_f32 v[184:185], v[184:185], 1.0 op_sel_hi:[1,0]
  v_pk_add_f32 v[186:187], v[186:187], 1.0 op_sel_hi:[1,0]
  v_pk_add_f32 v[188:189], v[188:189], 1.0 op_sel_hi:[1,0]
  v_pk_add_f32 v[190:191], v[190:191], 1.0 op_sel_hi:[1,0]
  v_pk_add_f32 v[192:193], v[192:193], 1.0 op_sel_hi:[1,0]
  v_pk_add_f32 v[194:195], v[194:195], 1.0 op_sel_hi:[1,0]
  v_pk_add_f32 v[196:197], v[196:197], 1.0 op_sel_hi:[1,0]
  v_pk_add_f32 v[198:199], v[198:199], 1.0 op_sel_hi:[1,0]
  v_rcp_f32 v184, v184
  v_rcp_f32 v185, v185
  v_rcp_f32 v186, v186
  v_rcp_f32 v187, v187
  v_rcp_f32 v188, v188
  v_rcp_f32 v189, v189
  v_rcp_f32 v190, v190
  v_rcp_f32 v191, v191
  v_rcp_f32 v192, v192
  v_rcp_f32 v193, v193
  v_rcp_f32 v194, v194
  v_rcp_f32 v195, v195
  v_rcp_f32 v196, v196
  v_rcp_f32 v197, v197
  v_rcp_f32 v198, v198
  v_rcp_f32 v199, v199
  s_nop 0
  v_pk_fma_f32 v[128:129], v[128:129], v[184:185], v[80:81]
  v_pk_fma_f32 v[130:131], v[130:131], v[186:187], v[82:83]
  v_pk_fma_f32 v[132:133], v[132:133], v[188:189], v[84:85]
  v_pk_fma_f32 v[134:135], v[134:135], v[190:191], v[86:87]
  v_pk_fma_f32 v[136:137], v[136:137], v[192:193], v[88:89]
  v_pk_fma_f32 v[138:139], v[138:139], v[194:195], v[90:91]
  v_pk_fma_f32 v[140:141], v[140:141], v[196:197], v[92:93]
  v_pk_fma_f32 v[142:143], v[142:143], v[198:199], v[94:95]
  v_cvt_pk_bf16_f32 v216, v128, v129
  v_cvt_pk_bf16_f32 v217, v130, v131
  v_cvt_pk_bf16_f32 v218, v132, v133
  v_cvt_pk_bf16_f32 v219, v134, v135
  v_cvt_pk_bf16_f32 v220, v136, v137
  v_cvt_pk_bf16_f32 v221, v138, v139
  v_cvt_pk_bf16_f32 v222, v140, v141
  v_cvt_pk_bf16_f32 v223, v142, v143
  s_nop 1
  v_permlane32_swap_b32 v216, v218
  v_permlane32_swap_b32 v217, v219
  v_permlane32_swap_b32 v220, v222
  v_permlane32_swap_b32 v221, v223
  buffer_store_dwordx4 v[216:219], v248, s[24:27], s66 offen nt
  buffer_store_dwordx4 v[220:223], v248, s[24:27], s66 offen offset:32 nt
  s_branch .Latt_done
.Latt_even:
  s_cmp_lg_u32 s68, 0
  s_cbranch_scc1 .Latt_plain
  buffer_load_dwordx4 a[136:139], v4, s[52:55], s44 offen offset:0 sc1
  buffer_load_dwordx4 a[140:143], v4, s[52:55], s44 offen offset:1024 sc1
  s_add_u32 s44, s44, 2359296
  buffer_load_dwordx4 a[144:147], v4, s[52:55], s44 offen offset:0 sc1
  buffer_load_dwordx4 a[148:151], v4, s[52:55], s44 offen offset:1024 sc1
  s_add_u32 s44, s44, 2359296
  buffer_load_dwordx4 a[152:155], v4, s[52:55], s44 offen offset:0 sc1
  buffer_load_dwordx4 a[156:159], v4, s[52:55], s44 offen offset:1024 sc1
  s_add_u32 s44, s44, 2359296
  buffer_load_dwordx4 a[160:163], v4, s[52:55], s44 offen offset:0 sc1
  buffer_load_dwordx4 a[164:167], v4, s[52:55], s44 offen offset:1024 sc1
  s_add_u32 s44, s44, 2359296
  buffer_load_dwordx4 a[168:171], v4, s[52:55], s44 offen offset:0 sc1
  buffer_load_dwordx4 a[172:175], v4, s[52:55], s44 offen offset:1024 sc1
  s_add_u32 s44, s44, 2359296
  buffer_load_dwordx4 a[176:179], v4, s[52:55], s44 offen offset:0 sc1
  buffer_load_dwordx4 a[180:183], v4, s[52:55], s44 offen offset:1024 sc1
  s_add_u32 s44, s44, 2359296
  buffer_load_dwordx4 a[184:187], v4, s[52:55], s44 offen offset:0 sc1
  buffer_load_dwordx4 a[188:191], v4, s[52:55], s44 offen offset:1024 sc1
  s_add_u32 s44, s44, 2359296
  buffer_load_dwordx4 a[192:195], v4, s[52:55], s44 offen offset:0 sc1
  buffer_load_dwordx4 a[196:199], v4, s[52:55], s44 offen offset:1024 sc1
  ds_read_b128 v[160:163], v254 offset:0
  ds_read_b128 v[164:167], v254 offset:1024
  ds_read_b128 v[168:171], v254 offset:2048
  ds_read_b128 v[172:175], v254 offset:3072
  s_waitcnt vmcnt(16)
  v_mfma_f32_32x32x16_bf16 v[128:143], v[176:179], a[72:75], 0
  v_mfma_f32_32x32x16_bf16 v[128:143], v[180:183], a[76:79], v[128:143]
  v_mfma_f32_32x32x16_bf16 v[128:143], v[176:179], a[80:83], v[128:143]
  v_mfma_f32_32x32x16_bf16 v[128:143], v[180:183], a[84:87], v[128:143]
  v_mfma_f32_32x32x16_bf16 v[128:143], v[176:179], a[88:91], v[128:143]
  v_mfma_f32_32x32x16_bf16 v[128:143], v[180:183], a[92:95], v[128:143]
  v_mfma_f32_32x32x16_bf16 v[128:143], v[176:179], a[96:99], v[128:143]
  v_mfma_f32_32x32x16_bf16 v[128:143], v[180:183], a[100:103], v[128:143]
  v_mfma_f32_32x32x16_bf16 v[128:143], v[176:179], a[104:107], v[128:143]
  v_mfma_f32_32x32x16_bf16 v[128:143], v[180:183], a[108:111], v[128:143]
  v_mfma_f32_32x32x16_bf16 v[128:143], v[176:179], a[112:115], v[128:143]
  v_mfma_f32_32x32x16_bf16 v[128:143], v[180:183], a[116:119], v[128:143]
  v_mfma_f32_32x32x16_bf16 v[128:143], v[176:179], a[120:123], v[128:143]
  v_mfma_f32_32x32x16_bf16 v[128:143], v[180:183], a[124:127], v[128:143]
  v_mfma_f32_32x32x16_bf16 v[128:143], v[176:179], a[128:131], v[128:143]
  v_mfma_f32_32x32x16_bf16 v[128:143], v[180:183], a[132:135], v[128:143]
  s_waitcnt lgkmcnt(0)
  v_pk_add_f32 v[32:33], v[32:33], v[160:161]
  v_pk_add_f32 v[34:35], v[34:35], v[162:163]
  v_pk_add_f32 v[36:37], v[36:37], v[164:165]
  v_pk_add_f32 v[38:39], v[38:39], v[166:167]
  v_pk_add_f32 v[40:41], v[40:41], v[168:169]
  v_pk_add_f32 v[42:43], v[42:43], v[170:171]
  v_pk_add_f32 v[44:45], v[44:45], v[172:173]
  v_pk_add_f32 v[46:47], v[46:47], v[174:175]
  s_nop 3
  ds_read_b128 v[160:163], v254 offset:4096
  ds_read_b128 v[164:167], v254 offset:5120
  ds_read_b128 v[168:171], v254 offset:6144
  ds_read_b128 v[172:175], v254 offset:7168
  v_pk_mul_f32 v[184:185], v[128:129], s[40:41] op_sel_hi:[1,0]
  v_pk_mul_f32 v[186:187], v[130:131], s[40:41] op_sel_hi:[1,0]
  v_pk_mul_f32 v[188:189], v[132:133], s[40:41] op_sel_hi:[1,0]
  v_pk_mul_f32 v[190:191], v[134:135], s[40:41] op_sel_hi:[1,0]
  v_pk_mul_f32 v[192:193], v[136:137], s[40:41] op_sel_hi:[1,0]
  v_pk_mul_f32 v[194:195], v[138:139], s[40:41] op_sel_hi:[1,0]
  v_pk_mul_f32 v[196:197], v[140:141], s[40:41] op_sel_hi:[1,0]
  v_pk_mul_f32 v[198:199], v[142:143], s[40:41] op_sel_hi:[1,0]
  v_exp_f32 v184, v184
  v_exp_f32 v185, v185
  v_exp_f32 v186, v186
  v_exp_f32 v187, v187
  v_exp_f32 v188, v188
  v_exp_f32 v189, v189
  v_exp_f32 v190, v190
  v_exp_f32 v191, v191
  v_exp_f32 v192, v192
  v_exp_f32 v193, v193
  v_exp_f32 v194, v194
  v_exp_f32 v195, v195
  v_exp_f32 v196, v196
  v_exp_f32 v197, v197
  v_exp_f32 v198, v198
  v_exp_f32 v199, v199
  v_pk_mul_f32 v[128:129], v[128:129], v[32:33]
  v_pk_mul_f32 v[130:131], v[130:131], v[34:35]
  v_pk_mul_f32 v[132:133], v[132:133], v[36:37]
  v_pk_mul_f32 v[134:135], v[134:135], v[38:39]
  v_pk_mul_f32 v[136:137], v[136:137], v[40:41]
  v_pk_mul_f32 v[138:139], v[138:139], v[42:43]
  v_pk_mul_f32 v[140:141], v[140:141], v[44:45]
  v_pk_mul_f32 v[142:143], v[142:143], v[46:47]
  v_pk_add_f32 v[184:185], v[184:185], 1.0 op_sel_hi:[1,0]
  v_pk_add_f32 v[186:187], v[186:187], 1.0 op_sel_hi:[1,0]
  v_pk_add_f32 v[188:189], v[188:189], 1.0 op_sel_hi:[1,0]
  v_pk_add_f32 v[190:191], v[190:191], 1.0 op_sel_hi:[1,0]
  v_pk_add_f32 v[192:193], v[192:193], 1.0 op_sel_hi:[1,0]
  v_pk_add_f32 v[194:195], v[194:195], 1.0 op_sel_hi:[1,0]
  v_pk_add_f32 v[196:197], v[196:197], 1.0 op_sel_hi:[1,0]
  v_pk_add_f32 v[198:199], v[198:199], 1.0 op_sel_hi:[1,0]
  v_rcp_f32 v184, v184
  v_rcp_f32 v185, v185
  v_rcp_f32 v186, v186
  v_rcp_f32 v187, v187
  v_rcp_f32 v188, v188
  v_rcp_f32 v189, v189
  v_rcp_f32 v190, v190
  v_rcp_f32 v191, v191
  v_rcp_f32 v192, v192
  v_rcp_f32 v193, v193
  v_rcp_f32 v194, v194
  v_rcp_f32 v195, v195
  v_rcp_f32 v196, v196
  v_rcp_f32 v197, v197
  v_rcp_f32 v198, v198
  v_rcp_f32 v199, v199
  s_nop 0
  v_pk_fma_f32 v[128:129], v[128:129], v[184:185], v[80:81]
  v_pk_fma_f32 v[130:131], v[130:131], v[186:187], v[82:83]
  v_pk_fma_f32 v[132:133], v[132:133], v[188:189], v[84:85]
  v_pk_fma_f32 v[134:135], v[134:135], v[190:191], v[86:87]
  v_pk_fma_f32 v[136:137], v[136:137], v[192:193], v[88:89]
  v_pk_fma_f32 v[138:139], v[138:139], v[194:195], v[90:91]
  v_pk_fma_f32 v[140:141], v[140:141], v[196:197], v[92:93]
  v_pk_fma_f32 v[142:143], v[142:143], v[198:199], v[94:95]
  v_cvt_pk_bf16_f32 v216, v128, v129
  v_cvt_pk_bf16_f32 v217, v130, v131
  v_cvt_pk_bf16_f32 v218, v132, v133
  v_cvt_pk_bf16_f32 v219, v134, v135
  v_cvt_pk_bf16_f32 v220, v136, v137
  v_cvt_pk_bf16_f32 v221, v138, v139
  v_cvt_pk_bf16_f32 v222, v140, v141
  v_cvt_pk_bf16_f32 v223, v142, v143
  s_nop 1
  v_permlane32_swap_b32 v216, v218
  v_permlane32_swap_b32 v217, v219
  v_permlane32_swap_b32 v220, v222
  v_permlane32_swap_b32 v221, v223
  buffer_store_dwordx4 v[216:219], v248, s[24:27], s66 offen nt
  buffer_store_dwordx4 v[220:223], v248, s[24:27], s66 offen offset:32 nt
  s_waitcnt vmcnt(14)
  v_mfma_f32_32x32x16_bf16 v[144:159], v[176:179], a[136:139], 0
  v_mfma_f32_32x32x16_bf16 v[144:159], v[180:183], a[140:143], v[144:159]
  v_mfma_f32_32x32x16_bf16 v[144:159], v[176:179], a[144:147], v[144:159]
  v_mfma_f32_32x32x16_bf16 v[144:159], v[180:183], a[148:151], v[144:159]
  s_waitcnt vmcnt(10)
  v_mfma_f32_32x32x16_bf16 v[144:159], v[176:179], a[152:155], v[144:159]
  v_mfma_f32_32x32x16_bf16 v[144:159], v[180:183], a[156:159], v[144:159]
  v_mfma_f32_32x32x16_bf16 v[144:159], v[176:179], a[160:163], v[144:159]
  v_mfma_f32_32x32x16_bf16 v[144:159], v[180:183], a[164:167], v[144:159]
  s_waitcnt vmcnt(6)
  v_mfma_f32_32x32x16_bf16 v[144:159], v[176:179], a[168:171], v[144:159]
  v_mfma_f32_32x32x16_bf16 v[144:159], v[180:183], a[172:175], v[144:159]
  v_mfma_f32_32x32x16_bf16 v[144:159], v[176:179], a[176:179], v[144:159]
  v_mfma_f32_32x32x16_bf16 v[144:159], v[180:183], a[180:183], v[144:159]
  s_waitcnt vmcnt(2)
  v_mfma_f32_32x32x16_bf16 v[144:159], v[176:179], a[184:187], v[144:159]
  v_mfma_f32_32x32x16_bf16 v[144:159], v[180:183], a[188:191], v[144:159]
  v_mfma_f32_32x32x16_bf16 v[144:159], v[176:179], a[192:195], v[144:159]
  v_mfma_f32_32x32x16_bf16 v[144:159], v[180:183], a[196:199], v[144:159]
  s_waitcnt lgkmcnt(0)
  v_pk_add_f32 v[64:65], v[64:65], v[160:161]
  v_pk_add_f32 v[66:67], v[66:67], v[162:163]
  v_pk_add_f32 v[68:69], v[68:69], v[164:165]
  v_pk_add_f32 v[70:71], v[70:71], v[166:167]
  v_pk_add_f32 v[72:73], v[72:73], v[168:169]
  v_pk_add_f32 v[74:75], v[74:75], v[170:171]
  v_pk_add_f32 v[76:77], v[76:77], v[172:173]
  v_pk_add_f32 v[78:79], v[78:79], v[174:175]
  s_nop 3
  v_pk_mul_f32 v[184:185], v[144:145], s[40:41] op_sel_hi:[1,0]
  v_pk_mul_f32 v[186:187], v[146:147], s[40:41] op_sel_hi:[1,0]
  v_pk_mul_f32 v[188:189], v[148:149], s[40:41] op_sel_hi:[1,0]
  v_pk_mul_f32 v[190:191], v[150:151], s[40:41] op_sel_hi:[1,0]
  v_pk_mul_f32 v[192:193], v[152:153], s[40:41] op_sel_hi:[1,0]
  v_pk_mul_f32 v[194:195], v[154:155], s[40:41] op_sel_hi:[1,0]
  v_pk_mul_f32 v[196:197], v[156:157], s[40:41] op_sel_hi:[1,0]
  v_pk_mul_f32 v[198:199], v[158:159], s[40:41] op_sel_hi:[1,0]
  v_exp_f32 v184, v184
  v_exp_f32 v185, v185
  v_exp_f32 v186, v186
  v_exp_f32 v187, v187
  v_exp_f32 v188, v188
  v_exp_f32 v189, v189
  v_exp_f32 v190, v190
  v_exp_f32 v191, v191
  v_exp_f32 v192, v192
  v_exp_f32 v193, v193
  v_exp_f32 v194, v194
  v_exp_f32 v195, v195
  v_exp_f32 v196, v196
  v_exp_f32 v197, v197
  v_exp_f32 v198, v198
  v_exp_f32 v199, v199
  v_pk_mul_f32 v[144:145], v[144:145], v[64:65]
  v_pk_mul_f32 v[146:147], v[146:147], v[66:67]
  v_pk_mul_f32 v[148:149], v[148:149], v[68:69]
  v_pk_mul_f32 v[150:151], v[150:151], v[70:71]
  v_pk_mul_f32 v[152:153], v[152:153], v[72:73]
  v_pk_mul_f32 v[154:155], v[154:155], v[74:75]
  v_pk_mul_f32 v[156:157], v[156:157], v[76:77]
  v_pk_mul_f32 v[158:159], v[158:159], v[78:79]
  v_pk_add_f32 v[184:185], v[184:185], 1.0 op_sel_hi:[1,0]
  v_pk_add_f32 v[186:187], v[186:187], 1.0 op_sel_hi:[1,0]
  v_pk_add_f32 v[188:189], v[188:189], 1.0 op_sel_hi:[1,0]
  v_pk_add_f32 v[190:191], v[190:191], 1.0 op_sel_hi:[1,0]
  v_pk_add_f32 v[192:193], v[192:193], 1.0 op_sel_hi:[1,0]
  v_pk_add_f32 v[194:195], v[194:195], 1.0 op_sel_hi:[1,0]
  v_pk_add_f32 v[196:197], v[196:197], 1.0 op_sel_hi:[1,0]
  v_pk_add_f32 v[198:199], v[198:199], 1.0 op_sel_hi:[1,0]
  v_rcp_f32 v184, v184
  v_rcp_f32 v185, v185
  v_rcp_f32 v186, v186
  v_rcp_f32 v187, v187
  v_rcp_f32 v188, v188
  v_rcp_f32 v189, v189
  v_rcp_f32 v190, v190
  v_rcp_f32 v191, v191
  v_rcp_f32 v192, v192
  v_rcp_f32 v193, v193
  v_rcp_f32 v194, v194
  v_rcp_f32 v195, v195
  v_rcp_f32 v196, v196
  v_rcp_f32 v197, v197
  v_rcp_f32 v198, v198
  v_rcp_f32 v199, v199
  s_nop 0
  v_pk_fma_f32 v[144:145], v[144:145], v[184:185], v[96:97]
  v_pk_fma_f32 v[146:147], v[146:147], v[186:187], v[98:99]
  v_pk_fma_f32 v[148:149], v[148:149], v[188:189], v[100:101]
  v_pk_fma_f32 v[150:151], v[150:151], v[190:191], v[102:103]
  v_pk_fma_f32 v[152:153], v[152:153], v[192:193], v[104:105]
  v_pk_fma_f32 v[154:155], v[154:155], v[194:195], v[106:107]
  v_pk_fma_f32 v[156:157], v[156:157], v[196:197], v[108:109]
  v_pk_fma_f32 v[158:159], v[158:159], v[198:199], v[110:111]
  v_cvt_pk_bf16_f32 v224, v144, v145
  v_cvt_pk_bf16_f32 v225, v146, v147
  v_cvt_pk_bf16_f32 v226, v148, v149
  v_cvt_pk_bf16_f32 v227, v150, v151
  v_cvt_pk_bf16_f32 v228, v152, v153
  v_cvt_pk_bf16_f32 v229, v154, v155
  v_cvt_pk_bf16_f32 v230, v156, v157
  v_cvt_pk_bf16_f32 v231, v158, v159
  s_nop 1
  v_permlane32_swap_b32 v224, v226
  v_permlane32_swap_b32 v225, v227
  v_permlane32_swap_b32 v228, v230
  v_permlane32_swap_b32 v229, v231
  buffer_store_dwordx4 v[224:227], v248, s[24:27], s67 offen nt
  buffer_store_dwordx4 v[228:231], v248, s[24:27], s67 offen offset:32 nt
  s_branch .Latt_done
.Latt_plain:
  ds_read_b128 v[160:163], v254 offset:0
  ds_read_b128 v[164:167], v254 offset:1024
  ds_read_b128 v[168:171], v254 offset:2048
  ds_read_b128 v[172:175], v254 offset:3072
  s_waitcnt vmcnt(0)
  v_mfma_f32_32x32x16_bf16 v[128:143], v[176:179], a[72:75], 0
  v_mfma_f32_32x32x16_bf16 v[128:143], v[180:183], a[76:79], v[128:143]
  v_mfma_f32_32x32x16_bf16 v[128:143], v[176:179], a[80:83], v[128:143]
  v_mfma_f32_32x32x16_bf16 v[128:143], v[180:183], a[84:87], v[128:143]
  v_mfma_f32_32x32x16_bf16 v[128:143], v[176:179], a[88:91], v[128:143]
  v_mfma_f32_32x32x16_bf16 v[128:143], v[180:183], a[92:95], v[128:143]
  v_mfma_f32_32x32x16_bf16 v[128:143], v[176:179], a[96:99], v[128:143]
  v_mfma_f32_32x32x16_bf16 v[128:143], v[180:183], a[100:103], v[128:143]
  v_mfma_f32_32x32x16_bf16 v[128:143], v[176:179], a[104:107], v[128:143]
  v_mfma_f32_32x32x16_bf16 v[128:143], v[180:183], a[108:111], v[128:143]
  v_mfma_f32_32x32x16_bf16 v[128:143], v[176:179], a[112:115], v[128:143]
  v_mfma_f32_32x32x16_bf16 v[128:143], v[180:183], a[116:119], v[128:143]
  v_mfma_f32_32x32x16_bf16 v[128:143], v[176:179], a[120:123], v[128:143]
  v_mfma_f32_32x32x16_bf16 v[128:143], v[180:183], a[124:127], v[128:143]
  v_mfma_f32_32x32x16_bf16 v[128:143], v[176:179], a[128:131], v[128:143]
  v_mfma_f32_32x32x16_bf16 v[128:143], v[180:183], a[132:135], v[128:143]
  s_waitcnt lgkmcnt(0)
  v_pk_add_f32 v[32:33], v[32:33], v[160:161]
  v_pk_add_f32 v[34:35], v[34:35], v[162:163]
  v_pk_add_f32 v[36:37], v[36:37], v[164:165]
  v_pk_add_f32 v[38:39], v[38:39], v[166:167]
  v_pk_add_f32 v[40:41], v[40:41], v[168:169]
  v_pk_add_f32 v[42:43], v[42:43], v[170:171]
  v_pk_add_f32 v[44:45], v[44:45], v[172:173]
  v_pk_add_f32 v[46:47], v[46:47], v[174:175]
  s_nop 3
  v_pk_mul_f32 v[184:185], v[128:129], s[40:41] op_sel_hi:[1,0]
  v_pk_mul_f32 v[186:187], v[130:131], s[40:41] op_sel_hi:[1,0]
  v_pk_mul_f32 v[188:189], v[132:133], s[40:41] op_sel_hi:[1,0]
  v_pk_mul_f32 v[190:191], v[134:135], s[40:41] op_sel_hi:[1,0]
  v_pk_mul_f32 v[192:193], v[136:137], s[40:41] op_sel_hi:[1,0]
  v_pk_mul_f32 v[194:195], v[138:139], s[40:41] op_sel_hi:[1,0]
  v_pk_mul_f32 v[196:197], v[140:141], s[40:41] op_sel_hi:[1,0]
  v_pk_mul_f32 v[198:199], v[142:143], s[40:41] op_sel_hi:[1,0]
  v_exp_f32 v184, v184
  v_exp_f32 v185, v185
  v_exp_f32 v186, v186
  v_exp_f32 v187, v187
  v_exp_f32 v188, v188
  v_exp_f32 v189, v189
  v_exp_f32 v190, v190
  v_exp_f32 v191, v191
  v_exp_f32 v192, v192
  v_exp_f32 v193, v193
  v_exp_f32 v194, v194
  v_exp_f32 v195, v195
  v_exp_f32 v196, v196
  v_exp_f32 v197, v197
  v_exp_f32 v198, v198
  v_exp_f32 v199, v199
  v_pk_mul_f32 v[128:129], v[128:129], v[32:33]
  v_pk_mul_f32 v[130:131], v[130:131], v[34:35]
  v_pk_mul_f32 v[132:133], v[132:133], v[36:37]
  v_pk_mul_f32 v[134:135], v[134:135], v[38:39]
  v_pk_mul_f32 v[136:137], v[136:137], v[40:41]
  v_pk_mul_f32 v[138:139], v[138:139], v[42:43]
  v_pk_mul_f32 v[140:141], v[140:141], v[44:45]
  v_pk_mul_f32 v[142:143], v[142:143], v[46:47]
  v_pk_add_f32 v[184:185], v[184:185], 1.0 op_sel_hi:[1,0]
  v_pk_add_f32 v[186:187], v[186:187], 1.0 op_sel_hi:[1,0]
  v_pk_add_f32 v[188:189], v[188:189], 1.0 op_sel_hi:[1,0]
  v_pk_add_f32 v[190:191], v[190:191], 1.0 op_sel_hi:[1,0]
  v_pk_add_f32 v[192:193], v[192:193], 1.0 op_sel_hi:[1,0]
  v_pk_add_f32 v[194:195], v[194:195], 1.0 op_sel_hi:[1,0]
  v_pk_add_f32 v[196:197], v[196:197], 1.0 op_sel_hi:[1,0]
  v_pk_add_f32 v[198:199], v[198:199], 1.0 op_sel_hi:[1,0]
  v_rcp_f32 v184, v184
  v_rcp_f32 v185, v185
  v_rcp_f32 v186, v186
  v_rcp_f32 v187, v187
  v_rcp_f32 v188, v188
  v_rcp_f32 v189, v189
  v_rcp_f32 v190, v190
  v_rcp_f32 v191, v191
  v_rcp_f32 v192, v192
  v_rcp_f32 v193, v193
  v_rcp_f32 v194, v194
  v_rcp_f32 v195, v195
  v_rcp_f32 v196, v196
  v_rcp_f32 v197, v197
  v_rcp_f32 v198, v198
  v_rcp_f32 v199, v199
  s_nop 0
  v_pk_fma_f32 v[128:129], v[128:129], v[184:185], v[80:81]
  v_pk_fma_f32 v[130:131], v[130:131], v[186:187], v[82:83]
  v_pk_fma_f32 v[132:133], v[132:133], v[188:189], v[84:85]
  v_pk_fma_f32 v[134:135], v[134:135], v[190:191], v[86:87]
  v_pk_fma_f32 v[136:137], v[136:137], v[192:193], v[88:89]
  v_pk_fma_f32 v[138:139], v[138:139], v[194:195], v[90:91]
  v_pk_fma_f32 v[140:141], v[140:141], v[196:197], v[92:93]
  v_pk_fma_f32 v[142:143], v[142:143], v[198:199], v[94:95]
  v_cvt_pk_bf16_f32 v216, v128, v129
  v_cvt_pk_bf16_f32 v217, v130, v131
  v_cvt_pk_bf16_f32 v218, v132, v133
  v_cvt_pk_bf16_f32 v219, v134, v135
  v_cvt_pk_bf16_f32 v220, v136, v137
  v_cvt_pk_bf16_f32 v221, v138, v139
  v_cvt_pk_bf16_f32 v222, v140, v141
  v_cvt_pk_bf16_f32 v223, v142, v143
  s_nop 1
  v_permlane32_swap_b32 v216, v218
  v_permlane32_swap_b32 v217, v219
  v_permlane32_swap_b32 v220, v222
  v_permlane32_swap_b32 v221, v223
  buffer_store_dwordx4 v[216:219], v248, s[24:27], s66 offen nt
  buffer_store_dwordx4 v[220:223], v248, s[24:27], s66 offen offset:32 nt
.Latt_done:
.Lk2_end:

  s_endpgm
.section .rodata,"a"
.p2align 6
.amdhsa_kernel recurrent_scan__mha_block__geglu_ffn__prompt_kernel
  .amdhsa_next_free_vgpr 512
  .amdhsa_next_free_sgpr 102
  .amdhsa_accum_offset 256
  .amdhsa_group_segment_fixed_size 0
  .amdhsa_kernarg_size 80
  .amdhsa_user_sgpr_count 2
  .amdhsa_user_sgpr_kernarg_segment_ptr 1
  .amdhsa_system_sgpr_workgroup_id_x 1
.end_amdhsa_kernel
.text
```
